```python
import torch

def _softmax(x, axis=-1):
    return torch.softmax(x, dim=axis)
def _gelu(x):
    return torch.nn.functional.gelu(x, approximate="tanh")
def _silu(x):
    return torch.nn.functional.silu(x)
def _sigmoid(x):
    return torch.sigmoid(x)
def _layernorm(x, axis=-1, eps=1e-5):
    m = x.mean(dim=axis, keepdim=True)
    v = x.var(dim=axis, keepdim=True, unbiased=False)
    return (x - m) / torch.sqrt(v + eps)
def _scatter_add(tgt, idx, src, axis=0):
    return tgt.clone().index_add_(axis, idx, src)
def _segment_sum(src, seg, n):
    out = torch.zeros((n,) + src.shape[1:], dtype=src.dtype)
    return out.index_add_(0, seg, src)
def _pad(x, pw):
    flat = tuple(v for pair in reversed(pw) for v in pair)
    return torch.nn.functional.pad(x, flat)

kernel_name = 'gated_mix__linear_attn_block__dense_activation_mish__prompt'

def setup_inputs():

    _w = (lambda a: (lambda t: t.to(torch.bfloat16) if t.is_floating_point() else t)(torch.as_tensor(a)))
    def _A_setup():
        B, S, D = 1, 2048, 576
        return {
            "x": _w((lambda *s: torch.randn(*s, dtype=torch.bfloat16) * 0.05)(B, S, D)),
            "wqkv": _w((lambda *s: torch.randn(*s, dtype=torch.bfloat16) * 0.8)(D, 3 * D)),
            "wo": _w((lambda *s: torch.randn(*s, dtype=torch.bfloat16) * 0.05)(D, D)),
        }
    _A_in = _A_setup()

    def _B_setup():
        B, S, D, F = 1, 2048, 576, 4608
        return {
            "x": _w((lambda *s: torch.randn(*s, dtype=torch.bfloat16) * 0.05)(B, S, D)),
            "w1": _w((lambda *s: torch.randn(*s, dtype=torch.bfloat16) * 12.8)(D, F) * (D ** -0.5)),
            "b1": _w((lambda *s: torch.randn(*s, dtype=torch.bfloat16) * 0.2)(F)),
            "w2": _w((lambda *s: torch.randn(*s, dtype=torch.bfloat16) * 0.05)(F, D) * (F ** -0.5)),
        }
    _B_in = _B_setup()

    return {
        "A_x": _A_in["x"],
        "A_wqkv": _A_in["wqkv"],
        "A_wo": _A_in["wo"],
        "B_x": _B_in["x"],
        "B_w1": _B_in["w1"],
        "B_b1": _B_in["b1"],
        "B_w2": _B_in["w2"],
        "gate_w": _w((lambda *s: torch.randn(*s, dtype=torch.bfloat16) * 0.05)(576) * 16.0),
    }

def reference(A_x, A_wqkv, A_wo, B_x, B_w1, B_b1, B_w2, gate_w):
    def _A_ref(x, wqkv, wo):
        B, S, D = x.shape
        H = 32; Dh = D // H
        qkv = (lambda x, *d: x.permute(*d))((x @ wqkv).reshape(B, S, 3, H, Dh), 2, 0, 3, 1, 4)
        q, k, v = qkv[0], qkv[1], qkv[2]
        phi = lambda t: torch.where(t > 0, t + 1, torch.exp(t)) + 1e-6
        pq, pk = phi(q), phi(k)
        kv = torch.einsum("bhsd,bhse->bhde", pk, v)
        z = torch.einsum("bhsd->bhd", pk)
        num = torch.einsum("bhqd,bhde->bhqe", pq, kv)
        den = torch.einsum("bhqd,bhd->bhq", pq, z)[..., None] + 1e-6
        o = num / den
        return (lambda x, *d: x.permute(*d))(o, 0, 2, 1, 3).reshape(B, S, D) @ wo

    def _B_ref(x, w1, b1, w2):
        h = torch.einsum("bsd,df->bsf", x, w1) + b1
        sp = torch.log1p(torch.exp(-torch.abs(h))) + torch.where(h > 0, h, torch.zeros_like(h))
        act = h * torch.tanh(sp)
        return torch.einsum("bsf,fd->bsd", act, w2)

    x = A_x
    g = _sigmoid((x * gate_w).sum(-1, keepdims=True))
    a = _A_ref(x, A_wqkv, A_wo)
    b = _B_ref(x, B_w1, B_b1, B_w2)
    return g * a + (1 - g) * b
```

```asm
; @launch grid=(256,1,1) block=(256,1,1) lds=163840
.amdgcn_target "amdgcn-amd-amdhsa--gfx950"
.text
.globl gated_mix__linear_attn_block__dense_activation_mish__prompt_kernel
.p2align 8
.type gated_mix__linear_attn_block__dense_activation_mish__prompt_kernel,@function
gated_mix__linear_attn_block__dense_activation_mish__prompt_kernel:
    s_cmp_ge_u32 s2, 256
    s_cbranch_scc1 L_end
    s_load_dwordx16 s[8:23], s[0:1], 0x0
    s_load_dwordx4 s[24:27], s[0:1], 0x40
    s_load_dwordx2 s[28:29], s[0:1], 0x50
    s_getpc_b64 s[4:5]
L_pc:
    s_lshr_b32 s62, s2, 3
    s_mul_i32 s62, s62, 0xb00
    v_min_u32 v2, 21, v0
    v_lshl_add_u32 v2, v2, 7, s62
    v_min_u32 v2, L_last-L_pc-4, v2
    global_load_dword v253, v2, s[4:5]
    s_and_b32 s62, s2, 7
    s_lshr_b32 s63, s2, 3
    s_lshr_b32 s57, s62, 1
    s_and_b32 s62, s62, 1
    s_lshl_b32 s62, s62, 3
    s_and_b32 s56, s63, 7
    s_add_u32 s56, s56, s62
    s_lshr_b32 s58, s63, 3
    v_lshrrev_b32 v1, 6, v0
    v_and_b32 v0, 63, v0
    v_readfirstlane_b32 s59, v1
    s_mov_b32 s67, 0x3fb8aa3b
    s_and_b32 s63, s63, 7
    s_lshr_b32 s62, s62, 3
    s_add_u32 s62, s62, s63
    s_add_u32 s62, s62, s57
    s_mul_i32 s62, s62, 1
    s_mul_i32 s63, s62, 43
    s_lshr_b32 s63, s63, 7
    s_mul_i32 s63, s63, 3
    s_sub_u32 s62, s62, s63
    s_mul_i32 s93, s62, 0x180
    s_add_u32 s94, s93, 0x180
    s_cmp_eq_u32 s62, 2
    s_cselect_b32 s94, 0, s94
    s_add_u32 s95, s94, 0x180
    s_cmp_eq_u32 s62, 1
    s_cselect_b32 s95, 0, s95
    s_cmp_eq_u32 s58, 3
    s_cbranch_scc1 L_attn
L_ffn:
    v_lshrrev_b32 v96, 3, v0
    s_lshl_b32 s62, s56, 7
    s_lshl_b32 s63, s59, 5
    s_add_u32 s62, s62, s63
    v_add_u32 v96, s62, v96
    v_mul_u32_u24 v96, 0x480, v96
    v_lshrrev_b32 v97, 4, v0
    v_and_b32 v248, 7, v0
    v_xor_b32 v97, v97, v248
    v_lshl_add_u32 v248, v97, 4, v96
    v_xor_b32 v97, 4, v97
    v_lshl_add_u32 v249, v97, 4, v96
    v_add_u32 v249, 0x2400, v249
    s_lshl_b32 s64, s59, 12
    s_mul_i32 s62, s57, 3
    s_add_u32 s63, s62, s58
    s_lshl_b32 s87, s59, 11
    s_mul_i32 s96, s93, 0x1200
    s_mul_i32 s97, s94, 0x1200
    s_mul_i32 s98, s95, 0x1200
    v_bfe_u32 v96, v0, 3, 2
    v_lshrrev_b32 v97, 5, v0
    v_lshl_add_u32 v96, v97, 3, v96
    s_and_b32 s65, s59, 1
    s_lshl_b32 s65, s65, 2
    s_lshl_b32 s76, s59, 3
    s_and_b32 s76, s76, 16
    s_add_u32 s65, s65, s76
    v_add_u32 v96, s65, v96
    v_mul_u32_u24 v96, 0x2400, v96
    v_lshrrev_b32 v97, 4, v0
    v_lshlrev_b32 v97, 1, v97
    v_and_b32 v98, 7, v0
    v_xor_b32 v97, v97, v98
    v_lshl_add_u32 v96, v97, 4, v96
    s_mul_i32 s65, s63, 0x300
    v_add_u32 v5, s65, v96
    v_add_u32 v6, 0x47c00, v5
    s_lshl_b32 s76, s59, 8
    v_lshl_add_u32 v101, v0, 2, s76
    s_lshl_b32 s74, s56, 7
    s_add_u32 s74, s74, 0x301c000
    s_waitcnt lgkmcnt(0)
    s_mov_b32 s32, s8
    s_mov_b32 s33, s9
    s_mov_b32 s34, 0x240000
    s_mov_b32 s35, 0x20000
    s_mov_b32 s36, s16
    s_mov_b32 s37, s17
    s_mov_b32 s38, 0x510000
    s_mov_b32 s39, 0x20000
    s_add_u32 m0, s64, 0x18000
    s_add_u32 s66, s93, 0
    buffer_load_dwordx4 v248, s[32:35], s66 offen lds
    s_add_u32 m0, s64, 0x18400
    s_add_u32 s66, s93, 0
    buffer_load_dwordx4 v249, s[32:35], s66 offen lds
    s_add_u32 m0, s64, 0x18800
    s_add_u32 s66, s93, 0x4800
    buffer_load_dwordx4 v248, s[32:35], s66 offen lds
    s_add_u32 m0, s64, 0x18c00
    s_add_u32 s66, s93, 0x4800
    buffer_load_dwordx4 v249, s[32:35], s66 offen lds
    s_add_u32 m0, s87, 0x1c000
    s_add_u32 s66, s96, 0
    buffer_load_dwordx4 v5, s[36:39], s66 offen lds
    buffer_load_dwordx4 v6, s[36:39], s66 offen offset:1024 lds
    s_add_u32 m0, s87, 0x1e000
    s_add_u32 s66, s96, 0x80
    buffer_load_dwordx4 v5, s[36:39], s66 offen lds
    buffer_load_dwordx4 v6, s[36:39], s66 offen offset:1024 lds
    s_mov_b32 s44, s18
    s_mov_b32 s45, s19
    s_mov_b32 s46, 0x2400
    s_mov_b32 s47, 0x20000
    buffer_load_dword v102, v101, s[44:47], s65 offen
    s_load_dword s61, s[28:29], s74
    s_add_u32 m0, s64, 0
    s_add_u32 s66, s93, 0x80
    buffer_load_dwordx4 v248, s[32:35], s66 offen lds
    s_add_u32 m0, s64, 0x400
    s_add_u32 s66, s93, 0x80
    buffer_load_dwordx4 v249, s[32:35], s66 offen lds
    s_add_u32 m0, s64, 0x800
    s_add_u32 s66, s93, 0x4880
    buffer_load_dwordx4 v248, s[32:35], s66 offen lds
    s_add_u32 m0, s64, 0xc00
    s_add_u32 s66, s93, 0x4880
    buffer_load_dwordx4 v249, s[32:35], s66 offen lds
    s_add_u32 m0, s87, 0x4000
    s_add_u32 s66, s96, 0x90000
    buffer_load_dwordx4 v5, s[36:39], s66 offen lds
    buffer_load_dwordx4 v6, s[36:39], s66 offen offset:1024 lds
    s_add_u32 m0, s87, 0x6000
    s_add_u32 s66, s96, 0x90080
    buffer_load_dwordx4 v5, s[36:39], s66 offen lds
    buffer_load_dwordx4 v6, s[36:39], s66 offen offset:1024 lds
    s_and_b32 s62, s59, 1
    v_bfe_u32 v96, v0, 2, 3
    v_lshlrev_b32 v251, 7, v96
    v_lshrrev_b32 v96, 1, v96
    v_lshl_add_u32 v251, v96, 5, v251
    v_and_b32 v96, 3, v0
    v_lshl_add_u32 v251, v96, 3, v251
    v_lshrrev_b32 v96, 5, v0
    v_lshl_add_u32 v97, v96, 12, v251
    s_lshl_b32 s63, s62, 6
    v_xor_b32 v2, s63, v97
    v_xor_b32 v4, 32, v2
    v_add_u32 v3, 0x12000, v2
    v_add_u32 v252, 0x12000, v4
    v_and_b32 v96, 48, v0
    s_lshl_b32 s63, s62, 7
    s_add_u32 s63, s63, 0x24000
    v_add_u32 v11, s63, v96
    v_and_b32 v96, 15, v0
    v_lshlrev_b32 v96, 7, v96
    v_bfe_u32 v97, v0, 1, 3
    v_lshrrev_b32 v103, 4, v0
    v_xor_b32 v97, v97, v103
    v_lshl_add_u32 v96, v97, 4, v96
    s_add_u32 s63, s64, 0x10000
    v_add_u32 v240, s63, v96
    v_xor_b32 v241, 64, v240
    v_xor_b32 v242, 0x1000, v240
    v_xor_b32 v243, 0x1000, v241
    s_lshl_b32 s63, s59, 9
    s_add_u32 s63, s63, 0x24000
    v_lshl_add_u32 v103, v0, 3, s63
    s_waitcnt vmcnt(8)
    v_lshlrev_b32 v98, 16, v102
    v_and_b32 v99, 0xffff0000, v102
    ds_write_b64 v103, v[98:99]
    s_waitcnt lgkmcnt(0)
    s_barrier
    ds_read_b128 a[0:3], v240 offset:32768
    ds_read_b128 a[16:19], v241 offset:32768
    ds_read_b128 a[4:7], v240 offset:34816
    ds_read_b128 a[20:23], v241 offset:34816
    ds_read_b128 a[8:11], v242 offset:32768
    ds_read_b128 a[24:27], v243 offset:32768
    ds_read_b128 a[12:15], v242 offset:34816
    ds_read_b128 a[28:31], v243 offset:34816
    ds_read_b128 v[232:235], v11
    ds_read_b128 v[236:239], v11 offset:64
    ds_read_b64_tr_b16 v[208:209], v3 offset:40960
    ds_read_b64_tr_b16 v[210:211], v3 offset:43008
    ds_read_b64_tr_b16 v[212:213], v3 offset:41984
    ds_read_b64_tr_b16 v[214:215], v3 offset:44032
    ds_read_b64_tr_b16 v[216:217], v252 offset:40960
    ds_read_b64_tr_b16 v[218:219], v252 offset:43008
    ds_read_b64_tr_b16 v[220:221], v252 offset:41984
    ds_read_b64_tr_b16 v[222:223], v252 offset:44032
    ds_read_b128 v[80:83], v11 offset:256
    ds_read_b128 v[84:87], v11 offset:320
    s_waitcnt lgkmcnt(8)
    v_mfma_f32_16x16x32_bf16 v[16:19], v[208:211], a[0:3], v[232:235]
    s_add_u32 m0, s64, 0x8000
    ds_read_b64_tr_b16 v[224:225], v3 offset:49152
    ds_read_b64_tr_b16 v[226:227], v3 offset:51200
    s_waitcnt lgkmcnt(8)
    v_mfma_f32_16x16x32_bf16 v[16:19], v[212:215], a[16:19], v[16:19]
    s_add_u32 s66, s93, 0x100
    buffer_load_dwordx4 v248, s[32:35], s66 offen lds
    v_mfma_f32_16x16x32_bf16 v[24:27], v[212:215], a[20:23], v[232:235]
    s_add_u32 m0, s64, 0x8400
    ds_read_b64_tr_b16 v[228:229], v3 offset:50176
    ds_read_b64_tr_b16 v[230:231], v3 offset:52224
    v_mfma_f32_16x16x32_bf16 v[24:27], v[208:211], a[4:7], v[24:27]
    s_add_u32 s66, s93, 0x100
    buffer_load_dwordx4 v249, s[32:35], s66 offen lds
    v_mfma_f32_16x16x32_bf16 v[32:35], v[208:211], a[8:11], v[232:235]
    s_add_u32 m0, s64, 0x8800
    s_add_u32 s66, s93, 0x4900
    buffer_load_dwordx4 v248, s[32:35], s66 offen lds
    v_mfma_f32_16x16x32_bf16 v[32:35], v[212:215], a[24:27], v[32:35]
    s_add_u32 m0, s64, 0x8c00
    v_mfma_f32_16x16x32_bf16 v[40:43], v[212:215], a[28:31], v[232:235]
    s_add_u32 s66, s93, 0x4900
    buffer_load_dwordx4 v249, s[32:35], s66 offen lds
    v_mfma_f32_16x16x32_bf16 v[40:43], v[208:211], a[12:15], v[40:43]
    s_waitcnt lgkmcnt(6)
    s_add_u32 m0, s87, 0xc000
    s_add_u32 s66, s96, 0x120000
    buffer_load_dwordx4 v5, s[36:39], s66 offen lds
    v_mfma_f32_16x16x32_bf16 v[44:47], v[216:219], a[12:15], v[236:239]
    ds_read_b64_tr_b16 v[208:209], v252 offset:49152
    ds_read_b64_tr_b16 v[210:211], v252 offset:51200
    v_mfma_f32_16x16x32_bf16 v[44:47], v[220:223], a[28:31], v[44:47]
    buffer_load_dwordx4 v6, s[36:39], s66 offen offset:1024 lds
    v_mfma_f32_16x16x32_bf16 v[36:39], v[220:223], a[24:27], v[236:239]
    ds_read_b64_tr_b16 v[212:213], v252 offset:50176
    ds_read_b64_tr_b16 v[214:215], v252 offset:52224
    v_mfma_f32_16x16x32_bf16 v[36:39], v[216:219], a[8:11], v[36:39]
    s_add_u32 m0, s87, 0xe000
    v_mfma_f32_16x16x32_bf16 v[28:31], v[216:219], a[4:7], v[236:239]
    s_add_u32 s66, s96, 0x120080
    buffer_load_dwordx4 v5, s[36:39], s66 offen lds
    v_mfma_f32_16x16x32_bf16 v[28:31], v[220:223], a[20:23], v[28:31]
    buffer_load_dwordx4 v6, s[36:39], s66 offen offset:1024 lds
    v_xor_b32 v240, 0x10000, v240
    v_xor_b32 v241, 0x10000, v241
    v_xor_b32 v242, 0x10000, v242
    v_xor_b32 v243, 0x10000, v243
    v_mfma_f32_16x16x32_bf16 v[20:23], v[220:223], a[16:19], v[236:239]
    v_mfma_f32_16x16x32_bf16 v[20:23], v[216:219], a[0:3], v[20:23]
    s_mov_b64 exec, 0
    s_cmp_eq_u32 s59, 0
    s_cbranch_scc1 L_pad_f0
    s_cmp_eq_u32 s59, 1
    s_cbranch_scc1 L_pad_f1
    s_cmp_eq_u32 s59, 2
    s_cbranch_scc1 L_pad_f2
    s_branch L_pad_f3
L_end:
    s_endpgm
.p2align 12
L_padret_f:
    s_mov_b64 exec, -1
    s_waitcnt vmcnt(8) lgkmcnt(4)
    s_barrier
    v_mfma_f32_16x16x32_bf16 v[48:51], v[224:227], a[0:3], v[80:83]
    ds_read_b64_tr_b16 v[216:217], v2 offset:16384
    ds_read_b64_tr_b16 v[218:219], v2 offset:18432
    v_mfma_f32_16x16x32_bf16 v[48:51], v[228:231], a[16:19], v[48:51]
    ds_read_b128 a[32:35], v240
    ds_read_b128 a[48:51], v241
    v_mfma_f32_16x16x32_bf16 v[56:59], v[228:231], a[20:23], v[80:83]
    ds_read_b64_tr_b16 v[220:221], v2 offset:17408
    ds_read_b64_tr_b16 v[222:223], v2 offset:19456
    v_mfma_f32_16x16x32_bf16 v[56:59], v[224:227], a[4:7], v[56:59]
    s_add_u32 m0, s64, 0x10000
    ds_read_b128 a[36:39], v240 offset:2048
    ds_read_b128 a[52:55], v241 offset:2048
    v_mfma_f32_16x16x32_bf16 v[64:67], v[224:227], a[8:11], v[80:83]
    s_add_u32 s66, s94, 0
    buffer_load_dwordx4 v248, s[32:35], s66 offen lds
    v_mfma_f32_16x16x32_bf16 v[64:67], v[228:231], a[24:27], v[64:67]
    ds_read_b128 a[40:43], v242
    ds_read_b128 a[56:59], v243
    v_mfma_f32_16x16x32_bf16 v[72:75], v[228:231], a[28:31], v[80:83]
    s_and_b32 s88, s56, 7
    s_lshl_b32 s62, s59, 3
    v_mfma_f32_16x16x32_bf16 v[72:75], v[224:227], a[12:15], v[72:75]
    s_waitcnt lgkmcnt(10)
    ds_read_b128 a[44:47], v242 offset:2048
    ds_read_b128 a[60:63], v243 offset:2048
    v_mfma_f32_16x16x32_bf16 v[76:79], v[208:211], a[12:15], v[84:87]
    s_add_u32 m0, s64, 0x10400
    ds_read_b64_tr_b16 v[224:225], v4 offset:16384
    ds_read_b64_tr_b16 v[226:227], v4 offset:18432
    v_mfma_f32_16x16x32_bf16 v[76:79], v[212:215], a[28:31], v[76:79]
    s_add_u32 s66, s94, 0
    buffer_load_dwordx4 v249, s[32:35], s66 offen lds
    v_mfma_f32_16x16x32_bf16 v[68:71], v[212:215], a[24:27], v[84:87]
    ds_read_b64_tr_b16 v[228:229], v4 offset:17408
    ds_read_b64_tr_b16 v[230:231], v4 offset:19456
    v_mfma_f32_16x16x32_bf16 v[68:71], v[208:211], a[8:11], v[68:71]
    s_add_u32 m0, s64, 0x10800
    s_add_u32 s88, s88, s62
    s_mul_i32 s62, s88, 57
    v_mfma_f32_16x16x32_bf16 v[60:63], v[208:211], a[4:7], v[84:87]
    s_add_u32 s66, s94, 0x4800
    buffer_load_dwordx4 v248, s[32:35], s66 offen lds
    v_mfma_f32_16x16x32_bf16 v[60:63], v[212:215], a[20:23], v[60:63]
    s_add_u32 m0, s64, 0x10c00
    s_lshr_b32 s62, s62, 9
    s_mul_i32 s78, s62, 9
    v_mfma_f32_16x16x32_bf16 v[52:55], v[212:215], a[16:19], v[84:87]
    s_add_u32 s66, s94, 0x4800
    buffer_load_dwordx4 v249, s[32:35], s66 offen lds
    v_mfma_f32_16x16x32_bf16 v[52:55], v[208:211], a[0:3], v[52:55]
    s_waitcnt lgkmcnt(4)
    s_sub_u32 s76, s88, s78
    s_mul_i32 s76, s76, 0x90000
    v_mfma_f32_16x16x32_bf16 v[16:19], v[216:219], a[32:35], v[16:19]
    s_add_u32 m0, s87, 0x14000
    ds_read_b64_tr_b16 v[208:209], v2 offset:24576
    ds_read_b64_tr_b16 v[210:211], v2 offset:26624
    v_mfma_f32_16x16x32_bf16 v[16:19], v[220:223], a[48:51], v[16:19]
    s_add_u32 s66, s97, 0
    buffer_load_dwordx4 v5, s[36:39], s66 offen lds
    v_mfma_f32_16x16x32_bf16 v[24:27], v[220:223], a[52:55], v[24:27]
    ds_read_b64_tr_b16 v[212:213], v2 offset:25600
    ds_read_b64_tr_b16 v[214:215], v2 offset:27648
    v_mfma_f32_16x16x32_bf16 v[24:27], v[216:219], a[36:39], v[24:27]
    s_lshl_b32 s62, s62, 7
    s_add_u32 s78, s76, s62
    v_mfma_f32_16x16x32_bf16 v[32:35], v[216:219], a[40:43], v[32:35]
    buffer_load_dwordx4 v6, s[36:39], s66 offen offset:1024 lds
    v_mfma_f32_16x16x32_bf16 v[32:35], v[220:223], a[56:59], v[32:35]
    s_add_u32 m0, s87, 0x16000
    s_add_u32 s78, s78, s65
    v_mul_u32_u24 v108, 0x2400, v0
    v_mfma_f32_16x16x32_bf16 v[40:43], v[220:223], a[60:63], v[40:43]
    s_add_u32 s66, s97, 0x80
    buffer_load_dwordx4 v5, s[36:39], s66 offen lds
    v_mfma_f32_16x16x32_bf16 v[40:43], v[216:219], a[44:47], v[40:43]
    s_waitcnt lgkmcnt(4)
    s_mul_i32 s60, s59, 0x1800
    v_add_u32 v7, 0x47c00, v6
    v_mfma_f32_16x16x32_bf16 v[44:47], v[224:227], a[44:47], v[44:47]
    ds_read_b64_tr_b16 v[216:217], v4 offset:24576
    ds_read_b64_tr_b16 v[218:219], v4 offset:26624
    v_mfma_f32_16x16x32_bf16 v[44:47], v[228:231], a[60:63], v[44:47]
    buffer_load_dwordx4 v6, s[36:39], s66 offen offset:1024 lds
    v_mfma_f32_16x16x32_bf16 v[36:39], v[228:231], a[56:59], v[36:39]
    ds_read_b64_tr_b16 v[220:221], v4 offset:25600
    ds_read_b64_tr_b16 v[222:223], v4 offset:27648
    v_mfma_f32_16x16x32_bf16 v[36:39], v[224:227], a[40:43], v[36:39]
    s_cmp_lt_u32 s88, 27
    s_cselect_b32 s89, s78, 0x1000000
    s_mul_i32 s61, s61, 0x19660d
    v_mfma_f32_16x16x32_bf16 v[28:31], v[224:227], a[36:39], v[28:31]
    s_add_u32 s61, s61, 0x3c6ef35f
    v_mov_b32 v14, s61
    v_mfma_f32_16x16x32_bf16 v[28:31], v[228:231], a[52:55], v[28:31]
    v_lshlrev_b32 v1, 4, v0
    v_mfma_f32_16x16x32_bf16 v[20:23], v[228:231], a[48:51], v[20:23]
    s_mov_b32 s48, s28
    s_mov_b32 s49, s29
    v_mfma_f32_16x16x32_bf16 v[20:23], v[224:227], a[32:35], v[20:23]
    s_waitcnt vmcnt(8) lgkmcnt(4)
    s_barrier
    s_mov_b32 s50, 0x10000000
    v_mfma_f32_16x16x32_bf16 v[48:51], v[208:211], a[32:35], v[48:51]
    ds_read_b64_tr_b16 v[224:225], v2 offset:49152
    ds_read_b64_tr_b16 v[226:227], v2 offset:51200
    v_mfma_f32_16x16x32_bf16 v[48:51], v[212:215], a[48:51], v[48:51]
    ds_read_b128 a[64:67], v240 offset:32768
    ds_read_b128 a[80:83], v241 offset:32768
    v_mfma_f32_16x16x32_bf16 v[56:59], v[212:215], a[52:55], v[56:59]
    ds_read_b64_tr_b16 v[228:229], v2 offset:50176
    ds_read_b64_tr_b16 v[230:231], v2 offset:52224
    v_mfma_f32_16x16x32_bf16 v[56:59], v[208:211], a[36:39], v[56:59]
    s_add_u32 m0, s64, 0x18000
    ds_read_b128 a[68:71], v240 offset:34816
    ds_read_b128 a[84:87], v241 offset:34816
    v_mfma_f32_16x16x32_bf16 v[64:67], v[208:211], a[40:43], v[64:67]
    s_add_u32 s66, s94, 0x80
    buffer_load_dwordx4 v248, s[32:35], s66 offen lds
    v_mfma_f32_16x16x32_bf16 v[64:67], v[212:215], a[56:59], v[64:67]
    ds_read_b128 a[72:75], v242 offset:32768
    ds_read_b128 a[88:91], v243 offset:32768
    v_mfma_f32_16x16x32_bf16 v[72:75], v[212:215], a[60:63], v[72:75]
    s_mov_b32 s51, 0x20000
    s_sub_u32 s40, s20, 2048
    s_subb_u32 s41, s21, 0
    v_mfma_f32_16x16x32_bf16 v[72:75], v[208:211], a[44:47], v[72:75]
    s_waitcnt lgkmcnt(10)
    ds_read_b128 a[76:79], v242 offset:34816
    ds_read_b128 a[92:95], v243 offset:34816
    v_mfma_f32_16x16x32_bf16 v[76:79], v[216:219], a[44:47], v[76:79]
    s_add_u32 m0, s64, 0x18400
    ds_read_b64_tr_b16 v[208:209], v4 offset:49152
    ds_read_b64_tr_b16 v[210:211], v4 offset:51200
    v_mfma_f32_16x16x32_bf16 v[76:79], v[220:223], a[60:63], v[76:79]
    s_add_u32 s66, s94, 0x80
    buffer_load_dwordx4 v249, s[32:35], s66 offen lds
    v_mfma_f32_16x16x32_bf16 v[68:71], v[220:223], a[56:59], v[68:71]
    ds_read_b64_tr_b16 v[212:213], v4 offset:50176
    ds_read_b64_tr_b16 v[214:215], v4 offset:52224
    v_mfma_f32_16x16x32_bf16 v[68:71], v[216:219], a[40:43], v[68:71]
    s_add_u32 m0, s64, 0x18800
    s_mov_b32 s42, 0x510800
    v_mfma_f32_16x16x32_bf16 v[60:63], v[216:219], a[36:39], v[60:63]
    s_add_u32 s66, s94, 0x4880
    buffer_load_dwordx4 v248, s[32:35], s66 offen lds
    v_mfma_f32_16x16x32_bf16 v[60:63], v[220:223], a[52:55], v[60:63]
    s_add_u32 m0, s64, 0x18c00
    s_mov_b32 s43, 0x20000
    s_lshl_b32 s68, s56, 2
    v_mfma_f32_16x16x32_bf16 v[52:55], v[220:223], a[48:51], v[52:55]
    s_add_u32 s66, s94, 0x4880
    buffer_load_dwordx4 v249, s[32:35], s66 offen lds
    v_mfma_f32_16x16x32_bf16 v[52:55], v[216:219], a[32:35], v[52:55]
    s_waitcnt lgkmcnt(4)
    s_add_u32 s68, s68, s57
    s_mul_i32 s68, s68, 3
    v_mfma_f32_16x16x32_bf16 v[16:19], v[224:227], a[64:67], v[16:19]
    s_add_u32 m0, s87, 0x1c000
    ds_read_b64_tr_b16 v[216:217], v2 offset:57344
    ds_read_b64_tr_b16 v[218:219], v2 offset:59392
    v_mfma_f32_16x16x32_bf16 v[16:19], v[228:231], a[80:83], v[16:19]
    s_add_u32 s66, s97, 0x90000
    buffer_load_dwordx4 v5, s[36:39], s66 offen lds
    v_mfma_f32_16x16x32_bf16 v[24:27], v[228:231], a[84:87], v[24:27]
    ds_read_b64_tr_b16 v[220:221], v2 offset:58368
    ds_read_b64_tr_b16 v[222:223], v2 offset:60416
    v_mfma_f32_16x16x32_bf16 v[24:27], v[224:227], a[68:71], v[24:27]
    s_mul_i32 s62, s57, 3
    v_mfma_f32_16x16x32_bf16 v[32:35], v[224:227], a[72:75], v[32:35]
    buffer_load_dwordx4 v6, s[36:39], s66 offen offset:1024 lds
    v_mfma_f32_16x16x32_bf16 v[32:35], v[228:231], a[88:91], v[32:35]
    s_add_u32 m0, s87, 0x1e000
    s_add_u32 s69, s58, 1
    s_cmp_eq_u32 s69, 3
    s_cselect_b32 s69, 0, s69
    v_mfma_f32_16x16x32_bf16 v[40:43], v[228:231], a[92:95], v[40:43]
    s_add_u32 s66, s97, 0x90080
    buffer_load_dwordx4 v5, s[36:39], s66 offen lds
    v_mfma_f32_16x16x32_bf16 v[40:43], v[224:227], a[76:79], v[40:43]
    s_waitcnt lgkmcnt(4)
    s_add_u32 s70, s69, 1
    s_cmp_eq_u32 s70, 3
    s_cselect_b32 s70, 0, s70
    v_mfma_f32_16x16x32_bf16 v[44:47], v[208:211], a[76:79], v[44:47]
    ds_read_b64_tr_b16 v[224:225], v4 offset:57344
    ds_read_b64_tr_b16 v[226:227], v4 offset:59392
    v_mfma_f32_16x16x32_bf16 v[44:47], v[212:215], a[92:95], v[44:47]
    buffer_load_dwordx4 v6, s[36:39], s66 offen offset:1024 lds
    v_mfma_f32_16x16x32_bf16 v[36:39], v[212:215], a[88:91], v[36:39]
    ds_read_b64_tr_b16 v[228:229], v4 offset:58368
    ds_read_b64_tr_b16 v[230:231], v4 offset:60416
    v_mfma_f32_16x16x32_bf16 v[36:39], v[208:211], a[72:75], v[36:39]
    s_add_u32 s71, s62, s58
    v_mfma_f32_16x16x32_bf16 v[28:31], v[208:211], a[68:71], v[28:31]
    s_mul_i32 s71, s71, 0x6c000
    s_add_u32 s72, s62, s69
    v_mfma_f32_16x16x32_bf16 v[28:31], v[212:215], a[84:87], v[28:31]
    v_xor_b32 v240, 0x10000, v240
    v_xor_b32 v241, 0x10000, v241
    v_xor_b32 v242, 0x10000, v242
    v_xor_b32 v243, 0x10000, v243
    v_mfma_f32_16x16x32_bf16 v[20:23], v[212:215], a[80:83], v[20:23]
    s_mul_i32 s72, s72, 0x6c000
    s_add_u32 s73, s62, s70
    v_mfma_f32_16x16x32_bf16 v[20:23], v[208:211], a[64:67], v[20:23]
    s_waitcnt vmcnt(8) lgkmcnt(4)
    s_barrier
    s_mul_i32 s73, s73, 0x6c000
    v_mfma_f32_16x16x32_bf16 v[48:51], v[216:219], a[64:67], v[48:51]
    ds_read_b64_tr_b16 v[208:209], v3 offset:8192
    ds_read_b64_tr_b16 v[210:211], v3 offset:10240
    v_mfma_f32_16x16x32_bf16 v[48:51], v[220:223], a[80:83], v[48:51]
    ds_read_b128 a[96:99], v240
    ds_read_b128 a[112:115], v241
    v_mfma_f32_16x16x32_bf16 v[56:59], v[220:223], a[84:87], v[56:59]
    ds_read_b64_tr_b16 v[212:213], v3 offset:9216
    ds_read_b64_tr_b16 v[214:215], v3 offset:11264
    v_mfma_f32_16x16x32_bf16 v[56:59], v[216:219], a[68:71], v[56:59]
    s_add_u32 m0, s64, 0
    ds_read_b128 a[100:103], v240 offset:2048
    ds_read_b128 a[116:119], v241 offset:2048
    v_mfma_f32_16x16x32_bf16 v[64:67], v[216:219], a[72:75], v[64:67]
    s_add_u32 s66, s94, 0x100
    buffer_load_dwordx4 v248, s[32:35], s66 offen lds
    v_mfma_f32_16x16x32_bf16 v[64:67], v[220:223], a[88:91], v[64:67]
    ds_read_b128 a[104:107], v242
    ds_read_b128 a[120:123], v243
    v_mfma_f32_16x16x32_bf16 v[72:75], v[220:223], a[92:95], v[72:75]
    s_add_u32 s69, s69, s68
    v_mfma_f32_16x16x32_bf16 v[72:75], v[216:219], a[76:79], v[72:75]
    s_waitcnt lgkmcnt(10)
    ds_read_b128 a[108:111], v242 offset:2048
    ds_read_b128 a[124:127], v243 offset:2048
    v_mfma_f32_16x16x32_bf16 v[76:79], v[224:227], a[76:79], v[76:79]
    s_add_u32 m0, s64, 0x400
    ds_read_b64_tr_b16 v[216:217], v252 offset:8192
    ds_read_b64_tr_b16 v[218:219], v252 offset:10240
    v_mfma_f32_16x16x32_bf16 v[76:79], v[228:231], a[92:95], v[76:79]
    s_add_u32 s66, s94, 0x100
    buffer_load_dwordx4 v249, s[32:35], s66 offen lds
    v_mfma_f32_16x16x32_bf16 v[68:71], v[228:231], a[88:91], v[68:71]
    ds_read_b64_tr_b16 v[220:221], v252 offset:9216
    ds_read_b64_tr_b16 v[222:223], v252 offset:11264
    v_mfma_f32_16x16x32_bf16 v[68:71], v[224:227], a[72:75], v[68:71]
    s_add_u32 m0, s64, 0x800
    s_lshl_b32 s69, s69, 2
    s_add_u32 s69, s69, s59
    v_mfma_f32_16x16x32_bf16 v[60:63], v[224:227], a[68:71], v[60:63]
    s_add_u32 s66, s94, 0x4900
    buffer_load_dwordx4 v248, s[32:35], s66 offen lds
    v_mfma_f32_16x16x32_bf16 v[60:63], v[228:231], a[84:87], v[60:63]
    s_add_u32 m0, s64, 0xc00
    s_add_u32 s70, s70, s68
    s_lshl_b32 s70, s70, 2
    v_mfma_f32_16x16x32_bf16 v[52:55], v[228:231], a[80:83], v[52:55]
    s_add_u32 s66, s94, 0x4900
    buffer_load_dwordx4 v249, s[32:35], s66 offen lds
    v_mfma_f32_16x16x32_bf16 v[52:55], v[224:227], a[64:67], v[52:55]
    s_waitcnt lgkmcnt(4)
    s_add_u32 s70, s70, s59
    v_mfma_f32_16x16x32_bf16 v[16:19], v[208:211], a[96:99], v[16:19]
    s_add_u32 m0, s87, 0x4000
    ds_read_b64_tr_b16 v[224:225], v3 offset:16384
    ds_read_b64_tr_b16 v[226:227], v3 offset:18432
    v_mfma_f32_16x16x32_bf16 v[16:19], v[212:215], a[112:115], v[16:19]
    s_add_u32 s66, s97, 0x120000
    buffer_load_dwordx4 v5, s[36:39], s66 offen lds
    v_mfma_f32_16x16x32_bf16 v[24:27], v[212:215], a[116:119], v[24:27]
    ds_read_b64_tr_b16 v[228:229], v3 offset:17408
    ds_read_b64_tr_b16 v[230:231], v3 offset:19456
    v_mfma_f32_16x16x32_bf16 v[24:27], v[208:211], a[100:103], v[24:27]
    s_add_u32 s68, s68, s58
    s_lshl_b32 s68, s68, 2
    v_mfma_f32_16x16x32_bf16 v[32:35], v[208:211], a[104:107], v[32:35]
    buffer_load_dwordx4 v6, s[36:39], s66 offen offset:1024 lds
    v_mfma_f32_16x16x32_bf16 v[32:35], v[212:215], a[120:123], v[32:35]
    s_add_u32 m0, s87, 0x6000
    s_add_u32 s68, s68, s59
    v_mov_b32 v97, s69
    v_mfma_f32_16x16x32_bf16 v[40:43], v[212:215], a[124:127], v[40:43]
    s_add_u32 s66, s97, 0x120080
    buffer_load_dwordx4 v5, s[36:39], s66 offen lds
    v_mfma_f32_16x16x32_bf16 v[40:43], v[208:211], a[108:111], v[40:43]
    s_waitcnt lgkmcnt(4)
    v_mov_b32 v12, s70
    v_cmp_eq_u32 vcc, 0, v0
    v_mfma_f32_16x16x32_bf16 v[44:47], v[216:219], a[108:111], v[44:47]
    ds_read_b64_tr_b16 v[208:209], v252 offset:16384
    ds_read_b64_tr_b16 v[210:211], v252 offset:18432
    v_mfma_f32_16x16x32_bf16 v[44:47], v[220:223], a[124:127], v[44:47]
    buffer_load_dwordx4 v6, s[36:39], s66 offen offset:1024 lds
    v_mfma_f32_16x16x32_bf16 v[36:39], v[220:223], a[120:123], v[36:39]
    ds_read_b64_tr_b16 v[212:213], v252 offset:17408
    ds_read_b64_tr_b16 v[214:215], v252 offset:19456
    v_mfma_f32_16x16x32_bf16 v[36:39], v[216:219], a[104:107], v[36:39]
    v_cndmask_b32 v12, v12, v97, vcc
    v_mfma_f32_16x16x32_bf16 v[28:31], v[216:219], a[100:103], v[28:31]
    v_lshlrev_b32 v12, 10, v12
    v_add_u32 v12, 0x2f50000, v12
    v_mfma_f32_16x16x32_bf16 v[28:31], v[220:223], a[116:119], v[28:31]
    v_cmp_gt_u32 vcc, 2, v0
    v_mov_b32 v250, 0x10000000
    v_mfma_f32_16x16x32_bf16 v[20:23], v[220:223], a[112:115], v[20:23]
    v_cndmask_b32 v12, v250, v12, vcc
    v_mfma_f32_16x16x32_bf16 v[20:23], v[216:219], a[96:99], v[20:23]
    s_waitcnt vmcnt(8) lgkmcnt(4)
    s_barrier
    v_mov_b32 v250, s61
    v_mfma_f32_16x16x32_bf16 v[48:51], v[224:227], a[96:99], v[48:51]
    ds_read_b64_tr_b16 v[216:217], v3 offset:40960
    ds_read_b64_tr_b16 v[218:219], v3 offset:43008
    v_mfma_f32_16x16x32_bf16 v[48:51], v[228:231], a[112:115], v[48:51]
    ds_read_b128 a[128:131], v240 offset:32768
    ds_read_b128 a[144:147], v241 offset:32768
    v_mfma_f32_16x16x32_bf16 v[56:59], v[228:231], a[116:119], v[56:59]
    ds_read_b64_tr_b16 v[220:221], v3 offset:41984
    ds_read_b64_tr_b16 v[222:223], v3 offset:44032
    v_mfma_f32_16x16x32_bf16 v[56:59], v[224:227], a[100:103], v[56:59]
    s_add_u32 m0, s64, 0x8000
    ds_read_b128 a[132:135], v240 offset:34816
    ds_read_b128 a[148:151], v241 offset:34816
    v_mfma_f32_16x16x32_bf16 v[64:67], v[224:227], a[104:107], v[64:67]
    s_add_u32 s66, s95, 0
    buffer_load_dwordx4 v248, s[32:35], s66 offen lds
    v_mfma_f32_16x16x32_bf16 v[64:67], v[228:231], a[120:123], v[64:67]
    ds_read_b128 a[136:139], v242 offset:32768
    ds_read_b128 a[152:155], v243 offset:32768
    v_mfma_f32_16x16x32_bf16 v[72:75], v[228:231], a[124:127], v[72:75]
    v_cndmask_b32 v250, 0, v250, vcc
    s_lshl_b32 s62, s68, 10
    v_mfma_f32_16x16x32_bf16 v[72:75], v[224:227], a[108:111], v[72:75]
    s_waitcnt lgkmcnt(10)
    ds_read_b128 a[140:143], v242 offset:34816
    ds_read_b128 a[156:159], v243 offset:34816
    v_mfma_f32_16x16x32_bf16 v[76:79], v[208:211], a[108:111], v[76:79]
    s_add_u32 m0, s64, 0x8400
    ds_read_b64_tr_b16 v[224:225], v252 offset:40960
    ds_read_b64_tr_b16 v[226:227], v252 offset:43008
    v_mfma_f32_16x16x32_bf16 v[76:79], v[212:215], a[124:127], v[76:79]
    s_add_u32 s66, s95, 0
    buffer_load_dwordx4 v249, s[32:35], s66 offen lds
    v_mfma_f32_16x16x32_bf16 v[68:71], v[212:215], a[120:123], v[68:71]
    ds_read_b64_tr_b16 v[228:229], v252 offset:41984
    ds_read_b64_tr_b16 v[230:231], v252 offset:44032
    v_mfma_f32_16x16x32_bf16 v[68:71], v[208:211], a[104:107], v[68:71]
    s_add_u32 m0, s64, 0x8800
    s_add_u32 s92, s62, 0x2f50000
    v_lshrrev_b32 v15, 5, v0
    v_mfma_f32_16x16x32_bf16 v[60:63], v[208:211], a[100:103], v[60:63]
    s_add_u32 s66, s95, 0x4800
    buffer_load_dwordx4 v248, s[32:35], s66 offen lds
    v_mfma_f32_16x16x32_bf16 v[60:63], v[212:215], a[116:119], v[60:63]
    s_add_u32 m0, s64, 0x8c00
    v_lshl_add_u32 v15, v15, 28, s92
    v_mfma_f32_16x16x32_bf16 v[52:55], v[212:215], a[112:115], v[52:55]
    s_add_u32 s66, s95, 0x4800
    buffer_load_dwordx4 v249, s[32:35], s66 offen lds
    v_mfma_f32_16x16x32_bf16 v[52:55], v[208:211], a[96:99], v[52:55]
    s_waitcnt lgkmcnt(4)
    v_lshl_add_u32 v15, v0, 2, v15
    s_mul_i32 s77, s68, 0x3000
    v_mfma_f32_16x16x32_bf16 v[16:19], v[216:219], a[128:131], v[16:19]
    s_add_u32 m0, s87, 0xc000
    ds_read_b64_tr_b16 v[208:209], v3 offset:49152
    ds_read_b64_tr_b16 v[210:211], v3 offset:51200
    v_mfma_f32_16x16x32_bf16 v[16:19], v[220:223], a[144:147], v[16:19]
    s_add_u32 s66, s98, 0
    buffer_load_dwordx4 v5, s[36:39], s66 offen lds
    v_mfma_f32_16x16x32_bf16 v[24:27], v[220:223], a[148:151], v[24:27]
    ds_read_b64_tr_b16 v[212:213], v3 offset:50176
    ds_read_b64_tr_b16 v[214:215], v3 offset:52224
    v_mfma_f32_16x16x32_bf16 v[24:27], v[216:219], a[132:135], v[24:27]
    s_add_u32 s77, s77, 0x1400000
    s_mul_i32 s68, s68, 0x6000
    v_mfma_f32_16x16x32_bf16 v[32:35], v[216:219], a[136:139], v[32:35]
    buffer_load_dwordx4 v6, s[36:39], s66 offen offset:1024 lds
    v_mfma_f32_16x16x32_bf16 v[32:35], v[220:223], a[152:155], v[32:35]
    s_add_u32 m0, s87, 0xe000
    s_mul_i32 s69, s69, 0x6000
    v_mfma_f32_16x16x32_bf16 v[40:43], v[220:223], a[156:159], v[40:43]
    s_add_u32 s66, s98, 0x80
    buffer_load_dwordx4 v5, s[36:39], s66 offen lds
    v_mfma_f32_16x16x32_bf16 v[40:43], v[216:219], a[140:143], v[40:43]
    s_waitcnt lgkmcnt(4)
    s_mul_i32 s70, s70, 0x6000
    v_mov_b32 v104, 0
    v_mfma_f32_16x16x32_bf16 v[44:47], v[224:227], a[140:143], v[44:47]
    ds_read_b64_tr_b16 v[216:217], v252 offset:49152
    ds_read_b64_tr_b16 v[218:219], v252 offset:51200
    v_mfma_f32_16x16x32_bf16 v[44:47], v[228:231], a[156:159], v[44:47]
    buffer_load_dwordx4 v6, s[36:39], s66 offen offset:1024 lds
    v_mfma_f32_16x16x32_bf16 v[36:39], v[228:231], a[152:155], v[36:39]
    ds_read_b64_tr_b16 v[220:221], v252 offset:50176
    ds_read_b64_tr_b16 v[222:223], v252 offset:52224
    v_mfma_f32_16x16x32_bf16 v[36:39], v[224:227], a[136:139], v[36:39]
    v_mov_b32 v105, 0
    v_mov_b32 v106, 0
    v_mfma_f32_16x16x32_bf16 v[28:31], v[224:227], a[132:135], v[28:31]
    v_mov_b32 v107, 0
    v_mfma_f32_16x16x32_bf16 v[28:31], v[228:231], a[148:151], v[28:31]
    v_xor_b32 v240, 0x10000, v240
    v_xor_b32 v241, 0x10000, v241
    v_xor_b32 v242, 0x10000, v242
    v_xor_b32 v243, 0x10000, v243
    v_mfma_f32_16x16x32_bf16 v[20:23], v[228:231], a[144:147], v[20:23]
    v_lshrrev_b32 v96, 3, v0
    v_lshrrev_b32 v97, 4, v0
    v_mfma_f32_16x16x32_bf16 v[20:23], v[224:227], a[128:131], v[20:23]
    s_waitcnt vmcnt(8) lgkmcnt(4)
    s_barrier
    buffer_store_dwordx4 v[104:107], v1, s[48:51], s92 offen sc1
    v_mfma_f32_16x16x32_bf16 v[48:51], v[208:211], a[128:131], v[48:51]
    ds_read_b64_tr_b16 v[224:225], v2 offset:16384
    ds_read_b64_tr_b16 v[226:227], v2 offset:18432
    v_mfma_f32_16x16x32_bf16 v[48:51], v[212:215], a[144:147], v[48:51]
    ds_read_b128 a[160:163], v240
    ds_read_b128 a[176:179], v241
    v_mfma_f32_16x16x32_bf16 v[56:59], v[212:215], a[148:151], v[56:59]
    ds_read_b64_tr_b16 v[228:229], v2 offset:17408
    ds_read_b64_tr_b16 v[230:231], v2 offset:19456
    v_mfma_f32_16x16x32_bf16 v[56:59], v[208:211], a[132:135], v[56:59]
    s_add_u32 m0, s64, 0x10000
    ds_read_b128 a[164:167], v240 offset:2048
    ds_read_b128 a[180:183], v241 offset:2048
    v_mfma_f32_16x16x32_bf16 v[64:67], v[208:211], a[136:139], v[64:67]
    s_add_u32 s66, s95, 0x80
    buffer_load_dwordx4 v248, s[32:35], s66 offen lds
    v_mfma_f32_16x16x32_bf16 v[64:67], v[212:215], a[152:155], v[64:67]
    ds_read_b128 a[168:171], v242
    ds_read_b128 a[184:187], v243
    v_mfma_f32_16x16x32_bf16 v[72:75], v[212:215], a[156:159], v[72:75]
    v_mfma_f32_16x16x32_bf16 v[72:75], v[208:211], a[140:143], v[72:75]
    s_waitcnt lgkmcnt(10)
    ds_read_b128 a[172:175], v242 offset:2048
    ds_read_b128 a[188:191], v243 offset:2048
    v_mfma_f32_16x16x32_bf16 v[76:79], v[216:219], a[140:143], v[76:79]
    s_add_u32 m0, s64, 0x10400
    ds_read_b64_tr_b16 v[208:209], v4 offset:16384
    ds_read_b64_tr_b16 v[210:211], v4 offset:18432
    v_mfma_f32_16x16x32_bf16 v[76:79], v[220:223], a[156:159], v[76:79]
    s_add_u32 s66, s95, 0x80
    buffer_load_dwordx4 v249, s[32:35], s66 offen lds
    v_mfma_f32_16x16x32_bf16 v[68:71], v[220:223], a[152:155], v[68:71]
    ds_read_b64_tr_b16 v[212:213], v4 offset:17408
    ds_read_b64_tr_b16 v[214:215], v4 offset:19456
    v_mfma_f32_16x16x32_bf16 v[68:71], v[216:219], a[136:139], v[68:71]
    s_add_u32 m0, s64, 0x10800
    v_mfma_f32_16x16x32_bf16 v[60:63], v[216:219], a[132:135], v[60:63]
    s_add_u32 s66, s95, 0x4880
    buffer_load_dwordx4 v248, s[32:35], s66 offen lds
    v_mfma_f32_16x16x32_bf16 v[60:63], v[220:223], a[148:151], v[60:63]
    s_add_u32 m0, s64, 0x10c00
    v_mfma_f32_16x16x32_bf16 v[52:55], v[220:223], a[144:147], v[52:55]
    s_add_u32 s66, s95, 0x4880
    buffer_load_dwordx4 v249, s[32:35], s66 offen lds
    v_mfma_f32_16x16x32_bf16 v[52:55], v[216:219], a[128:131], v[52:55]
    s_waitcnt lgkmcnt(4)
    s_lshl_b32 s63, s59, 4
    v_add_u32 v96, s63, v96
    v_mfma_f32_16x16x32_bf16 v[16:19], v[224:227], a[160:163], v[16:19]
    s_add_u32 m0, s87, 0x14000
    ds_read_b64_tr_b16 v[216:217], v2 offset:24576
    ds_read_b64_tr_b16 v[218:219], v2 offset:26624
    v_mfma_f32_16x16x32_bf16 v[16:19], v[228:231], a[176:179], v[16:19]
    s_add_u32 s66, s98, 0x90000
    buffer_load_dwordx4 v5, s[36:39], s66 offen lds
    v_mfma_f32_16x16x32_bf16 v[24:27], v[228:231], a[180:183], v[24:27]
    ds_read_b64_tr_b16 v[220:221], v2 offset:25600
    ds_read_b64_tr_b16 v[222:223], v2 offset:27648
    v_mfma_f32_16x16x32_bf16 v[24:27], v[224:227], a[164:167], v[24:27]
    v_mul_u32_u24 v96, 0x480, v96
    v_mfma_f32_16x16x32_bf16 v[32:35], v[224:227], a[168:171], v[32:35]
    buffer_load_dwordx4 v6, s[36:39], s66 offen offset:1024 lds
    v_mfma_f32_16x16x32_bf16 v[32:35], v[228:231], a[184:187], v[32:35]
    s_add_u32 m0, s87, 0x16000
    v_lshlrev_b32 v97, 1, v97
    v_and_b32 v8, 7, v0
    v_mfma_f32_16x16x32_bf16 v[40:43], v[228:231], a[188:191], v[40:43]
    s_add_u32 s66, s98, 0x90080
    buffer_load_dwordx4 v5, s[36:39], s66 offen lds
    v_mfma_f32_16x16x32_bf16 v[40:43], v[224:227], a[172:175], v[40:43]
    s_waitcnt lgkmcnt(4)
    v_xor_b32 v97, v97, v8
    v_lshl_add_u32 v96, v97, 4, v96
    v_mfma_f32_16x16x32_bf16 v[44:47], v[208:211], a[172:175], v[44:47]
    ds_read_b64_tr_b16 v[224:225], v4 offset:24576
    ds_read_b64_tr_b16 v[226:227], v4 offset:26624
    v_mfma_f32_16x16x32_bf16 v[44:47], v[212:215], a[188:191], v[44:47]
    buffer_load_dwordx4 v6, s[36:39], s66 offen offset:1024 lds
    v_mfma_f32_16x16x32_bf16 v[36:39], v[212:215], a[184:187], v[36:39]
    ds_read_b64_tr_b16 v[228:229], v4 offset:25600
    ds_read_b64_tr_b16 v[230:231], v4 offset:27648
    v_mfma_f32_16x16x32_bf16 v[36:39], v[208:211], a[168:171], v[36:39]
    s_mul_i32 s63, s58, 0x180
    v_mfma_f32_16x16x32_bf16 v[28:31], v[208:211], a[164:167], v[28:31]
    s_add_u32 s63, s63, 0x800
    v_add_u32 v8, s63, v96
    v_mfma_f32_16x16x32_bf16 v[28:31], v[212:215], a[180:183], v[28:31]
    v_subrev_u32 v9, 0x400, v8
    v_subrev_u32 v10, 0x400, v9
    v_mfma_f32_16x16x32_bf16 v[20:23], v[212:215], a[176:179], v[20:23]
    v_lshrrev_b32 v96, 5, v0
    v_lshlrev_b32 v13, 13, v96
    v_mfma_f32_16x16x32_bf16 v[20:23], v[208:211], a[160:163], v[20:23]
    s_waitcnt vmcnt(9) lgkmcnt(4)
    s_barrier
    v_mfma_f32_16x16x32_bf16 v[48:51], v[216:219], a[160:163], v[48:51]
    ds_read_b64_tr_b16 v[208:209], v2 offset:49152
    ds_read_b64_tr_b16 v[210:211], v2 offset:51200
    v_mfma_f32_16x16x32_bf16 v[48:51], v[220:223], a[176:179], v[48:51]
    ds_read_b128 a[192:195], v240 offset:32768
    ds_read_b128 a[208:211], v241 offset:32768
    v_mfma_f32_16x16x32_bf16 v[56:59], v[220:223], a[180:183], v[56:59]
    ds_read_b64_tr_b16 v[212:213], v2 offset:50176
    ds_read_b64_tr_b16 v[214:215], v2 offset:52224
    v_mfma_f32_16x16x32_bf16 v[56:59], v[216:219], a[164:167], v[56:59]
    s_add_u32 m0, s64, 0x18000
    ds_read_b128 a[196:199], v240 offset:34816
    ds_read_b128 a[212:215], v241 offset:34816
    v_mfma_f32_16x16x32_bf16 v[64:67], v[216:219], a[168:171], v[64:67]
    s_add_u32 s66, s95, 0x100
    buffer_load_dwordx4 v248, s[32:35], s66 offen lds
    v_mfma_f32_16x16x32_bf16 v[64:67], v[220:223], a[184:187], v[64:67]
    ds_read_b128 a[200:203], v242 offset:32768
    ds_read_b128 a[216:219], v243 offset:32768
    v_mfma_f32_16x16x32_bf16 v[72:75], v[220:223], a[188:191], v[72:75]
    v_mul_u32_u24 v96, 0xc00, v96
    v_add_u32 v251, v96, v251
    v_mfma_f32_16x16x32_bf16 v[72:75], v[216:219], a[172:175], v[72:75]
    s_waitcnt lgkmcnt(10)
    ds_read_b128 a[204:207], v242 offset:34816
    ds_read_b128 a[220:223], v243 offset:34816
    v_mfma_f32_16x16x32_bf16 v[76:79], v[224:227], a[172:175], v[76:79]
    s_add_u32 m0, s64, 0x18400
    ds_read_b64_tr_b16 v[216:217], v4 offset:49152
    ds_read_b64_tr_b16 v[218:219], v4 offset:51200
    v_mfma_f32_16x16x32_bf16 v[76:79], v[228:231], a[188:191], v[76:79]
    s_add_u32 s66, s95, 0x100
    buffer_load_dwordx4 v249, s[32:35], s66 offen lds
    v_mfma_f32_16x16x32_bf16 v[68:71], v[228:231], a[184:187], v[68:71]
    ds_read_b64_tr_b16 v[220:221], v4 offset:50176
    ds_read_b64_tr_b16 v[222:223], v4 offset:52224
    v_mfma_f32_16x16x32_bf16 v[68:71], v[224:227], a[168:171], v[68:71]
    s_add_u32 m0, s64, 0x18800
    s_and_b32 s62, s59, 1
    s_mul_i32 s62, s62, 0x3000
    v_mfma_f32_16x16x32_bf16 v[60:63], v[224:227], a[164:167], v[60:63]
    s_add_u32 s66, s95, 0x4900
    buffer_load_dwordx4 v248, s[32:35], s66 offen lds
    v_mfma_f32_16x16x32_bf16 v[60:63], v[228:231], a[180:183], v[60:63]
    s_add_u32 m0, s64, 0x18c00
    v_add_u32 v251, s62, v251
    v_mfma_f32_16x16x32_bf16 v[52:55], v[228:231], a[176:179], v[52:55]
    s_add_u32 s66, s95, 0x4900
    buffer_load_dwordx4 v249, s[32:35], s66 offen lds
    v_mfma_f32_16x16x32_bf16 v[52:55], v[224:227], a[160:163], v[52:55]
    s_waitcnt lgkmcnt(4)
    s_xor_b32 s62, s57, 3
    s_lshl_b32 s62, s62, 5
    v_mfma_f32_16x16x32_bf16 v[16:19], v[208:211], a[192:195], v[16:19]
    s_add_u32 m0, s87, 0x1c000
L_pad_f0:
    s_cbranch_execz L_pad_f4
    ds_read_b64_tr_b16 v[224:225], v2 offset:57344
    ds_read_b64_tr_b16 v[226:227], v2 offset:59392
    v_mfma_f32_16x16x32_bf16 v[16:19], v[212:215], a[208:211], v[16:19]
    s_add_u32 s66, s98, 0x120000
    buffer_load_dwordx4 v5, s[36:39], s66 offen lds
    v_mfma_f32_16x16x32_bf16 v[24:27], v[212:215], a[212:215], v[24:27]
    ds_read_b64_tr_b16 v[228:229], v2 offset:58368
    ds_read_b64_tr_b16 v[230:231], v2 offset:60416
    v_mfma_f32_16x16x32_bf16 v[24:27], v[208:211], a[196:199], v[24:27]
    v_xor_b32 v251, s62, v251
    v_mfma_f32_16x16x32_bf16 v[32:35], v[208:211], a[200:203], v[32:35]
    buffer_load_dwordx4 v6, s[36:39], s66 offen offset:1024 lds
    v_mfma_f32_16x16x32_bf16 v[32:35], v[212:215], a[216:219], v[32:35]
    s_add_u32 m0, s87, 0x1e000
    v_mfma_f32_16x16x32_bf16 v[40:43], v[212:215], a[220:223], v[40:43]
    s_add_u32 s66, s98, 0x120080
    buffer_load_dwordx4 v5, s[36:39], s66 offen lds
    v_mfma_f32_16x16x32_bf16 v[40:43], v[208:211], a[204:207], v[40:43]
    s_waitcnt lgkmcnt(4)
    v_mfma_f32_16x16x32_bf16 v[44:47], v[216:219], a[204:207], v[44:47]
    ds_read_b64_tr_b16 v[208:209], v4 offset:57344
    ds_read_b64_tr_b16 v[210:211], v4 offset:59392
    v_mfma_f32_16x16x32_bf16 v[44:47], v[220:223], a[220:223], v[44:47]
    buffer_load_dwordx4 v6, s[36:39], s66 offen offset:1024 lds
    v_mfma_f32_16x16x32_bf16 v[36:39], v[220:223], a[216:219], v[36:39]
    ds_read_b64_tr_b16 v[212:213], v4 offset:58368
    ds_read_b64_tr_b16 v[214:215], v4 offset:60416
    v_mfma_f32_16x16x32_bf16 v[36:39], v[216:219], a[200:203], v[36:39]
    v_mfma_f32_16x16x32_bf16 v[28:31], v[216:219], a[196:199], v[28:31]
    v_mfma_f32_16x16x32_bf16 v[28:31], v[220:223], a[212:215], v[28:31]
    v_xor_b32 v240, 0x10000, v240
    v_xor_b32 v241, 0x10000, v241
    v_xor_b32 v242, 0x10000, v242
    v_xor_b32 v243, 0x10000, v243
    v_mfma_f32_16x16x32_bf16 v[20:23], v[220:223], a[208:211], v[20:23]
    v_mfma_f32_16x16x32_bf16 v[20:23], v[216:219], a[192:195], v[20:23]
    s_waitcnt vmcnt(8) lgkmcnt(4)
    s_barrier
    v_mfma_f32_16x16x32_bf16 v[48:51], v[224:227], a[192:195], v[48:51]
    ds_read_b64_tr_b16 v[216:217], v3 offset:8192
    ds_read_b64_tr_b16 v[218:219], v3 offset:10240
    v_mfma_f32_16x16x32_bf16 v[48:51], v[228:231], a[208:211], v[48:51]
    ds_read_b128 a[224:227], v240
    ds_read_b128 a[240:243], v241
    v_mfma_f32_16x16x32_bf16 v[56:59], v[228:231], a[212:215], v[56:59]
    ds_read_b64_tr_b16 v[220:221], v3 offset:9216
    ds_read_b64_tr_b16 v[222:223], v3 offset:11264
    v_mfma_f32_16x16x32_bf16 v[56:59], v[224:227], a[196:199], v[56:59]
    s_add_u32 m0, s60, 0
    ds_read_b128 a[228:231], v240 offset:2048
    ds_read_b128 a[244:247], v241 offset:2048
    v_mfma_f32_16x16x32_bf16 v[64:67], v[224:227], a[200:203], v[64:67]
    s_add_u32 s66, s96, 0x100
    buffer_load_dwordx4 v5, s[36:39], s66 offen lds
    v_mfma_f32_16x16x32_bf16 v[64:67], v[228:231], a[216:219], v[64:67]
    ds_read_b128 a[232:235], v242
    ds_read_b128 a[248:251], v243
    v_mfma_f32_16x16x32_bf16 v[72:75], v[228:231], a[220:223], v[72:75]
    buffer_load_dwordx4 v6, s[36:39], s66 offen offset:1024 lds
    v_mfma_f32_16x16x32_bf16 v[72:75], v[224:227], a[204:207], v[72:75]
    s_waitcnt lgkmcnt(10)
    ds_read_b128 a[236:239], v242 offset:2048
    ds_read_b128 a[252:255], v243 offset:2048
    v_mfma_f32_16x16x32_bf16 v[76:79], v[208:211], a[204:207], v[76:79]
    ds_read_b64_tr_b16 v[224:225], v252 offset:8192
    ds_read_b64_tr_b16 v[226:227], v252 offset:10240
    v_mfma_f32_16x16x32_bf16 v[76:79], v[212:215], a[220:223], v[76:79]
    s_and_b32 s62, s56, 7
    s_lshl_b32 s62, s62, 2
    v_mfma_f32_16x16x32_bf16 v[68:71], v[212:215], a[216:219], v[68:71]
    ds_read_b64_tr_b16 v[228:229], v252 offset:9216
    ds_read_b64_tr_b16 v[230:231], v252 offset:11264
    v_mfma_f32_16x16x32_bf16 v[68:71], v[208:211], a[200:203], v[68:71]
    s_add_u32 s62, s62, s59
    s_lshl_b32 s62, s62, 6
    v_mfma_f32_16x16x32_bf16 v[60:63], v[208:211], a[196:199], v[60:63]
    buffer_load_dwordx4 v7, s[36:39], s66 offen offset:2048 lds
    v_mfma_f32_16x16x32_bf16 v[60:63], v[212:215], a[212:215], v[60:63]
    s_add_u32 m0, s60, 0xc00
    v_mfma_f32_16x16x32_bf16 v[52:55], v[212:215], a[208:211], v[52:55]
    s_add_u32 s66, s96, 0xd8100
    buffer_load_dwordx4 v5, s[36:39], s66 offen lds
    v_mfma_f32_16x16x32_bf16 v[52:55], v[208:211], a[192:195], v[52:55]
    s_waitcnt lgkmcnt(4)
    s_lshl_b32 s63, s58, 11
    v_mfma_f32_16x16x32_bf16 v[16:19], v[216:219], a[224:227], v[16:19]
    ds_read_b64_tr_b16 v[208:209], v3 offset:16384
    ds_read_b64_tr_b16 v[210:211], v3 offset:18432
    v_mfma_f32_16x16x32_bf16 v[16:19], v[220:223], a[240:243], v[16:19]
    v_add_u32 v2, v13, v2
    v_add_u32 v4, v13, v4
    v_mfma_f32_16x16x32_bf16 v[24:27], v[220:223], a[244:247], v[24:27]
    ds_read_b64_tr_b16 v[212:213], v3 offset:17408
    ds_read_b64_tr_b16 v[214:215], v3 offset:19456
    v_mfma_f32_16x16x32_bf16 v[24:27], v[216:219], a[228:231], v[24:27]
    s_add_u32 s62, s62, s63
    v_mfma_f32_16x16x32_bf16 v[32:35], v[216:219], a[232:235], v[32:35]
    buffer_load_dwordx4 v6, s[36:39], s66 offen offset:1024 lds
    v_mfma_f32_16x16x32_bf16 v[32:35], v[220:223], a[248:251], v[32:35]
    v_mfma_f32_16x16x32_bf16 v[40:43], v[220:223], a[252:255], v[40:43]
    buffer_load_dwordx4 v7, s[36:39], s66 offen offset:2048 lds
    v_mfma_f32_16x16x32_bf16 v[40:43], v[216:219], a[236:239], v[40:43]
    s_waitcnt lgkmcnt(4)
    v_add_u32 v248, s62, v0
    v_mfma_f32_16x16x32_bf16 v[44:47], v[224:227], a[236:239], v[44:47]
    ds_read_b64_tr_b16 v[216:217], v252 offset:16384
    ds_read_b64_tr_b16 v[218:219], v252 offset:18432
    v_mfma_f32_16x16x32_bf16 v[44:47], v[228:231], a[252:255], v[44:47]
    v_mfma_f32_16x16x32_bf16 v[36:39], v[228:231], a[248:251], v[36:39]
    ds_read_b64_tr_b16 v[220:221], v252 offset:17408
    ds_read_b64_tr_b16 v[222:223], v252 offset:19456
    v_mfma_f32_16x16x32_bf16 v[36:39], v[224:227], a[232:235], v[36:39]
    v_lshlrev_b32 v248, 7, v248
    v_mfma_f32_16x16x32_bf16 v[28:31], v[224:227], a[228:231], v[28:31]
    v_mfma_f32_16x16x32_bf16 v[28:31], v[228:231], a[244:247], v[28:31]
    s_mul_i32 s78, s57, 0x144000
    v_mfma_f32_16x16x32_bf16 v[20:23], v[228:231], a[240:243], v[20:23]
    v_mfma_f32_16x16x32_bf16 v[20:23], v[224:227], a[224:227], v[20:23]
    s_waitcnt vmcnt(6) lgkmcnt(4)
    s_barrier
    v_mfma_f32_16x16x32_bf16 v[48:51], v[208:211], a[224:227], v[48:51]
    ds_read_b64_tr_b16 v[224:225], v3 offset:40960
    ds_read_b64_tr_b16 v[226:227], v3 offset:43008
    v_mfma_f32_16x16x32_bf16 v[48:51], v[212:215], a[240:243], v[48:51]
    ds_read_b128 v[176:179], v240 offset:32768
    ds_read_b128 v[192:195], v241 offset:32768
    v_mfma_f32_16x16x32_bf16 v[56:59], v[212:215], a[244:247], v[56:59]
    ds_read_b64_tr_b16 v[228:229], v3 offset:41984
    ds_read_b64_tr_b16 v[230:231], v3 offset:44032
    v_mfma_f32_16x16x32_bf16 v[56:59], v[208:211], a[228:231], v[56:59]
    s_add_u32 m0, s60, 0x6000
    ds_read_b128 v[180:183], v240 offset:34816
    ds_read_b128 v[196:199], v241 offset:34816
    v_mfma_f32_16x16x32_bf16 v[64:67], v[208:211], a[232:235], v[64:67]
    s_add_u32 s66, s97, 0x100
    buffer_load_dwordx4 v5, s[36:39], s66 offen lds
    v_mfma_f32_16x16x32_bf16 v[64:67], v[212:215], a[248:251], v[64:67]
    ds_read_b128 v[184:187], v242 offset:32768
    ds_read_b128 v[200:203], v243 offset:32768
    v_mfma_f32_16x16x32_bf16 v[72:75], v[212:215], a[252:255], v[72:75]
    buffer_load_dwordx4 v6, s[36:39], s66 offen offset:1024 lds
    v_mfma_f32_16x16x32_bf16 v[72:75], v[208:211], a[236:239], v[72:75]
    s_waitcnt lgkmcnt(10)
    ds_read_b128 v[188:191], v242 offset:34816
    ds_read_b128 v[204:207], v243 offset:34816
    v_mfma_f32_16x16x32_bf16 v[76:79], v[216:219], a[236:239], v[76:79]
    ds_read_b64_tr_b16 v[208:209], v252 offset:40960
    ds_read_b64_tr_b16 v[210:211], v252 offset:43008
    v_mfma_f32_16x16x32_bf16 v[76:79], v[220:223], a[252:255], v[76:79]
    s_add_u32 s78, s78, 0x800
    v_mfma_f32_16x16x32_bf16 v[68:71], v[220:223], a[248:251], v[68:71]
    ds_read_b64_tr_b16 v[212:213], v252 offset:41984
    ds_read_b64_tr_b16 v[214:215], v252 offset:44032
    v_mfma_f32_16x16x32_bf16 v[68:71], v[216:219], a[232:235], v[68:71]
    v_mfma_f32_16x16x32_bf16 v[60:63], v[216:219], a[228:231], v[60:63]
    buffer_load_dwordx4 v7, s[36:39], s66 offen offset:2048 lds
    v_mfma_f32_16x16x32_bf16 v[60:63], v[220:223], a[244:247], v[60:63]
    s_add_u32 m0, s60, 0x6c00
    v_min_u32 v248, 0xa1f80, v248
    v_mfma_f32_16x16x32_bf16 v[52:55], v[220:223], a[240:243], v[52:55]
    s_add_u32 s66, s97, 0xd8100
    buffer_load_dwordx4 v5, s[36:39], s66 offen lds
    v_mfma_f32_16x16x32_bf16 v[52:55], v[216:219], a[224:227], v[52:55]
    s_waitcnt lgkmcnt(4)
    s_lshr_b32 s62, s56, 3
    v_mfma_f32_16x16x32_bf16 v[16:19], v[224:227], v[176:179], v[16:19]
    ds_read_b64_tr_b16 v[216:217], v3 offset:49152
    ds_read_b64_tr_b16 v[218:219], v3 offset:51200
    v_mfma_f32_16x16x32_bf16 v[16:19], v[228:231], v[192:195], v[16:19]
    v_mfma_f32_16x16x32_bf16 v[24:27], v[228:231], v[196:199], v[24:27]
    ds_read_b64_tr_b16 v[220:221], v3 offset:50176
    ds_read_b64_tr_b16 v[222:223], v3 offset:52224
    v_mfma_f32_16x16x32_bf16 v[24:27], v[224:227], v[180:183], v[24:27]
    s_mul_i32 s62, s62, 0xa2000
    v_mfma_f32_16x16x32_bf16 v[32:35], v[224:227], v[184:187], v[32:35]
    buffer_load_dwordx4 v6, s[36:39], s66 offen offset:1024 lds
    v_mfma_f32_16x16x32_bf16 v[32:35], v[228:231], v[200:203], v[32:35]
    v_mfma_f32_16x16x32_bf16 v[40:43], v[228:231], v[204:207], v[40:43]
    buffer_load_dwordx4 v7, s[36:39], s66 offen offset:2048 lds
    v_mfma_f32_16x16x32_bf16 v[40:43], v[224:227], v[188:191], v[40:43]
    s_waitcnt lgkmcnt(4)
    s_sub_u32 s63, 0xa2000, s62
    v_mfma_f32_16x16x32_bf16 v[44:47], v[208:211], v[188:191], v[44:47]
    ds_read_b64_tr_b16 v[224:225], v252 offset:49152
    ds_read_b64_tr_b16 v[226:227], v252 offset:51200
    v_mfma_f32_16x16x32_bf16 v[44:47], v[212:215], v[204:207], v[44:47]
    v_mfma_f32_16x16x32_bf16 v[36:39], v[212:215], v[200:203], v[36:39]
    ds_read_b64_tr_b16 v[228:229], v252 offset:50176
    ds_read_b64_tr_b16 v[230:231], v252 offset:52224
    v_mfma_f32_16x16x32_bf16 v[36:39], v[208:211], v[184:187], v[36:39]
    v_add_u32 v249, s63, v248
    v_mfma_f32_16x16x32_bf16 v[28:31], v[208:211], v[180:183], v[28:31]
    ds_read_b128 v[232:235], v11 offset:512
    ds_read_b128 v[236:239], v11 offset:576
    v_mfma_f32_16x16x32_bf16 v[28:31], v[212:215], v[196:199], v[28:31]
    v_mfma_f32_16x16x32_bf16 v[20:23], v[212:215], v[192:195], v[20:23]
    v_add_u32 v248, s62, v248
    v_mfma_f32_16x16x32_bf16 v[20:23], v[208:211], v[176:179], v[20:23]
    s_waitcnt vmcnt(6) lgkmcnt(6)
    s_barrier
    v_mfma_f32_16x16x32_bf16 v[48:51], v[216:219], v[176:179], v[48:51]
    s_add_u32 m0, s60, 0xc000
    ds_read_b64_tr_b16 v[208:209], v2
    ds_read_b64_tr_b16 v[210:211], v2 offset:6144
    v_mfma_f32_16x16x32_bf16 v[48:51], v[220:223], v[192:195], v[48:51]
    s_add_u32 s66, s98, 0x100
    buffer_load_dwordx4 v5, s[36:39], s66 offen lds
    v_mfma_f32_16x16x32_bf16 v[56:59], v[220:223], v[196:199], v[56:59]
    ds_read_b64_tr_b16 v[212:213], v2 offset:1024
    ds_read_b64_tr_b16 v[214:215], v2 offset:7168
    v_mfma_f32_16x16x32_bf16 v[56:59], v[216:219], v[180:183], v[56:59]
    v_mfma_f32_16x16x32_bf16 v[64:67], v[216:219], v[184:187], v[64:67]
    v_mfma_f32_16x16x32_bf16 v[64:67], v[220:223], v[200:203], v[64:67]
    buffer_load_dwordx4 v6, s[36:39], s66 offen offset:1024 lds
    v_mfma_f32_16x16x32_bf16 v[72:75], v[220:223], v[204:207], v[72:75]
    v_mfma_f32_16x16x32_bf16 v[72:75], v[216:219], v[188:191], v[72:75]
    s_waitcnt lgkmcnt(6)
    v_mfma_f32_16x16x32_bf16 v[76:79], v[224:227], v[188:191], v[76:79]
    ds_read_b64_tr_b16 v[216:217], v4
    ds_read_b64_tr_b16 v[218:219], v4 offset:6144
    v_mfma_f32_16x16x32_bf16 v[76:79], v[228:231], v[204:207], v[76:79]
    buffer_load_dwordx4 v7, s[36:39], s66 offen offset:2048 lds
    v_mfma_f32_16x16x32_bf16 v[68:71], v[228:231], v[200:203], v[68:71]
    ds_read_b64_tr_b16 v[220:221], v4 offset:1024
    ds_read_b64_tr_b16 v[222:223], v4 offset:7168
    v_mfma_f32_16x16x32_bf16 v[68:71], v[224:227], v[184:187], v[68:71]
    v_mfma_f32_16x16x32_bf16 v[60:63], v[224:227], v[180:183], v[60:63]
    s_add_u32 m0, s60, 0xcc00
    v_mfma_f32_16x16x32_bf16 v[60:63], v[228:231], v[196:199], v[60:63]
    s_add_u32 s66, s98, 0xd8100
    buffer_load_dwordx4 v5, s[36:39], s66 offen lds
    v_mfma_f32_16x16x32_bf16 v[52:55], v[228:231], v[192:195], v[52:55]
    v_mfma_f32_16x16x32_bf16 v[52:55], v[224:227], v[176:179], v[52:55]
    s_waitcnt lgkmcnt(4)
    v_mfma_f32_16x16x32_bf16 v[144:147], v[208:211], a[0:3], v[232:235]
    ds_read_b64_tr_b16 v[224:225], v2 offset:2048
    v_add_u32 v3, v13, v3
    v_mfma_f32_16x16x32_bf16 v[144:147], v[212:215], a[16:19], v[144:147]
    buffer_load_dwordx4 v6, s[36:39], s66 offen offset:1024 lds
    v_mfma_f32_16x16x32_bf16 v[152:155], v[212:215], a[20:23], v[232:235]
    ds_read_b64_tr_b16 v[226:227], v2 offset:8192
    v_add_u32 v252, v13, v252
    v_mfma_f32_16x16x32_bf16 v[152:155], v[208:211], a[4:7], v[152:155]
    v_mfma_f32_16x16x32_bf16 v[160:163], v[208:211], a[8:11], v[232:235]
    ds_read_b64_tr_b16 v[228:229], v2 offset:3072
    v_mul_f32 v240, s67, v16
    v_mfma_f32_16x16x32_bf16 v[160:163], v[212:215], a[24:27], v[160:163]
    v_mul_f32 v241, s67, v17
    v_mul_f32 v242, s67, v18
    v_exp_f32 v240, v240
    v_mfma_f32_16x16x32_bf16 v[168:171], v[212:215], a[28:31], v[232:235]
    ds_read_b64_tr_b16 v[230:231], v2 offset:9216
    v_fma_f32 v244, v240, -0.5, -1.0
    v_mfma_f32_16x16x32_bf16 v[168:171], v[208:211], a[12:15], v[168:171]
    s_waitcnt lgkmcnt(4)
    buffer_load_dwordx4 v7, s[36:39], s66 offen offset:2048 lds
    v_mfma_f32_16x16x32_bf16 v[172:175], v[216:219], a[12:15], v[236:239]
    ds_read_b64_tr_b16 v[208:209], v4 offset:2048
    v_mul_f32 v243, s67, v19
    v_mfma_f32_16x16x32_bf16 v[172:175], v[220:223], a[28:31], v[172:175]
    v_exp_f32 v241, v241
    v_exp_f32 v242, v242
    v_fma_f32 v245, v241, -0.5, -1.0
    v_mfma_f32_16x16x32_bf16 v[164:167], v[220:223], a[24:27], v[236:239]
    ds_read_b64_tr_b16 v[210:211], v4 offset:8192
    v_fma_f32 v244, v240, v244, -1.0
    v_mfma_f32_16x16x32_bf16 v[164:167], v[216:219], a[8:11], v[164:167]
    v_mul_f32 v240, s67, v20
    v_fma_f32 v246, v242, -0.5, -1.0
    v_exp_f32 v243, v243
    v_mfma_f32_16x16x32_bf16 v[156:159], v[216:219], a[4:7], v[236:239]
    ds_read_b64_tr_b16 v[212:213], v4 offset:3072
    v_fma_f32 v245, v241, v245, -1.0
    v_mfma_f32_16x16x32_bf16 v[156:159], v[220:223], a[20:23], v[156:159]
    buffer_load_dword v253, v108, s[36:39], s89 offen offset:384
    v_mfma_f32_16x16x32_bf16 v[148:151], v[220:223], a[16:19], v[236:239]
    ds_read_b64_tr_b16 v[214:215], v4 offset:9216
    v_mul_f32 v241, s67, v21
    v_mfma_f32_16x16x32_bf16 v[148:151], v[216:219], a[0:3], v[148:151]
    s_waitcnt lgkmcnt(4)
    v_rcp_f32 v244, v244
    v_exp_f32 v240, v240
    v_fma_f32 v247, v243, -0.5, -1.0
    v_fma_f32 v246, v242, v246, -1.0
    v_mfma_f32_16x16x32_bf16 v[144:147], v[224:227], a[32:35], v[144:147]
    ds_read_b64_tr_b16 v[216:217], v2 offset:4096
    v_fmac_f32 v16, v16, v244
    v_mfma_f32_16x16x32_bf16 v[144:147], v[228:231], a[48:51], v[144:147]
    v_rcp_f32 v245, v245
    v_mul_f32 v242, s67, v22
    v_mfma_f32_16x16x32_bf16 v[152:155], v[228:231], a[52:55], v[152:155]
    ds_read_b64_tr_b16 v[218:219], v2 offset:10240
    v_fma_f32 v244, v240, -0.5, -1.0
    v_mfma_f32_16x16x32_bf16 v[152:155], v[224:227], a[36:39], v[152:155]
    v_exp_f32 v241, v241
    v_fma_f32 v247, v243, v247, -1.0
    v_rcp_f32 v246, v246
    v_mfma_f32_16x16x32_bf16 v[160:163], v[224:227], a[40:43], v[160:163]
    ds_read_b64_tr_b16 v[220:221], v2 offset:5120
    v_fmac_f32 v17, v17, v245
    v_mfma_f32_16x16x32_bf16 v[160:163], v[228:231], a[56:59], v[160:163]
    v_mul_f32 v243, s67, v23
    v_fma_f32 v245, v241, -0.5, -1.0
    v_exp_f32 v242, v242
    v_fma_f32 v244, v240, v244, -1.0
    v_mfma_f32_16x16x32_bf16 v[168:171], v[228:231], a[60:63], v[168:171]
    ds_read_b64_tr_b16 v[222:223], v2 offset:11264
    v_cvt_pk_bf16_f32 v80, v16, v17
    v_mfma_f32_16x16x32_bf16 v[168:171], v[224:227], a[44:47], v[168:171]
    s_waitcnt lgkmcnt(4)
    v_rcp_f32 v247, v247
    v_fmac_f32 v18, v18, v246
    v_mul_f32 v240, s67, v24
    v_mfma_f32_16x16x32_bf16 v[172:175], v[208:211], a[44:47], v[172:175]
    ds_read_b64_tr_b16 v[224:225], v4 offset:4096
    v_fma_f32 v246, v242, -0.5, -1.0
    v_mfma_f32_16x16x32_bf16 v[172:175], v[212:215], a[60:63], v[172:175]
    v_exp_f32 v243, v243
    v_fma_f32 v245, v241, v245, -1.0
    v_mfma_f32_16x16x32_bf16 v[164:167], v[212:215], a[56:59], v[164:167]
    ds_read_b64_tr_b16 v[226:227], v4 offset:10240
    v_fmac_f32 v19, v19, v247
    v_mfma_f32_16x16x32_bf16 v[164:167], v[208:211], a[40:43], v[164:167]
    v_rcp_f32 v244, v244
    v_mul_f32 v241, s67, v25
    v_exp_f32 v240, v240
    v_fma_f32 v247, v243, -0.5, -1.0
    v_mfma_f32_16x16x32_bf16 v[156:159], v[208:211], a[36:39], v[156:159]
    ds_read_b64_tr_b16 v[228:229], v4 offset:5120
    v_fma_f32 v246, v242, v246, -1.0
    v_mfma_f32_16x16x32_bf16 v[156:159], v[212:215], a[52:55], v[156:159]
    v_rcp_f32 v245, v245
    v_cvt_pk_bf16_f32 v81, v18, v19
    v_fmac_f32 v20, v20, v244
    v_mfma_f32_16x16x32_bf16 v[148:151], v[212:215], a[48:51], v[148:151]
    ds_read_b64_tr_b16 v[230:231], v4 offset:11264
    v_mul_f32 v242, s67, v26
    v_mfma_f32_16x16x32_bf16 v[148:151], v[208:211], a[32:35], v[148:151]
    s_waitcnt vmcnt(7) lgkmcnt(4)
    s_barrier
    v_fma_f32 v244, v240, -0.5, -1.0
    v_exp_f32 v241, v241
    v_mfma_f32_16x16x32_bf16 v[144:147], v[216:219], a[64:67], v[144:147]
    s_add_u32 m0, s60, 0x12000
    ds_read_b64_tr_b16 v[208:209], v2 offset:24576
    v_fma_f32 v247, v243, v247, -1.0
    v_mfma_f32_16x16x32_bf16 v[144:147], v[220:223], a[80:83], v[144:147]
    s_add_u32 s66, s96, 0x180
    buffer_load_dwordx4 v5, s[36:39], s66 offen lds
    v_mfma_f32_16x16x32_bf16 v[152:155], v[220:223], a[84:87], v[152:155]
    ds_read_b64_tr_b16 v[210:211], v2 offset:30720
    v_fmac_f32 v21, v21, v245
    v_mfma_f32_16x16x32_bf16 v[152:155], v[216:219], a[68:71], v[152:155]
    v_rcp_f32 v246, v246
    v_mul_f32 v243, s67, v27
    v_exp_f32 v242, v242
    v_mfma_f32_16x16x32_bf16 v[160:163], v[216:219], a[72:75], v[160:163]
    ds_read_b64_tr_b16 v[212:213], v2 offset:25600
    v_fma_f32 v245, v241, -0.5, -1.0
    v_mfma_f32_16x16x32_bf16 v[160:163], v[220:223], a[88:91], v[160:163]
    v_fma_f32 v244, v240, v244, -1.0
    v_cvt_pk_bf16_f32 v82, v20, v21
    v_rcp_f32 v247, v247
    v_mfma_f32_16x16x32_bf16 v[168:171], v[220:223], a[92:95], v[168:171]
    ds_read_b64_tr_b16 v[214:215], v2 offset:31744
    v_fmac_f32 v22, v22, v246
    v_mfma_f32_16x16x32_bf16 v[168:171], v[216:219], a[76:79], v[168:171]
    s_waitcnt lgkmcnt(4)
    buffer_load_dwordx4 v6, s[36:39], s66 offen offset:1024 lds
    v_mul_f32 v240, s67, v28
    v_mfma_f32_16x16x32_bf16 v[172:175], v[224:227], a[76:79], v[172:175]
    ds_read_b64_tr_b16 v[216:217], v4 offset:24576
    v_fma_f32 v246, v242, -0.5, -1.0
    v_mfma_f32_16x16x32_bf16 v[172:175], v[228:231], a[92:95], v[172:175]
    v_exp_f32 v243, v243
    v_fma_f32 v245, v241, v245, -1.0
    v_mfma_f32_16x16x32_bf16 v[164:167], v[228:231], a[88:91], v[164:167]
    ds_read_b64_tr_b16 v[218:219], v4 offset:30720
    v_fmac_f32 v23, v23, v247
    v_mfma_f32_16x16x32_bf16 v[164:167], v[224:227], a[72:75], v[164:167]
    v_rcp_f32 v244, v244
    v_mul_f32 v241, s67, v29
    v_exp_f32 v240, v240
    v_fma_f32 v247, v243, -0.5, -1.0
    v_mfma_f32_16x16x32_bf16 v[156:159], v[224:227], a[68:71], v[156:159]
    ds_read_b64_tr_b16 v[220:221], v4 offset:25600
    v_fma_f32 v246, v242, v246, -1.0
    v_mfma_f32_16x16x32_bf16 v[156:159], v[228:231], a[84:87], v[156:159]
    v_rcp_f32 v245, v245
    v_cvt_pk_bf16_f32 v83, v22, v23
    v_fmac_f32 v24, v24, v244
    v_mfma_f32_16x16x32_bf16 v[148:151], v[228:231], a[80:83], v[148:151]
    ds_read_b64_tr_b16 v[222:223], v4 offset:31744
    v_mul_f32 v242, s67, v30
    v_mfma_f32_16x16x32_bf16 v[148:151], v[224:227], a[64:67], v[148:151]
    s_waitcnt lgkmcnt(4)
    buffer_load_dwordx4 v7, s[36:39], s66 offen offset:2048 lds
    v_mfma_f32_16x16x32_bf16 v[144:147], v[208:211], a[96:99], v[144:147]
    ds_read_b64_tr_b16 v[224:225], v2 offset:26624
    v_fma_f32 v244, v240, -0.5, -1.0
    v_mfma_f32_16x16x32_bf16 v[144:147], v[212:215], a[112:115], v[144:147]
    v_exp_f32 v241, v241
    v_fma_f32 v247, v243, v247, -1.0
    v_rcp_f32 v246, v246
    v_mfma_f32_16x16x32_bf16 v[152:155], v[212:215], a[116:119], v[152:155]
    ds_read_b64_tr_b16 v[226:227], v2 offset:32768
    v_fmac_f32 v25, v25, v245
    v_mfma_f32_16x16x32_bf16 v[152:155], v[208:211], a[100:103], v[152:155]
    v_mul_f32 v243, s67, v31
    v_fma_f32 v245, v241, -0.5, -1.0
    v_exp_f32 v242, v242
    v_fma_f32 v244, v240, v244, -1.0
    v_mfma_f32_16x16x32_bf16 v[160:163], v[208:211], a[104:107], v[160:163]
    ds_read_b64_tr_b16 v[228:229], v2 offset:27648
    v_cvt_pk_bf16_f32 v84, v24, v25
    v_mfma_f32_16x16x32_bf16 v[160:163], v[212:215], a[120:123], v[160:163]
    s_add_u32 m0, s60, 0x12c00
    v_rcp_f32 v247, v247
    v_fmac_f32 v26, v26, v246
    v_mul_f32 v240, s67, v32
    v_mfma_f32_16x16x32_bf16 v[168:171], v[212:215], a[124:127], v[168:171]
    s_add_u32 s66, s96, 0xd8180
    ds_read_b64_tr_b16 v[230:231], v2 offset:33792
    v_fma_f32 v246, v242, -0.5, -1.0
    v_mfma_f32_16x16x32_bf16 v[168:171], v[208:211], a[108:111], v[168:171]
    s_waitcnt lgkmcnt(4)
    buffer_load_dwordx4 v5, s[36:39], s66 offen lds
    v_mfma_f32_16x16x32_bf16 v[172:175], v[216:219], a[108:111], v[172:175]
    ds_read_b64_tr_b16 v[208:209], v4 offset:26624
    v_fma_f32 v245, v241, v245, -1.0
    v_mfma_f32_16x16x32_bf16 v[172:175], v[220:223], a[124:127], v[172:175]
    v_exp_f32 v243, v243
    v_rcp_f32 v244, v244
    v_fmac_f32 v27, v27, v247
    v_mfma_f32_16x16x32_bf16 v[164:167], v[220:223], a[120:123], v[164:167]
    ds_read_b64_tr_b16 v[210:211], v4 offset:32768
    v_mul_f32 v241, s67, v33
    v_mfma_f32_16x16x32_bf16 v[164:167], v[216:219], a[104:107], v[164:167]
    v_exp_f32 v240, v240
    v_fma_f32 v247, v243, -0.5, -1.0
    v_fma_f32 v246, v242, v246, -1.0
    v_mfma_f32_16x16x32_bf16 v[156:159], v[216:219], a[100:103], v[156:159]
    ds_read_b64_tr_b16 v[212:213], v4 offset:27648
    v_cvt_pk_bf16_f32 v85, v26, v27
    v_mfma_f32_16x16x32_bf16 v[156:159], v[220:223], a[116:119], v[156:159]
    v_rcp_f32 v245, v245
    v_fmac_f32 v28, v28, v244
    v_mul_f32 v242, s67, v34
    v_mfma_f32_16x16x32_bf16 v[148:151], v[220:223], a[112:115], v[148:151]
    ds_read_b64_tr_b16 v[214:215], v4 offset:33792
    v_fma_f32 v244, v240, -0.5, -1.0
    v_mfma_f32_16x16x32_bf16 v[148:151], v[216:219], a[96:99], v[148:151]
    s_waitcnt lgkmcnt(4)
    buffer_load_dwordx4 v6, s[36:39], s66 offen offset:1024 lds
    v_exp_f32 v241, v241
    v_mfma_f32_16x16x32_bf16 v[144:147], v[224:227], a[128:131], v[144:147]
    ds_read_b64_tr_b16 v[216:217], v2 offset:28672
    v_fma_f32 v247, v243, v247, -1.0
    v_mfma_f32_16x16x32_bf16 v[144:147], v[228:231], a[144:147], v[144:147]
    v_rcp_f32 v246, v246
    v_fmac_f32 v29, v29, v245
    v_mul_f32 v243, s67, v35
    v_mfma_f32_16x16x32_bf16 v[152:155], v[228:231], a[148:151], v[152:155]
    ds_read_b64_tr_b16 v[218:219], v2 offset:34816
    v_fma_f32 v245, v241, -0.5, -1.0
    v_mfma_f32_16x16x32_bf16 v[152:155], v[224:227], a[132:135], v[152:155]
    v_exp_f32 v242, v242
    v_fma_f32 v244, v240, v244, -1.0
    v_mfma_f32_16x16x32_bf16 v[160:163], v[224:227], a[136:139], v[160:163]
    ds_read_b64_tr_b16 v[220:221], v2 offset:29696
    v_cvt_pk_bf16_f32 v86, v28, v29
    v_mfma_f32_16x16x32_bf16 v[160:163], v[228:231], a[152:155], v[160:163]
    v_rcp_f32 v247, v247
    v_fmac_f32 v30, v30, v246
    v_mul_f32 v240, s67, v36
    v_exp_f32 v243, v243
    v_mfma_f32_16x16x32_bf16 v[168:171], v[228:231], a[156:159], v[168:171]
    ds_read_b64_tr_b16 v[222:223], v2 offset:35840
    v_fma_f32 v246, v242, -0.5, -1.0
    v_mfma_f32_16x16x32_bf16 v[168:171], v[224:227], a[140:143], v[168:171]
    s_waitcnt lgkmcnt(4)
    buffer_load_dwordx4 v7, s[36:39], s66 offen offset:2048 lds
    v_fma_f32 v245, v241, v245, -1.0
    v_mfma_f32_16x16x32_bf16 v[172:175], v[208:211], a[140:143], v[172:175]
    ds_read_b64_tr_b16 v[224:225], v4 offset:28672
    v_fmac_f32 v31, v31, v247
    v_mfma_f32_16x16x32_bf16 v[172:175], v[212:215], a[156:159], v[172:175]
    v_rcp_f32 v244, v244
    v_mul_f32 v241, s67, v37
    v_mfma_f32_16x16x32_bf16 v[164:167], v[212:215], a[152:155], v[164:167]
    ds_read_b64_tr_b16 v[226:227], v4 offset:34816
    v_fma_f32 v247, v243, -0.5, -1.0
    v_mfma_f32_16x16x32_bf16 v[164:167], v[208:211], a[136:139], v[164:167]
    v_exp_f32 v240, v240
    v_fma_f32 v246, v242, v246, -1.0
    v_rcp_f32 v245, v245
    v_mfma_f32_16x16x32_bf16 v[156:159], v[208:211], a[132:135], v[156:159]
    ds_read_b64_tr_b16 v[228:229], v4 offset:29696
    v_cvt_pk_bf16_f32 v87, v30, v31
    v_mfma_f32_16x16x32_bf16 v[156:159], v[212:215], a[148:151], v[156:159]
    v_fmac_f32 v32, v32, v244
    v_mul_f32 v242, s67, v38
    v_exp_f32 v241, v241
    v_fma_f32 v244, v240, -0.5, -1.0
    v_mfma_f32_16x16x32_bf16 v[148:151], v[212:215], a[144:147], v[148:151]
    ds_read_b64_tr_b16 v[230:231], v4 offset:35840
    v_fma_f32 v247, v243, v247, -1.0
    v_mfma_f32_16x16x32_bf16 v[148:151], v[208:211], a[128:131], v[148:151]
    s_waitcnt vmcnt(7) lgkmcnt(4)
    s_barrier
    v_fmac_f32 v33, v33, v245
    v_mfma_f32_16x16x32_bf16 v[144:147], v[216:219], a[160:163], v[144:147]
    s_add_u32 m0, s60, 0x18000
    ds_read_b64_tr_b16 v[208:209], v2 offset:49152
    v_mul_f32 v243, s67, v39
    v_mfma_f32_16x16x32_bf16 v[144:147], v[220:223], a[176:179], v[144:147]
    s_add_u32 s66, s97, 0x180
    buffer_load_dwordx4 v5, s[36:39], s66 offen lds
    v_rcp_f32 v246, v246
    v_mfma_f32_16x16x32_bf16 v[152:155], v[220:223], a[180:183], v[152:155]
    ds_read_b64_tr_b16 v[210:211], v2 offset:55296
    v_fma_f32 v245, v241, -0.5, -1.0
    v_mfma_f32_16x16x32_bf16 v[152:155], v[216:219], a[164:167], v[152:155]
    buffer_load_dwordx4 v6, s[36:39], s66 offen offset:1024 lds
    v_mfma_f32_16x16x32_bf16 v[160:163], v[216:219], a[168:171], v[160:163]
    ds_read_b64_tr_b16 v[212:213], v2 offset:50176
    v_fma_f32 v244, v240, v244, -1.0
    v_mfma_f32_16x16x32_bf16 v[160:163], v[220:223], a[184:187], v[160:163]
    v_exp_f32 v242, v242
    v_rcp_f32 v247, v247
    v_cvt_pk_bf16_f32 v88, v32, v33
    v_mfma_f32_16x16x32_bf16 v[168:171], v[220:223], a[188:191], v[168:171]
    ds_read_b64_tr_b16 v[214:215], v2 offset:56320
    v_fmac_f32 v34, v34, v246
    v_mfma_f32_16x16x32_bf16 v[168:171], v[216:219], a[172:175], v[168:171]
    s_waitcnt lgkmcnt(4)
    buffer_load_dwordx4 v7, s[36:39], s66 offen offset:2048 lds
    v_mul_f32 v240, s67, v40
    v_mfma_f32_16x16x32_bf16 v[172:175], v[224:227], a[172:175], v[172:175]
    ds_read_b64_tr_b16 v[216:217], v4 offset:49152
    v_fma_f32 v246, v242, -0.5, -1.0
    v_mfma_f32_16x16x32_bf16 v[172:175], v[228:231], a[188:191], v[172:175]
    v_exp_f32 v243, v243
    v_fma_f32 v245, v241, v245, -1.0
    v_mfma_f32_16x16x32_bf16 v[164:167], v[228:231], a[184:187], v[164:167]
    s_add_u32 m0, s60, 0x18c00
    ds_read_b64_tr_b16 v[218:219], v4 offset:55296
    v_fmac_f32 v35, v35, v247
    v_mfma_f32_16x16x32_bf16 v[164:167], v[224:227], a[168:171], v[164:167]
    s_add_u32 s66, s97, 0xd8180
    buffer_load_dwordx4 v5, s[36:39], s66 offen lds
    v_rcp_f32 v244, v244
    v_mfma_f32_16x16x32_bf16 v[156:159], v[224:227], a[164:167], v[156:159]
    ds_read_b64_tr_b16 v[220:221], v4 offset:50176
    v_mul_f32 v241, s67, v41
    v_mfma_f32_16x16x32_bf16 v[156:159], v[228:231], a[180:183], v[156:159]
    v_exp_f32 v240, v240
    v_fma_f32 v247, v243, -0.5, -1.0
    v_fma_f32 v246, v242, v246, -1.0
    v_mfma_f32_16x16x32_bf16 v[148:151], v[228:231], a[176:179], v[148:151]
    ds_read_b64_tr_b16 v[222:223], v4 offset:56320
    v_cvt_pk_bf16_f32 v89, v34, v35
    v_mfma_f32_16x16x32_bf16 v[148:151], v[224:227], a[160:163], v[148:151]
    s_waitcnt lgkmcnt(4)
    buffer_load_dwordx4 v6, s[36:39], s66 offen offset:1024 lds
    v_mfma_f32_16x16x32_bf16 v[144:147], v[208:211], a[192:195], v[144:147]
    ds_read_b64_tr_b16 v[224:225], v2 offset:51200
    v_fmac_f32 v36, v36, v244
    v_mfma_f32_16x16x32_bf16 v[144:147], v[212:215], a[208:211], v[144:147]
    v_rcp_f32 v245, v245
    v_mul_f32 v242, s67, v42
    v_exp_f32 v241, v241
    v_fma_f32 v244, v240, -0.5, -1.0
    v_mfma_f32_16x16x32_bf16 v[152:155], v[212:215], a[212:215], v[152:155]
    ds_read_b64_tr_b16 v[226:227], v2 offset:57344
    v_fma_f32 v247, v243, v247, -1.0
    v_mfma_f32_16x16x32_bf16 v[152:155], v[208:211], a[196:199], v[152:155]
    buffer_load_dwordx4 v7, s[36:39], s66 offen offset:2048 lds
    v_mfma_f32_16x16x32_bf16 v[160:163], v[208:211], a[200:203], v[160:163]
    ds_read_b64_tr_b16 v[228:229], v2 offset:52224
    v_fmac_f32 v37, v37, v245
    v_mfma_f32_16x16x32_bf16 v[160:163], v[212:215], a[216:219], v[160:163]
L_pad_f1:
    s_cbranch_execz L_pad_f5
    s_add_u32 m0, s60, 0x1e000
    v_rcp_f32 v246, v246
    v_mul_f32 v243, s67, v43
    v_exp_f32 v242, v242
    v_mfma_f32_16x16x32_bf16 v[168:171], v[212:215], a[220:223], v[168:171]
    s_add_u32 s66, s98, 0x180
    ds_read_b64_tr_b16 v[230:231], v2 offset:58368
    v_fma_f32 v245, v241, -0.5, -1.0
    v_mfma_f32_16x16x32_bf16 v[168:171], v[208:211], a[204:207], v[168:171]
    s_waitcnt lgkmcnt(4)
    buffer_load_dwordx4 v5, s[36:39], s66 offen lds
    v_fma_f32 v244, v240, v244, -1.0
    v_mfma_f32_16x16x32_bf16 v[172:175], v[216:219], a[204:207], v[172:175]
    ds_read_b64_tr_b16 v[208:209], v4 offset:51200
    v_cvt_pk_bf16_f32 v90, v36, v37
    v_mfma_f32_16x16x32_bf16 v[172:175], v[220:223], a[220:223], v[172:175]
    v_rcp_f32 v247, v247
    v_fmac_f32 v38, v38, v246
    v_mul_f32 v240, s67, v44
    v_mfma_f32_16x16x32_bf16 v[164:167], v[220:223], a[216:219], v[164:167]
    ds_read_b64_tr_b16 v[210:211], v4 offset:57344
    v_fma_f32 v246, v242, -0.5, -1.0
    v_mfma_f32_16x16x32_bf16 v[164:167], v[216:219], a[200:203], v[164:167]
    buffer_load_dwordx4 v6, s[36:39], s66 offen offset:1024 lds
    v_mfma_f32_16x16x32_bf16 v[156:159], v[216:219], a[196:199], v[156:159]
    ds_read_b64_tr_b16 v[212:213], v4 offset:52224
    v_fma_f32 v245, v241, v245, -1.0
    v_mfma_f32_16x16x32_bf16 v[156:159], v[220:223], a[212:215], v[156:159]
    v_exp_f32 v243, v243
    v_rcp_f32 v244, v244
    v_fmac_f32 v39, v39, v247
    v_mfma_f32_16x16x32_bf16 v[148:151], v[220:223], a[208:211], v[148:151]
    ds_read_b64_tr_b16 v[214:215], v4 offset:58368
    v_mul_f32 v241, s67, v45
    v_mfma_f32_16x16x32_bf16 v[148:151], v[216:219], a[192:195], v[148:151]
    s_waitcnt lgkmcnt(4)
    buffer_load_dwordx4 v7, s[36:39], s66 offen offset:2048 lds
    v_mfma_f32_16x16x32_bf16 v[144:147], v[224:227], a[224:227], v[144:147]
    ds_read_b64_tr_b16 v[216:217], v2 offset:53248
    v_fma_f32 v247, v243, -0.5, -1.0
    v_mfma_f32_16x16x32_bf16 v[144:147], v[228:231], a[240:243], v[144:147]
    v_exp_f32 v240, v240
    v_fma_f32 v246, v242, v246, -1.0
    v_rcp_f32 v245, v245
    v_mfma_f32_16x16x32_bf16 v[152:155], v[228:231], a[244:247], v[152:155]
    s_add_u32 m0, s60, 0x1ec00
    ds_read_b64_tr_b16 v[218:219], v2 offset:59392
    v_cvt_pk_bf16_f32 v91, v38, v39
    v_mfma_f32_16x16x32_bf16 v[152:155], v[224:227], a[228:231], v[152:155]
    s_add_u32 s66, s98, 0xd8180
    buffer_load_dwordx4 v5, s[36:39], s66 offen lds
    v_fmac_f32 v40, v40, v244
    v_mfma_f32_16x16x32_bf16 v[160:163], v[224:227], a[232:235], v[160:163]
    ds_read_b64_tr_b16 v[220:221], v2 offset:54272
    v_mul_f32 v242, s67, v46
    v_mfma_f32_16x16x32_bf16 v[160:163], v[228:231], a[248:251], v[160:163]
    v_exp_f32 v241, v241
    v_fma_f32 v244, v240, -0.5, -1.0
    v_fma_f32 v247, v243, v247, -1.0
    v_mfma_f32_16x16x32_bf16 v[168:171], v[228:231], a[252:255], v[168:171]
    ds_read_b64_tr_b16 v[222:223], v2 offset:60416
    v_fmac_f32 v41, v41, v245
    v_mfma_f32_16x16x32_bf16 v[168:171], v[224:227], a[236:239], v[168:171]
    s_waitcnt lgkmcnt(4)
    buffer_load_dwordx4 v6, s[36:39], s66 offen offset:1024 lds
    v_mfma_f32_16x16x32_bf16 v[172:175], v[208:211], a[236:239], v[172:175]
    ds_read_b64_tr_b16 v[224:225], v4 offset:53248
    v_mul_f32 v243, s67, v47
    v_mfma_f32_16x16x32_bf16 v[172:175], v[212:215], a[252:255], v[172:175]
    ds_read_b128 v[232:235], v11 offset:768
    ds_read_b128 v[236:239], v11 offset:832
    v_rcp_f32 v246, v246
    v_mfma_f32_16x16x32_bf16 v[164:167], v[212:215], a[248:251], v[164:167]
    ds_read_b64_tr_b16 v[226:227], v4 offset:59392
    v_fma_f32 v245, v241, -0.5, -1.0
    v_mfma_f32_16x16x32_bf16 v[164:167], v[208:211], a[232:235], v[164:167]
    buffer_load_dwordx4 v7, s[36:39], s66 offen offset:2048 lds
    v_mfma_f32_16x16x32_bf16 v[156:159], v[208:211], a[228:231], v[156:159]
    ds_read_b64_tr_b16 v[228:229], v4 offset:54272
    v_fma_f32 v244, v240, v244, -1.0
    v_mfma_f32_16x16x32_bf16 v[156:159], v[212:215], a[244:247], v[156:159]
    v_exp_f32 v242, v242
    v_rcp_f32 v247, v247
    v_cvt_pk_bf16_f32 v92, v40, v41
    v_mfma_f32_16x16x32_bf16 v[148:151], v[212:215], a[240:243], v[148:151]
    ds_read_b64_tr_b16 v[230:231], v4 offset:60416
    v_fmac_f32 v42, v42, v246
    v_mfma_f32_16x16x32_bf16 v[148:151], v[208:211], a[224:227], v[148:151]
    s_waitcnt vmcnt(12) lgkmcnt(6)
    s_barrier
    v_fma_f32 v246, v242, -0.5, -1.0
    v_exp_f32 v243, v243
    v_mfma_f32_16x16x32_bf16 v[144:147], v[216:219], v[176:179], v[144:147]
    s_add_u32 m0, s60, 0
    ds_read_b64_tr_b16 v[208:209], v3
    v_fma_f32 v245, v241, v245, -1.0
    v_mfma_f32_16x16x32_bf16 v[144:147], v[220:223], v[192:195], v[144:147]
    s_add_u32 s66, s96, 0x200
    buffer_load_dwordx4 v5, s[36:39], s66 offen lds
    v_mfma_f32_16x16x32_bf16 v[152:155], v[220:223], v[196:199], v[152:155]
    ds_read_b64_tr_b16 v[210:211], v3 offset:6144
    v_fmac_f32 v43, v43, v247
    v_mfma_f32_16x16x32_bf16 v[152:155], v[216:219], v[180:183], v[152:155]
    buffer_load_dwordx4 v6, s[36:39], s66 offen offset:1024 lds
    v_mfma_f32_16x16x32_bf16 v[160:163], v[216:219], v[184:187], v[160:163]
    ds_read_b64_tr_b16 v[212:213], v3 offset:1024
    v_fma_f32 v247, v243, -0.5, -1.0
    v_mfma_f32_16x16x32_bf16 v[160:163], v[220:223], v[200:203], v[160:163]
    v_rcp_f32 v244, v244
    v_fma_f32 v246, v242, v246, -1.0
    v_rcp_f32 v245, v245
    v_cvt_pk_bf16_f32 v93, v42, v43
    v_mfma_f32_16x16x32_bf16 v[168:171], v[220:223], v[204:207], v[168:171]
    ds_read_b64_tr_b16 v[214:215], v3 offset:7168
    v_fmac_f32 v44, v44, v244
    v_mfma_f32_16x16x32_bf16 v[168:171], v[216:219], v[188:191], v[168:171]
    s_waitcnt lgkmcnt(4)
    buffer_load_dwordx4 v7, s[36:39], s66 offen offset:2048 lds
    v_fma_f32 v247, v243, v247, -1.0
    v_mfma_f32_16x16x32_bf16 v[172:175], v[224:227], v[188:191], v[172:175]
    s_add_u32 m0, s60, 0xc00
    ds_read_b64_tr_b16 v[216:217], v252
    v_fmac_f32 v45, v45, v245
    v_mfma_f32_16x16x32_bf16 v[172:175], v[228:231], v[204:207], v[172:175]
    s_add_u32 s66, s96, 0xd8200
    buffer_load_dwordx4 v5, s[36:39], s66 offen lds
    v_mfma_f32_16x16x32_bf16 v[164:167], v[228:231], v[200:203], v[164:167]
    ds_read_b64_tr_b16 v[218:219], v252 offset:6144
    v_cvt_pk_bf16_f32 v94, v44, v45
    v_mfma_f32_16x16x32_bf16 v[164:167], v[224:227], v[184:187], v[164:167]
    v_rcp_f32 v246, v246
    v_rcp_f32 v247, v247
    v_fmac_f32 v46, v46, v246
    v_mfma_f32_16x16x32_bf16 v[156:159], v[224:227], v[180:183], v[156:159]
    ds_read_b64_tr_b16 v[220:221], v252 offset:1024
    v_fmac_f32 v47, v47, v247
    v_mfma_f32_16x16x32_bf16 v[156:159], v[228:231], v[196:199], v[156:159]
    buffer_load_dwordx4 v6, s[36:39], s66 offen offset:1024 lds
    v_cvt_pk_bf16_f32 v95, v46, v47
    v_mfma_f32_16x16x32_bf16 v[148:151], v[228:231], v[192:195], v[148:151]
    ds_read_b64_tr_b16 v[222:223], v252 offset:7168
    v_mfma_f32_16x16x32_bf16 v[148:151], v[224:227], v[176:179], v[148:151]
    s_waitcnt lgkmcnt(4)
    buffer_load_dwordx4 v7, s[36:39], s66 offen offset:2048 lds
    v_mfma_f32_16x16x32_bf16 v[16:19], v[208:211], a[0:3], v[232:235]
    ds_read_b64_tr_b16 v[224:225], v3 offset:2048
    v_mul_f32 v240, s67, v48
    v_mfma_f32_16x16x32_bf16 v[16:19], v[212:215], a[16:19], v[16:19]
    v_mul_f32 v241, s67, v49
    v_mul_f32 v242, s67, v50
    v_mfma_f32_16x16x32_bf16 v[24:27], v[212:215], a[20:23], v[232:235]
    ds_read_b64_tr_b16 v[226:227], v3 offset:8192
    v_mul_f32 v243, s67, v51
    v_mfma_f32_16x16x32_bf16 v[24:27], v[208:211], a[4:7], v[24:27]
    s_add_u32 s65, s68, 0
    buffer_store_dwordx4 v[80:83], v1, s[48:51], s65 offen sc1
    v_exp_f32 v240, v240
    v_mfma_f32_16x16x32_bf16 v[32:35], v[208:211], a[8:11], v[232:235]
    s_add_u32 m0, s60, 0x6000
    ds_read_b64_tr_b16 v[228:229], v3 offset:3072
    v_fma_f32 v244, v240, -0.5, -1.0
    v_mfma_f32_16x16x32_bf16 v[32:35], v[212:215], a[24:27], v[32:35]
    s_add_u32 s66, s97, 0x200
    buffer_load_dwordx4 v5, s[36:39], s66 offen lds
    v_mfma_f32_16x16x32_bf16 v[40:43], v[212:215], a[28:31], v[232:235]
    ds_read_b64_tr_b16 v[230:231], v3 offset:9216
    v_fma_f32 v244, v240, v244, -1.0
    v_mfma_f32_16x16x32_bf16 v[40:43], v[208:211], a[12:15], v[40:43]
    s_waitcnt lgkmcnt(4)
    v_exp_f32 v241, v241
    v_exp_f32 v242, v242
    v_mfma_f32_16x16x32_bf16 v[44:47], v[216:219], a[12:15], v[236:239]
    ds_read_b64_tr_b16 v[208:209], v252 offset:2048
    v_fma_f32 v245, v241, -0.5, -1.0
    v_mfma_f32_16x16x32_bf16 v[44:47], v[220:223], a[28:31], v[44:47]
    buffer_load_dwordx4 v6, s[36:39], s66 offen offset:1024 lds
    v_mul_f32 v240, s67, v52
    v_mfma_f32_16x16x32_bf16 v[36:39], v[220:223], a[24:27], v[236:239]
    ds_read_b64_tr_b16 v[210:211], v252 offset:8192
    v_fma_f32 v246, v242, -0.5, -1.0
    v_mfma_f32_16x16x32_bf16 v[36:39], v[216:219], a[8:11], v[36:39]
    buffer_store_dwordx4 v[84:87], v1, s[48:51], s65 offen offset:1024 sc1
    v_mfma_f32_16x16x32_bf16 v[28:31], v[216:219], a[4:7], v[236:239]
    ds_read_b64_tr_b16 v[212:213], v252 offset:3072
    v_fma_f32 v245, v241, v245, -1.0
    v_mfma_f32_16x16x32_bf16 v[28:31], v[220:223], a[20:23], v[28:31]
    buffer_load_dwordx4 v7, s[36:39], s66 offen offset:2048 lds
    v_mfma_f32_16x16x32_bf16 v[20:23], v[220:223], a[16:19], v[236:239]
    ds_read_b64_tr_b16 v[214:215], v252 offset:9216
    v_mul_f32 v241, s67, v53
    v_mfma_f32_16x16x32_bf16 v[20:23], v[216:219], a[0:3], v[20:23]
    s_waitcnt lgkmcnt(4)
    v_exp_f32 v243, v243
    v_rcp_f32 v244, v244
    v_mfma_f32_16x16x32_bf16 v[16:19], v[224:227], a[32:35], v[16:19]
    s_add_u32 m0, s60, 0x6c00
    ds_read_b64_tr_b16 v[216:217], v3 offset:4096
    v_fma_f32 v247, v243, -0.5, -1.0
    v_mfma_f32_16x16x32_bf16 v[16:19], v[228:231], a[48:51], v[16:19]
    s_add_u32 s66, s97, 0xd8200
    buffer_load_dwordx4 v5, s[36:39], s66 offen lds
    v_mfma_f32_16x16x32_bf16 v[24:27], v[228:231], a[52:55], v[24:27]
    ds_read_b64_tr_b16 v[218:219], v3 offset:10240
    v_fma_f32 v246, v242, v246, -1.0
    v_mfma_f32_16x16x32_bf16 v[24:27], v[224:227], a[36:39], v[24:27]
    buffer_store_dwordx4 v[88:91], v1, s[48:51], s65 offen offset:2048 sc1
    v_exp_f32 v240, v240
    v_mfma_f32_16x16x32_bf16 v[32:35], v[224:227], a[40:43], v[32:35]
    ds_read_b64_tr_b16 v[220:221], v3 offset:5120
    v_fmac_f32 v48, v48, v244
    v_mfma_f32_16x16x32_bf16 v[32:35], v[228:231], a[56:59], v[32:35]
    buffer_load_dwordx4 v6, s[36:39], s66 offen offset:1024 lds
    v_mfma_f32_16x16x32_bf16 v[40:43], v[228:231], a[60:63], v[40:43]
    ds_read_b64_tr_b16 v[222:223], v3 offset:11264
    v_mul_f32 v242, s67, v54
    v_mfma_f32_16x16x32_bf16 v[40:43], v[224:227], a[44:47], v[40:43]
    s_waitcnt lgkmcnt(4)
    v_rcp_f32 v245, v245
    v_exp_f32 v241, v241
    v_mfma_f32_16x16x32_bf16 v[44:47], v[208:211], a[44:47], v[44:47]
    ds_read_b64_tr_b16 v[224:225], v252 offset:4096
    v_fma_f32 v244, v240, -0.5, -1.0
    v_mfma_f32_16x16x32_bf16 v[44:47], v[212:215], a[60:63], v[44:47]
    buffer_load_dwordx4 v7, s[36:39], s66 offen offset:2048 lds
    v_mfma_f32_16x16x32_bf16 v[36:39], v[212:215], a[56:59], v[36:39]
    ds_read_b64_tr_b16 v[226:227], v252 offset:10240
    v_fma_f32 v247, v243, v247, -1.0
    v_mfma_f32_16x16x32_bf16 v[36:39], v[208:211], a[40:43], v[36:39]
    buffer_store_dwordx4 v[92:95], v1, s[48:51], s65 offen offset:3072 sc1
    v_mfma_f32_16x16x32_bf16 v[28:31], v[208:211], a[36:39], v[28:31]
    ds_read_b64_tr_b16 v[228:229], v252 offset:5120
    v_fmac_f32 v49, v49, v245
    v_mfma_f32_16x16x32_bf16 v[28:31], v[212:215], a[52:55], v[28:31]
    v_rcp_f32 v246, v246
    v_mul_f32 v243, s67, v55
    v_exp_f32 v242, v242
    v_mfma_f32_16x16x32_bf16 v[20:23], v[212:215], a[48:51], v[20:23]
    ds_read_b64_tr_b16 v[230:231], v252 offset:11264
    v_fma_f32 v245, v241, -0.5, -1.0
    v_mfma_f32_16x16x32_bf16 v[20:23], v[208:211], a[32:35], v[20:23]
    s_waitcnt vmcnt(22) lgkmcnt(4)
    s_barrier
    v_fma_f32 v244, v240, v244, -1.0
    v_mfma_f32_16x16x32_bf16 v[16:19], v[216:219], a[64:67], v[16:19]
    s_add_u32 m0, s60, 0xc000
    ds_read_b64_tr_b16 v[208:209], v3 offset:24576
    v_cvt_pk_bf16_f32 v96, v48, v49
    v_mfma_f32_16x16x32_bf16 v[16:19], v[220:223], a[80:83], v[16:19]
    s_add_u32 s66, s98, 0x200
    buffer_load_dwordx4 v5, s[36:39], s66 offen lds
    v_mfma_f32_16x16x32_bf16 v[24:27], v[220:223], a[84:87], v[24:27]
    ds_read_b64_tr_b16 v[210:211], v3 offset:30720
    v_fmac_f32 v50, v50, v246
    v_mfma_f32_16x16x32_bf16 v[24:27], v[216:219], a[68:71], v[24:27]
    v_rcp_f32 v247, v247
    v_mul_f32 v240, s67, v56
    v_exp_f32 v243, v243
    v_mfma_f32_16x16x32_bf16 v[32:35], v[216:219], a[72:75], v[32:35]
    ds_read_b64_tr_b16 v[212:213], v3 offset:25600
    v_fma_f32 v246, v242, -0.5, -1.0
    v_mfma_f32_16x16x32_bf16 v[32:35], v[220:223], a[88:91], v[32:35]
    v_fma_f32 v245, v241, v245, -1.0
    v_fmac_f32 v51, v51, v247
    v_rcp_f32 v244, v244
    v_mfma_f32_16x16x32_bf16 v[40:43], v[220:223], a[92:95], v[40:43]
    ds_read_b64_tr_b16 v[214:215], v3 offset:31744
    v_mul_f32 v241, s67, v57
    v_mfma_f32_16x16x32_bf16 v[40:43], v[216:219], a[76:79], v[40:43]
    s_waitcnt lgkmcnt(4)
    buffer_load_dwordx4 v6, s[36:39], s66 offen offset:1024 lds
    v_mfma_f32_16x16x32_bf16 v[44:47], v[224:227], a[76:79], v[44:47]
    ds_read_b64_tr_b16 v[216:217], v252 offset:24576
    v_fma_f32 v247, v243, -0.5, -1.0
    v_mfma_f32_16x16x32_bf16 v[44:47], v[228:231], a[92:95], v[44:47]
    v_exp_f32 v240, v240
    v_fma_f32 v246, v242, v246, -1.0
    v_mfma_f32_16x16x32_bf16 v[36:39], v[228:231], a[88:91], v[36:39]
    ds_read_b64_tr_b16 v[218:219], v252 offset:30720
    v_cvt_pk_bf16_f32 v97, v50, v51
    v_mfma_f32_16x16x32_bf16 v[36:39], v[224:227], a[72:75], v[36:39]
    v_rcp_f32 v245, v245
    v_fmac_f32 v52, v52, v244
    v_mul_f32 v242, s67, v58
    v_mfma_f32_16x16x32_bf16 v[28:31], v[224:227], a[68:71], v[28:31]
    ds_read_b64_tr_b16 v[220:221], v252 offset:25600
    v_fma_f32 v244, v240, -0.5, -1.0
    v_mfma_f32_16x16x32_bf16 v[28:31], v[228:231], a[84:87], v[28:31]
    v_exp_f32 v241, v241
    v_fma_f32 v247, v243, v247, -1.0
    v_mfma_f32_16x16x32_bf16 v[20:23], v[228:231], a[80:83], v[20:23]
    ds_read_b64_tr_b16 v[222:223], v252 offset:31744
    v_fmac_f32 v53, v53, v245
    v_mfma_f32_16x16x32_bf16 v[20:23], v[224:227], a[64:67], v[20:23]
    s_waitcnt lgkmcnt(4)
    buffer_load_dwordx4 v7, s[36:39], s66 offen offset:2048 lds
    v_rcp_f32 v246, v246
    v_mfma_f32_16x16x32_bf16 v[16:19], v[208:211], a[96:99], v[16:19]
    ds_read_b64_tr_b16 v[224:225], v3 offset:26624
    v_mul_f32 v243, s67, v59
    v_mfma_f32_16x16x32_bf16 v[16:19], v[212:215], a[112:115], v[16:19]
    v_exp_f32 v242, v242
    v_fma_f32 v245, v241, -0.5, -1.0
    v_fma_f32 v244, v240, v244, -1.0
    v_mfma_f32_16x16x32_bf16 v[24:27], v[212:215], a[116:119], v[24:27]
    ds_read_b64_tr_b16 v[226:227], v3 offset:32768
    v_cvt_pk_bf16_f32 v98, v52, v53
    v_mfma_f32_16x16x32_bf16 v[24:27], v[208:211], a[100:103], v[24:27]
    v_rcp_f32 v247, v247
    v_fmac_f32 v54, v54, v246
    v_mfma_f32_16x16x32_bf16 v[32:35], v[208:211], a[104:107], v[32:35]
    ds_read_b64_tr_b16 v[228:229], v3 offset:27648
    v_mul_f32 v240, s67, v60
    v_mfma_f32_16x16x32_bf16 v[32:35], v[212:215], a[120:123], v[32:35]
    s_add_u32 m0, s60, 0xcc00
    v_exp_f32 v243, v243
    v_fma_f32 v246, v242, -0.5, -1.0
    v_fma_f32 v245, v241, v245, -1.0
    v_mfma_f32_16x16x32_bf16 v[40:43], v[212:215], a[124:127], v[40:43]
    s_add_u32 s66, s98, 0xd8200
    ds_read_b64_tr_b16 v[230:231], v3 offset:33792
    v_fmac_f32 v55, v55, v247
    v_mfma_f32_16x16x32_bf16 v[40:43], v[208:211], a[108:111], v[40:43]
    s_waitcnt lgkmcnt(4)
    buffer_load_dwordx4 v5, s[36:39], s66 offen lds
    v_mfma_f32_16x16x32_bf16 v[44:47], v[216:219], a[108:111], v[44:47]
    ds_read_b64_tr_b16 v[208:209], v252 offset:26624
    v_mul_f32 v241, s67, v61
    v_mfma_f32_16x16x32_bf16 v[44:47], v[220:223], a[124:127], v[44:47]
    v_rcp_f32 v244, v244
    v_exp_f32 v240, v240
    v_mfma_f32_16x16x32_bf16 v[36:39], v[220:223], a[120:123], v[36:39]
    ds_read_b64_tr_b16 v[210:211], v252 offset:32768
    v_fma_f32 v247, v243, -0.5, -1.0
    v_mfma_f32_16x16x32_bf16 v[36:39], v[216:219], a[104:107], v[36:39]
    v_fma_f32 v246, v242, v246, -1.0
    v_cvt_pk_bf16_f32 v99, v54, v55
    v_rcp_f32 v245, v245
    v_mfma_f32_16x16x32_bf16 v[28:31], v[216:219], a[100:103], v[28:31]
    ds_read_b64_tr_b16 v[212:213], v252 offset:27648
    v_fmac_f32 v56, v56, v244
    v_mfma_f32_16x16x32_bf16 v[28:31], v[220:223], a[116:119], v[28:31]
    v_mul_f32 v242, s67, v62
    v_fma_f32 v244, v240, -0.5, -1.0
    v_exp_f32 v241, v241
    v_mfma_f32_16x16x32_bf16 v[20:23], v[220:223], a[112:115], v[20:23]
    ds_read_b64_tr_b16 v[214:215], v252 offset:33792
    v_fma_f32 v247, v243, v247, -1.0
    v_mfma_f32_16x16x32_bf16 v[20:23], v[216:219], a[96:99], v[20:23]
    s_waitcnt lgkmcnt(4)
    buffer_load_dwordx4 v6, s[36:39], s66 offen offset:1024 lds
    v_mfma_f32_16x16x32_bf16 v[16:19], v[224:227], a[128:131], v[16:19]
    ds_read_b64_tr_b16 v[216:217], v3 offset:28672
    v_fmac_f32 v57, v57, v245
    v_mfma_f32_16x16x32_bf16 v[16:19], v[228:231], a[144:147], v[16:19]
    v_rcp_f32 v246, v246
    v_mul_f32 v243, s67, v63
    v_mfma_f32_16x16x32_bf16 v[24:27], v[228:231], a[148:151], v[24:27]
    ds_read_b64_tr_b16 v[218:219], v3 offset:34816
    v_fma_f32 v245, v241, -0.5, -1.0
    v_mfma_f32_16x16x32_bf16 v[24:27], v[224:227], a[132:135], v[24:27]
    v_exp_f32 v242, v242
    v_fma_f32 v244, v240, v244, -1.0
    v_mfma_f32_16x16x32_bf16 v[32:35], v[224:227], a[136:139], v[32:35]
    ds_read_b64_tr_b16 v[220:221], v3 offset:29696
    v_cvt_pk_bf16_f32 v100, v56, v57
    v_mfma_f32_16x16x32_bf16 v[32:35], v[228:231], a[152:155], v[32:35]
    v_rcp_f32 v247, v247
    v_fmac_f32 v58, v58, v246
    v_mul_f32 v240, s67, v64
    v_mfma_f32_16x16x32_bf16 v[40:43], v[228:231], a[156:159], v[40:43]
    ds_read_b64_tr_b16 v[222:223], v3 offset:35840
    v_fma_f32 v246, v242, -0.5, -1.0
    v_mfma_f32_16x16x32_bf16 v[40:43], v[224:227], a[140:143], v[40:43]
    s_waitcnt lgkmcnt(4)
    buffer_load_dwordx4 v7, s[36:39], s66 offen offset:2048 lds
    v_exp_f32 v243, v243
    v_mfma_f32_16x16x32_bf16 v[44:47], v[208:211], a[140:143], v[44:47]
    ds_read_b64_tr_b16 v[224:225], v252 offset:28672
    v_fma_f32 v245, v241, v245, -1.0
    v_mfma_f32_16x16x32_bf16 v[44:47], v[212:215], a[156:159], v[44:47]
    v_rcp_f32 v244, v244
    v_fmac_f32 v59, v59, v247
    v_mfma_f32_16x16x32_bf16 v[36:39], v[212:215], a[152:155], v[36:39]
    ds_read_b64_tr_b16 v[226:227], v252 offset:34816
    v_mul_f32 v241, s67, v65
    v_mfma_f32_16x16x32_bf16 v[36:39], v[208:211], a[136:139], v[36:39]
    v_exp_f32 v240, v240
    v_fma_f32 v247, v243, -0.5, -1.0
    v_fma_f32 v246, v242, v246, -1.0
    v_mfma_f32_16x16x32_bf16 v[28:31], v[208:211], a[132:135], v[28:31]
    ds_read_b64_tr_b16 v[228:229], v252 offset:29696
    v_cvt_pk_bf16_f32 v101, v58, v59
    v_mfma_f32_16x16x32_bf16 v[28:31], v[212:215], a[148:151], v[28:31]
    v_rcp_f32 v245, v245
    v_fmac_f32 v60, v60, v244
    v_mul_f32 v242, s67, v66
    v_mfma_f32_16x16x32_bf16 v[20:23], v[212:215], a[144:147], v[20:23]
    ds_read_b64_tr_b16 v[230:231], v252 offset:35840
    v_fma_f32 v244, v240, -0.5, -1.0
    v_mfma_f32_16x16x32_bf16 v[20:23], v[208:211], a[128:131], v[20:23]
    s_waitcnt vmcnt(22) lgkmcnt(4)
    s_barrier
    v_fma_f32 v247, v243, v247, -1.0
    v_mfma_f32_16x16x32_bf16 v[16:19], v[216:219], a[160:163], v[16:19]
    ds_read_b64_tr_b16 v[208:209], v3 offset:49152
    v_fmac_f32 v61, v61, v245
    v_mfma_f32_16x16x32_bf16 v[16:19], v[220:223], a[176:179], v[16:19]
    buffer_load_dword v253, v248, s[40:43], s78 offen
    v_exp_f32 v241, v241
    v_mfma_f32_16x16x32_bf16 v[24:27], v[220:223], a[180:183], v[24:27]
    ds_read_b64_tr_b16 v[210:211], v3 offset:55296
    v_mul_f32 v243, s67, v67
    v_mfma_f32_16x16x32_bf16 v[24:27], v[216:219], a[164:167], v[24:27]
    v_rcp_f32 v246, v246
    v_mfma_f32_16x16x32_bf16 v[32:35], v[216:219], a[168:171], v[32:35]
    ds_read_b64_tr_b16 v[212:213], v3 offset:50176
    v_fma_f32 v245, v241, -0.5, -1.0
    v_mfma_f32_16x16x32_bf16 v[32:35], v[220:223], a[184:187], v[32:35]
    v_exp_f32 v242, v242
    v_fma_f32 v244, v240, v244, -1.0
    v_rcp_f32 v247, v247
    v_mfma_f32_16x16x32_bf16 v[40:43], v[220:223], a[188:191], v[40:43]
    ds_read_b64_tr_b16 v[214:215], v3 offset:56320
    v_cvt_pk_bf16_f32 v102, v60, v61
    v_mfma_f32_16x16x32_bf16 v[40:43], v[216:219], a[172:175], v[40:43]
    s_waitcnt lgkmcnt(4)
    v_fmac_f32 v62, v62, v246
    v_mul_f32 v240, s67, v68
    v_exp_f32 v243, v243
    v_mfma_f32_16x16x32_bf16 v[44:47], v[224:227], a[172:175], v[44:47]
    ds_read_b64_tr_b16 v[216:217], v252 offset:49152
    v_fma_f32 v246, v242, -0.5, -1.0
    v_mfma_f32_16x16x32_bf16 v[44:47], v[228:231], a[188:191], v[44:47]
    v_fma_f32 v245, v241, v245, -1.0
    v_fmac_f32 v63, v63, v247
    v_mfma_f32_16x16x32_bf16 v[36:39], v[228:231], a[184:187], v[36:39]
    ds_read_b64_tr_b16 v[218:219], v252 offset:55296
    v_mul_f32 v241, s67, v69
    v_mfma_f32_16x16x32_bf16 v[36:39], v[224:227], a[168:171], v[36:39]
    v_rcp_f32 v244, v244
    v_exp_f32 v240, v240
    v_fma_f32 v247, v243, -0.5, -1.0
    v_mfma_f32_16x16x32_bf16 v[28:31], v[224:227], a[164:167], v[28:31]
    ds_read_b64_tr_b16 v[220:221], v252 offset:50176
    v_fma_f32 v246, v242, v246, -1.0
    v_mfma_f32_16x16x32_bf16 v[28:31], v[228:231], a[180:183], v[28:31]
    v_rcp_f32 v245, v245
    v_cvt_pk_bf16_f32 v103, v62, v63
    v_fmac_f32 v64, v64, v244
    v_mfma_f32_16x16x32_bf16 v[20:23], v[228:231], a[176:179], v[20:23]
    ds_read_b64_tr_b16 v[222:223], v252 offset:56320
    v_mul_f32 v242, s67, v70
    v_mfma_f32_16x16x32_bf16 v[20:23], v[224:227], a[160:163], v[20:23]
    s_waitcnt lgkmcnt(4)
    v_exp_f32 v241, v241
    v_fma_f32 v244, v240, -0.5, -1.0
    v_mfma_f32_16x16x32_bf16 v[16:19], v[208:211], a[192:195], v[16:19]
    ds_read_b64_tr_b16 v[224:225], v3 offset:51200
    v_fma_f32 v247, v243, v247, -1.0
    v_mfma_f32_16x16x32_bf16 v[16:19], v[212:215], a[208:211], v[16:19]
    v_rcp_f32 v246, v246
    v_fmac_f32 v65, v65, v245
    v_mul_f32 v243, s67, v71
    v_mfma_f32_16x16x32_bf16 v[24:27], v[212:215], a[212:215], v[24:27]
    ds_read_b64_tr_b16 v[226:227], v3 offset:57344
    v_fma_f32 v245, v241, -0.5, -1.0
    v_mfma_f32_16x16x32_bf16 v[24:27], v[208:211], a[196:199], v[24:27]
    v_exp_f32 v242, v242
    v_fma_f32 v244, v240, v244, -1.0
    v_mfma_f32_16x16x32_bf16 v[32:35], v[208:211], a[200:203], v[32:35]
    ds_read_b64_tr_b16 v[228:229], v3 offset:52224
    v_cvt_pk_bf16_f32 v104, v64, v65
    v_mfma_f32_16x16x32_bf16 v[32:35], v[212:215], a[216:219], v[32:35]
    v_rcp_f32 v247, v247
    v_fmac_f32 v66, v66, v246
    v_mul_f32 v240, s67, v72
    v_mfma_f32_16x16x32_bf16 v[40:43], v[212:215], a[220:223], v[40:43]
    ds_read_b64_tr_b16 v[230:231], v3 offset:58368
    v_fma_f32 v246, v242, -0.5, -1.0
    v_mfma_f32_16x16x32_bf16 v[40:43], v[208:211], a[204:207], v[40:43]
    s_waitcnt lgkmcnt(4)
    v_exp_f32 v243, v243
    v_fma_f32 v245, v241, v245, -1.0
    v_mfma_f32_16x16x32_bf16 v[44:47], v[216:219], a[204:207], v[44:47]
    ds_read_b64_tr_b16 v[208:209], v252 offset:51200
    v_fmac_f32 v67, v67, v247
    v_mfma_f32_16x16x32_bf16 v[44:47], v[220:223], a[220:223], v[44:47]
    v_rcp_f32 v244, v244
    v_mul_f32 v241, s67, v73
    v_exp_f32 v240, v240
    v_mfma_f32_16x16x32_bf16 v[36:39], v[220:223], a[216:219], v[36:39]
    ds_read_b64_tr_b16 v[210:211], v252 offset:57344
    v_fma_f32 v247, v243, -0.5, -1.0
    v_mfma_f32_16x16x32_bf16 v[36:39], v[216:219], a[200:203], v[36:39]
    v_fma_f32 v246, v242, v246, -1.0
    v_cvt_pk_bf16_f32 v105, v66, v67
    v_mfma_f32_16x16x32_bf16 v[28:31], v[216:219], a[196:199], v[28:31]
    ds_read_b64_tr_b16 v[212:213], v252 offset:52224
    v_fmac_f32 v68, v68, v244
    v_mfma_f32_16x16x32_bf16 v[28:31], v[220:223], a[212:215], v[28:31]
    v_rcp_f32 v245, v245
    v_mul_f32 v242, s67, v74
    v_exp_f32 v241, v241
    v_mfma_f32_16x16x32_bf16 v[20:23], v[220:223], a[208:211], v[20:23]
    ds_read_b64_tr_b16 v[214:215], v252 offset:58368
    v_fma_f32 v244, v240, -0.5, -1.0
    v_mfma_f32_16x16x32_bf16 v[20:23], v[216:219], a[192:195], v[20:23]
    s_waitcnt lgkmcnt(4)
    v_fma_f32 v247, v243, v247, -1.0
    v_fmac_f32 v69, v69, v245
    v_rcp_f32 v246, v246
    v_mfma_f32_16x16x32_bf16 v[16:19], v[224:227], a[224:227], v[16:19]
    ds_read_b64_tr_b16 v[216:217], v3 offset:53248
    v_mul_f32 v243, s67, v75
    v_mfma_f32_16x16x32_bf16 v[16:19], v[228:231], a[240:243], v[16:19]
    v_exp_f32 v242, v242
    v_fma_f32 v245, v241, -0.5, -1.0
    v_fma_f32 v244, v240, v244, -1.0
    v_mfma_f32_16x16x32_bf16 v[24:27], v[228:231], a[244:247], v[24:27]
    ds_read_b64_tr_b16 v[218:219], v3 offset:59392
    v_cvt_pk_bf16_f32 v106, v68, v69
    v_mfma_f32_16x16x32_bf16 v[24:27], v[224:227], a[228:231], v[24:27]
    v_rcp_f32 v247, v247
    v_fmac_f32 v70, v70, v246
    v_mfma_f32_16x16x32_bf16 v[32:35], v[224:227], a[232:235], v[32:35]
    ds_read_b64_tr_b16 v[220:221], v3 offset:54272
    v_mul_f32 v240, s67, v76
    v_mfma_f32_16x16x32_bf16 v[32:35], v[228:231], a[248:251], v[32:35]
    v_exp_f32 v243, v243
    v_fma_f32 v246, v242, -0.5, -1.0
    v_fma_f32 v245, v241, v245, -1.0
    v_mfma_f32_16x16x32_bf16 v[40:43], v[228:231], a[252:255], v[40:43]
    ds_read_b64_tr_b16 v[222:223], v3 offset:60416
    v_fmac_f32 v71, v71, v247
    v_mfma_f32_16x16x32_bf16 v[40:43], v[224:227], a[236:239], v[40:43]
    s_waitcnt lgkmcnt(4)
    v_rcp_f32 v244, v244
    v_mul_f32 v241, s67, v77
    v_mfma_f32_16x16x32_bf16 v[44:47], v[208:211], a[236:239], v[44:47]
    ds_read_b64_tr_b16 v[224:225], v252 offset:53248
    v_fma_f32 v247, v243, -0.5, -1.0
    v_mfma_f32_16x16x32_bf16 v[44:47], v[212:215], a[252:255], v[44:47]
    ds_read_b128 v[232:235], v11 offset:1024
    ds_read_b128 v[236:239], v11 offset:1088
    v_mfma_f32_16x16x32_bf16 v[36:39], v[212:215], a[248:251], v[36:39]
    ds_read_b64_tr_b16 v[226:227], v252 offset:59392
    v_fma_f32 v246, v242, v246, -1.0
    v_mfma_f32_16x16x32_bf16 v[36:39], v[208:211], a[232:235], v[36:39]
    v_exp_f32 v240, v240
    v_rcp_f32 v245, v245
    v_cvt_pk_bf16_f32 v107, v70, v71
    v_mfma_f32_16x16x32_bf16 v[28:31], v[208:211], a[228:231], v[28:31]
    ds_read_b64_tr_b16 v[228:229], v252 offset:54272
    v_fmac_f32 v72, v72, v244
    v_mfma_f32_16x16x32_bf16 v[28:31], v[212:215], a[244:247], v[28:31]
    v_mul_f32 v242, s67, v78
    v_fma_f32 v244, v240, -0.5, -1.0
    v_exp_f32 v241, v241
    v_mfma_f32_16x16x32_bf16 v[20:23], v[212:215], a[240:243], v[20:23]
    ds_read_b64_tr_b16 v[230:231], v252 offset:60416
    v_fma_f32 v247, v243, v247, -1.0
    v_mfma_f32_16x16x32_bf16 v[20:23], v[208:211], a[224:227], v[20:23]
    s_waitcnt vmcnt(17) lgkmcnt(6)
    s_barrier
    v_fmac_f32 v73, v73, v245
    v_mfma_f32_16x16x32_bf16 v[16:19], v[216:219], v[176:179], v[16:19]
    ds_read_b64_tr_b16 v[208:209], v2
    v_mul_f32 v243, s67, v79
    v_mfma_f32_16x16x32_bf16 v[16:19], v[220:223], v[192:195], v[16:19]
    v_rcp_f32 v246, v246
    v_exp_f32 v242, v242
    v_mfma_f32_16x16x32_bf16 v[24:27], v[220:223], v[196:199], v[24:27]
    ds_read_b64_tr_b16 v[210:211], v2 offset:6144
    v_fma_f32 v245, v241, -0.5, -1.0
    v_mfma_f32_16x16x32_bf16 v[24:27], v[216:219], v[180:183], v[24:27]
    v_fma_f32 v244, v240, v244, -1.0
    v_cvt_pk_bf16_f32 v108, v72, v73
    v_rcp_f32 v247, v247
    v_mfma_f32_16x16x32_bf16 v[32:35], v[216:219], v[184:187], v[32:35]
    ds_read_b64_tr_b16 v[212:213], v2 offset:1024
    v_fmac_f32 v74, v74, v246
    v_mfma_f32_16x16x32_bf16 v[32:35], v[220:223], v[200:203], v[32:35]
    v_exp_f32 v243, v243
    v_fma_f32 v246, v242, -0.5, -1.0
    v_fma_f32 v245, v241, v245, -1.0
    v_mfma_f32_16x16x32_bf16 v[40:43], v[220:223], v[204:207], v[40:43]
    ds_read_b64_tr_b16 v[214:215], v2 offset:7168
    v_fmac_f32 v75, v75, v247
    v_mfma_f32_16x16x32_bf16 v[40:43], v[216:219], v[188:191], v[40:43]
    s_waitcnt lgkmcnt(4)
    v_rcp_f32 v244, v244
    v_fma_f32 v247, v243, -0.5, -1.0
    v_mfma_f32_16x16x32_bf16 v[44:47], v[224:227], v[188:191], v[44:47]
    ds_read_b64_tr_b16 v[216:217], v4
    v_fma_f32 v246, v242, v246, -1.0
    v_mfma_f32_16x16x32_bf16 v[44:47], v[228:231], v[204:207], v[44:47]
    v_rcp_f32 v245, v245
    v_cvt_pk_bf16_f32 v109, v74, v75
    v_fmac_f32 v76, v76, v244
    v_mfma_f32_16x16x32_bf16 v[36:39], v[228:231], v[200:203], v[36:39]
    ds_read_b64_tr_b16 v[218:219], v4 offset:6144
    v_fma_f32 v247, v243, v247, -1.0
    v_mfma_f32_16x16x32_bf16 v[36:39], v[224:227], v[184:187], v[36:39]
L_pad_f2:
    s_cbranch_execz L_pad_f6
    v_rcp_f32 v246, v246
    v_fmac_f32 v77, v77, v245
    v_mfma_f32_16x16x32_bf16 v[28:31], v[224:227], v[180:183], v[28:31]
    ds_read_b64_tr_b16 v[220:221], v4 offset:1024
    v_cvt_pk_bf16_f32 v110, v76, v77
    v_mfma_f32_16x16x32_bf16 v[28:31], v[228:231], v[196:199], v[28:31]
    v_rcp_f32 v247, v247
    v_fmac_f32 v78, v78, v246
    v_fmac_f32 v79, v79, v247
    v_cvt_pk_bf16_f32 v111, v78, v79
    v_mfma_f32_16x16x32_bf16 v[20:23], v[228:231], v[192:195], v[20:23]
    ds_read_b64_tr_b16 v[222:223], v4 offset:7168
    v_mfma_f32_16x16x32_bf16 v[20:23], v[224:227], v[176:179], v[20:23]
    s_waitcnt lgkmcnt(4)
    v_mfma_f32_16x16x32_bf16 v[48:51], v[208:211], a[0:3], v[232:235]
    ds_read_b64_tr_b16 v[224:225], v2 offset:2048
    v_mul_f32 v240, s67, v144
    v_mfma_f32_16x16x32_bf16 v[48:51], v[212:215], a[16:19], v[48:51]
    v_mul_f32 v241, s67, v145
    v_mul_f32 v242, s67, v146
    v_exp_f32 v240, v240
    v_mfma_f32_16x16x32_bf16 v[56:59], v[212:215], a[20:23], v[232:235]
    ds_read_b64_tr_b16 v[226:227], v2 offset:8192
    v_fma_f32 v244, v240, -0.5, -1.0
    v_mfma_f32_16x16x32_bf16 v[56:59], v[208:211], a[4:7], v[56:59]
    s_add_u32 s65, s68, 0x1000
    buffer_store_dwordx4 v[96:99], v1, s[48:51], s65 offen sc1
    v_mfma_f32_16x16x32_bf16 v[64:67], v[208:211], a[8:11], v[232:235]
    ds_read_b64_tr_b16 v[228:229], v2 offset:3072
    v_mul_f32 v243, s67, v147
    v_mfma_f32_16x16x32_bf16 v[64:67], v[212:215], a[24:27], v[64:67]
    v_exp_f32 v241, v241
    v_exp_f32 v242, v242
    v_mfma_f32_16x16x32_bf16 v[72:75], v[212:215], a[28:31], v[232:235]
    ds_read_b64_tr_b16 v[230:231], v2 offset:9216
    v_fma_f32 v245, v241, -0.5, -1.0
    v_mfma_f32_16x16x32_bf16 v[72:75], v[208:211], a[12:15], v[72:75]
    s_waitcnt lgkmcnt(4)
    v_fma_f32 v244, v240, v244, -1.0
    v_mul_f32 v240, s67, v148
    v_exp_f32 v243, v243
    v_mfma_f32_16x16x32_bf16 v[76:79], v[216:219], a[12:15], v[236:239]
    ds_read_b64_tr_b16 v[208:209], v4 offset:2048
    v_fma_f32 v246, v242, -0.5, -1.0
    v_mfma_f32_16x16x32_bf16 v[76:79], v[220:223], a[28:31], v[76:79]
    v_fma_f32 v245, v241, v245, -1.0
    v_mul_f32 v241, s67, v149
    v_rcp_f32 v244, v244
    v_mfma_f32_16x16x32_bf16 v[68:71], v[220:223], a[24:27], v[236:239]
    ds_read_b64_tr_b16 v[210:211], v4 offset:8192
    v_fma_f32 v247, v243, -0.5, -1.0
    v_mfma_f32_16x16x32_bf16 v[68:71], v[216:219], a[8:11], v[68:71]
    buffer_store_dwordx4 v[100:103], v1, s[48:51], s65 offen offset:1024 sc1
    v_mfma_f32_16x16x32_bf16 v[60:63], v[216:219], a[4:7], v[236:239]
    ds_read_b64_tr_b16 v[212:213], v4 offset:3072
    v_fma_f32 v246, v242, v246, -1.0
    v_mfma_f32_16x16x32_bf16 v[60:63], v[220:223], a[20:23], v[60:63]
    v_exp_f32 v240, v240
    v_rcp_f32 v245, v245
    v_fmac_f32 v144, v144, v244
    v_mfma_f32_16x16x32_bf16 v[52:55], v[220:223], a[16:19], v[236:239]
    ds_read_b64_tr_b16 v[214:215], v4 offset:9216
    v_mul_f32 v242, s67, v150
    v_mfma_f32_16x16x32_bf16 v[52:55], v[216:219], a[0:3], v[52:55]
    s_waitcnt lgkmcnt(4)
    v_exp_f32 v241, v241
    v_fma_f32 v244, v240, -0.5, -1.0
    v_fma_f32 v247, v243, v247, -1.0
    v_mfma_f32_16x16x32_bf16 v[48:51], v[224:227], a[32:35], v[48:51]
    ds_read_b64_tr_b16 v[216:217], v2 offset:4096
    v_fmac_f32 v145, v145, v245
    v_mfma_f32_16x16x32_bf16 v[48:51], v[228:231], a[48:51], v[48:51]
    v_rcp_f32 v246, v246
    v_mul_f32 v243, s67, v151
    v_mfma_f32_16x16x32_bf16 v[56:59], v[228:231], a[52:55], v[56:59]
    ds_read_b64_tr_b16 v[218:219], v2 offset:10240
    v_fma_f32 v245, v241, -0.5, -1.0
    v_mfma_f32_16x16x32_bf16 v[56:59], v[224:227], a[36:39], v[56:59]
    buffer_store_dwordx4 v[104:107], v1, s[48:51], s65 offen offset:2048 sc1
    v_exp_f32 v242, v242
    v_mfma_f32_16x16x32_bf16 v[64:67], v[224:227], a[40:43], v[64:67]
    ds_read_b64_tr_b16 v[220:221], v2 offset:5120
    v_fma_f32 v244, v240, v244, -1.0
    v_mfma_f32_16x16x32_bf16 v[64:67], v[228:231], a[56:59], v[64:67]
    v_rcp_f32 v247, v247
    v_cvt_pk_bf16_f32 v112, v144, v145
    v_fmac_f32 v146, v146, v246
    v_mfma_f32_16x16x32_bf16 v[72:75], v[228:231], a[60:63], v[72:75]
    ds_read_b64_tr_b16 v[222:223], v2 offset:11264
    v_mul_f32 v240, s67, v152
    v_mfma_f32_16x16x32_bf16 v[72:75], v[224:227], a[44:47], v[72:75]
    s_waitcnt lgkmcnt(4)
    v_exp_f32 v243, v243
    v_fma_f32 v246, v242, -0.5, -1.0
    v_fma_f32 v245, v241, v245, -1.0
    v_mfma_f32_16x16x32_bf16 v[76:79], v[208:211], a[44:47], v[76:79]
    ds_read_b64_tr_b16 v[224:225], v4 offset:4096
    v_fmac_f32 v147, v147, v247
    v_mfma_f32_16x16x32_bf16 v[76:79], v[212:215], a[60:63], v[76:79]
    v_rcp_f32 v244, v244
    v_mul_f32 v241, s67, v153
    v_mfma_f32_16x16x32_bf16 v[68:71], v[212:215], a[56:59], v[68:71]
    ds_read_b64_tr_b16 v[226:227], v4 offset:10240
    v_fma_f32 v247, v243, -0.5, -1.0
    v_mfma_f32_16x16x32_bf16 v[68:71], v[208:211], a[40:43], v[68:71]
    buffer_store_dwordx4 v[108:111], v1, s[48:51], s65 offen offset:3072 sc1
    v_exp_f32 v240, v240
    v_mfma_f32_16x16x32_bf16 v[60:63], v[208:211], a[36:39], v[60:63]
    ds_read_b64_tr_b16 v[228:229], v4 offset:5120
    v_fma_f32 v246, v242, v246, -1.0
    v_mfma_f32_16x16x32_bf16 v[60:63], v[212:215], a[52:55], v[60:63]
    v_rcp_f32 v245, v245
    v_cvt_pk_bf16_f32 v113, v146, v147
    v_fmac_f32 v148, v148, v244
    v_mfma_f32_16x16x32_bf16 v[52:55], v[212:215], a[48:51], v[52:55]
    ds_read_b64_tr_b16 v[230:231], v4 offset:11264
    v_mul_f32 v242, s67, v154
    v_mfma_f32_16x16x32_bf16 v[52:55], v[208:211], a[32:35], v[52:55]
    s_waitcnt vmcnt(12) lgkmcnt(4)
    s_barrier
    v_fma_f32 v244, v240, -0.5, -1.0
    v_mfma_f32_16x16x32_bf16 v[48:51], v[216:219], a[64:67], v[48:51]
    s_add_u32 m0, s60, 0x12000
    ds_read_b64_tr_b16 v[208:209], v2 offset:24576
    v_fma_f32 v247, v243, v247, -1.0
    v_mfma_f32_16x16x32_bf16 v[48:51], v[220:223], a[80:83], v[48:51]
    s_add_u32 s66, s96, 0x280
    buffer_load_dwordx4 v5, s[36:39], s66 offen lds
    v_exp_f32 v241, v241
    v_mfma_f32_16x16x32_bf16 v[56:59], v[220:223], a[84:87], v[56:59]
    ds_read_b64_tr_b16 v[210:211], v2 offset:30720
    v_fmac_f32 v149, v149, v245
    v_mfma_f32_16x16x32_bf16 v[56:59], v[216:219], a[68:71], v[56:59]
    buffer_load_dwordx4 v6, s[36:39], s66 offen offset:1024 lds
    v_mfma_f32_16x16x32_bf16 v[64:67], v[216:219], a[72:75], v[64:67]
    ds_read_b64_tr_b16 v[212:213], v2 offset:25600
    v_mul_f32 v243, s67, v155
    v_mfma_f32_16x16x32_bf16 v[64:67], v[220:223], a[88:91], v[64:67]
    v_rcp_f32 v246, v246
    v_exp_f32 v242, v242
    v_fma_f32 v245, v241, -0.5, -1.0
    v_mfma_f32_16x16x32_bf16 v[72:75], v[220:223], a[92:95], v[72:75]
    ds_read_b64_tr_b16 v[214:215], v2 offset:31744
    v_fma_f32 v244, v240, v244, -1.0
    v_mfma_f32_16x16x32_bf16 v[72:75], v[216:219], a[76:79], v[72:75]
    s_waitcnt lgkmcnt(4)
    buffer_load_dwordx4 v7, s[36:39], s66 offen offset:2048 lds
    v_mfma_f32_16x16x32_bf16 v[76:79], v[224:227], a[76:79], v[76:79]
    ds_read_b64_tr_b16 v[216:217], v4 offset:24576
    v_cvt_pk_bf16_f32 v114, v148, v149
    v_mfma_f32_16x16x32_bf16 v[76:79], v[228:231], a[92:95], v[76:79]
    v_rcp_f32 v247, v247
    v_fmac_f32 v150, v150, v246
    v_mul_f32 v240, s67, v156
    v_mfma_f32_16x16x32_bf16 v[68:71], v[228:231], a[88:91], v[68:71]
    s_add_u32 m0, s60, 0x12c00
    ds_read_b64_tr_b16 v[218:219], v4 offset:30720
    v_fma_f32 v246, v242, -0.5, -1.0
    v_mfma_f32_16x16x32_bf16 v[68:71], v[224:227], a[72:75], v[68:71]
    s_add_u32 s66, s96, 0xd8280
    buffer_load_dwordx4 v5, s[36:39], s66 offen lds
    v_mfma_f32_16x16x32_bf16 v[60:63], v[224:227], a[68:71], v[60:63]
    ds_read_b64_tr_b16 v[220:221], v4 offset:25600
    v_fma_f32 v245, v241, v245, -1.0
    v_mfma_f32_16x16x32_bf16 v[60:63], v[228:231], a[84:87], v[60:63]
    v_exp_f32 v243, v243
    v_rcp_f32 v244, v244
    v_fmac_f32 v151, v151, v247
    v_mfma_f32_16x16x32_bf16 v[52:55], v[228:231], a[80:83], v[52:55]
    ds_read_b64_tr_b16 v[222:223], v4 offset:31744
    v_mul_f32 v241, s67, v157
    v_mfma_f32_16x16x32_bf16 v[52:55], v[224:227], a[64:67], v[52:55]
    s_waitcnt lgkmcnt(4)
    buffer_load_dwordx4 v6, s[36:39], s66 offen offset:1024 lds
    v_mfma_f32_16x16x32_bf16 v[48:51], v[208:211], a[96:99], v[48:51]
    ds_read_b64_tr_b16 v[224:225], v2 offset:26624
    v_fma_f32 v247, v243, -0.5, -1.0
    v_mfma_f32_16x16x32_bf16 v[48:51], v[212:215], a[112:115], v[48:51]
    v_exp_f32 v240, v240
    v_fma_f32 v246, v242, v246, -1.0
    v_rcp_f32 v245, v245
    v_mfma_f32_16x16x32_bf16 v[56:59], v[212:215], a[116:119], v[56:59]
    ds_read_b64_tr_b16 v[226:227], v2 offset:32768
    v_cvt_pk_bf16_f32 v115, v150, v151
    v_mfma_f32_16x16x32_bf16 v[56:59], v[208:211], a[100:103], v[56:59]
    buffer_load_dwordx4 v7, s[36:39], s66 offen offset:2048 lds
    v_fmac_f32 v152, v152, v244
    v_mfma_f32_16x16x32_bf16 v[64:67], v[208:211], a[104:107], v[64:67]
    ds_read_b64_tr_b16 v[228:229], v2 offset:27648
    v_mul_f32 v242, s67, v158
    v_mfma_f32_16x16x32_bf16 v[64:67], v[212:215], a[120:123], v[64:67]
    s_add_u32 m0, s60, 0x18000
    v_exp_f32 v241, v241
    v_fma_f32 v244, v240, -0.5, -1.0
    v_fma_f32 v247, v243, v247, -1.0
    v_mfma_f32_16x16x32_bf16 v[72:75], v[212:215], a[124:127], v[72:75]
    s_add_u32 s66, s97, 0x280
    ds_read_b64_tr_b16 v[230:231], v2 offset:33792
    v_fmac_f32 v153, v153, v245
    v_mfma_f32_16x16x32_bf16 v[72:75], v[208:211], a[108:111], v[72:75]
    s_waitcnt lgkmcnt(4)
    buffer_load_dwordx4 v5, s[36:39], s66 offen lds
    v_mfma_f32_16x16x32_bf16 v[76:79], v[216:219], a[108:111], v[76:79]
    ds_read_b64_tr_b16 v[208:209], v4 offset:26624
    v_mul_f32 v243, s67, v159
    v_mfma_f32_16x16x32_bf16 v[76:79], v[220:223], a[124:127], v[76:79]
    v_rcp_f32 v246, v246
    v_exp_f32 v242, v242
    v_fma_f32 v245, v241, -0.5, -1.0
    v_mfma_f32_16x16x32_bf16 v[68:71], v[220:223], a[120:123], v[68:71]
    ds_read_b64_tr_b16 v[210:211], v4 offset:32768
    v_fma_f32 v244, v240, v244, -1.0
    v_mfma_f32_16x16x32_bf16 v[68:71], v[216:219], a[104:107], v[68:71]
    buffer_load_dwordx4 v6, s[36:39], s66 offen offset:1024 lds
    v_mfma_f32_16x16x32_bf16 v[60:63], v[216:219], a[100:103], v[60:63]
    ds_read_b64_tr_b16 v[212:213], v4 offset:27648
    v_cvt_pk_bf16_f32 v116, v152, v153
    v_mfma_f32_16x16x32_bf16 v[60:63], v[220:223], a[116:119], v[60:63]
    v_rcp_f32 v247, v247
    v_fmac_f32 v154, v154, v246
    v_mul_f32 v240, s67, v160
    v_mfma_f32_16x16x32_bf16 v[52:55], v[220:223], a[112:115], v[52:55]
    ds_read_b64_tr_b16 v[214:215], v4 offset:33792
    v_fma_f32 v246, v242, -0.5, -1.0
    v_mfma_f32_16x16x32_bf16 v[52:55], v[216:219], a[96:99], v[52:55]
    s_waitcnt lgkmcnt(4)
    buffer_load_dwordx4 v7, s[36:39], s66 offen offset:2048 lds
    v_mfma_f32_16x16x32_bf16 v[48:51], v[224:227], a[128:131], v[48:51]
    ds_read_b64_tr_b16 v[216:217], v2 offset:28672
    v_fma_f32 v245, v241, v245, -1.0
    v_mfma_f32_16x16x32_bf16 v[48:51], v[228:231], a[144:147], v[48:51]
    v_exp_f32 v243, v243
    v_rcp_f32 v244, v244
    v_fmac_f32 v155, v155, v247
    v_mfma_f32_16x16x32_bf16 v[56:59], v[228:231], a[148:151], v[56:59]
    s_add_u32 m0, s60, 0x18c00
    ds_read_b64_tr_b16 v[218:219], v2 offset:34816
    v_mul_f32 v241, s67, v161
    v_mfma_f32_16x16x32_bf16 v[56:59], v[224:227], a[132:135], v[56:59]
    s_add_u32 s66, s97, 0xd8280
    buffer_load_dwordx4 v5, s[36:39], s66 offen lds
    v_mfma_f32_16x16x32_bf16 v[64:67], v[224:227], a[136:139], v[64:67]
    ds_read_b64_tr_b16 v[220:221], v2 offset:29696
    v_fma_f32 v247, v243, -0.5, -1.0
    v_mfma_f32_16x16x32_bf16 v[64:67], v[228:231], a[152:155], v[64:67]
    v_exp_f32 v240, v240
    v_fma_f32 v246, v242, v246, -1.0
    v_rcp_f32 v245, v245
    v_mfma_f32_16x16x32_bf16 v[72:75], v[228:231], a[156:159], v[72:75]
    ds_read_b64_tr_b16 v[222:223], v2 offset:35840
    v_cvt_pk_bf16_f32 v117, v154, v155
    v_mfma_f32_16x16x32_bf16 v[72:75], v[224:227], a[140:143], v[72:75]
    s_waitcnt lgkmcnt(4)
    buffer_load_dwordx4 v6, s[36:39], s66 offen offset:1024 lds
    v_fmac_f32 v156, v156, v244
    v_mfma_f32_16x16x32_bf16 v[76:79], v[208:211], a[140:143], v[76:79]
    ds_read_b64_tr_b16 v[224:225], v4 offset:28672
    v_mul_f32 v242, s67, v162
    v_mfma_f32_16x16x32_bf16 v[76:79], v[212:215], a[156:159], v[76:79]
    v_exp_f32 v241, v241
    v_fma_f32 v244, v240, -0.5, -1.0
    v_fma_f32 v247, v243, v247, -1.0
    v_mfma_f32_16x16x32_bf16 v[68:71], v[212:215], a[152:155], v[68:71]
    ds_read_b64_tr_b16 v[226:227], v4 offset:34816
    v_fmac_f32 v157, v157, v245
    v_mfma_f32_16x16x32_bf16 v[68:71], v[208:211], a[136:139], v[68:71]
    buffer_load_dwordx4 v7, s[36:39], s66 offen offset:2048 lds
    v_mfma_f32_16x16x32_bf16 v[60:63], v[208:211], a[132:135], v[60:63]
    ds_read_b64_tr_b16 v[228:229], v4 offset:29696
    v_mul_f32 v243, s67, v163
    v_mfma_f32_16x16x32_bf16 v[60:63], v[212:215], a[148:151], v[60:63]
    v_rcp_f32 v246, v246
    v_exp_f32 v242, v242
    v_mfma_f32_16x16x32_bf16 v[52:55], v[212:215], a[144:147], v[52:55]
    ds_read_b64_tr_b16 v[230:231], v4 offset:35840
    v_fma_f32 v245, v241, -0.5, -1.0
    v_mfma_f32_16x16x32_bf16 v[52:55], v[208:211], a[128:131], v[52:55]
    s_waitcnt vmcnt(12) lgkmcnt(4)
    s_barrier
    buffer_store_dword v14, v15, s[48:51], 0 offen sc1
    v_fma_f32 v244, v240, v244, -1.0
    v_mfma_f32_16x16x32_bf16 v[48:51], v[216:219], a[160:163], v[48:51]
    s_add_u32 m0, s60, 0x1e000
    ds_read_b64_tr_b16 v[208:209], v2 offset:49152
    v_cvt_pk_bf16_f32 v118, v156, v157
    v_mfma_f32_16x16x32_bf16 v[48:51], v[220:223], a[176:179], v[48:51]
    s_add_u32 s66, s98, 0x280
    buffer_load_dwordx4 v5, s[36:39], s66 offen lds
    v_mfma_f32_16x16x32_bf16 v[56:59], v[220:223], a[180:183], v[56:59]
    ds_read_b64_tr_b16 v[210:211], v2 offset:55296
    v_fmac_f32 v158, v158, v246
    v_mfma_f32_16x16x32_bf16 v[56:59], v[216:219], a[164:167], v[56:59]
    v_rcp_f32 v247, v247
    v_mul_f32 v240, s67, v164
    v_exp_f32 v243, v243
    v_mfma_f32_16x16x32_bf16 v[64:67], v[216:219], a[168:171], v[64:67]
    ds_read_b64_tr_b16 v[212:213], v2 offset:50176
    v_fma_f32 v246, v242, -0.5, -1.0
    v_mfma_f32_16x16x32_bf16 v[64:67], v[220:223], a[184:187], v[64:67]
    v_fma_f32 v245, v241, v245, -1.0
    v_fmac_f32 v159, v159, v247
    v_rcp_f32 v244, v244
    v_mfma_f32_16x16x32_bf16 v[72:75], v[220:223], a[188:191], v[72:75]
    ds_read_b64_tr_b16 v[214:215], v2 offset:56320
    v_mul_f32 v241, s67, v165
    v_mfma_f32_16x16x32_bf16 v[72:75], v[216:219], a[172:175], v[72:75]
    s_waitcnt lgkmcnt(4)
    buffer_load_dwordx4 v6, s[36:39], s66 offen offset:1024 lds
    v_mfma_f32_16x16x32_bf16 v[76:79], v[224:227], a[172:175], v[76:79]
    ds_read_b64_tr_b16 v[216:217], v4 offset:49152
    v_fma_f32 v247, v243, -0.5, -1.0
    v_mfma_f32_16x16x32_bf16 v[76:79], v[228:231], a[188:191], v[76:79]
    v_exp_f32 v240, v240
    v_fma_f32 v246, v242, v246, -1.0
    v_rcp_f32 v245, v245
    v_mfma_f32_16x16x32_bf16 v[68:71], v[228:231], a[184:187], v[68:71]
    ds_read_b64_tr_b16 v[218:219], v4 offset:55296
    v_cvt_pk_bf16_f32 v119, v158, v159
    v_mfma_f32_16x16x32_bf16 v[68:71], v[224:227], a[168:171], v[68:71]
    v_fmac_f32 v160, v160, v244
    v_mul_f32 v242, s67, v166
    v_exp_f32 v241, v241
    v_mfma_f32_16x16x32_bf16 v[60:63], v[224:227], a[164:167], v[60:63]
    ds_read_b64_tr_b16 v[220:221], v4 offset:50176
    v_fma_f32 v244, v240, -0.5, -1.0
    v_mfma_f32_16x16x32_bf16 v[60:63], v[228:231], a[180:183], v[60:63]
    v_fma_f32 v247, v243, v247, -1.0
    v_fmac_f32 v161, v161, v245
    v_rcp_f32 v246, v246
    v_mfma_f32_16x16x32_bf16 v[52:55], v[228:231], a[176:179], v[52:55]
    ds_read_b64_tr_b16 v[222:223], v4 offset:56320
    v_mul_f32 v243, s67, v167
    v_mfma_f32_16x16x32_bf16 v[52:55], v[224:227], a[160:163], v[52:55]
    s_waitcnt lgkmcnt(4)
    buffer_load_dwordx4 v7, s[36:39], s66 offen offset:2048 lds
    v_mfma_f32_16x16x32_bf16 v[48:51], v[208:211], a[192:195], v[48:51]
    ds_read_b64_tr_b16 v[224:225], v2 offset:51200
    v_fma_f32 v245, v241, -0.5, -1.0
    v_mfma_f32_16x16x32_bf16 v[48:51], v[212:215], a[208:211], v[48:51]
    v_exp_f32 v242, v242
    v_fma_f32 v244, v240, v244, -1.0
    v_rcp_f32 v247, v247
    v_mfma_f32_16x16x32_bf16 v[56:59], v[212:215], a[212:215], v[56:59]
    ds_read_b64_tr_b16 v[226:227], v2 offset:57344
    v_cvt_pk_bf16_f32 v120, v160, v161
    v_mfma_f32_16x16x32_bf16 v[56:59], v[208:211], a[196:199], v[56:59]
    v_fmac_f32 v162, v162, v246
    v_mul_f32 v240, s67, v168
    v_exp_f32 v243, v243
    v_mfma_f32_16x16x32_bf16 v[64:67], v[208:211], a[200:203], v[64:67]
    ds_read_b64_tr_b16 v[228:229], v2 offset:52224
    v_fma_f32 v246, v242, -0.5, -1.0
    v_mfma_f32_16x16x32_bf16 v[64:67], v[212:215], a[216:219], v[64:67]
    s_add_u32 m0, s60, 0x1ec00
    v_fma_f32 v245, v241, v245, -1.0
    v_fmac_f32 v163, v163, v247
    v_rcp_f32 v244, v244
    v_mfma_f32_16x16x32_bf16 v[72:75], v[212:215], a[220:223], v[72:75]
    s_add_u32 s66, s98, 0xd8280
    ds_read_b64_tr_b16 v[230:231], v2 offset:58368
    v_mul_f32 v241, s67, v169
    v_mfma_f32_16x16x32_bf16 v[72:75], v[208:211], a[204:207], v[72:75]
    s_waitcnt lgkmcnt(4)
    buffer_load_dwordx4 v5, s[36:39], s66 offen lds
    v_mfma_f32_16x16x32_bf16 v[76:79], v[216:219], a[204:207], v[76:79]
    ds_read_b64_tr_b16 v[208:209], v4 offset:51200
    v_fma_f32 v247, v243, -0.5, -1.0
    v_mfma_f32_16x16x32_bf16 v[76:79], v[220:223], a[220:223], v[76:79]
    v_exp_f32 v240, v240
    v_fma_f32 v246, v242, v246, -1.0
    v_mfma_f32_16x16x32_bf16 v[68:71], v[220:223], a[216:219], v[68:71]
    ds_read_b64_tr_b16 v[210:211], v4 offset:57344
    v_cvt_pk_bf16_f32 v121, v162, v163
    v_mfma_f32_16x16x32_bf16 v[68:71], v[216:219], a[200:203], v[68:71]
    v_rcp_f32 v245, v245
    v_fmac_f32 v164, v164, v244
    v_mul_f32 v242, s67, v170
    v_exp_f32 v241, v241
    v_mfma_f32_16x16x32_bf16 v[60:63], v[216:219], a[196:199], v[60:63]
    ds_read_b64_tr_b16 v[212:213], v4 offset:52224
    v_fma_f32 v244, v240, -0.5, -1.0
    v_mfma_f32_16x16x32_bf16 v[60:63], v[220:223], a[212:215], v[60:63]
    v_fma_f32 v247, v243, v247, -1.0
    v_fmac_f32 v165, v165, v245
    v_rcp_f32 v246, v246
    v_mfma_f32_16x16x32_bf16 v[52:55], v[220:223], a[208:211], v[52:55]
    ds_read_b64_tr_b16 v[214:215], v4 offset:58368
    v_mul_f32 v243, s67, v171
    v_mfma_f32_16x16x32_bf16 v[52:55], v[216:219], a[192:195], v[52:55]
    s_waitcnt lgkmcnt(4)
    buffer_load_dwordx4 v6, s[36:39], s66 offen offset:1024 lds
    v_mfma_f32_16x16x32_bf16 v[48:51], v[224:227], a[224:227], v[48:51]
    ds_read_b64_tr_b16 v[216:217], v2 offset:53248
    v_fma_f32 v245, v241, -0.5, -1.0
    v_mfma_f32_16x16x32_bf16 v[48:51], v[228:231], a[240:243], v[48:51]
    v_exp_f32 v242, v242
    v_fma_f32 v244, v240, v244, -1.0
    v_mfma_f32_16x16x32_bf16 v[56:59], v[228:231], a[244:247], v[56:59]
    ds_read_b64_tr_b16 v[218:219], v2 offset:59392
    v_cvt_pk_bf16_f32 v122, v164, v165
    v_mfma_f32_16x16x32_bf16 v[56:59], v[224:227], a[228:231], v[56:59]
    v_rcp_f32 v247, v247
    v_fmac_f32 v166, v166, v246
    v_mul_f32 v240, s67, v172
    v_mfma_f32_16x16x32_bf16 v[64:67], v[224:227], a[232:235], v[64:67]
    ds_read_b64_tr_b16 v[220:221], v2 offset:54272
    v_fma_f32 v246, v242, -0.5, -1.0
    v_mfma_f32_16x16x32_bf16 v[64:67], v[228:231], a[248:251], v[64:67]
    v_exp_f32 v243, v243
    v_fma_f32 v245, v241, v245, -1.0
    v_rcp_f32 v244, v244
    v_fmac_f32 v167, v167, v247
    v_mfma_f32_16x16x32_bf16 v[72:75], v[228:231], a[252:255], v[72:75]
    ds_read_b64_tr_b16 v[222:223], v2 offset:60416
    v_mul_f32 v241, s67, v173
    v_mfma_f32_16x16x32_bf16 v[72:75], v[224:227], a[236:239], v[72:75]
    s_waitcnt lgkmcnt(4)
    buffer_load_dwordx4 v7, s[36:39], s66 offen offset:2048 lds
    v_mfma_f32_16x16x32_bf16 v[76:79], v[208:211], a[236:239], v[76:79]
    ds_read_b64_tr_b16 v[224:225], v4 offset:53248
    v_fma_f32 v247, v243, -0.5, -1.0
    v_mfma_f32_16x16x32_bf16 v[76:79], v[212:215], a[252:255], v[76:79]
    ds_read_b128 v[232:235], v11 offset:1280
    ds_read_b128 v[236:239], v11 offset:1344
    v_mfma_f32_16x16x32_bf16 v[68:71], v[212:215], a[248:251], v[68:71]
    ds_read_b64_tr_b16 v[226:227], v4 offset:59392
    v_fma_f32 v246, v242, v246, -1.0
    v_mfma_f32_16x16x32_bf16 v[68:71], v[208:211], a[232:235], v[68:71]
    v_exp_f32 v240, v240
    v_rcp_f32 v245, v245
    v_cvt_pk_bf16_f32 v123, v166, v167
    v_mfma_f32_16x16x32_bf16 v[60:63], v[208:211], a[228:231], v[60:63]
    ds_read_b64_tr_b16 v[228:229], v4 offset:54272
    v_fmac_f32 v168, v168, v244
    v_mfma_f32_16x16x32_bf16 v[60:63], v[212:215], a[244:247], v[60:63]
    v_mul_f32 v242, s67, v174
    v_fma_f32 v244, v240, -0.5, -1.0
    v_exp_f32 v241, v241
    v_mfma_f32_16x16x32_bf16 v[52:55], v[212:215], a[240:243], v[52:55]
    ds_read_b64_tr_b16 v[230:231], v4 offset:60416
    v_fma_f32 v247, v243, v247, -1.0
    v_mfma_f32_16x16x32_bf16 v[52:55], v[208:211], a[224:227], v[52:55]
    s_waitcnt vmcnt(13) lgkmcnt(6)
    s_barrier
    v_fmac_f32 v169, v169, v245
    v_mfma_f32_16x16x32_bf16 v[48:51], v[216:219], v[176:179], v[48:51]
    ds_read_b64_tr_b16 v[208:209], v3
    v_mul_f32 v243, s67, v175
    v_mfma_f32_16x16x32_bf16 v[48:51], v[220:223], v[192:195], v[48:51]
    buffer_load_dword v253, v249, s[40:43], s78 offen
    v_rcp_f32 v246, v246
    v_mfma_f32_16x16x32_bf16 v[56:59], v[220:223], v[196:199], v[56:59]
    ds_read_b64_tr_b16 v[210:211], v3 offset:6144
    v_fma_f32 v245, v241, -0.5, -1.0
    v_mfma_f32_16x16x32_bf16 v[56:59], v[216:219], v[180:183], v[56:59]
    v_exp_f32 v242, v242
    v_fma_f32 v244, v240, v244, -1.0
    v_mfma_f32_16x16x32_bf16 v[64:67], v[216:219], v[184:187], v[64:67]
    ds_read_b64_tr_b16 v[212:213], v3 offset:1024
    v_cvt_pk_bf16_f32 v124, v168, v169
    v_mfma_f32_16x16x32_bf16 v[64:67], v[220:223], v[200:203], v[64:67]
    v_rcp_f32 v247, v247
    v_fmac_f32 v170, v170, v246
    v_exp_f32 v243, v243
    v_mfma_f32_16x16x32_bf16 v[72:75], v[220:223], v[204:207], v[72:75]
    ds_read_b64_tr_b16 v[214:215], v3 offset:7168
    v_fma_f32 v246, v242, -0.5, -1.0
    v_mfma_f32_16x16x32_bf16 v[72:75], v[216:219], v[188:191], v[72:75]
    s_waitcnt lgkmcnt(4)
    v_fma_f32 v245, v241, v245, -1.0
    v_fmac_f32 v171, v171, v247
    v_rcp_f32 v244, v244
    v_mfma_f32_16x16x32_bf16 v[76:79], v[224:227], v[188:191], v[76:79]
    ds_read_b64_tr_b16 v[216:217], v252
    v_fma_f32 v247, v243, -0.5, -1.0
    v_mfma_f32_16x16x32_bf16 v[76:79], v[228:231], v[204:207], v[76:79]
    v_fma_f32 v246, v242, v246, -1.0
    v_cvt_pk_bf16_f32 v125, v170, v171
    v_rcp_f32 v245, v245
    v_mfma_f32_16x16x32_bf16 v[68:71], v[228:231], v[200:203], v[68:71]
    ds_read_b64_tr_b16 v[218:219], v252 offset:6144
    v_fmac_f32 v172, v172, v244
    v_mfma_f32_16x16x32_bf16 v[68:71], v[224:227], v[184:187], v[68:71]
    v_fma_f32 v247, v243, v247, -1.0
    v_fmac_f32 v173, v173, v245
    v_rcp_f32 v246, v246
    v_mfma_f32_16x16x32_bf16 v[60:63], v[224:227], v[180:183], v[60:63]
    ds_read_b64_tr_b16 v[220:221], v252 offset:1024
    v_cvt_pk_bf16_f32 v126, v172, v173
    v_mfma_f32_16x16x32_bf16 v[60:63], v[228:231], v[196:199], v[60:63]
    v_rcp_f32 v247, v247
    v_fmac_f32 v174, v174, v246
    v_fmac_f32 v175, v175, v247
    v_cvt_pk_bf16_f32 v127, v174, v175
    v_mfma_f32_16x16x32_bf16 v[52:55], v[228:231], v[192:195], v[52:55]
    ds_read_b64_tr_b16 v[222:223], v252 offset:7168
    v_mfma_f32_16x16x32_bf16 v[52:55], v[224:227], v[176:179], v[52:55]
    s_waitcnt lgkmcnt(4)
    v_mfma_f32_16x16x32_bf16 v[144:147], v[208:211], a[0:3], v[232:235]
    ds_read_b64_tr_b16 v[224:225], v3 offset:2048
    v_mul_f32 v240, s67, v16
    v_mfma_f32_16x16x32_bf16 v[144:147], v[212:215], a[16:19], v[144:147]
    v_mul_f32 v241, s67, v17
    v_mul_f32 v242, s67, v18
    v_exp_f32 v240, v240
    v_mfma_f32_16x16x32_bf16 v[152:155], v[212:215], a[20:23], v[232:235]
    ds_read_b64_tr_b16 v[226:227], v3 offset:8192
    v_fma_f32 v244, v240, -0.5, -1.0
    v_mfma_f32_16x16x32_bf16 v[152:155], v[208:211], a[4:7], v[152:155]
    s_add_u32 s65, s68, 0x2000
    buffer_store_dwordx4 v[112:115], v1, s[48:51], s65 offen sc1
    v_mfma_f32_16x16x32_bf16 v[160:163], v[208:211], a[8:11], v[232:235]
    ds_read_b64_tr_b16 v[228:229], v3 offset:3072
    v_mul_f32 v243, s67, v19
    v_mfma_f32_16x16x32_bf16 v[160:163], v[212:215], a[24:27], v[160:163]
    v_exp_f32 v241, v241
    v_exp_f32 v242, v242
    v_fma_f32 v245, v241, -0.5, -1.0
    v_fma_f32 v244, v240, v244, -1.0
    v_mfma_f32_16x16x32_bf16 v[168:171], v[212:215], a[28:31], v[232:235]
    ds_read_b64_tr_b16 v[230:231], v3 offset:9216
    v_mul_f32 v240, s67, v20
    v_mfma_f32_16x16x32_bf16 v[168:171], v[208:211], a[12:15], v[168:171]
    s_waitcnt lgkmcnt(4)
    v_exp_f32 v243, v243
    v_fma_f32 v246, v242, -0.5, -1.0
    v_fma_f32 v245, v241, v245, -1.0
    v_mfma_f32_16x16x32_bf16 v[172:175], v[216:219], a[12:15], v[236:239]
    ds_read_b64_tr_b16 v[208:209], v252 offset:2048
    v_mul_f32 v241, s67, v21
    v_mfma_f32_16x16x32_bf16 v[172:175], v[220:223], a[28:31], v[172:175]
    v_rcp_f32 v244, v244
    v_exp_f32 v240, v240
    v_fma_f32 v247, v243, -0.5, -1.0
    v_fma_f32 v246, v242, v246, -1.0
    v_mfma_f32_16x16x32_bf16 v[164:167], v[220:223], a[24:27], v[236:239]
    ds_read_b64_tr_b16 v[210:211], v252 offset:8192
    v_fmac_f32 v16, v16, v244
    v_mfma_f32_16x16x32_bf16 v[164:167], v[216:219], a[8:11], v[164:167]
    buffer_store_dwordx4 v[116:119], v1, s[48:51], s65 offen offset:1024 sc1
    v_mfma_f32_16x16x32_bf16 v[156:159], v[216:219], a[4:7], v[236:239]
    ds_read_b64_tr_b16 v[212:213], v252 offset:3072
    v_mul_f32 v242, s67, v22
    v_mfma_f32_16x16x32_bf16 v[156:159], v[220:223], a[20:23], v[156:159]
    v_rcp_f32 v245, v245
    v_exp_f32 v241, v241
    v_fma_f32 v244, v240, -0.5, -1.0
    v_mfma_f32_16x16x32_bf16 v[148:151], v[220:223], a[16:19], v[236:239]
    ds_read_b64_tr_b16 v[214:215], v252 offset:9216
    v_fma_f32 v247, v243, v247, -1.0
    v_mfma_f32_16x16x32_bf16 v[148:151], v[216:219], a[0:3], v[148:151]
    s_waitcnt lgkmcnt(4)
    v_rcp_f32 v246, v246
    v_fmac_f32 v17, v17, v245
    v_mul_f32 v243, s67, v23
    v_mfma_f32_16x16x32_bf16 v[144:147], v[224:227], a[32:35], v[144:147]
    ds_read_b64_tr_b16 v[216:217], v3 offset:4096
    v_fma_f32 v245, v241, -0.5, -1.0
    v_mfma_f32_16x16x32_bf16 v[144:147], v[228:231], a[48:51], v[144:147]
    v_exp_f32 v242, v242
    v_fma_f32 v244, v240, v244, -1.0
    v_rcp_f32 v247, v247
    v_cvt_pk_bf16_f32 v128, v16, v17
    v_mfma_f32_16x16x32_bf16 v[152:155], v[228:231], a[52:55], v[152:155]
    ds_read_b64_tr_b16 v[218:219], v3 offset:10240
    v_fmac_f32 v18, v18, v246
    v_mfma_f32_16x16x32_bf16 v[152:155], v[224:227], a[36:39], v[152:155]
    buffer_store_dwordx4 v[120:123], v1, s[48:51], s65 offen offset:2048 sc1
    v_mul_f32 v240, s67, v24
    v_mfma_f32_16x16x32_bf16 v[160:163], v[224:227], a[40:43], v[160:163]
    ds_read_b64_tr_b16 v[220:221], v3 offset:5120
    v_fma_f32 v246, v242, -0.5, -1.0
    v_mfma_f32_16x16x32_bf16 v[160:163], v[228:231], a[56:59], v[160:163]
    v_exp_f32 v243, v243
    v_fma_f32 v245, v241, v245, -1.0
    v_rcp_f32 v244, v244
    v_mfma_f32_16x16x32_bf16 v[168:171], v[228:231], a[60:63], v[168:171]
    ds_read_b64_tr_b16 v[222:223], v3 offset:11264
    v_fmac_f32 v19, v19, v247
    v_mfma_f32_16x16x32_bf16 v[168:171], v[224:227], a[44:47], v[168:171]
    s_waitcnt lgkmcnt(4)
    v_mul_f32 v241, s67, v25
    v_fma_f32 v247, v243, -0.5, -1.0
    v_exp_f32 v240, v240
    v_mfma_f32_16x16x32_bf16 v[172:175], v[208:211], a[44:47], v[172:175]
    ds_read_b64_tr_b16 v[224:225], v252 offset:4096
    v_fma_f32 v246, v242, v246, -1.0
    v_mfma_f32_16x16x32_bf16 v[172:175], v[212:215], a[60:63], v[172:175]
    v_rcp_f32 v245, v245
    v_cvt_pk_bf16_f32 v129, v18, v19
    v_fmac_f32 v20, v20, v244
    v_mul_f32 v242, s67, v26
    v_mfma_f32_16x16x32_bf16 v[164:167], v[212:215], a[56:59], v[164:167]
    ds_read_b64_tr_b16 v[226:227], v252 offset:10240
    v_fma_f32 v244, v240, -0.5, -1.0
    v_mfma_f32_16x16x32_bf16 v[164:167], v[208:211], a[40:43], v[164:167]
    buffer_store_dwordx4 v[124:127], v1, s[48:51], s65 offen offset:3072 sc1
    v_mfma_f32_16x16x32_bf16 v[156:159], v[208:211], a[36:39], v[156:159]
    ds_read_b64_tr_b16 v[228:229], v252 offset:5120
    v_fma_f32 v247, v243, v247, -1.0
    v_mfma_f32_16x16x32_bf16 v[156:159], v[212:215], a[52:55], v[156:159]
    v_exp_f32 v241, v241
    v_rcp_f32 v246, v246
    v_fmac_f32 v21, v21, v245
    v_mul_f32 v243, s67, v27
    v_mfma_f32_16x16x32_bf16 v[148:151], v[212:215], a[48:51], v[148:151]
    ds_read_b64_tr_b16 v[230:231], v252 offset:11264
    v_fma_f32 v245, v241, -0.5, -1.0
L_pad_f3:
    s_cbranch_execz L_pad_f7
    v_mfma_f32_16x16x32_bf16 v[148:151], v[208:211], a[32:35], v[148:151]
    s_waitcnt vmcnt(12) lgkmcnt(4)
    s_barrier
    buffer_load_dword v13, v12, s[48:51], 0 offen sc1
    v_mfma_f32_16x16x32_bf16 v[144:147], v[216:219], a[64:67], v[144:147]
    s_add_u32 m0, s60, 0
    ds_read_b64_tr_b16 v[208:209], v3 offset:24576
    v_xor_b32 v232, 0, v251
    v_mfma_f32_16x16x32_bf16 v[144:147], v[220:223], a[80:83], v[144:147]
    s_add_u32 s66, s71, 0
    buffer_load_dwordx4 v8, s[40:43], s66 offen lds
    v_mfma_f32_16x16x32_bf16 v[152:155], v[220:223], a[84:87], v[152:155]
    ds_read_b64_tr_b16 v[210:211], v3 offset:30720
    v_add_u32 v233, 0x12000, v232
    v_mfma_f32_16x16x32_bf16 v[152:155], v[216:219], a[68:71], v[152:155]
    s_add_u32 s66, s71, 0x80
    buffer_load_dwordx4 v9, s[40:43], s66 offen offset:1024 lds
    v_mfma_f32_16x16x32_bf16 v[160:163], v[216:219], a[72:75], v[160:163]
    ds_read_b64_tr_b16 v[212:213], v3 offset:25600
    v_xor_b32 v234, 32, v251
    v_mfma_f32_16x16x32_bf16 v[160:163], v[220:223], a[88:91], v[160:163]
    v_exp_f32 v242, v242
    v_fma_f32 v244, v240, v244, -1.0
    v_rcp_f32 v247, v247
    v_mfma_f32_16x16x32_bf16 v[168:171], v[220:223], a[92:95], v[168:171]
    s_add_u32 s66, s71, 0x100
    ds_read_b64_tr_b16 v[214:215], v3 offset:31744
    v_cvt_pk_bf16_f32 v130, v20, v21
    v_mfma_f32_16x16x32_bf16 v[168:171], v[216:219], a[76:79], v[168:171]
    s_waitcnt lgkmcnt(4)
    buffer_load_dwordx4 v10, s[40:43], s66 offen offset:2048 lds
    v_fmac_f32 v22, v22, v246
    v_mfma_f32_16x16x32_bf16 v[172:175], v[224:227], a[76:79], v[172:175]
    ds_read_b64_tr_b16 v[216:217], v252 offset:24576
    v_mul_f32 v240, s67, v28
    v_mfma_f32_16x16x32_bf16 v[172:175], v[228:231], a[92:95], v[172:175]
    v_add_u32 v235, 0x12000, v234
    v_fma_f32 v246, v242, -0.5, -1.0
    v_mfma_f32_16x16x32_bf16 v[164:167], v[228:231], a[88:91], v[164:167]
    s_add_u32 m0, s60, 0xc00
    ds_read_b64_tr_b16 v[218:219], v252 offset:30720
    v_fma_f32 v245, v241, v245, -1.0
    v_mfma_f32_16x16x32_bf16 v[164:167], v[224:227], a[72:75], v[164:167]
    s_add_u32 s66, s71, 0x2400
    buffer_load_dwordx4 v8, s[40:43], s66 offen lds
    v_exp_f32 v243, v243
    v_mfma_f32_16x16x32_bf16 v[156:159], v[224:227], a[68:71], v[156:159]
    ds_read_b64_tr_b16 v[220:221], v252 offset:25600
    v_fmac_f32 v23, v23, v247
    v_mfma_f32_16x16x32_bf16 v[156:159], v[228:231], a[84:87], v[156:159]
    v_rcp_f32 v244, v244
    v_mul_f32 v241, s67, v29
    v_exp_f32 v240, v240
    v_mfma_f32_16x16x32_bf16 v[148:151], v[228:231], a[80:83], v[148:151]
    s_add_u32 s66, s71, 0x2480
    ds_read_b64_tr_b16 v[222:223], v252 offset:31744
    v_fma_f32 v247, v243, -0.5, -1.0
    v_mfma_f32_16x16x32_bf16 v[148:151], v[224:227], a[64:67], v[148:151]
    s_waitcnt lgkmcnt(4)
    buffer_load_dwordx4 v9, s[40:43], s66 offen offset:1024 lds
    v_fma_f32 v246, v242, v246, -1.0
    v_mfma_f32_16x16x32_bf16 v[144:147], v[208:211], a[96:99], v[144:147]
    ds_read_b64_tr_b16 v[224:225], v3 offset:26624
    v_cvt_pk_bf16_f32 v131, v22, v23
    v_mfma_f32_16x16x32_bf16 v[144:147], v[212:215], a[112:115], v[144:147]
    v_rcp_f32 v245, v245
    v_fmac_f32 v24, v24, v244
    v_mul_f32 v242, s67, v30
    v_mfma_f32_16x16x32_bf16 v[152:155], v[212:215], a[116:119], v[152:155]
    ds_read_b64_tr_b16 v[226:227], v3 offset:32768
    v_xor_b32 v236, 64, v251
    v_mfma_f32_16x16x32_bf16 v[152:155], v[208:211], a[100:103], v[152:155]
    s_add_u32 s66, s71, 0x2500
    buffer_load_dwordx4 v10, s[40:43], s66 offen offset:2048 lds
    v_mfma_f32_16x16x32_bf16 v[160:163], v[208:211], a[104:107], v[160:163]
    ds_read_b64_tr_b16 v[228:229], v3 offset:27648
    v_fma_f32 v244, v240, -0.5, -1.0
    v_mfma_f32_16x16x32_bf16 v[160:163], v[212:215], a[120:123], v[160:163]
    s_add_u32 m0, s60, 0x6000
    v_exp_f32 v241, v241
    v_fma_f32 v247, v243, v247, -1.0
    v_rcp_f32 v246, v246
    v_fmac_f32 v25, v25, v245
    v_mfma_f32_16x16x32_bf16 v[168:171], v[212:215], a[124:127], v[168:171]
    s_add_u32 s66, s71, 0x12000
    ds_read_b64_tr_b16 v[230:231], v3 offset:33792
    v_mul_f32 v243, s67, v31
    v_mfma_f32_16x16x32_bf16 v[168:171], v[208:211], a[108:111], v[168:171]
    s_waitcnt lgkmcnt(4)
    buffer_load_dwordx4 v8, s[40:43], s66 offen lds
    v_mfma_f32_16x16x32_bf16 v[172:175], v[216:219], a[108:111], v[172:175]
    ds_read_b64_tr_b16 v[208:209], v252 offset:26624
    v_fma_f32 v245, v241, -0.5, -1.0
    v_mfma_f32_16x16x32_bf16 v[172:175], v[220:223], a[124:127], v[172:175]
    v_exp_f32 v242, v242
    v_fma_f32 v244, v240, v244, -1.0
    v_rcp_f32 v247, v247
    v_mfma_f32_16x16x32_bf16 v[164:167], v[220:223], a[120:123], v[164:167]
    ds_read_b64_tr_b16 v[210:211], v252 offset:32768
    v_add_u32 v237, 0x12000, v236
    v_mfma_f32_16x16x32_bf16 v[164:167], v[216:219], a[104:107], v[164:167]
    s_add_u32 s66, s71, 0x12080
    buffer_load_dwordx4 v9, s[40:43], s66 offen offset:1024 lds
    v_mfma_f32_16x16x32_bf16 v[156:159], v[216:219], a[100:103], v[156:159]
    ds_read_b64_tr_b16 v[212:213], v252 offset:27648
    v_cvt_pk_bf16_f32 v132, v24, v25
    v_mfma_f32_16x16x32_bf16 v[156:159], v[220:223], a[116:119], v[156:159]
    v_fmac_f32 v26, v26, v246
    v_mul_f32 v240, s67, v32
    v_exp_f32 v243, v243
    v_fma_f32 v246, v242, -0.5, -1.0
    v_mfma_f32_16x16x32_bf16 v[148:151], v[220:223], a[112:115], v[148:151]
    s_add_u32 s66, s71, 0x12100
    ds_read_b64_tr_b16 v[214:215], v252 offset:33792
    v_fma_f32 v245, v241, v245, -1.0
    v_mfma_f32_16x16x32_bf16 v[148:151], v[216:219], a[96:99], v[148:151]
    s_waitcnt lgkmcnt(4)
    buffer_load_dwordx4 v10, s[40:43], s66 offen offset:2048 lds
    v_mfma_f32_16x16x32_bf16 v[144:147], v[224:227], a[128:131], v[144:147]
    ds_read_b64_tr_b16 v[216:217], v3 offset:28672
    v_fmac_f32 v27, v27, v247
    v_mfma_f32_16x16x32_bf16 v[144:147], v[228:231], a[144:147], v[144:147]
    v_rcp_f32 v244, v244
    v_mul_f32 v241, s67, v33
    v_exp_f32 v240, v240
    v_fma_f32 v247, v243, -0.5, -1.0
    v_mfma_f32_16x16x32_bf16 v[152:155], v[228:231], a[148:151], v[152:155]
    s_add_u32 m0, s60, 0x6c00
    ds_read_b64_tr_b16 v[218:219], v3 offset:34816
    v_fma_f32 v246, v242, v246, -1.0
    v_mfma_f32_16x16x32_bf16 v[152:155], v[224:227], a[132:135], v[152:155]
    s_add_u32 s66, s71, 0x14400
    buffer_load_dwordx4 v8, s[40:43], s66 offen lds
    v_mfma_f32_16x16x32_bf16 v[160:163], v[224:227], a[136:139], v[160:163]
    ds_read_b64_tr_b16 v[220:221], v3 offset:29696
    v_xor_b32 v238, 0x60, v251
    v_mfma_f32_16x16x32_bf16 v[160:163], v[228:231], a[152:155], v[160:163]
    v_rcp_f32 v245, v245
    v_cvt_pk_bf16_f32 v133, v26, v27
    v_fmac_f32 v28, v28, v244
    v_mul_f32 v242, s67, v34
    v_mfma_f32_16x16x32_bf16 v[168:171], v[228:231], a[156:159], v[168:171]
    s_add_u32 s66, s71, 0x14480
    ds_read_b64_tr_b16 v[222:223], v3 offset:35840
    v_fma_f32 v244, v240, -0.5, -1.0
    v_mfma_f32_16x16x32_bf16 v[168:171], v[224:227], a[140:143], v[168:171]
    s_waitcnt lgkmcnt(4)
    buffer_load_dwordx4 v9, s[40:43], s66 offen offset:1024 lds
    v_mfma_f32_16x16x32_bf16 v[172:175], v[208:211], a[140:143], v[172:175]
    ds_read_b64_tr_b16 v[224:225], v252 offset:28672
    v_fma_f32 v247, v243, v247, -1.0
    v_mfma_f32_16x16x32_bf16 v[172:175], v[212:215], a[156:159], v[172:175]
    v_exp_f32 v241, v241
    v_rcp_f32 v246, v246
    v_fmac_f32 v29, v29, v245
    v_mfma_f32_16x16x32_bf16 v[164:167], v[212:215], a[152:155], v[164:167]
    ds_read_b64_tr_b16 v[226:227], v252 offset:34816
    v_mul_f32 v243, s67, v35
    v_mfma_f32_16x16x32_bf16 v[164:167], v[208:211], a[136:139], v[164:167]
    s_add_u32 s66, s71, 0x14500
    buffer_load_dwordx4 v10, s[40:43], s66 offen offset:2048 lds
    v_mfma_f32_16x16x32_bf16 v[156:159], v[208:211], a[132:135], v[156:159]
    ds_read_b64_tr_b16 v[228:229], v252 offset:29696
    v_fma_f32 v245, v241, -0.5, -1.0
    v_mfma_f32_16x16x32_bf16 v[156:159], v[212:215], a[148:151], v[156:159]
    v_add_u32 v239, 0x12000, v238
    v_fma_f32 v244, v240, v244, -1.0
    v_exp_f32 v242, v242
    v_mfma_f32_16x16x32_bf16 v[148:151], v[212:215], a[144:147], v[148:151]
    ds_read_b64_tr_b16 v[230:231], v252 offset:35840
    v_cvt_pk_bf16_f32 v134, v28, v29
    v_mfma_f32_16x16x32_bf16 v[148:151], v[208:211], a[128:131], v[148:151]
    s_waitcnt vmcnt(18) lgkmcnt(4)
    s_barrier
    v_fmac_f32 v30, v30, v246
    v_rcp_f32 v247, v247
    v_mul_f32 v240, s67, v36
    v_mfma_f32_16x16x32_bf16 v[144:147], v[216:219], a[160:163], v[144:147]
    s_add_u32 m0, s60, 0xc000
    ds_read_b64_tr_b16 v[208:209], v3 offset:49152
    v_fma_f32 v246, v242, -0.5, -1.0
    v_mfma_f32_16x16x32_bf16 v[144:147], v[220:223], a[176:179], v[144:147]
    s_add_u32 s66, s71, 0x24000
    buffer_load_dwordx4 v8, s[40:43], s66 offen lds
    v_mfma_f32_16x16x32_bf16 v[152:155], v[220:223], a[180:183], v[152:155]
    ds_read_b64_tr_b16 v[210:211], v3 offset:55296
    v_fma_f32 v245, v241, v245, -1.0
    v_mfma_f32_16x16x32_bf16 v[152:155], v[216:219], a[164:167], v[152:155]
    s_add_u32 s66, s71, 0x24080
    buffer_load_dwordx4 v9, s[40:43], s66 offen offset:1024 lds
    v_exp_f32 v243, v243
    v_mfma_f32_16x16x32_bf16 v[160:163], v[216:219], a[168:171], v[160:163]
    ds_read_b64_tr_b16 v[212:213], v3 offset:50176
    v_fmac_f32 v31, v31, v247
    v_mfma_f32_16x16x32_bf16 v[160:163], v[220:223], a[184:187], v[160:163]
    v_rcp_f32 v244, v244
    v_mul_f32 v241, s67, v37
    v_exp_f32 v240, v240
    v_mfma_f32_16x16x32_bf16 v[168:171], v[220:223], a[188:191], v[168:171]
    s_add_u32 s66, s71, 0x24100
    ds_read_b64_tr_b16 v[214:215], v3 offset:56320
    v_fma_f32 v247, v243, -0.5, -1.0
    v_mfma_f32_16x16x32_bf16 v[168:171], v[216:219], a[172:175], v[168:171]
    s_waitcnt lgkmcnt(4)
    buffer_load_dwordx4 v10, s[40:43], s66 offen offset:2048 lds
    v_fma_f32 v246, v242, v246, -1.0
    v_mfma_f32_16x16x32_bf16 v[172:175], v[224:227], a[172:175], v[172:175]
    ds_read_b64_tr_b16 v[216:217], v252 offset:49152
    v_cvt_pk_bf16_f32 v135, v30, v31
    v_mfma_f32_16x16x32_bf16 v[172:175], v[228:231], a[188:191], v[172:175]
    v_rcp_f32 v245, v245
    v_fmac_f32 v32, v32, v244
    v_mul_f32 v242, s67, v38
    v_mfma_f32_16x16x32_bf16 v[164:167], v[228:231], a[184:187], v[164:167]
    s_add_u32 m0, s60, 0xcc00
    ds_read_b64_tr_b16 v[218:219], v252 offset:55296
    v_fma_f32 v244, v240, -0.5, -1.0
    v_mfma_f32_16x16x32_bf16 v[164:167], v[224:227], a[168:171], v[164:167]
    s_add_u32 s66, s71, 0x26400
    buffer_load_dwordx4 v8, s[40:43], s66 offen lds
    v_mfma_f32_16x16x32_bf16 v[156:159], v[224:227], a[164:167], v[156:159]
    ds_read_b64_tr_b16 v[220:221], v252 offset:50176
    v_fma_f32 v247, v243, v247, -1.0
    v_mfma_f32_16x16x32_bf16 v[156:159], v[228:231], a[180:183], v[156:159]
    v_exp_f32 v241, v241
    v_rcp_f32 v246, v246
    v_fmac_f32 v33, v33, v245
    v_mul_f32 v243, s67, v39
    v_mfma_f32_16x16x32_bf16 v[148:151], v[228:231], a[176:179], v[148:151]
    s_add_u32 s66, s71, 0x26480
    ds_read_b64_tr_b16 v[222:223], v252 offset:56320
    v_fma_f32 v245, v241, -0.5, -1.0
    v_mfma_f32_16x16x32_bf16 v[148:151], v[224:227], a[160:163], v[148:151]
    s_waitcnt lgkmcnt(4)
    buffer_load_dwordx4 v9, s[40:43], s66 offen offset:1024 lds
    v_mfma_f32_16x16x32_bf16 v[144:147], v[208:211], a[192:195], v[144:147]
    ds_read_b64_tr_b16 v[224:225], v3 offset:51200
    v_fma_f32 v244, v240, v244, -1.0
    v_mfma_f32_16x16x32_bf16 v[144:147], v[212:215], a[208:211], v[144:147]
    v_exp_f32 v242, v242
    v_rcp_f32 v247, v247
    v_cvt_pk_bf16_f32 v136, v32, v33
    v_fmac_f32 v34, v34, v246
    v_mfma_f32_16x16x32_bf16 v[152:155], v[212:215], a[212:215], v[152:155]
    ds_read_b64_tr_b16 v[226:227], v3 offset:57344
    v_mul_f32 v240, s67, v40
    v_mfma_f32_16x16x32_bf16 v[152:155], v[208:211], a[196:199], v[152:155]
    s_add_u32 s66, s71, 0x26500
    buffer_load_dwordx4 v10, s[40:43], s66 offen offset:2048 lds
    v_mfma_f32_16x16x32_bf16 v[160:163], v[208:211], a[200:203], v[160:163]
    ds_read_b64_tr_b16 v[228:229], v3 offset:52224
    v_fma_f32 v246, v242, -0.5, -1.0
    v_mfma_f32_16x16x32_bf16 v[160:163], v[212:215], a[216:219], v[160:163]
    s_add_u32 m0, s60, 0x12000
    v_exp_f32 v243, v243
    v_fma_f32 v245, v241, v245, -1.0
    v_rcp_f32 v244, v244
    v_fmac_f32 v35, v35, v247
    v_mfma_f32_16x16x32_bf16 v[168:171], v[212:215], a[220:223], v[168:171]
    s_add_u32 s66, s71, 0x36000
    ds_read_b64_tr_b16 v[230:231], v3 offset:58368
    v_mul_f32 v241, s67, v41
    v_mfma_f32_16x16x32_bf16 v[168:171], v[208:211], a[204:207], v[168:171]
    s_waitcnt lgkmcnt(4)
    buffer_load_dwordx4 v8, s[40:43], s66 offen lds
    v_mfma_f32_16x16x32_bf16 v[172:175], v[216:219], a[204:207], v[172:175]
    ds_read_b64_tr_b16 v[208:209], v252 offset:51200
    v_fma_f32 v247, v243, -0.5, -1.0
    v_mfma_f32_16x16x32_bf16 v[172:175], v[220:223], a[220:223], v[172:175]
    v_exp_f32 v240, v240
    v_fma_f32 v246, v242, v246, -1.0
    v_rcp_f32 v245, v245
    v_mfma_f32_16x16x32_bf16 v[164:167], v[220:223], a[216:219], v[164:167]
    ds_read_b64_tr_b16 v[210:211], v252 offset:57344
    v_cvt_pk_bf16_f32 v137, v34, v35
    v_mfma_f32_16x16x32_bf16 v[164:167], v[216:219], a[200:203], v[164:167]
    s_add_u32 s66, s71, 0x36080
    buffer_load_dwordx4 v9, s[40:43], s66 offen offset:1024 lds
    v_fmac_f32 v36, v36, v244
    v_mfma_f32_16x16x32_bf16 v[156:159], v[216:219], a[196:199], v[156:159]
    ds_read_b64_tr_b16 v[212:213], v252 offset:52224
    v_mul_f32 v242, s67, v42
    v_mfma_f32_16x16x32_bf16 v[156:159], v[220:223], a[212:215], v[156:159]
    v_exp_f32 v241, v241
    v_fma_f32 v244, v240, -0.5, -1.0
    v_fma_f32 v247, v243, v247, -1.0
    v_mfma_f32_16x16x32_bf16 v[148:151], v[220:223], a[208:211], v[148:151]
    s_add_u32 s66, s71, 0x36100
    ds_read_b64_tr_b16 v[214:215], v252 offset:58368
    v_fmac_f32 v37, v37, v245
    v_mfma_f32_16x16x32_bf16 v[148:151], v[216:219], a[192:195], v[148:151]
    s_waitcnt lgkmcnt(4)
    buffer_load_dwordx4 v10, s[40:43], s66 offen offset:2048 lds
    v_rcp_f32 v246, v246
    v_mfma_f32_16x16x32_bf16 v[144:147], v[224:227], a[224:227], v[144:147]
    ds_read_b64_tr_b16 v[216:217], v3 offset:53248
    v_mul_f32 v243, s67, v43
    v_mfma_f32_16x16x32_bf16 v[144:147], v[228:231], a[240:243], v[144:147]
    v_exp_f32 v242, v242
    v_fma_f32 v245, v241, -0.5, -1.0
    v_fma_f32 v244, v240, v244, -1.0
    v_mfma_f32_16x16x32_bf16 v[152:155], v[228:231], a[244:247], v[152:155]
    s_add_u32 m0, s60, 0x12c00
    ds_read_b64_tr_b16 v[218:219], v3 offset:59392
    v_cvt_pk_bf16_f32 v138, v36, v37
    v_mfma_f32_16x16x32_bf16 v[152:155], v[224:227], a[228:231], v[152:155]
    s_add_u32 s66, s71, 0x38400
    buffer_load_dwordx4 v8, s[40:43], s66 offen lds
    v_rcp_f32 v247, v247
    v_mfma_f32_16x16x32_bf16 v[160:163], v[224:227], a[232:235], v[160:163]
    ds_read_b64_tr_b16 v[220:221], v3 offset:54272
    v_fmac_f32 v38, v38, v246
    v_mfma_f32_16x16x32_bf16 v[160:163], v[228:231], a[248:251], v[160:163]
    v_mul_f32 v240, s67, v44
    v_fma_f32 v246, v242, -0.5, -1.0
    v_exp_f32 v243, v243
    v_mfma_f32_16x16x32_bf16 v[168:171], v[228:231], a[252:255], v[168:171]
    s_add_u32 s66, s71, 0x38480
    ds_read_b64_tr_b16 v[222:223], v3 offset:60416
    v_fma_f32 v245, v241, v245, -1.0
    v_mfma_f32_16x16x32_bf16 v[168:171], v[224:227], a[236:239], v[168:171]
    s_waitcnt lgkmcnt(4)
    buffer_load_dwordx4 v9, s[40:43], s66 offen offset:1024 lds
    v_mfma_f32_16x16x32_bf16 v[172:175], v[208:211], a[236:239], v[172:175]
    ds_read_b64_tr_b16 v[224:225], v252 offset:53248
    v_fmac_f32 v39, v39, v247
    v_mfma_f32_16x16x32_bf16 v[172:175], v[212:215], a[252:255], v[172:175]
    v_rcp_f32 v244, v244
    v_mul_f32 v241, s67, v45
    v_exp_f32 v240, v240
    v_fma_f32 v247, v243, -0.5, -1.0
    v_mfma_f32_16x16x32_bf16 v[164:167], v[212:215], a[248:251], v[164:167]
    ds_read_b64_tr_b16 v[226:227], v252 offset:59392
    v_fma_f32 v246, v242, v246, -1.0
    v_mfma_f32_16x16x32_bf16 v[164:167], v[208:211], a[232:235], v[164:167]
    s_add_u32 s66, s71, 0x38500
    buffer_load_dwordx4 v10, s[40:43], s66 offen offset:2048 lds
    v_mfma_f32_16x16x32_bf16 v[156:159], v[208:211], a[228:231], v[156:159]
    ds_read_b64_tr_b16 v[228:229], v252 offset:54272
    v_cvt_pk_bf16_f32 v139, v38, v39
    v_mfma_f32_16x16x32_bf16 v[156:159], v[212:215], a[244:247], v[156:159]
    v_rcp_f32 v245, v245
    v_fmac_f32 v40, v40, v244
    v_mul_f32 v242, s67, v46
    v_exp_f32 v241, v241
    v_mfma_f32_16x16x32_bf16 v[148:151], v[212:215], a[240:243], v[148:151]
    ds_read_b64_tr_b16 v[230:231], v252 offset:60416
    v_fma_f32 v244, v240, -0.5, -1.0
    v_mfma_f32_16x16x32_bf16 v[148:151], v[208:211], a[224:227], v[148:151]
    s_waitcnt vmcnt(18) lgkmcnt(4)
    s_barrier
    v_cmp_ne_u32 vcc, v13, v250
    s_cbranch_vccz L_ok1
    s_mov_b32 s75, 131072
L_sp1:
    s_sleep 2
    buffer_load_dword v13, v12, s[48:51], 0 offen sc1
    s_waitcnt vmcnt(0)
    v_cmp_ne_u32 vcc, v13, v250
    s_cbranch_vccz L_ok1
    s_sub_u32 s75, s75, 1
    s_cmp_lg_u32 s75, 0
    s_cbranch_scc1 L_sp1
L_ok1:
    v_fma_f32 v247, v243, v247, -1.0
    v_mfma_f32_16x16x32_bf16 v[144:147], v[216:219], v[176:179], v[144:147]
    s_add_u32 m0, s60, 0x18000
    ds_read_b64_tr_b16 v[208:209], v232
    v_fmac_f32 v41, v41, v245
    v_mfma_f32_16x16x32_bf16 v[144:147], v[220:223], v[192:195], v[144:147]
    s_add_u32 s66, s72, 0
    buffer_load_dwordx4 v8, s[40:43], s66 offen lds
    v_mfma_f32_16x16x32_bf16 v[152:155], v[220:223], v[196:199], v[152:155]
    ds_read_b64_tr_b16 v[210:211], v232 offset:6144
    v_mul_f32 v243, s67, v47
    v_mfma_f32_16x16x32_bf16 v[152:155], v[216:219], v[180:183], v[152:155]
    v_rcp_f32 v246, v246
    v_exp_f32 v242, v242
    v_fma_f32 v245, v241, -0.5, -1.0
    v_mfma_f32_16x16x32_bf16 v[160:163], v[216:219], v[184:187], v[160:163]
    ds_read_b64_tr_b16 v[212:213], v234
    v_fma_f32 v244, v240, v244, -1.0
    v_mfma_f32_16x16x32_bf16 v[160:163], v[220:223], v[200:203], v[160:163]
    v_rcp_f32 v247, v247
    v_cvt_pk_bf16_f32 v140, v40, v41
    v_fmac_f32 v42, v42, v246
    v_mfma_f32_16x16x32_bf16 v[168:171], v[220:223], v[204:207], v[168:171]
    s_add_u32 s66, s72, 0x80
    ds_read_b64_tr_b16 v[214:215], v234 offset:6144
    v_fma_f32 v246, v242, -0.5, -1.0
    v_mfma_f32_16x16x32_bf16 v[168:171], v[216:219], v[188:191], v[168:171]
    s_waitcnt lgkmcnt(4)
    buffer_load_dwordx4 v9, s[40:43], s66 offen offset:1024 lds
    v_exp_f32 v243, v243
    v_mfma_f32_16x16x32_bf16 v[172:175], v[224:227], v[188:191], v[172:175]
    ds_read_b64_tr_b16 v[216:217], v236
    v_fma_f32 v245, v241, v245, -1.0
    v_mfma_f32_16x16x32_bf16 v[172:175], v[228:231], v[204:207], v[172:175]
    v_rcp_f32 v244, v244
    v_fmac_f32 v43, v43, v247
    v_fma_f32 v247, v243, -0.5, -1.0
    v_fma_f32 v246, v242, v246, -1.0
    v_mfma_f32_16x16x32_bf16 v[164:167], v[228:231], v[200:203], v[164:167]
    ds_read_b64_tr_b16 v[218:219], v236 offset:6144
    v_cvt_pk_bf16_f32 v141, v42, v43
    v_mfma_f32_16x16x32_bf16 v[164:167], v[224:227], v[184:187], v[164:167]
    v_rcp_f32 v245, v245
    v_fmac_f32 v44, v44, v244
    v_fma_f32 v247, v243, v247, -1.0
    v_mfma_f32_16x16x32_bf16 v[156:159], v[224:227], v[180:183], v[156:159]
    ds_read_b64_tr_b16 v[220:221], v238
    v_fmac_f32 v45, v45, v245
    v_mfma_f32_16x16x32_bf16 v[156:159], v[228:231], v[196:199], v[156:159]
    v_rcp_f32 v246, v246
    v_rcp_f32 v247, v247
    v_cvt_pk_bf16_f32 v142, v44, v45
    v_fmac_f32 v46, v46, v246
    v_mfma_f32_16x16x32_bf16 v[148:151], v[228:231], v[192:195], v[148:151]
    s_add_u32 s66, s72, 0x100
    ds_read_b64_tr_b16 v[222:223], v238 offset:6144
    v_fmac_f32 v47, v47, v247
    v_mfma_f32_16x16x32_bf16 v[148:151], v[224:227], v[176:179], v[148:151]
    s_waitcnt lgkmcnt(6)
    buffer_load_dwordx4 v10, s[40:43], s66 offen offset:2048 lds
    v_cvt_pk_bf16_f32 v143, v46, v47
    v_mfma_f32_16x16x32_bf16 a[0:3], v[208:211], v[80:83], 0
    s_sub_u32 s36, s12, 2048
    s_subb_u32 s37, s13, 0
    v_mul_f32 v240, s67, v48
    v_mul_f32 v241, s67, v49
    v_mfma_f32_16x16x32_bf16 a[4:7], v[208:211], v[84:87], 0
    s_mov_b32 s38, 0xa2800
    v_exp_f32 v240, v240
    v_mfma_f32_16x16x32_bf16 a[8:11], v[208:211], v[88:91], 0
    s_add_u32 s65, s68, 0x3000
    v_mul_f32 v242, s67, v50
    v_fma_f32 v244, v240, -0.5, -1.0
    v_mfma_f32_16x16x32_bf16 a[12:15], v[208:211], v[92:95], 0
    s_waitcnt lgkmcnt(4)
    buffer_store_dwordx4 v[128:131], v1, s[48:51], s65 offen sc1
    v_mfma_f32_16x16x32_bf16 a[28:31], v[212:215], v[92:95], 0
    s_mov_b32 s39, 0x20000
    ds_read_b64_tr_b16 v[224:225], v232 offset:1024
    v_mul_f32 v243, s67, v51
    v_mfma_f32_16x16x32_bf16 a[24:27], v[212:215], v[88:91], 0
    s_add_u32 m0, s60, 0x18c00
    ds_read_b64_tr_b16 v[226:227], v232 offset:7168
    v_fma_f32 v244, v240, v244, -1.0
    v_mfma_f32_16x16x32_bf16 a[20:23], v[212:215], v[84:87], 0
    s_add_u32 s66, s72, 0x2400
    buffer_load_dwordx4 v8, s[40:43], s66 offen lds
    v_mfma_f32_16x16x32_bf16 a[16:19], v[212:215], v[80:83], 0
    s_waitcnt lgkmcnt(4)
    v_exp_f32 v241, v241
    v_mfma_f32_16x16x32_bf16 a[32:35], v[216:219], v[80:83], 0
    s_mul_i32 s88, s57, 0x28800
    ds_read_b64_tr_b16 v[228:229], v234 offset:1024
    v_fma_f32 v245, v241, -0.5, -1.0
    v_exp_f32 v242, v242
    v_mfma_f32_16x16x32_bf16 a[36:39], v[216:219], v[84:87], 0
    s_lshr_b32 s89, s59, 1
    ds_read_b64_tr_b16 v[230:231], v234 offset:7168
    v_mul_f32 v240, s67, v52
    v_mfma_f32_16x16x32_bf16 a[40:43], v[216:219], v[88:91], 0
    s_lshl_b32 s89, s89, 24
    v_exp_f32 v243, v243
    v_mfma_f32_16x16x32_bf16 a[44:47], v[216:219], v[92:95], 0
    s_waitcnt lgkmcnt(4)
    buffer_store_dwordx4 v[132:135], v1, s[48:51], s65 offen offset:1024 sc1
    v_mfma_f32_16x16x32_bf16 a[60:63], v[220:223], v[92:95], 0
    s_add_u32 s89, s88, s89
    ds_read_b64_tr_b16 v[208:209], v236 offset:1024
    v_fma_f32 v246, v242, -0.5, -1.0
    v_mfma_f32_16x16x32_bf16 a[56:59], v[220:223], v[88:91], 0
    s_xor_b32 s62, s57, 3
    ds_read_b64_tr_b16 v[210:211], v236 offset:7168
    v_fma_f32 v245, v241, v245, -1.0
    v_mfma_f32_16x16x32_bf16 a[52:55], v[220:223], v[84:87], 0
    s_add_u32 s66, s72, 0x2480
    v_rcp_f32 v244, v244
    v_mul_f32 v241, s67, v53
    v_mfma_f32_16x16x32_bf16 a[48:51], v[220:223], v[80:83], 0
    s_waitcnt lgkmcnt(4)
    buffer_load_dwordx4 v9, s[40:43], s66 offen offset:1024 lds
    v_mfma_f32_16x16x32_bf16 a[64:67], v[224:227], v[80:83], 0
    s_sub_u32 s62, s62, s57
    ds_read_b64_tr_b16 v[212:213], v238 offset:1024
    v_fma_f32 v247, v243, -0.5, -1.0
    v_mfma_f32_16x16x32_bf16 a[68:71], v[224:227], v[84:87], 0
    s_mul_i32 s62, s62, 0x24000
    ds_read_b64_tr_b16 v[214:215], v238 offset:7168
    v_fma_f32 v246, v242, v246, -1.0
    v_mfma_f32_16x16x32_bf16 a[72:75], v[224:227], v[88:91], 0
    s_add_u32 s62, s62, s77
    v_exp_f32 v240, v240
    v_mfma_f32_16x16x32_bf16 a[76:79], v[224:227], v[92:95], 0
    s_waitcnt lgkmcnt(4)
    buffer_store_dwordx4 v[136:139], v1, s[48:51], s65 offen offset:2048 sc1
    v_mfma_f32_16x16x32_bf16 a[92:95], v[228:231], v[92:95], 0
    s_add_u32 s82, s62, 0
    ds_read_b64_tr_b16 v[216:217], v232 offset:2048
    v_fmac_f32 v48, v48, v244
    v_mfma_f32_16x16x32_bf16 a[88:91], v[228:231], v[88:91], 0
    s_xor_b32 s62, s57, 2
    ds_read_b64_tr_b16 v[218:219], v232 offset:8192
    v_mul_f32 v242, s67, v54
    v_mfma_f32_16x16x32_bf16 a[84:87], v[228:231], v[84:87], 0
    s_sub_u32 s62, s62, s57
    v_rcp_f32 v245, v245
    v_exp_f32 v241, v241
    v_mfma_f32_16x16x32_bf16 a[80:83], v[228:231], v[80:83], 0
    s_waitcnt lgkmcnt(4)
    v_fma_f32 v244, v240, -0.5, -1.0
    v_fma_f32 v247, v243, v247, -1.0
    v_mfma_f32_16x16x32_bf16 a[96:99], v[208:211], v[80:83], 0
    s_mul_i32 s62, s62, 0x24000
    ds_read_b64_tr_b16 v[220:221], v234 offset:2048
    v_fmac_f32 v49, v49, v245
    v_mfma_f32_16x16x32_bf16 a[100:103], v[208:211], v[84:87], 0
    s_add_u32 s62, s62, s77
    ds_read_b64_tr_b16 v[222:223], v234 offset:8192
    v_mul_f32 v243, s67, v55
    v_mfma_f32_16x16x32_bf16 a[104:107], v[208:211], v[88:91], 0
    s_add_u32 s66, s72, 0x2500
    buffer_load_dwordx4 v10, s[40:43], s66 offen offset:2048 lds
    v_mfma_f32_16x16x32_bf16 a[108:111], v[208:211], v[92:95], 0
    s_waitcnt lgkmcnt(4)
    buffer_store_dwordx4 v[140:143], v1, s[48:51], s65 offen offset:3072 sc1
    v_mfma_f32_16x16x32_bf16 a[124:127], v[212:215], v[92:95], 0
    s_add_u32 s83, s62, 0x1000
    ds_read_b64_tr_b16 v[224:225], v236 offset:2048
    v_fma_f32 v245, v241, -0.5, -1.0
    v_mfma_f32_16x16x32_bf16 a[120:123], v[212:215], v[88:91], 0
    s_xor_b32 s62, s57, 1
    ds_read_b64_tr_b16 v[226:227], v236 offset:8192
    v_fma_f32 v244, v240, v244, -1.0
    v_mfma_f32_16x16x32_bf16 a[116:119], v[212:215], v[84:87], 0
    s_sub_u32 s62, s62, s57
    v_rcp_f32 v246, v246
    v_mfma_f32_16x16x32_bf16 a[112:115], v[212:215], v[80:83], 0
    s_waitcnt lgkmcnt(4)
    v_exp_f32 v242, v242
    v_rcp_f32 v247, v247
    v_mfma_f32_16x16x32_bf16 a[128:131], v[216:219], v[80:83], 0
    s_mul_i32 s62, s62, 0x24000
    ds_read_b64_tr_b16 v[228:229], v238 offset:2048
    v_cvt_pk_bf16_f32 v48, v48, v49
    v_mfma_f32_16x16x32_bf16 a[132:135], v[216:219], v[84:87], 0
    s_add_u32 s62, s62, s77
    ds_read_b64_tr_b16 v[230:231], v238 offset:8192
    v_fmac_f32 v50, v50, v246
    v_mfma_f32_16x16x32_bf16 a[136:139], v[216:219], v[88:91], 0
    s_add_u32 s84, s62, 0x2000
    v_mul_f32 v240, s67, v56
    v_fma_f32 v246, v242, -0.5, -1.0
    v_mfma_f32_16x16x32_bf16 a[140:143], v[216:219], v[92:95], 0
    s_waitcnt vmcnt(22) lgkmcnt(4)
    s_barrier
    v_fma_f32 v245, v241, v245, -1.0
    v_mfma_f32_16x16x32_bf16 a[156:159], v[220:223], v[92:95], 0
    s_mov_b32 s52, s24
    ds_read_b64_tr_b16 v[208:209], v232 offset:24576
    v_fmac_f32 v51, v51, v247
    v_mfma_f32_16x16x32_bf16 a[152:155], v[220:223], v[88:91], 0
    s_mov_b32 s53, s25
    ds_read_b64_tr_b16 v[210:211], v232 offset:30720
    v_mul_f32 v241, s67, v57
    v_mfma_f32_16x16x32_bf16 a[148:151], v[220:223], v[84:87], 0
    s_add_u32 s76, s69, 0
    buffer_load_dwordx4 a[192:195], v1, s[48:51], s76 offen sc1
    v_mfma_f32_16x16x32_bf16 a[144:147], v[220:223], v[80:83], 0
    s_waitcnt lgkmcnt(4)
    buffer_load_dwordx4 a[196:199], v1, s[48:51], s76 offen offset:1024 sc1
    v_mfma_f32_16x16x32_bf16 a[160:163], v[224:227], v[80:83], 0
    s_mov_b32 s54, 0x240000
    ds_read_b64_tr_b16 v[212:213], v234 offset:24576
    v_fma_f32 v246, v242, v246, -1.0
    v_mfma_f32_16x16x32_bf16 a[164:167], v[224:227], v[84:87], 0
    s_mov_b32 s55, 0x20000
    ds_read_b64_tr_b16 v[214:215], v234 offset:30720
    v_cvt_pk_bf16_f32 v49, v50, v51
    v_mfma_f32_16x16x32_bf16 a[168:171], v[224:227], v[88:91], 0
    s_add_u32 s93, s77, 0
    buffer_load_dwordx4 a[200:203], v1, s[48:51], s76 offen offset:2048 sc1
    v_mfma_f32_16x16x32_bf16 a[172:175], v[224:227], v[92:95], 0
    s_waitcnt lgkmcnt(4)
    buffer_load_dwordx4 a[204:207], v1, s[48:51], s76 offen offset:3072 sc1
    v_mfma_f32_16x16x32_bf16 a[188:191], v[228:231], v[92:95], 0
    s_add_u32 s94, s77, 0x1000
    ds_read_b64_tr_b16 v[216:217], v236 offset:24576
    v_exp_f32 v243, v243
    v_mfma_f32_16x16x32_bf16 a[184:187], v[228:231], v[88:91], 0
    s_add_u32 m0, s60, 0x1e000
    ds_read_b64_tr_b16 v[218:219], v236 offset:30720
    v_fma_f32 v247, v243, -0.5, -1.0
    v_mfma_f32_16x16x32_bf16 a[180:183], v[228:231], v[84:87], 0
    s_add_u32 s66, s73, 0
    buffer_load_dwordx4 v8, s[40:43], s66 offen lds
    v_mfma_f32_16x16x32_bf16 a[176:179], v[228:231], v[80:83], 0
    s_waitcnt lgkmcnt(4)
    v_rcp_f32 v244, v244
    v_mfma_f32_16x16x32_bf16 a[0:3], v[208:211], v[96:99], a[0:3]
    s_add_u32 s95, s77, 0x2000
    ds_read_b64_tr_b16 v[220:221], v238 offset:24576
    v_fmac_f32 v52, v52, v244
    v_mfma_f32_16x16x32_bf16 a[4:7], v[208:211], v[100:103], a[4:7]
L_pad_f4:
    s_cbranch_execz L_pad_f8
    s_lshl_b32 s62, s56, 2
    ds_read_b64_tr_b16 v[222:223], v238 offset:30720
    v_mul_f32 v242, s67, v58
    v_exp_f32 v240, v240
    v_mfma_f32_16x16x32_bf16 a[8:11], v[208:211], v[104:107], a[8:11]
    s_add_u32 s66, s73, 0x80
    v_rcp_f32 v245, v245
    v_mfma_f32_16x16x32_bf16 a[12:15], v[208:211], v[108:111], a[12:15]
    s_waitcnt lgkmcnt(4)
    buffer_load_dwordx4 v9, s[40:43], s66 offen offset:1024 lds
    v_mfma_f32_16x16x32_bf16 a[28:31], v[212:215], v[108:111], a[28:31]
    s_add_u32 s62, s62, s57
    ds_read_b64_tr_b16 v[224:225], v232 offset:25600
    v_fma_f32 v244, v240, -0.5, -1.0
    v_mfma_f32_16x16x32_bf16 a[24:27], v[212:215], v[104:107], a[24:27]
    s_lshl_b32 s62, s62, 2
    ds_read_b64_tr_b16 v[226:227], v232 offset:31744
    v_fma_f32 v247, v243, v247, -1.0
    v_mfma_f32_16x16x32_bf16 a[20:23], v[212:215], v[100:103], a[20:23]
    s_add_u32 s86, s62, s59
    v_exp_f32 v241, v241
    v_mfma_f32_16x16x32_bf16 a[16:19], v[212:215], v[96:99], a[16:19]
    s_waitcnt lgkmcnt(4)
    v_rcp_f32 v246, v246
    v_fmac_f32 v53, v53, v245
    v_mfma_f32_16x16x32_bf16 a[32:35], v[216:219], v[96:99], a[32:35]
    s_mul_i32 s90, s86, 0x2800
    ds_read_b64_tr_b16 v[228:229], v234 offset:25600
    v_mul_f32 v243, s67, v59
    v_mfma_f32_16x16x32_bf16 a[36:39], v[216:219], v[100:103], a[36:39]
    s_add_u32 s90, s90, 0x2000000
    ds_read_b64_tr_b16 v[230:231], v234 offset:31744
    v_fma_f32 v245, v241, -0.5, -1.0
    v_mfma_f32_16x16x32_bf16 a[40:43], v[216:219], v[104:107], a[40:43]
    s_add_u32 s66, s73, 0x100
    buffer_load_dwordx4 v10, s[40:43], s66 offen offset:2048 lds
    v_mfma_f32_16x16x32_bf16 a[44:47], v[216:219], v[108:111], a[44:47]
    s_waitcnt lgkmcnt(4)
    v_exp_f32 v242, v242
    v_fma_f32 v244, v240, v244, -1.0
    v_mfma_f32_16x16x32_bf16 a[60:63], v[220:223], v[108:111], a[60:63]
    s_and_b32 s85, s59, 1
    ds_read_b64_tr_b16 v[208:209], v236 offset:25600
    v_cvt_pk_bf16_f32 v50, v52, v53
    v_mfma_f32_16x16x32_bf16 a[56:59], v[220:223], v[104:107], a[56:59]
    s_add_u32 m0, s60, 0x1ec00
    ds_read_b64_tr_b16 v[210:211], v236 offset:31744
    v_fmac_f32 v54, v54, v246
    v_mfma_f32_16x16x32_bf16 a[52:55], v[220:223], v[100:103], a[52:55]
    s_add_u32 s66, s73, 0x2400
    v_rcp_f32 v247, v247
    v_mul_f32 v240, s67, v60
    v_mfma_f32_16x16x32_bf16 a[48:51], v[220:223], v[96:99], a[48:51]
    s_waitcnt lgkmcnt(4)
    buffer_load_dwordx4 v8, s[40:43], s66 offen lds
    v_mfma_f32_16x16x32_bf16 a[64:67], v[224:227], v[96:99], a[64:67]
    s_mul_i32 s85, s85, 0x3000
    ds_read_b64_tr_b16 v[212:213], v238 offset:25600
    v_fma_f32 v246, v242, -0.5, -1.0
    v_mfma_f32_16x16x32_bf16 a[68:71], v[224:227], v[100:103], a[68:71]
    s_lshl_b32 s62, s86, 7
    ds_read_b64_tr_b16 v[214:215], v238 offset:31744
    v_fma_f32 v245, v241, v245, -1.0
    v_mfma_f32_16x16x32_bf16 a[72:75], v[224:227], v[104:107], a[72:75]
    s_add_u32 s78, s62, 0x2f40000
    v_exp_f32 v243, v243
    v_mfma_f32_16x16x32_bf16 a[76:79], v[224:227], v[108:111], a[76:79]
    s_waitcnt lgkmcnt(4)
    v_rcp_f32 v244, v244
    v_fmac_f32 v55, v55, v247
    v_mfma_f32_16x16x32_bf16 a[92:95], v[228:231], v[108:111], a[92:95]
    ds_read_b64_tr_b16 v[216:217], v232 offset:26624
    v_mul_f32 v241, s67, v61
    v_mfma_f32_16x16x32_bf16 a[88:91], v[228:231], v[104:107], a[88:91]
    ds_read_b64_tr_b16 v[218:219], v232 offset:32768
    v_fma_f32 v247, v243, -0.5, -1.0
    v_mfma_f32_16x16x32_bf16 a[84:87], v[228:231], v[100:103], a[84:87]
    s_add_u32 s66, s73, 0x2480
    buffer_load_dwordx4 v9, s[40:43], s66 offen offset:1024 lds
    v_mfma_f32_16x16x32_bf16 a[80:83], v[228:231], v[96:99], a[80:83]
    s_waitcnt lgkmcnt(4)
    v_exp_f32 v240, v240
    v_fma_f32 v246, v242, v246, -1.0
    v_mfma_f32_16x16x32_bf16 a[96:99], v[208:211], v[96:99], a[96:99]
    ds_read_b64_tr_b16 v[220:221], v234 offset:26624
    v_cvt_pk_bf16_f32 v51, v54, v55
    v_mfma_f32_16x16x32_bf16 a[100:103], v[208:211], v[100:103], a[100:103]
    ds_read_b64_tr_b16 v[222:223], v234 offset:32768
    v_fmac_f32 v56, v56, v244
    v_mfma_f32_16x16x32_bf16 a[104:107], v[208:211], v[104:107], a[104:107]
    s_add_u32 s66, s73, 0x2500
    v_rcp_f32 v245, v245
    v_mul_f32 v242, s67, v62
    v_mfma_f32_16x16x32_bf16 a[108:111], v[208:211], v[108:111], a[108:111]
    s_waitcnt lgkmcnt(4)
    buffer_load_dwordx4 v10, s[40:43], s66 offen offset:2048 lds
    v_mfma_f32_16x16x32_bf16 a[124:127], v[212:215], v[108:111], a[124:127]
    ds_read_b64_tr_b16 v[224:225], v236 offset:26624
    v_fma_f32 v244, v240, -0.5, -1.0
    v_mfma_f32_16x16x32_bf16 a[120:123], v[212:215], v[104:107], a[120:123]
    ds_read_b64_tr_b16 v[226:227], v236 offset:32768
    v_fma_f32 v247, v243, v247, -1.0
    v_mfma_f32_16x16x32_bf16 a[116:119], v[212:215], v[100:103], a[116:119]
    v_exp_f32 v241, v241
    v_mfma_f32_16x16x32_bf16 a[112:115], v[212:215], v[96:99], a[112:115]
    s_waitcnt lgkmcnt(4)
    v_rcp_f32 v246, v246
    v_fmac_f32 v57, v57, v245
    v_mfma_f32_16x16x32_bf16 a[128:131], v[216:219], v[96:99], a[128:131]
    ds_read_b64_tr_b16 v[228:229], v238 offset:26624
    v_mul_f32 v243, s67, v63
    v_mfma_f32_16x16x32_bf16 a[132:135], v[216:219], v[100:103], a[132:135]
    ds_read_b64_tr_b16 v[230:231], v238 offset:32768
    v_fma_f32 v245, v241, -0.5, -1.0
    v_mfma_f32_16x16x32_bf16 a[136:139], v[216:219], v[104:107], a[136:139]
    v_exp_f32 v242, v242
    v_fma_f32 v244, v240, v244, -1.0
    v_mfma_f32_16x16x32_bf16 a[140:143], v[216:219], v[108:111], a[140:143]
    s_waitcnt vmcnt(10) lgkmcnt(4)
    s_barrier
    buffer_store_dword v14, v15, s[48:51], 0 offen offset:128 sc1
    v_mfma_f32_16x16x32_bf16 a[156:159], v[220:223], v[108:111], a[156:159]
    ds_read_b64_tr_b16 v[208:209], v232 offset:49152
    v_cvt_pk_bf16_f32 v52, v56, v57
    v_mfma_f32_16x16x32_bf16 a[152:155], v[220:223], v[104:107], a[152:155]
    ds_read_b64_tr_b16 v[210:211], v232 offset:55296
    v_fmac_f32 v58, v58, v246
    v_mfma_f32_16x16x32_bf16 a[148:151], v[220:223], v[100:103], a[148:151]
    s_add_u32 s76, s70, 0
    buffer_load_dwordx4 a[208:211], v1, s[48:51], s76 offen sc1
    v_mfma_f32_16x16x32_bf16 a[144:147], v[220:223], v[96:99], a[144:147]
    s_waitcnt lgkmcnt(4)
    buffer_load_dwordx4 a[212:215], v1, s[48:51], s76 offen offset:1024 sc1
    v_mfma_f32_16x16x32_bf16 a[160:163], v[224:227], v[96:99], a[160:163]
    ds_read_b64_tr_b16 v[212:213], v234 offset:49152
    v_mul_f32 v240, s67, v64
    v_mfma_f32_16x16x32_bf16 a[164:167], v[224:227], v[100:103], a[164:167]
    ds_read_b64_tr_b16 v[214:215], v234 offset:55296
    v_fma_f32 v246, v242, -0.5, -1.0
    v_mfma_f32_16x16x32_bf16 a[168:171], v[224:227], v[104:107], a[168:171]
    buffer_load_dwordx4 a[216:219], v1, s[48:51], s76 offen offset:2048 sc1
    v_mfma_f32_16x16x32_bf16 a[172:175], v[224:227], v[108:111], a[172:175]
    s_waitcnt lgkmcnt(4)
    buffer_load_dwordx4 a[220:223], v1, s[48:51], s76 offen offset:3072 sc1
    v_mfma_f32_16x16x32_bf16 a[188:191], v[228:231], v[108:111], a[188:191]
    ds_read_b64_tr_b16 v[216:217], v236 offset:49152
    v_fma_f32 v245, v241, v245, -1.0
    v_mfma_f32_16x16x32_bf16 a[184:187], v[228:231], v[104:107], a[184:187]
    s_add_u32 m0, s60, 0
    ds_read_b64_tr_b16 v[218:219], v236 offset:55296
    v_mul_f32 v241, s67, v65
    v_mfma_f32_16x16x32_bf16 a[180:183], v[228:231], v[100:103], a[180:183]
    s_add_u32 s66, s72, 0x12000
    buffer_load_dwordx4 v8, s[40:43], s66 offen lds
    v_mfma_f32_16x16x32_bf16 a[176:179], v[228:231], v[96:99], a[176:179]
    s_waitcnt lgkmcnt(4)
    v_rcp_f32 v247, v247
    v_mfma_f32_16x16x32_bf16 a[0:3], v[208:211], v[112:115], a[0:3]
    ds_read_b64_tr_b16 v[220:221], v238 offset:49152
    v_fmac_f32 v59, v59, v247
    v_mfma_f32_16x16x32_bf16 a[4:7], v[208:211], v[116:119], a[4:7]
    ds_read_b64_tr_b16 v[222:223], v238 offset:55296
    v_fma_f32 v246, v242, v246, -1.0
    v_exp_f32 v243, v243
    v_mfma_f32_16x16x32_bf16 a[8:11], v[208:211], v[120:123], a[8:11]
    s_add_u32 s66, s72, 0x12080
    v_rcp_f32 v244, v244
    v_mfma_f32_16x16x32_bf16 a[12:15], v[208:211], v[124:127], a[12:15]
    s_waitcnt lgkmcnt(4)
    buffer_load_dwordx4 v9, s[40:43], s66 offen offset:1024 lds
    v_mfma_f32_16x16x32_bf16 a[28:31], v[212:215], v[124:127], a[28:31]
    ds_read_b64_tr_b16 v[224:225], v232 offset:50176
    v_fma_f32 v247, v243, -0.5, -1.0
    v_mfma_f32_16x16x32_bf16 a[24:27], v[212:215], v[120:123], a[24:27]
    ds_read_b64_tr_b16 v[226:227], v232 offset:56320
    v_cvt_pk_bf16_f32 v53, v58, v59
    v_mfma_f32_16x16x32_bf16 a[20:23], v[212:215], v[116:119], a[20:23]
    v_exp_f32 v240, v240
    v_mfma_f32_16x16x32_bf16 a[16:19], v[212:215], v[112:115], a[16:19]
    s_waitcnt lgkmcnt(4)
    v_rcp_f32 v245, v245
    v_fmac_f32 v60, v60, v244
    v_mfma_f32_16x16x32_bf16 a[32:35], v[216:219], v[112:115], a[32:35]
    ds_read_b64_tr_b16 v[228:229], v234 offset:50176
    v_mul_f32 v242, s67, v66
    v_mfma_f32_16x16x32_bf16 a[36:39], v[216:219], v[116:119], a[36:39]
    ds_read_b64_tr_b16 v[230:231], v234 offset:56320
    v_fma_f32 v244, v240, -0.5, -1.0
    v_mfma_f32_16x16x32_bf16 a[40:43], v[216:219], v[120:123], a[40:43]
    s_add_u32 s66, s72, 0x12100
    buffer_load_dwordx4 v10, s[40:43], s66 offen offset:2048 lds
    v_mfma_f32_16x16x32_bf16 a[44:47], v[216:219], v[124:127], a[44:47]
    s_waitcnt lgkmcnt(4)
    v_exp_f32 v241, v241
    v_fma_f32 v247, v243, v247, -1.0
    v_mfma_f32_16x16x32_bf16 a[60:63], v[220:223], v[124:127], a[60:63]
    ds_read_b64_tr_b16 v[208:209], v236 offset:50176
    v_fmac_f32 v61, v61, v245
    v_mfma_f32_16x16x32_bf16 a[56:59], v[220:223], v[120:123], a[56:59]
    s_add_u32 m0, s60, 0xc00
    ds_read_b64_tr_b16 v[210:211], v236 offset:56320
    v_mul_f32 v243, s67, v67
    v_mfma_f32_16x16x32_bf16 a[52:55], v[220:223], v[116:119], a[52:55]
    s_add_u32 s66, s72, 0x14400
    v_rcp_f32 v246, v246
    v_mfma_f32_16x16x32_bf16 a[48:51], v[220:223], v[112:115], a[48:51]
    s_waitcnt lgkmcnt(4)
    buffer_load_dwordx4 v8, s[40:43], s66 offen lds
    v_mfma_f32_16x16x32_bf16 a[64:67], v[224:227], v[112:115], a[64:67]
    ds_read_b64_tr_b16 v[212:213], v238 offset:50176
    v_fma_f32 v245, v241, -0.5, -1.0
    v_mfma_f32_16x16x32_bf16 a[68:71], v[224:227], v[116:119], a[68:71]
    ds_read_b64_tr_b16 v[214:215], v238 offset:56320
    v_fma_f32 v244, v240, v244, -1.0
    v_mfma_f32_16x16x32_bf16 a[72:75], v[224:227], v[120:123], a[72:75]
    v_exp_f32 v242, v242
    v_mfma_f32_16x16x32_bf16 a[76:79], v[224:227], v[124:127], a[76:79]
    s_waitcnt lgkmcnt(4)
    v_rcp_f32 v247, v247
    v_cvt_pk_bf16_f32 v54, v60, v61
    v_fmac_f32 v62, v62, v246
    v_mfma_f32_16x16x32_bf16 a[92:95], v[228:231], v[124:127], a[92:95]
    ds_read_b64_tr_b16 v[216:217], v232 offset:51200
    v_mul_f32 v240, s67, v68
    v_mfma_f32_16x16x32_bf16 a[88:91], v[228:231], v[120:123], a[88:91]
    ds_read_b64_tr_b16 v[218:219], v232 offset:57344
    v_fma_f32 v246, v242, -0.5, -1.0
    v_mfma_f32_16x16x32_bf16 a[84:87], v[228:231], v[116:119], a[84:87]
    s_add_u32 s66, s72, 0x14480
    buffer_load_dwordx4 v9, s[40:43], s66 offen offset:1024 lds
    v_mfma_f32_16x16x32_bf16 a[80:83], v[228:231], v[112:115], a[80:83]
    s_waitcnt lgkmcnt(4)
    v_exp_f32 v243, v243
    v_fma_f32 v245, v241, v245, -1.0
    v_mfma_f32_16x16x32_bf16 a[96:99], v[208:211], v[112:115], a[96:99]
    ds_read_b64_tr_b16 v[220:221], v234 offset:51200
    v_fmac_f32 v63, v63, v247
    v_mfma_f32_16x16x32_bf16 a[100:103], v[208:211], v[116:119], a[100:103]
    ds_read_b64_tr_b16 v[222:223], v234 offset:57344
    v_mul_f32 v241, s67, v69
    v_mfma_f32_16x16x32_bf16 a[104:107], v[208:211], v[120:123], a[104:107]
    s_add_u32 s66, s72, 0x14500
    v_rcp_f32 v244, v244
    v_mfma_f32_16x16x32_bf16 a[108:111], v[208:211], v[124:127], a[108:111]
    s_waitcnt lgkmcnt(4)
    buffer_load_dwordx4 v10, s[40:43], s66 offen offset:2048 lds
    v_mfma_f32_16x16x32_bf16 a[124:127], v[212:215], v[124:127], a[124:127]
    ds_read_b64_tr_b16 v[224:225], v236 offset:51200
    v_fma_f32 v247, v243, -0.5, -1.0
    v_mfma_f32_16x16x32_bf16 a[120:123], v[212:215], v[120:123], a[120:123]
    ds_read_b64_tr_b16 v[226:227], v236 offset:57344
    v_fma_f32 v246, v242, v246, -1.0
    v_mfma_f32_16x16x32_bf16 a[116:119], v[212:215], v[116:119], a[116:119]
    v_exp_f32 v240, v240
    v_mfma_f32_16x16x32_bf16 a[112:115], v[212:215], v[112:115], a[112:115]
    s_waitcnt lgkmcnt(4)
    v_rcp_f32 v245, v245
    v_cvt_pk_bf16_f32 v55, v62, v63
    v_fmac_f32 v64, v64, v244
    v_mfma_f32_16x16x32_bf16 a[128:131], v[216:219], v[112:115], a[128:131]
    ds_read_b64_tr_b16 v[228:229], v238 offset:51200
    v_mul_f32 v242, s67, v70
    v_mfma_f32_16x16x32_bf16 a[132:135], v[216:219], v[116:119], a[132:135]
    ds_read_b64_tr_b16 v[230:231], v238 offset:57344
    v_fma_f32 v244, v240, -0.5, -1.0
    v_mfma_f32_16x16x32_bf16 a[136:139], v[216:219], v[120:123], a[136:139]
    v_exp_f32 v241, v241
    v_mfma_f32_16x16x32_bf16 a[140:143], v[216:219], v[124:127], a[140:143]
    s_waitcnt lgkmcnt(4)
    s_barrier
    v_fma_f32 v247, v243, v247, -1.0
    v_mfma_f32_16x16x32_bf16 a[156:159], v[220:223], v[124:127], a[156:159]
    ds_read_b64_tr_b16 v[208:209], v233
    v_fmac_f32 v65, v65, v245
    v_mfma_f32_16x16x32_bf16 a[152:155], v[220:223], v[120:123], a[152:155]
    ds_read_b64_tr_b16 v[210:211], v233 offset:6144
    v_mul_f32 v243, s67, v71
    v_mfma_f32_16x16x32_bf16 a[148:151], v[220:223], v[116:119], a[148:151]
    s_add_u32 s76, s69, 0x1000
    buffer_load_dwordx4 a[224:227], v1, s[48:51], s76 offen sc1
    v_mfma_f32_16x16x32_bf16 a[144:147], v[220:223], v[112:115], a[144:147]
    s_waitcnt lgkmcnt(4)
    buffer_load_dwordx4 a[228:231], v1, s[48:51], s76 offen offset:1024 sc1
    v_mfma_f32_16x16x32_bf16 a[160:163], v[224:227], v[112:115], a[160:163]
    ds_read_b64_tr_b16 v[212:213], v235
    v_fma_f32 v245, v241, -0.5, -1.0
    v_mfma_f32_16x16x32_bf16 a[164:167], v[224:227], v[116:119], a[164:167]
    ds_read_b64_tr_b16 v[214:215], v235 offset:6144
    v_fma_f32 v244, v240, v244, -1.0
    v_mfma_f32_16x16x32_bf16 a[168:171], v[224:227], v[120:123], a[168:171]
    buffer_load_dwordx4 a[232:235], v1, s[48:51], s76 offen offset:2048 sc1
    v_mfma_f32_16x16x32_bf16 a[172:175], v[224:227], v[124:127], a[172:175]
    s_waitcnt lgkmcnt(4)
    buffer_load_dwordx4 a[236:239], v1, s[48:51], s76 offen offset:3072 sc1
    v_mfma_f32_16x16x32_bf16 a[188:191], v[228:231], v[124:127], a[188:191]
    ds_read_b64_tr_b16 v[216:217], v237
    v_cvt_pk_bf16_f32 v56, v64, v65
    v_rcp_f32 v246, v246
    v_mfma_f32_16x16x32_bf16 a[184:187], v[228:231], v[120:123], a[184:187]
    s_add_u32 m0, s60, 0x6000
    ds_read_b64_tr_b16 v[218:219], v237 offset:6144
    v_fmac_f32 v66, v66, v246
    v_mfma_f32_16x16x32_bf16 a[180:183], v[228:231], v[116:119], a[180:183]
    s_add_u32 s66, s73, 0x12000
    buffer_load_dwordx4 v8, s[40:43], s66 offen lds
    v_mfma_f32_16x16x32_bf16 a[176:179], v[228:231], v[112:115], a[176:179]
    s_waitcnt lgkmcnt(4)
    v_exp_f32 v242, v242
    v_mfma_f32_16x16x32_bf16 a[0:3], v[208:211], v[128:131], a[0:3]
    ds_read_b64_tr_b16 v[220:221], v239
    v_mul_f32 v240, s67, v72
    v_mfma_f32_16x16x32_bf16 a[4:7], v[208:211], v[132:135], a[4:7]
    ds_read_b64_tr_b16 v[222:223], v239 offset:6144
    v_fma_f32 v246, v242, -0.5, -1.0
    v_mfma_f32_16x16x32_bf16 a[8:11], v[208:211], v[136:139], a[8:11]
    s_add_u32 s66, s73, 0x12080
    v_rcp_f32 v247, v247
    v_mfma_f32_16x16x32_bf16 a[12:15], v[208:211], v[140:143], a[12:15]
    s_waitcnt lgkmcnt(4)
    buffer_load_dwordx4 v9, s[40:43], s66 offen offset:1024 lds
    v_mfma_f32_16x16x32_bf16 a[28:31], v[212:215], v[140:143], a[28:31]
    ds_read_b64_tr_b16 v[224:225], v233 offset:1024
    v_fma_f32 v245, v241, v245, -1.0
    v_mfma_f32_16x16x32_bf16 a[24:27], v[212:215], v[136:139], a[24:27]
    ds_read_b64_tr_b16 v[226:227], v233 offset:7168
    v_fmac_f32 v67, v67, v247
    v_mfma_f32_16x16x32_bf16 a[20:23], v[212:215], v[132:135], a[20:23]
    v_exp_f32 v243, v243
    v_rcp_f32 v244, v244
    v_mfma_f32_16x16x32_bf16 a[16:19], v[212:215], v[128:131], a[16:19]
    s_waitcnt lgkmcnt(4)
    v_mul_f32 v241, s67, v73
    v_fma_f32 v247, v243, -0.5, -1.0
    v_mfma_f32_16x16x32_bf16 a[32:35], v[216:219], v[128:131], a[32:35]
    ds_read_b64_tr_b16 v[228:229], v235 offset:1024
    v_fma_f32 v246, v242, v246, -1.0
    v_mfma_f32_16x16x32_bf16 a[36:39], v[216:219], v[132:135], a[36:39]
    ds_read_b64_tr_b16 v[230:231], v235 offset:7168
    v_cvt_pk_bf16_f32 v57, v66, v67
    v_mfma_f32_16x16x32_bf16 a[40:43], v[216:219], v[136:139], a[40:43]
    s_add_u32 s66, s73, 0x12100
    buffer_load_dwordx4 v10, s[40:43], s66 offen offset:2048 lds
    v_mfma_f32_16x16x32_bf16 a[44:47], v[216:219], v[140:143], a[44:47]
    s_waitcnt lgkmcnt(4)
    buffer_load_dword v13, v12, s[48:51], 0 offen offset:128 sc1
    v_mfma_f32_16x16x32_bf16 a[60:63], v[220:223], v[140:143], a[60:63]
    ds_read_b64_tr_b16 v[208:209], v237 offset:1024
    v_fmac_f32 v68, v68, v244
    v_mfma_f32_16x16x32_bf16 a[56:59], v[220:223], v[136:139], a[56:59]
    s_add_u32 m0, s60, 0x6c00
    ds_read_b64_tr_b16 v[210:211], v237 offset:7168
    v_mul_f32 v242, s67, v74
    v_mfma_f32_16x16x32_bf16 a[52:55], v[220:223], v[132:135], a[52:55]
    s_add_u32 s66, s73, 0x14400
    v_exp_f32 v240, v240
    v_mfma_f32_16x16x32_bf16 a[48:51], v[220:223], v[128:131], a[48:51]
    s_waitcnt lgkmcnt(4)
    buffer_load_dwordx4 v8, s[40:43], s66 offen lds
    v_mfma_f32_16x16x32_bf16 a[64:67], v[224:227], v[128:131], a[64:67]
    ds_read_b64_tr_b16 v[212:213], v239 offset:1024
    v_fma_f32 v244, v240, -0.5, -1.0
    v_rcp_f32 v245, v245
    v_mfma_f32_16x16x32_bf16 a[68:71], v[224:227], v[132:135], a[68:71]
    ds_read_b64_tr_b16 v[214:215], v239 offset:7168
    v_fma_f32 v247, v243, v247, -1.0
    v_mfma_f32_16x16x32_bf16 a[72:75], v[224:227], v[136:139], a[72:75]
    v_exp_f32 v241, v241
    v_mfma_f32_16x16x32_bf16 a[76:79], v[224:227], v[140:143], a[76:79]
    s_waitcnt lgkmcnt(4)
    v_rcp_f32 v246, v246
    v_fmac_f32 v69, v69, v245
    v_mfma_f32_16x16x32_bf16 a[92:95], v[228:231], v[140:143], a[92:95]
    ds_read_b64_tr_b16 v[216:217], v233 offset:2048
    v_mul_f32 v243, s67, v75
    v_mfma_f32_16x16x32_bf16 a[88:91], v[228:231], v[136:139], a[88:91]
    ds_read_b64_tr_b16 v[218:219], v233 offset:8192
    v_fma_f32 v245, v241, -0.5, -1.0
    v_mfma_f32_16x16x32_bf16 a[84:87], v[228:231], v[132:135], a[84:87]
    s_add_u32 s66, s73, 0x14480
    buffer_load_dwordx4 v9, s[40:43], s66 offen offset:1024 lds
    v_mfma_f32_16x16x32_bf16 a[80:83], v[228:231], v[128:131], a[80:83]
    s_waitcnt lgkmcnt(4)
    v_exp_f32 v242, v242
    v_mfma_f32_16x16x32_bf16 a[96:99], v[208:211], v[128:131], a[96:99]
    ds_read_b64_tr_b16 v[220:221], v235 offset:2048
    v_fma_f32 v244, v240, v244, -1.0
    v_mfma_f32_16x16x32_bf16 a[100:103], v[208:211], v[132:135], a[100:103]
    ds_read_b64_tr_b16 v[222:223], v235 offset:8192
    v_cvt_pk_bf16_f32 v58, v68, v69
    v_mfma_f32_16x16x32_bf16 a[104:107], v[208:211], v[136:139], a[104:107]
    s_add_u32 s66, s73, 0x14500
    v_rcp_f32 v247, v247
    v_fmac_f32 v70, v70, v246
    v_mfma_f32_16x16x32_bf16 a[108:111], v[208:211], v[140:143], a[108:111]
    s_waitcnt lgkmcnt(4)
    buffer_load_dwordx4 v10, s[40:43], s66 offen offset:2048 lds
    v_mfma_f32_16x16x32_bf16 a[124:127], v[212:215], v[140:143], a[124:127]
    ds_read_b64_tr_b16 v[224:225], v237 offset:2048
    v_mul_f32 v240, s67, v76
    v_mfma_f32_16x16x32_bf16 a[120:123], v[212:215], v[136:139], a[120:123]
    ds_read_b64_tr_b16 v[226:227], v237 offset:8192
    v_fma_f32 v246, v242, -0.5, -1.0
    v_mfma_f32_16x16x32_bf16 a[116:119], v[212:215], v[132:135], a[116:119]
    v_exp_f32 v243, v243
    v_fma_f32 v245, v241, v245, -1.0
    v_mfma_f32_16x16x32_bf16 a[112:115], v[212:215], v[128:131], a[112:115]
    s_waitcnt lgkmcnt(4)
    v_rcp_f32 v244, v244
    v_mfma_f32_16x16x32_bf16 a[128:131], v[216:219], v[128:131], a[128:131]
    ds_read_b64_tr_b16 v[228:229], v239 offset:2048
    v_fmac_f32 v71, v71, v247
    v_mul_f32 v241, s67, v77
    v_mfma_f32_16x16x32_bf16 a[132:135], v[216:219], v[132:135], a[132:135]
    ds_read_b64_tr_b16 v[230:231], v239 offset:8192
    v_fma_f32 v247, v243, -0.5, -1.0
    v_mfma_f32_16x16x32_bf16 a[136:139], v[216:219], v[136:139], a[136:139]
    v_exp_f32 v240, v240
    v_mfma_f32_16x16x32_bf16 a[140:143], v[216:219], v[140:143], a[140:143]
    s_waitcnt lgkmcnt(4)
    s_barrier
    v_fma_f32 v246, v242, v246, -1.0
    v_mfma_f32_16x16x32_bf16 a[156:159], v[220:223], v[140:143], a[156:159]
    ds_read_b64_tr_b16 v[208:209], v233 offset:24576
    v_cvt_pk_bf16_f32 v59, v70, v71
    v_mfma_f32_16x16x32_bf16 a[152:155], v[220:223], v[136:139], a[152:155]
    ds_read_b64_tr_b16 v[210:211], v233 offset:30720
    v_fmac_f32 v72, v72, v244
    v_mfma_f32_16x16x32_bf16 a[148:151], v[220:223], v[132:135], a[148:151]
    s_add_u32 s76, s70, 0x1000
    buffer_load_dwordx4 a[240:243], v1, s[48:51], s76 offen sc1
    v_mfma_f32_16x16x32_bf16 a[144:147], v[220:223], v[128:131], a[144:147]
    s_waitcnt lgkmcnt(4)
    buffer_load_dwordx4 a[244:247], v1, s[48:51], s76 offen offset:1024 sc1
    v_mfma_f32_16x16x32_bf16 a[160:163], v[224:227], v[128:131], a[160:163]
    ds_read_b64_tr_b16 v[212:213], v235 offset:24576
    v_mul_f32 v242, s67, v78
    v_mfma_f32_16x16x32_bf16 a[164:167], v[224:227], v[132:135], a[164:167]
    ds_read_b64_tr_b16 v[214:215], v235 offset:30720
    v_fma_f32 v244, v240, -0.5, -1.0
    v_mfma_f32_16x16x32_bf16 a[168:171], v[224:227], v[136:139], a[168:171]
    buffer_load_dwordx4 a[248:251], v1, s[48:51], s76 offen offset:2048 sc1
    v_mfma_f32_16x16x32_bf16 a[172:175], v[224:227], v[140:143], a[172:175]
    s_waitcnt lgkmcnt(4)
    buffer_load_dwordx4 a[252:255], v1, s[48:51], s76 offen offset:3072 sc1
    v_mfma_f32_16x16x32_bf16 a[188:191], v[228:231], v[140:143], a[188:191]
    ds_read_b64_tr_b16 v[216:217], v237 offset:24576
    v_fma_f32 v247, v243, v247, -1.0
    v_mfma_f32_16x16x32_bf16 a[184:187], v[228:231], v[136:139], a[184:187]
    s_add_u32 m0, s60, 0xc000
    ds_read_b64_tr_b16 v[218:219], v237 offset:30720
    v_mul_f32 v243, s67, v79
    v_rcp_f32 v245, v245
    v_mfma_f32_16x16x32_bf16 a[180:183], v[228:231], v[132:135], a[180:183]
    s_add_u32 s66, s72, 0x24000
    buffer_load_dwordx4 v8, s[40:43], s66 offen lds
    v_mfma_f32_16x16x32_bf16 a[176:179], v[228:231], v[128:131], a[176:179]
    s_waitcnt vmcnt(33) lgkmcnt(4)
    v_exp_f32 v241, v241
    v_mfma_f32_16x16x32_bf16 a[0:3], v[208:211], a[192:195], a[0:3]
    ds_read_b64_tr_b16 v[220:221], v239 offset:24576
    v_fmac_f32 v73, v73, v245
    v_mfma_f32_16x16x32_bf16 a[4:7], v[208:211], a[196:199], a[4:7]
    ds_read_b64_tr_b16 v[222:223], v239 offset:30720
    v_fma_f32 v245, v241, -0.5, -1.0
    v_mfma_f32_16x16x32_bf16 a[8:11], v[208:211], a[200:203], a[8:11]
    s_add_u32 s66, s72, 0x24080
    buffer_load_dwordx4 v9, s[40:43], s66 offen offset:1024 lds
    v_mfma_f32_16x16x32_bf16 a[12:15], v[208:211], a[204:207], a[12:15]
    s_waitcnt lgkmcnt(4)
    v_rcp_f32 v246, v246
    v_mfma_f32_16x16x32_bf16 a[28:31], v[212:215], a[204:207], a[28:31]
    ds_read_b64_tr_b16 v[224:225], v233 offset:25600
    v_fma_f32 v244, v240, v244, -1.0
    v_mfma_f32_16x16x32_bf16 a[24:27], v[212:215], a[200:203], a[24:27]
    ds_read_b64_tr_b16 v[226:227], v233 offset:31744
    v_cvt_pk_bf16_f32 v60, v72, v73
    v_mfma_f32_16x16x32_bf16 a[20:23], v[212:215], a[196:199], a[20:23]
    s_add_u32 s66, s72, 0x24100
    v_exp_f32 v242, v242
    v_rcp_f32 v247, v247
    v_mfma_f32_16x16x32_bf16 a[16:19], v[212:215], a[192:195], a[16:19]
    s_waitcnt lgkmcnt(4)
    buffer_load_dwordx4 v10, s[40:43], s66 offen offset:2048 lds
    v_mfma_f32_16x16x32_bf16 a[32:35], v[216:219], a[192:195], a[32:35]
    ds_read_b64_tr_b16 v[228:229], v235 offset:25600
    v_fmac_f32 v74, v74, v246
    v_mfma_f32_16x16x32_bf16 a[36:39], v[216:219], a[196:199], a[36:39]
    ds_read_b64_tr_b16 v[230:231], v235 offset:31744
    v_fma_f32 v246, v242, -0.5, -1.0
    v_mfma_f32_16x16x32_bf16 a[40:43], v[216:219], a[200:203], a[40:43]
    v_exp_f32 v243, v243
    v_mfma_f32_16x16x32_bf16 a[44:47], v[216:219], a[204:207], a[44:47]
    s_waitcnt lgkmcnt(4)
    v_fma_f32 v245, v241, v245, -1.0
    v_fmac_f32 v75, v75, v247
    v_mfma_f32_16x16x32_bf16 a[60:63], v[220:223], a[204:207], a[60:63]
    ds_read_b64_tr_b16 v[208:209], v237 offset:25600
    v_fma_f32 v247, v243, -0.5, -1.0
    v_mfma_f32_16x16x32_bf16 a[56:59], v[220:223], a[200:203], a[56:59]
    s_add_u32 m0, s60, 0xcc00
    ds_read_b64_tr_b16 v[210:211], v237 offset:31744
    v_fma_f32 v246, v242, v246, -1.0
    v_mfma_f32_16x16x32_bf16 a[52:55], v[220:223], a[196:199], a[52:55]
    s_add_u32 s66, s72, 0x26400
    buffer_load_dwordx4 v8, s[40:43], s66 offen lds
    v_mfma_f32_16x16x32_bf16 a[48:51], v[220:223], a[192:195], a[48:51]
    s_waitcnt lgkmcnt(4)
    v_rcp_f32 v244, v244
    v_rcp_f32 v245, v245
    v_mfma_f32_16x16x32_bf16 a[64:67], v[224:227], a[192:195], a[64:67]
    ds_read_b64_tr_b16 v[212:213], v239 offset:25600
    v_cvt_pk_bf16_f32 v61, v74, v75
    v_mfma_f32_16x16x32_bf16 a[68:71], v[224:227], a[196:199], a[68:71]
    ds_read_b64_tr_b16 v[214:215], v239 offset:31744
    v_fmac_f32 v76, v76, v244
    v_mfma_f32_16x16x32_bf16 a[72:75], v[224:227], a[200:203], a[72:75]
    s_add_u32 s66, s72, 0x26480
    v_fma_f32 v247, v243, v247, -1.0
    v_fmac_f32 v77, v77, v245
    v_mfma_f32_16x16x32_bf16 a[76:79], v[224:227], a[204:207], a[76:79]
    s_waitcnt lgkmcnt(4)
    buffer_load_dwordx4 v9, s[40:43], s66 offen offset:1024 lds
    v_mfma_f32_16x16x32_bf16 a[92:95], v[228:231], a[204:207], a[92:95]
    ds_read_b64_tr_b16 v[216:217], v233 offset:26624
    v_cvt_pk_bf16_f32 v62, v76, v77
    v_mfma_f32_16x16x32_bf16 a[88:91], v[228:231], a[200:203], a[88:91]
    ds_read_b64_tr_b16 v[218:219], v233 offset:32768
    v_rcp_f32 v246, v246
    v_mfma_f32_16x16x32_bf16 a[84:87], v[228:231], a[196:199], a[84:87]
    v_rcp_f32 v247, v247
    v_mfma_f32_16x16x32_bf16 a[80:83], v[228:231], a[192:195], a[80:83]
    s_waitcnt lgkmcnt(4)
    v_fmac_f32 v78, v78, v246
    v_fmac_f32 v79, v79, v247
    v_cvt_pk_bf16_f32 v63, v78, v79
    v_mfma_f32_16x16x32_bf16 a[96:99], v[208:211], a[192:195], a[96:99]
    ds_read_b64_tr_b16 v[220:221], v235 offset:26624
    v_mul_f32 v240, s67, v144
    v_mfma_f32_16x16x32_bf16 a[100:103], v[208:211], a[196:199], a[100:103]
    s_add_u32 s66, s72, 0x26500
    ds_read_b64_tr_b16 v[222:223], v235 offset:32768
    v_mul_f32 v241, s67, v145
    v_mfma_f32_16x16x32_bf16 a[104:107], v[208:211], a[200:203], a[104:107]
    s_add_u32 s65, s68, 0x4000
    buffer_load_dwordx4 v10, s[40:43], s66 offen offset:2048 lds
    v_mfma_f32_16x16x32_bf16 a[108:111], v[208:211], a[204:207], a[108:111]
    s_waitcnt lgkmcnt(4)
    buffer_store_dwordx4 v[48:51], v1, s[48:51], s65 offen sc1
    v_mfma_f32_16x16x32_bf16 a[124:127], v[212:215], a[204:207], a[124:127]
    ds_read_b64_tr_b16 v[224:225], v237 offset:26624
    v_mul_f32 v242, s67, v146
    v_mfma_f32_16x16x32_bf16 a[120:123], v[212:215], a[200:203], a[120:123]
    ds_read_b64_tr_b16 v[226:227], v237 offset:32768
    v_mul_f32 v243, s67, v147
    v_mfma_f32_16x16x32_bf16 a[116:119], v[212:215], a[196:199], a[116:119]
    v_exp_f32 v240, v240
    v_mfma_f32_16x16x32_bf16 a[112:115], v[212:215], a[192:195], a[112:115]
    s_waitcnt lgkmcnt(4)
    buffer_store_dwordx4 v[52:55], v1, s[48:51], s65 offen offset:1024 sc1
    v_mfma_f32_16x16x32_bf16 a[128:131], v[216:219], a[192:195], a[128:131]
    ds_read_b64_tr_b16 v[228:229], v239 offset:26624
    v_fma_f32 v244, v240, -0.5, -1.0
    v_mfma_f32_16x16x32_bf16 a[132:135], v[216:219], a[196:199], a[132:135]
    ds_read_b64_tr_b16 v[230:231], v239 offset:32768
    v_fma_f32 v244, v240, v244, -1.0
    v_mfma_f32_16x16x32_bf16 a[136:139], v[216:219], a[200:203], a[136:139]
    v_exp_f32 v241, v241
    v_exp_f32 v242, v242
    v_mfma_f32_16x16x32_bf16 a[140:143], v[216:219], a[204:207], a[140:143]
    s_waitcnt vmcnt(15) lgkmcnt(4)
    s_barrier
    v_cmp_ne_u32 vcc, v13, v250
    s_cbranch_vccz L_ok2
    s_mov_b32 s75, 131072
L_sp2:
    s_sleep 2
    buffer_load_dword v13, v12, s[48:51], 0 offen offset:128 sc1
    s_waitcnt vmcnt(0)
    v_cmp_ne_u32 vcc, v13, v250
    s_cbranch_vccz L_ok2
    s_sub_u32 s75, s75, 1
    s_cmp_lg_u32 s75, 0
    s_cbranch_scc1 L_sp2
L_ok2:
    v_mfma_f32_16x16x32_bf16 a[156:159], v[220:223], a[204:207], a[156:159]
    ds_read_b64_tr_b16 v[208:209], v233 offset:49152
    v_fma_f32 v245, v241, -0.5, -1.0
    v_mfma_f32_16x16x32_bf16 a[152:155], v[220:223], a[200:203], a[152:155]
    ds_read_b64_tr_b16 v[210:211], v233 offset:55296
    v_mul_f32 v240, s67, v148
    v_mfma_f32_16x16x32_bf16 a[148:151], v[220:223], a[196:199], a[148:151]
    s_add_u32 s76, s69, 0x2000
    buffer_load_dwordx4 v[192:195], v1, s[48:51], s76 offen sc1
    v_mfma_f32_16x16x32_bf16 a[144:147], v[220:223], a[192:195], a[144:147]
    s_waitcnt lgkmcnt(4)
    buffer_load_dwordx4 v[196:199], v1, s[48:51], s76 offen offset:1024 sc1
    v_mfma_f32_16x16x32_bf16 a[160:163], v[224:227], a[192:195], a[160:163]
    ds_read_b64_tr_b16 v[212:213], v235 offset:49152
    v_fma_f32 v246, v242, -0.5, -1.0
    v_mfma_f32_16x16x32_bf16 a[164:167], v[224:227], a[196:199], a[164:167]
    ds_read_b64_tr_b16 v[214:215], v235 offset:55296
L_pad_f5:
    s_cbranch_execz L_padret_f
    v_fma_f32 v245, v241, v245, -1.0
    v_mfma_f32_16x16x32_bf16 a[168:171], v[224:227], a[200:203], a[168:171]
    buffer_load_dwordx4 v[200:203], v1, s[48:51], s76 offen offset:2048 sc1
    v_mfma_f32_16x16x32_bf16 a[172:175], v[224:227], a[204:207], a[172:175]
    s_waitcnt lgkmcnt(4)
    buffer_store_dwordx4 v[56:59], v1, s[48:51], s65 offen offset:2048 sc1
    v_mfma_f32_16x16x32_bf16 a[188:191], v[228:231], a[204:207], a[188:191]
    ds_read_b64_tr_b16 v[216:217], v237 offset:49152
    v_mul_f32 v241, s67, v149
    v_mfma_f32_16x16x32_bf16 a[184:187], v[228:231], a[200:203], a[184:187]
    s_add_u32 m0, s60, 0x12000
    ds_read_b64_tr_b16 v[218:219], v237 offset:55296
    v_fma_f32 v246, v242, v246, -1.0
    v_mfma_f32_16x16x32_bf16 a[180:183], v[228:231], a[196:199], a[180:183]
    s_add_u32 s66, s73, 0x24000
    buffer_load_dwordx4 v[204:207], v1, s[48:51], s76 offen offset:3072 sc1
    v_mfma_f32_16x16x32_bf16 a[176:179], v[228:231], a[192:195], a[176:179]
    s_waitcnt lgkmcnt(4)
    buffer_load_dwordx4 v8, s[40:43], s66 offen lds
    v_mfma_f32_16x16x32_bf16 a[0:3], v[208:211], a[208:211], a[0:3]
    ds_read_b64_tr_b16 v[220:221], v239 offset:49152
    v_exp_f32 v243, v243
    v_mfma_f32_16x16x32_bf16 a[4:7], v[208:211], a[212:215], a[4:7]
    ds_read_b64_tr_b16 v[222:223], v239 offset:55296
    v_fma_f32 v247, v243, -0.5, -1.0
    v_mfma_f32_16x16x32_bf16 a[8:11], v[208:211], a[216:219], a[8:11]
    v_rcp_f32 v244, v244
    v_mfma_f32_16x16x32_bf16 a[12:15], v[208:211], a[220:223], a[12:15]
    s_waitcnt lgkmcnt(4)
    buffer_store_dwordx4 v[60:63], v1, s[48:51], s65 offen offset:3072 sc1
    v_mfma_f32_16x16x32_bf16 a[28:31], v[212:215], a[220:223], a[28:31]
    ds_read_b64_tr_b16 v[224:225], v233 offset:50176
    v_fmac_f32 v144, v144, v244
    v_mfma_f32_16x16x32_bf16 a[24:27], v[212:215], a[216:219], a[24:27]
    ds_read_b64_tr_b16 v[226:227], v233 offset:56320
    v_mul_f32 v242, s67, v150
    v_mfma_f32_16x16x32_bf16 a[20:23], v[212:215], a[212:215], a[20:23]
    s_add_u32 s66, s73, 0x24080
    buffer_load_dwordx4 v9, s[40:43], s66 offen offset:1024 lds
    v_mfma_f32_16x16x32_bf16 a[16:19], v[212:215], a[208:211], a[16:19]
    s_waitcnt lgkmcnt(4)
    v_exp_f32 v240, v240
    v_rcp_f32 v245, v245
    v_mfma_f32_16x16x32_bf16 a[32:35], v[216:219], a[208:211], a[32:35]
    ds_read_b64_tr_b16 v[228:229], v235 offset:50176
    v_fma_f32 v244, v240, -0.5, -1.0
    v_mfma_f32_16x16x32_bf16 a[36:39], v[216:219], a[212:215], a[36:39]
    ds_read_b64_tr_b16 v[230:231], v235 offset:56320
    v_fma_f32 v247, v243, v247, -1.0
    v_mfma_f32_16x16x32_bf16 a[40:43], v[216:219], a[216:219], a[40:43]
    s_add_u32 s66, s73, 0x24100
    v_exp_f32 v241, v241
    v_mfma_f32_16x16x32_bf16 a[44:47], v[216:219], a[220:223], a[44:47]
    s_waitcnt lgkmcnt(4)
    buffer_load_dwordx4 v10, s[40:43], s66 offen offset:2048 lds
    v_mfma_f32_16x16x32_bf16 a[60:63], v[220:223], a[220:223], a[60:63]
    ds_read_b64_tr_b16 v[208:209], v237 offset:50176
    v_fmac_f32 v145, v145, v245
    v_mfma_f32_16x16x32_bf16 a[56:59], v[220:223], a[216:219], a[56:59]
    ds_read_b64_tr_b16 v[210:211], v237 offset:56320
    v_mul_f32 v243, s67, v151
    v_mfma_f32_16x16x32_bf16 a[52:55], v[220:223], a[212:215], a[52:55]
    v_rcp_f32 v246, v246
    v_exp_f32 v242, v242
    v_mfma_f32_16x16x32_bf16 a[48:51], v[220:223], a[208:211], a[48:51]
    s_waitcnt lgkmcnt(4)
    v_fma_f32 v245, v241, -0.5, -1.0
    v_fma_f32 v244, v240, v244, -1.0
    v_mfma_f32_16x16x32_bf16 a[64:67], v[224:227], a[208:211], a[64:67]
    ds_read_b64_tr_b16 v[212:213], v239 offset:50176
    v_cvt_pk_bf16_f32 v144, v144, v145
    v_mfma_f32_16x16x32_bf16 a[68:71], v[224:227], a[212:215], a[68:71]
    s_add_u32 m0, s60, 0x12c00
    ds_read_b64_tr_b16 v[214:215], v239 offset:56320
    v_fmac_f32 v146, v146, v246
    v_mfma_f32_16x16x32_bf16 a[72:75], v[224:227], a[216:219], a[72:75]
    s_add_u32 s66, s73, 0x26400
    buffer_load_dwordx4 v8, s[40:43], s66 offen lds
    v_mfma_f32_16x16x32_bf16 a[76:79], v[224:227], a[220:223], a[76:79]
    s_waitcnt lgkmcnt(4)
    v_rcp_f32 v247, v247
    v_mul_f32 v240, s67, v152
    v_mfma_f32_16x16x32_bf16 a[92:95], v[228:231], a[220:223], a[92:95]
    ds_read_b64_tr_b16 v[216:217], v233 offset:51200
    v_fma_f32 v246, v242, -0.5, -1.0
    v_mfma_f32_16x16x32_bf16 a[88:91], v[228:231], a[216:219], a[88:91]
    ds_read_b64_tr_b16 v[218:219], v233 offset:57344
    v_fma_f32 v245, v241, v245, -1.0
    v_mfma_f32_16x16x32_bf16 a[84:87], v[228:231], a[212:215], a[84:87]
    s_add_u32 s66, s73, 0x26480
    v_exp_f32 v243, v243
    v_mfma_f32_16x16x32_bf16 a[80:83], v[228:231], a[208:211], a[80:83]
    s_waitcnt lgkmcnt(4)
    buffer_load_dwordx4 v9, s[40:43], s66 offen offset:1024 lds
    v_mfma_f32_16x16x32_bf16 a[96:99], v[208:211], a[208:211], a[96:99]
    ds_read_b64_tr_b16 v[220:221], v235 offset:51200
    v_fmac_f32 v147, v147, v247
    v_mfma_f32_16x16x32_bf16 a[100:103], v[208:211], a[212:215], a[100:103]
    ds_read_b64_tr_b16 v[222:223], v235 offset:57344
    v_mul_f32 v241, s67, v153
    v_mfma_f32_16x16x32_bf16 a[104:107], v[208:211], a[216:219], a[104:107]
    v_rcp_f32 v244, v244
    v_exp_f32 v240, v240
    v_mfma_f32_16x16x32_bf16 a[108:111], v[208:211], a[220:223], a[108:111]
    s_waitcnt lgkmcnt(4)
    v_fma_f32 v247, v243, -0.5, -1.0
    v_fma_f32 v246, v242, v246, -1.0
    v_mfma_f32_16x16x32_bf16 a[124:127], v[212:215], a[220:223], a[124:127]
    ds_read_b64_tr_b16 v[224:225], v237 offset:51200
    v_cvt_pk_bf16_f32 v145, v146, v147
    v_mfma_f32_16x16x32_bf16 a[120:123], v[212:215], a[216:219], a[120:123]
    ds_read_b64_tr_b16 v[226:227], v237 offset:57344
    v_fmac_f32 v148, v148, v244
    v_mfma_f32_16x16x32_bf16 a[116:119], v[212:215], a[212:215], a[116:119]
    s_add_u32 s66, s73, 0x26500
    buffer_load_dwordx4 v10, s[40:43], s66 offen offset:2048 lds
    v_mfma_f32_16x16x32_bf16 a[112:115], v[212:215], a[208:211], a[112:115]
    s_waitcnt lgkmcnt(4)
    v_rcp_f32 v245, v245
    v_mul_f32 v242, s67, v154
    v_mfma_f32_16x16x32_bf16 a[128:131], v[216:219], a[208:211], a[128:131]
    ds_read_b64_tr_b16 v[228:229], v239 offset:51200
    v_fma_f32 v244, v240, -0.5, -1.0
    v_mfma_f32_16x16x32_bf16 a[132:135], v[216:219], a[212:215], a[132:135]
    ds_read_b64_tr_b16 v[230:231], v239 offset:57344
    v_fma_f32 v247, v243, v247, -1.0
    v_mfma_f32_16x16x32_bf16 a[136:139], v[216:219], a[216:219], a[136:139]
    v_exp_f32 v241, v241
    v_mfma_f32_16x16x32_bf16 a[140:143], v[216:219], a[220:223], a[140:143]
    s_waitcnt lgkmcnt(4)
    s_barrier
    v_fmac_f32 v149, v149, v245
    v_mfma_f32_16x16x32_bf16 a[156:159], v[220:223], a[220:223], a[156:159]
    ds_read_b64_tr_b16 v[208:209], v232
    v_mul_f32 v243, s67, v155
    v_mfma_f32_16x16x32_bf16 a[152:155], v[220:223], a[216:219], a[152:155]
    ds_read_b64_tr_b16 v[210:211], v232 offset:6144
    v_fma_f32 v245, v241, -0.5, -1.0
    v_mfma_f32_16x16x32_bf16 a[148:151], v[220:223], a[212:215], a[148:151]
    s_add_u32 s76, s70, 0x2000
    buffer_load_dwordx4 v[176:179], v1, s[48:51], s76 offen sc1
    v_mfma_f32_16x16x32_bf16 a[144:147], v[220:223], a[208:211], a[144:147]
    s_waitcnt lgkmcnt(4)
    buffer_load_dwordx4 v[180:183], v1, s[48:51], s76 offen offset:1024 sc1
    v_mfma_f32_16x16x32_bf16 a[160:163], v[224:227], a[208:211], a[160:163]
    ds_read_b64_tr_b16 v[212:213], v234
    v_fma_f32 v244, v240, v244, -1.0
    v_rcp_f32 v246, v246
    v_mfma_f32_16x16x32_bf16 a[164:167], v[224:227], a[212:215], a[164:167]
    ds_read_b64_tr_b16 v[214:215], v234 offset:6144
    v_cvt_pk_bf16_f32 v146, v148, v149
    v_mfma_f32_16x16x32_bf16 a[168:171], v[224:227], a[216:219], a[168:171]
    buffer_load_dwordx4 v[184:187], v1, s[48:51], s76 offen offset:2048 sc1
    v_mfma_f32_16x16x32_bf16 a[172:175], v[224:227], a[220:223], a[172:175]
    s_waitcnt lgkmcnt(4)
    buffer_load_dwordx4 v[188:191], v1, s[48:51], s76 offen offset:3072 sc1
    v_mfma_f32_16x16x32_bf16 a[188:191], v[228:231], a[220:223], a[188:191]
    ds_read_b64_tr_b16 v[216:217], v236
    v_fmac_f32 v150, v150, v246
    v_mfma_f32_16x16x32_bf16 a[184:187], v[228:231], a[216:219], a[184:187]
    s_add_u32 m0, s60, 0x18000
    ds_read_b64_tr_b16 v[218:219], v236 offset:6144
    v_mul_f32 v240, s67, v156
    v_mfma_f32_16x16x32_bf16 a[180:183], v[228:231], a[212:215], a[180:183]
    s_add_u32 s66, s72, 0x36000
    buffer_load_dwordx4 v8, s[40:43], s66 offen lds
    v_mfma_f32_16x16x32_bf16 a[176:179], v[228:231], a[208:211], a[176:179]
    s_waitcnt lgkmcnt(4)
    v_exp_f32 v242, v242
    v_mfma_f32_16x16x32_bf16 a[0:3], v[208:211], a[224:227], a[0:3]
    ds_read_b64_tr_b16 v[220:221], v238
    v_fma_f32 v246, v242, -0.5, -1.0
    v_mfma_f32_16x16x32_bf16 a[4:7], v[208:211], a[228:231], a[4:7]
    ds_read_b64_tr_b16 v[222:223], v238 offset:6144
    v_fma_f32 v245, v241, v245, -1.0
    v_mfma_f32_16x16x32_bf16 a[8:11], v[208:211], a[232:235], a[8:11]
    s_add_u32 s66, s72, 0x36080
    v_rcp_f32 v247, v247
    v_exp_f32 v243, v243
    v_mfma_f32_16x16x32_bf16 a[12:15], v[208:211], a[236:239], a[12:15]
    s_waitcnt lgkmcnt(4)
    buffer_load_dwordx4 v9, s[40:43], s66 offen offset:1024 lds
    v_mfma_f32_16x16x32_bf16 a[28:31], v[212:215], a[236:239], a[28:31]
    ds_read_b64_tr_b16 v[224:225], v232 offset:1024
    v_fmac_f32 v151, v151, v247
    v_mfma_f32_16x16x32_bf16 a[24:27], v[212:215], a[232:235], a[24:27]
    ds_read_b64_tr_b16 v[226:227], v232 offset:7168
    v_mul_f32 v241, s67, v157
    v_mfma_f32_16x16x32_bf16 a[20:23], v[212:215], a[228:231], a[20:23]
    v_rcp_f32 v244, v244
    v_mfma_f32_16x16x32_bf16 a[16:19], v[212:215], a[224:227], a[16:19]
    s_waitcnt lgkmcnt(4)
    v_exp_f32 v240, v240
    v_fma_f32 v247, v243, -0.5, -1.0
    v_mfma_f32_16x16x32_bf16 a[32:35], v[216:219], a[224:227], a[32:35]
    ds_read_b64_tr_b16 v[228:229], v234 offset:1024
    v_fma_f32 v246, v242, v246, -1.0
    v_mfma_f32_16x16x32_bf16 a[36:39], v[216:219], a[228:231], a[36:39]
    ds_read_b64_tr_b16 v[230:231], v234 offset:7168
    v_cvt_pk_bf16_f32 v147, v150, v151
    v_mfma_f32_16x16x32_bf16 a[40:43], v[216:219], a[232:235], a[40:43]
    s_add_u32 s66, s72, 0x36100
    buffer_load_dwordx4 v10, s[40:43], s66 offen offset:2048 lds
    v_mfma_f32_16x16x32_bf16 a[44:47], v[216:219], a[236:239], a[44:47]
    s_waitcnt lgkmcnt(4)
    v_rcp_f32 v245, v245
    v_fmac_f32 v152, v152, v244
    v_mfma_f32_16x16x32_bf16 a[60:63], v[220:223], a[236:239], a[60:63]
    ds_read_b64_tr_b16 v[208:209], v236 offset:1024
    v_mul_f32 v242, s67, v158
    v_mfma_f32_16x16x32_bf16 a[56:59], v[220:223], a[232:235], a[56:59]
    s_add_u32 m0, s60, 0x18c00
    ds_read_b64_tr_b16 v[210:211], v236 offset:7168
    v_fma_f32 v244, v240, -0.5, -1.0
    v_mfma_f32_16x16x32_bf16 a[52:55], v[220:223], a[228:231], a[52:55]
    s_add_u32 s66, s72, 0x38400
    v_exp_f32 v241, v241
    v_fma_f32 v247, v243, v247, -1.0
    v_mfma_f32_16x16x32_bf16 a[48:51], v[220:223], a[224:227], a[48:51]
    s_waitcnt lgkmcnt(4)
    buffer_load_dwordx4 v8, s[40:43], s66 offen lds
    v_mfma_f32_16x16x32_bf16 a[64:67], v[224:227], a[224:227], a[64:67]
    ds_read_b64_tr_b16 v[212:213], v238 offset:1024
    v_fmac_f32 v153, v153, v245
    v_mfma_f32_16x16x32_bf16 a[68:71], v[224:227], a[228:231], a[68:71]
    ds_read_b64_tr_b16 v[214:215], v238 offset:7168
    v_mul_f32 v243, s67, v159
    v_mfma_f32_16x16x32_bf16 a[72:75], v[224:227], a[232:235], a[72:75]
    v_rcp_f32 v246, v246
    v_mfma_f32_16x16x32_bf16 a[76:79], v[224:227], a[236:239], a[76:79]
    s_waitcnt lgkmcnt(4)
    v_exp_f32 v242, v242
    v_fma_f32 v245, v241, -0.5, -1.0
    v_mfma_f32_16x16x32_bf16 a[92:95], v[228:231], a[236:239], a[92:95]
    ds_read_b64_tr_b16 v[216:217], v232 offset:2048
    v_fma_f32 v244, v240, v244, -1.0
    v_mfma_f32_16x16x32_bf16 a[88:91], v[228:231], a[232:235], a[88:91]
    ds_read_b64_tr_b16 v[218:219], v232 offset:8192
    v_cvt_pk_bf16_f32 v148, v152, v153
    v_mfma_f32_16x16x32_bf16 a[84:87], v[228:231], a[228:231], a[84:87]
    s_add_u32 s66, s72, 0x38480
    buffer_load_dwordx4 v9, s[40:43], s66 offen offset:1024 lds
    v_mfma_f32_16x16x32_bf16 a[80:83], v[228:231], a[224:227], a[80:83]
    s_waitcnt lgkmcnt(4)
    v_rcp_f32 v247, v247
    v_fmac_f32 v154, v154, v246
    v_mfma_f32_16x16x32_bf16 a[96:99], v[208:211], a[224:227], a[96:99]
    ds_read_b64_tr_b16 v[220:221], v234 offset:2048
    v_mul_f32 v240, s67, v160
    v_mfma_f32_16x16x32_bf16 a[100:103], v[208:211], a[228:231], a[100:103]
    ds_read_b64_tr_b16 v[222:223], v234 offset:8192
    v_fma_f32 v246, v242, -0.5, -1.0
    v_mfma_f32_16x16x32_bf16 a[104:107], v[208:211], a[232:235], a[104:107]
    s_add_u32 s66, s72, 0x38500
    v_exp_f32 v243, v243
    v_fma_f32 v245, v241, v245, -1.0
    v_mfma_f32_16x16x32_bf16 a[108:111], v[208:211], a[236:239], a[108:111]
    s_waitcnt lgkmcnt(4)
    buffer_load_dwordx4 v10, s[40:43], s66 offen offset:2048 lds
    v_mfma_f32_16x16x32_bf16 a[124:127], v[212:215], a[236:239], a[124:127]
    ds_read_b64_tr_b16 v[224:225], v236 offset:2048
    v_fmac_f32 v155, v155, v247
    v_mfma_f32_16x16x32_bf16 a[120:123], v[212:215], a[232:235], a[120:123]
    ds_read_b64_tr_b16 v[226:227], v236 offset:8192
    v_mul_f32 v241, s67, v161
    v_mfma_f32_16x16x32_bf16 a[116:119], v[212:215], a[228:231], a[116:119]
    v_rcp_f32 v244, v244
    v_mfma_f32_16x16x32_bf16 a[112:115], v[212:215], a[224:227], a[112:115]
    s_waitcnt lgkmcnt(4)
    v_exp_f32 v240, v240
    v_fma_f32 v247, v243, -0.5, -1.0
    v_mfma_f32_16x16x32_bf16 a[128:131], v[216:219], a[224:227], a[128:131]
    ds_read_b64_tr_b16 v[228:229], v238 offset:2048
    v_fma_f32 v246, v242, v246, -1.0
    v_mfma_f32_16x16x32_bf16 a[132:135], v[216:219], a[228:231], a[132:135]
    ds_read_b64_tr_b16 v[230:231], v238 offset:8192
    v_cvt_pk_bf16_f32 v149, v154, v155
    v_mfma_f32_16x16x32_bf16 a[136:139], v[216:219], a[232:235], a[136:139]
    v_rcp_f32 v245, v245
    v_fmac_f32 v156, v156, v244
    v_mfma_f32_16x16x32_bf16 a[140:143], v[216:219], a[236:239], a[140:143]
    s_waitcnt vmcnt(34) lgkmcnt(4)
    s_barrier
    v_mul_f32 v242, s67, v162
    v_mfma_f32_16x16x32_bf16 a[156:159], v[220:223], a[236:239], a[156:159]
    ds_read_b64_tr_b16 v[208:209], v232 offset:24576
    v_fma_f32 v244, v240, -0.5, -1.0
    v_mfma_f32_16x16x32_bf16 a[152:155], v[220:223], a[232:235], a[152:155]
    ds_read_b64_tr_b16 v[210:211], v232 offset:30720
    v_fma_f32 v247, v243, v247, -1.0
    v_mfma_f32_16x16x32_bf16 a[148:151], v[220:223], a[228:231], a[148:151]
    s_add_u32 s76, s69, 0x3000
    buffer_load_dwordx4 v[16:19], v1, s[48:51], s76 offen sc1
    v_mfma_f32_16x16x32_bf16 a[144:147], v[220:223], a[224:227], a[144:147]
    s_waitcnt lgkmcnt(4)
    buffer_load_dwordx4 v[20:23], v1, s[48:51], s76 offen offset:1024 sc1
    v_mfma_f32_16x16x32_bf16 a[160:163], v[224:227], a[224:227], a[160:163]
    ds_read_b64_tr_b16 v[212:213], v234 offset:24576
    v_fmac_f32 v157, v157, v245
    v_mfma_f32_16x16x32_bf16 a[164:167], v[224:227], a[228:231], a[164:167]
    ds_read_b64_tr_b16 v[214:215], v234 offset:30720
    v_mul_f32 v243, s67, v163
    v_mfma_f32_16x16x32_bf16 a[168:171], v[224:227], a[232:235], a[168:171]
    buffer_load_dwordx4 v[24:27], v1, s[48:51], s76 offen offset:2048 sc1
    v_mfma_f32_16x16x32_bf16 a[172:175], v[224:227], a[236:239], a[172:175]
    s_waitcnt lgkmcnt(4)
    buffer_load_dwordx4 v[28:31], v1, s[48:51], s76 offen offset:3072 sc1
    v_mfma_f32_16x16x32_bf16 a[188:191], v[228:231], a[236:239], a[188:191]
    ds_read_b64_tr_b16 v[216:217], v236 offset:24576
    v_fma_f32 v244, v240, v244, -1.0
    v_mfma_f32_16x16x32_bf16 a[184:187], v[228:231], a[232:235], a[184:187]
    s_add_u32 m0, s60, 0x1e000
    ds_read_b64_tr_b16 v[218:219], v236 offset:30720
    v_cvt_pk_bf16_f32 v150, v156, v157
    v_exp_f32 v241, v241
    v_mfma_f32_16x16x32_bf16 a[180:183], v[228:231], a[228:231], a[180:183]
    s_add_u32 s66, s73, 0x36000
    buffer_load_dwordx4 v8, s[40:43], s66 offen lds
    v_mfma_f32_16x16x32_bf16 a[176:179], v[228:231], a[224:227], a[176:179]
    s_waitcnt vmcnt(35) lgkmcnt(4)
    v_rcp_f32 v246, v246
    v_mfma_f32_16x16x32_bf16 a[0:3], v[208:211], a[240:243], a[0:3]
    ds_read_b64_tr_b16 v[220:221], v238 offset:24576
    v_fma_f32 v245, v241, -0.5, -1.0
    v_mfma_f32_16x16x32_bf16 a[4:7], v[208:211], a[244:247], a[4:7]
    ds_read_b64_tr_b16 v[222:223], v238 offset:30720
    v_fmac_f32 v158, v158, v246
    v_mfma_f32_16x16x32_bf16 a[8:11], v[208:211], a[248:251], a[8:11]
    s_add_u32 s66, s73, 0x36080
    v_exp_f32 v242, v242
    v_mfma_f32_16x16x32_bf16 a[12:15], v[208:211], a[252:255], a[12:15]
    s_waitcnt lgkmcnt(4)
    buffer_load_dwordx4 v9, s[40:43], s66 offen offset:1024 lds
    v_mfma_f32_16x16x32_bf16 a[28:31], v[212:215], a[252:255], a[28:31]
    ds_read_b64_tr_b16 v[224:225], v232 offset:25600
    v_mul_f32 v240, s67, v164
    v_mfma_f32_16x16x32_bf16 a[24:27], v[212:215], a[248:251], a[24:27]
    ds_read_b64_tr_b16 v[226:227], v232 offset:31744
    v_fma_f32 v246, v242, -0.5, -1.0
    v_mfma_f32_16x16x32_bf16 a[20:23], v[212:215], a[244:247], a[20:23]
    v_rcp_f32 v247, v247
    v_exp_f32 v243, v243
    v_mfma_f32_16x16x32_bf16 a[16:19], v[212:215], a[240:243], a[16:19]
    s_waitcnt lgkmcnt(4)
    v_fma_f32 v245, v241, v245, -1.0
    v_fmac_f32 v159, v159, v247
    v_mfma_f32_16x16x32_bf16 a[32:35], v[216:219], a[240:243], a[32:35]
    ds_read_b64_tr_b16 v[228:229], v234 offset:25600
    v_mul_f32 v241, s67, v165
    v_mfma_f32_16x16x32_bf16 a[36:39], v[216:219], a[244:247], a[36:39]
    ds_read_b64_tr_b16 v[230:231], v234 offset:31744
    v_fma_f32 v247, v243, -0.5, -1.0
    v_mfma_f32_16x16x32_bf16 a[40:43], v[216:219], a[248:251], a[40:43]
    s_add_u32 s66, s73, 0x36100
    buffer_load_dwordx4 v10, s[40:43], s66 offen offset:2048 lds
    v_mfma_f32_16x16x32_bf16 a[44:47], v[216:219], a[252:255], a[44:47]
    s_waitcnt lgkmcnt(4)
    v_rcp_f32 v244, v244
    v_mfma_f32_16x16x32_bf16 a[60:63], v[220:223], a[252:255], a[60:63]
    ds_read_b64_tr_b16 v[208:209], v236 offset:25600
    v_fma_f32 v246, v242, v246, -1.0
    v_mfma_f32_16x16x32_bf16 a[56:59], v[220:223], a[248:251], a[56:59]
    s_add_u32 m0, s60, 0x1ec00
    ds_read_b64_tr_b16 v[210:211], v236 offset:31744
    v_cvt_pk_bf16_f32 v151, v158, v159
    v_exp_f32 v240, v240
    v_mfma_f32_16x16x32_bf16 a[52:55], v[220:223], a[244:247], a[52:55]
    s_add_u32 s66, s73, 0x38400
    v_rcp_f32 v245, v245
    v_mfma_f32_16x16x32_bf16 a[48:51], v[220:223], a[240:243], a[48:51]
    s_waitcnt lgkmcnt(4)
    buffer_load_dwordx4 v8, s[40:43], s66 offen lds
    v_mfma_f32_16x16x32_bf16 a[64:67], v[224:227], a[240:243], a[64:67]
    ds_read_b64_tr_b16 v[212:213], v238 offset:25600
    v_fmac_f32 v160, v160, v244
    v_mfma_f32_16x16x32_bf16 a[68:71], v[224:227], a[244:247], a[68:71]
    ds_read_b64_tr_b16 v[214:215], v238 offset:31744
    v_mul_f32 v242, s67, v166
    v_mfma_f32_16x16x32_bf16 a[72:75], v[224:227], a[248:251], a[72:75]
    v_exp_f32 v241, v241
    v_fma_f32 v244, v240, -0.5, -1.0
    v_mfma_f32_16x16x32_bf16 a[76:79], v[224:227], a[252:255], a[76:79]
    s_waitcnt lgkmcnt(4)
    v_fma_f32 v247, v243, v247, -1.0
    v_fmac_f32 v161, v161, v245
    v_mfma_f32_16x16x32_bf16 a[92:95], v[228:231], a[252:255], a[92:95]
    ds_read_b64_tr_b16 v[216:217], v232 offset:26624
    v_mul_f32 v243, s67, v167
    v_mfma_f32_16x16x32_bf16 a[88:91], v[228:231], a[248:251], a[88:91]
    ds_read_b64_tr_b16 v[218:219], v232 offset:32768
    v_fma_f32 v245, v241, -0.5, -1.0
    v_mfma_f32_16x16x32_bf16 a[84:87], v[228:231], a[244:247], a[84:87]
    s_add_u32 s66, s73, 0x38480
    buffer_load_dwordx4 v9, s[40:43], s66 offen offset:1024 lds
    v_mfma_f32_16x16x32_bf16 a[80:83], v[228:231], a[240:243], a[80:83]
    s_waitcnt lgkmcnt(4)
    v_rcp_f32 v246, v246
    v_mfma_f32_16x16x32_bf16 a[96:99], v[208:211], a[240:243], a[96:99]
    ds_read_b64_tr_b16 v[220:221], v234 offset:26624
    v_fma_f32 v244, v240, v244, -1.0
    v_mfma_f32_16x16x32_bf16 a[100:103], v[208:211], a[244:247], a[100:103]
    ds_read_b64_tr_b16 v[222:223], v234 offset:32768
    v_cvt_pk_bf16_f32 v152, v160, v161
    v_exp_f32 v242, v242
    v_mfma_f32_16x16x32_bf16 a[104:107], v[208:211], a[248:251], a[104:107]
    s_add_u32 s66, s73, 0x38500
    v_rcp_f32 v247, v247
    v_mfma_f32_16x16x32_bf16 a[108:111], v[208:211], a[252:255], a[108:111]
    s_waitcnt lgkmcnt(4)
    buffer_load_dwordx4 v10, s[40:43], s66 offen offset:2048 lds
    v_mfma_f32_16x16x32_bf16 a[124:127], v[212:215], a[252:255], a[124:127]
    ds_read_b64_tr_b16 v[224:225], v236 offset:26624
    v_fmac_f32 v162, v162, v246
    v_mfma_f32_16x16x32_bf16 a[120:123], v[212:215], a[248:251], a[120:123]
    ds_read_b64_tr_b16 v[226:227], v236 offset:32768
    v_mul_f32 v240, s67, v168
    v_mfma_f32_16x16x32_bf16 a[116:119], v[212:215], a[244:247], a[116:119]
    v_exp_f32 v243, v243
    v_fma_f32 v246, v242, -0.5, -1.0
    v_mfma_f32_16x16x32_bf16 a[112:115], v[212:215], a[240:243], a[112:115]
    s_waitcnt lgkmcnt(4)
    v_fma_f32 v245, v241, v245, -1.0
    v_fmac_f32 v163, v163, v247
    v_mfma_f32_16x16x32_bf16 a[128:131], v[216:219], a[240:243], a[128:131]
    ds_read_b64_tr_b16 v[228:229], v238 offset:26624
    v_mul_f32 v241, s67, v169
    v_mfma_f32_16x16x32_bf16 a[132:135], v[216:219], a[244:247], a[132:135]
    ds_read_b64_tr_b16 v[230:231], v238 offset:32768
    v_fma_f32 v247, v243, -0.5, -1.0
    v_mfma_f32_16x16x32_bf16 a[136:139], v[216:219], a[248:251], a[136:139]
    v_rcp_f32 v244, v244
    v_mfma_f32_16x16x32_bf16 a[140:143], v[216:219], a[252:255], a[140:143]
    s_waitcnt vmcnt(25) lgkmcnt(4)
    s_barrier
    buffer_store_dword v14, v15, s[48:51], 0 offen offset:256 sc1
    v_mfma_f32_16x16x32_bf16 a[156:159], v[220:223], a[252:255], a[156:159]
    ds_read_b64_tr_b16 v[208:209], v232 offset:49152
    v_fma_f32 v246, v242, v246, -1.0
    v_mfma_f32_16x16x32_bf16 a[152:155], v[220:223], a[248:251], a[152:155]
    ds_read_b64_tr_b16 v[210:211], v232 offset:55296
    v_cvt_pk_bf16_f32 v153, v162, v163
    v_exp_f32 v240, v240
    v_mfma_f32_16x16x32_bf16 a[148:151], v[220:223], a[244:247], a[148:151]
    s_add_u32 s76, s70, 0x3000
    buffer_load_dwordx4 v[32:35], v1, s[48:51], s76 offen sc1
    v_mfma_f32_16x16x32_bf16 a[144:147], v[220:223], a[240:243], a[144:147]
    s_waitcnt lgkmcnt(4)
    buffer_load_dwordx4 v[36:39], v1, s[48:51], s76 offen offset:1024 sc1
    v_mfma_f32_16x16x32_bf16 a[160:163], v[224:227], a[240:243], a[160:163]
    ds_read_b64_tr_b16 v[212:213], v234 offset:49152
    v_fmac_f32 v164, v164, v244
    v_mfma_f32_16x16x32_bf16 a[164:167], v[224:227], a[244:247], a[164:167]
    ds_read_b64_tr_b16 v[214:215], v234 offset:55296
    v_mul_f32 v242, s67, v170
    v_mfma_f32_16x16x32_bf16 a[168:171], v[224:227], a[248:251], a[168:171]
    buffer_load_dwordx4 v[40:43], v1, s[48:51], s76 offen offset:2048 sc1
    v_mfma_f32_16x16x32_bf16 a[172:175], v[224:227], a[252:255], a[172:175]
    s_waitcnt lgkmcnt(4)
    buffer_load_dwordx4 v[44:47], v1, s[48:51], s76 offen offset:3072 sc1
    v_mfma_f32_16x16x32_bf16 a[188:191], v[228:231], a[252:255], a[188:191]
    ds_read_b64_tr_b16 v[216:217], v236 offset:49152
    v_fma_f32 v244, v240, -0.5, -1.0
    v_mfma_f32_16x16x32_bf16 a[184:187], v[228:231], a[248:251], a[184:187]
    s_add_u32 m0, s60, 0
    ds_read_b64_tr_b16 v[218:219], v236 offset:55296
    v_fma_f32 v247, v243, v247, -1.0
    v_mfma_f32_16x16x32_bf16 a[180:183], v[228:231], a[244:247], a[180:183]
    s_add_u32 s66, s71, 0x48000
    buffer_load_dwordx4 v8, s[40:43], s66 offen lds
    v_mfma_f32_16x16x32_bf16 a[176:179], v[228:231], a[240:243], a[176:179]
    s_waitcnt lgkmcnt(4)
    v_rcp_f32 v245, v245
    v_mfma_f32_16x16x32_bf16 a[0:3], v[208:211], v[192:195], a[0:3]
    ds_read_b64_tr_b16 v[220:221], v238 offset:49152
    v_fmac_f32 v165, v165, v245
    v_mfma_f32_16x16x32_bf16 a[4:7], v[208:211], v[196:199], a[4:7]
    ds_read_b64_tr_b16 v[222:223], v238 offset:55296
    v_mul_f32 v243, s67, v171
    v_mfma_f32_16x16x32_bf16 a[8:11], v[208:211], v[200:203], a[8:11]
    s_add_u32 s66, s71, 0x48080
    v_exp_f32 v241, v241
    v_rcp_f32 v246, v246
    v_mfma_f32_16x16x32_bf16 a[12:15], v[208:211], v[204:207], a[12:15]
    s_waitcnt lgkmcnt(4)
    buffer_load_dwordx4 v9, s[40:43], s66 offen offset:1024 lds
    v_mfma_f32_16x16x32_bf16 a[28:31], v[212:215], v[204:207], a[28:31]
    ds_read_b64_tr_b16 v[224:225], v232 offset:50176
    v_fma_f32 v245, v241, -0.5, -1.0
    v_mfma_f32_16x16x32_bf16 a[24:27], v[212:215], v[200:203], a[24:27]
    ds_read_b64_tr_b16 v[226:227], v232 offset:56320
    v_fma_f32 v244, v240, v244, -1.0
    v_mfma_f32_16x16x32_bf16 a[20:23], v[212:215], v[196:199], a[20:23]
    v_exp_f32 v242, v242
    v_mfma_f32_16x16x32_bf16 a[16:19], v[212:215], v[192:195], a[16:19]
    s_waitcnt lgkmcnt(4)
    v_rcp_f32 v247, v247
    v_cvt_pk_bf16_f32 v154, v164, v165
    v_mfma_f32_16x16x32_bf16 a[32:35], v[216:219], v[192:195], a[32:35]
    ds_read_b64_tr_b16 v[228:229], v234 offset:50176
    v_fmac_f32 v166, v166, v246
    v_mfma_f32_16x16x32_bf16 a[36:39], v[216:219], v[196:199], a[36:39]
    ds_read_b64_tr_b16 v[230:231], v234 offset:56320
    v_mul_f32 v240, s67, v172
    v_mfma_f32_16x16x32_bf16 a[40:43], v[216:219], v[200:203], a[40:43]
    s_add_u32 s66, s71, 0x48100
    buffer_load_dwordx4 v10, s[40:43], s66 offen offset:2048 lds
    v_mfma_f32_16x16x32_bf16 a[44:47], v[216:219], v[204:207], a[44:47]
    s_waitcnt lgkmcnt(4)
    v_exp_f32 v243, v243
    v_fma_f32 v246, v242, -0.5, -1.0
    v_mfma_f32_16x16x32_bf16 a[60:63], v[220:223], v[204:207], a[60:63]
    ds_read_b64_tr_b16 v[208:209], v236 offset:50176
    v_fma_f32 v245, v241, v245, -1.0
    v_mfma_f32_16x16x32_bf16 a[56:59], v[220:223], v[200:203], a[56:59]
    s_add_u32 m0, s60, 0xc00
    ds_read_b64_tr_b16 v[210:211], v236 offset:56320
    v_fmac_f32 v167, v167, v247
    v_mfma_f32_16x16x32_bf16 a[52:55], v[220:223], v[196:199], a[52:55]
    s_add_u32 s66, s71, 0x4a400
    v_rcp_f32 v244, v244
    v_mul_f32 v241, s67, v173
    v_mfma_f32_16x16x32_bf16 a[48:51], v[220:223], v[192:195], a[48:51]
    s_waitcnt lgkmcnt(4)
    buffer_load_dwordx4 v8, s[40:43], s66 offen lds
    v_mfma_f32_16x16x32_bf16 a[64:67], v[224:227], v[192:195], a[64:67]
    ds_read_b64_tr_b16 v[212:213], v238 offset:50176
    v_fma_f32 v247, v243, -0.5, -1.0
    v_mfma_f32_16x16x32_bf16 a[68:71], v[224:227], v[196:199], a[68:71]
    ds_read_b64_tr_b16 v[214:215], v238 offset:56320
    v_fma_f32 v246, v242, v246, -1.0
    v_mfma_f32_16x16x32_bf16 a[72:75], v[224:227], v[200:203], a[72:75]
    v_exp_f32 v240, v240
    v_mfma_f32_16x16x32_bf16 a[76:79], v[224:227], v[204:207], a[76:79]
    s_waitcnt lgkmcnt(4)
    v_rcp_f32 v245, v245
    v_cvt_pk_bf16_f32 v155, v166, v167
    v_mfma_f32_16x16x32_bf16 a[92:95], v[228:231], v[204:207], a[92:95]
    ds_read_b64_tr_b16 v[216:217], v232 offset:51200
    v_fmac_f32 v168, v168, v244
    v_mfma_f32_16x16x32_bf16 a[88:91], v[228:231], v[200:203], a[88:91]
    ds_read_b64_tr_b16 v[218:219], v232 offset:57344
    v_mul_f32 v242, s67, v174
    v_mfma_f32_16x16x32_bf16 a[84:87], v[228:231], v[196:199], a[84:87]
    s_add_u32 s66, s71, 0x4a480
    buffer_load_dwordx4 v9, s[40:43], s66 offen offset:1024 lds
    v_mfma_f32_16x16x32_bf16 a[80:83], v[228:231], v[192:195], a[80:83]
    s_waitcnt lgkmcnt(4)
    v_exp_f32 v241, v241
    v_fma_f32 v244, v240, -0.5, -1.0
    v_mfma_f32_16x16x32_bf16 a[96:99], v[208:211], v[192:195], a[96:99]
    ds_read_b64_tr_b16 v[220:221], v234 offset:51200
    v_fma_f32 v247, v243, v247, -1.0
    v_mfma_f32_16x16x32_bf16 a[100:103], v[208:211], v[196:199], a[100:103]
    ds_read_b64_tr_b16 v[222:223], v234 offset:57344
    v_fmac_f32 v169, v169, v245
    v_mfma_f32_16x16x32_bf16 a[104:107], v[208:211], v[200:203], a[104:107]
    s_add_u32 s66, s71, 0x4a500
    v_rcp_f32 v246, v246
    v_mul_f32 v243, s67, v175
    v_mfma_f32_16x16x32_bf16 a[108:111], v[208:211], v[204:207], a[108:111]
    s_waitcnt lgkmcnt(4)
    buffer_load_dwordx4 v10, s[40:43], s66 offen offset:2048 lds
    v_mfma_f32_16x16x32_bf16 a[124:127], v[212:215], v[204:207], a[124:127]
    ds_read_b64_tr_b16 v[224:225], v236 offset:51200
    v_fma_f32 v245, v241, -0.5, -1.0
    v_mfma_f32_16x16x32_bf16 a[120:123], v[212:215], v[200:203], a[120:123]
    ds_read_b64_tr_b16 v[226:227], v236 offset:57344
    v_fma_f32 v244, v240, v244, -1.0
    v_mfma_f32_16x16x32_bf16 a[116:119], v[212:215], v[196:199], a[116:119]
    v_exp_f32 v242, v242
    v_mfma_f32_16x16x32_bf16 a[112:115], v[212:215], v[192:195], a[112:115]
    s_waitcnt lgkmcnt(4)
    v_rcp_f32 v247, v247
    v_cvt_pk_bf16_f32 v156, v168, v169
    v_mfma_f32_16x16x32_bf16 a[128:131], v[216:219], v[192:195], a[128:131]
    ds_read_b64_tr_b16 v[228:229], v238 offset:51200
    v_fmac_f32 v170, v170, v246
    v_mfma_f32_16x16x32_bf16 a[132:135], v[216:219], v[196:199], a[132:135]
    ds_read_b64_tr_b16 v[230:231], v238 offset:57344
    v_fma_f32 v246, v242, -0.5, -1.0
    v_mfma_f32_16x16x32_bf16 a[136:139], v[216:219], v[200:203], a[136:139]
    v_exp_f32 v243, v243
    v_fma_f32 v245, v241, v245, -1.0
    v_mfma_f32_16x16x32_bf16 a[140:143], v[216:219], v[204:207], a[140:143]
    s_waitcnt vmcnt(31) lgkmcnt(4)
    s_barrier
    v_fmac_f32 v171, v171, v247
    v_mfma_f32_16x16x32_bf16 a[156:159], v[220:223], v[204:207], a[156:159]
    ds_read_b64_tr_b16 v[208:209], v233
    v_fma_f32 v247, v243, -0.5, -1.0
    v_mfma_f32_16x16x32_bf16 a[152:155], v[220:223], v[200:203], a[152:155]
    s_add_u32 m0, s60, 0x6000
    ds_read_b64_tr_b16 v[210:211], v233 offset:6144
    v_fma_f32 v246, v242, v246, -1.0
L_pad_f6:
    s_cbranch_execz L_padret_f
    v_mfma_f32_16x16x32_bf16 a[148:151], v[220:223], v[196:199], a[148:151]
    s_add_u32 s66, s71, 0x5a000
    buffer_load_dwordx4 v8, s[40:43], s66 offen lds
    v_mfma_f32_16x16x32_bf16 a[144:147], v[220:223], v[192:195], a[144:147]
    s_waitcnt lgkmcnt(4)
    v_rcp_f32 v244, v244
    v_mfma_f32_16x16x32_bf16 a[160:163], v[224:227], v[192:195], a[160:163]
    ds_read_b64_tr_b16 v[212:213], v235
    v_cvt_pk_bf16_f32 v157, v170, v171
    v_rcp_f32 v245, v245
    v_mfma_f32_16x16x32_bf16 a[164:167], v[224:227], v[196:199], a[164:167]
    ds_read_b64_tr_b16 v[214:215], v235 offset:6144
    v_fmac_f32 v172, v172, v244
    v_mfma_f32_16x16x32_bf16 a[168:171], v[224:227], v[200:203], a[168:171]
    s_add_u32 s66, s71, 0x5a080
    v_fma_f32 v247, v243, v247, -1.0
    v_fmac_f32 v173, v173, v245
    v_mfma_f32_16x16x32_bf16 a[172:175], v[224:227], v[204:207], a[172:175]
    s_waitcnt lgkmcnt(4)
    buffer_load_dwordx4 v9, s[40:43], s66 offen offset:1024 lds
    v_mfma_f32_16x16x32_bf16 a[188:191], v[228:231], v[204:207], a[188:191]
    ds_read_b64_tr_b16 v[216:217], v237
    v_cvt_pk_bf16_f32 v158, v172, v173
    v_mfma_f32_16x16x32_bf16 a[184:187], v[228:231], v[200:203], a[184:187]
    ds_read_b64_tr_b16 v[218:219], v237 offset:6144
    v_rcp_f32 v246, v246
    v_mfma_f32_16x16x32_bf16 a[180:183], v[228:231], v[196:199], a[180:183]
    v_rcp_f32 v247, v247
    v_mfma_f32_16x16x32_bf16 a[176:179], v[228:231], v[192:195], a[176:179]
    s_waitcnt vmcnt(29) lgkmcnt(4)
    v_fmac_f32 v174, v174, v246
    v_fmac_f32 v175, v175, v247
    v_cvt_pk_bf16_f32 v159, v174, v175
    v_mfma_f32_16x16x32_bf16 a[0:3], v[208:211], v[176:179], a[0:3]
    ds_read_b64_tr_b16 v[220:221], v239
    v_mfma_f32_16x16x32_bf16 a[4:7], v[208:211], v[180:183], a[4:7]
    s_add_u32 s66, s71, 0x5a100
    ds_read_b64_tr_b16 v[222:223], v239 offset:6144
    v_mfma_f32_16x16x32_bf16 a[8:11], v[208:211], v[184:187], a[8:11]
    s_add_u32 s65, s68, 0x5000
    buffer_load_dwordx4 v10, s[40:43], s66 offen offset:2048 lds
    v_mfma_f32_16x16x32_bf16 a[12:15], v[208:211], v[188:191], a[12:15]
    s_waitcnt lgkmcnt(4)
    buffer_store_dwordx4 v[144:147], v1, s[48:51], s65 offen sc1
    v_mfma_f32_16x16x32_bf16 a[28:31], v[212:215], v[188:191], a[28:31]
    ds_read_b64_tr_b16 v[224:225], v233 offset:1024
    v_mfma_f32_16x16x32_bf16 a[24:27], v[212:215], v[184:187], a[24:27]
    ds_read_b64_tr_b16 v[226:227], v233 offset:7168
    v_mfma_f32_16x16x32_bf16 a[20:23], v[212:215], v[180:183], a[20:23]
    v_mfma_f32_16x16x32_bf16 a[16:19], v[212:215], v[176:179], a[16:19]
    s_waitcnt lgkmcnt(4)
    v_mfma_f32_16x16x32_bf16 a[32:35], v[216:219], v[176:179], a[32:35]
    ds_read_b64_tr_b16 v[228:229], v235 offset:1024
    v_mfma_f32_16x16x32_bf16 a[36:39], v[216:219], v[180:183], a[36:39]
    s_add_u32 m0, s60, 0x6c00
    ds_read_b64_tr_b16 v[230:231], v235 offset:7168
    v_mfma_f32_16x16x32_bf16 a[40:43], v[216:219], v[184:187], a[40:43]
    s_add_u32 s66, s71, 0x5c400
    buffer_load_dwordx4 v8, s[40:43], s66 offen lds
    v_mfma_f32_16x16x32_bf16 a[44:47], v[216:219], v[188:191], a[44:47]
    s_waitcnt lgkmcnt(4)
    buffer_store_dwordx4 v[148:151], v1, s[48:51], s65 offen offset:1024 sc1
    v_mfma_f32_16x16x32_bf16 a[60:63], v[220:223], v[188:191], a[60:63]
    ds_read_b64_tr_b16 v[208:209], v237 offset:1024
    v_mfma_f32_16x16x32_bf16 a[56:59], v[220:223], v[184:187], a[56:59]
    ds_read_b64_tr_b16 v[210:211], v237 offset:7168
    v_mfma_f32_16x16x32_bf16 a[52:55], v[220:223], v[180:183], a[52:55]
    buffer_load_dword v13, v12, s[48:51], 0 offen offset:256 sc1
    v_mfma_f32_16x16x32_bf16 a[48:51], v[220:223], v[176:179], a[48:51]
    s_waitcnt lgkmcnt(4)
    v_mfma_f32_16x16x32_bf16 a[64:67], v[224:227], v[176:179], a[64:67]
    ds_read_b64_tr_b16 v[212:213], v239 offset:1024
    v_mfma_f32_16x16x32_bf16 a[68:71], v[224:227], v[180:183], a[68:71]
    ds_read_b64_tr_b16 v[214:215], v239 offset:7168
    v_mfma_f32_16x16x32_bf16 a[72:75], v[224:227], v[184:187], a[72:75]
    s_add_u32 s66, s71, 0x5c480
    buffer_load_dwordx4 v9, s[40:43], s66 offen offset:1024 lds
    v_mfma_f32_16x16x32_bf16 a[76:79], v[224:227], v[188:191], a[76:79]
    s_waitcnt lgkmcnt(4)
    buffer_store_dwordx4 v[152:155], v1, s[48:51], s65 offen offset:2048 sc1
    v_mfma_f32_16x16x32_bf16 a[92:95], v[228:231], v[188:191], a[92:95]
    ds_read_b64_tr_b16 v[216:217], v233 offset:2048
    v_mfma_f32_16x16x32_bf16 a[88:91], v[228:231], v[184:187], a[88:91]
    ds_read_b64_tr_b16 v[218:219], v233 offset:8192
    v_mfma_f32_16x16x32_bf16 a[84:87], v[228:231], v[180:183], a[84:87]
    v_mfma_f32_16x16x32_bf16 a[80:83], v[228:231], v[176:179], a[80:83]
    s_waitcnt lgkmcnt(4)
    v_mfma_f32_16x16x32_bf16 a[96:99], v[208:211], v[176:179], a[96:99]
    ds_read_b64_tr_b16 v[220:221], v235 offset:2048
    v_mfma_f32_16x16x32_bf16 a[100:103], v[208:211], v[180:183], a[100:103]
    ds_read_b64_tr_b16 v[222:223], v235 offset:8192
    v_mfma_f32_16x16x32_bf16 a[104:107], v[208:211], v[184:187], a[104:107]
    s_add_u32 s66, s71, 0x5c500
    buffer_load_dwordx4 v10, s[40:43], s66 offen offset:2048 lds
    v_mfma_f32_16x16x32_bf16 a[108:111], v[208:211], v[188:191], a[108:111]
    s_waitcnt lgkmcnt(4)
    buffer_store_dwordx4 v[156:159], v1, s[48:51], s65 offen offset:3072 sc1
    v_mfma_f32_16x16x32_bf16 a[124:127], v[212:215], v[188:191], a[124:127]
    ds_read_b64_tr_b16 v[224:225], v237 offset:2048
    v_mfma_f32_16x16x32_bf16 a[120:123], v[212:215], v[184:187], a[120:123]
    ds_read_b64_tr_b16 v[226:227], v237 offset:8192
    v_mfma_f32_16x16x32_bf16 a[116:119], v[212:215], v[180:183], a[116:119]
    v_mfma_f32_16x16x32_bf16 a[112:115], v[212:215], v[176:179], a[112:115]
    s_waitcnt lgkmcnt(4)
    v_mfma_f32_16x16x32_bf16 a[128:131], v[216:219], v[176:179], a[128:131]
    ds_read_b64_tr_b16 v[228:229], v239 offset:2048
    v_mfma_f32_16x16x32_bf16 a[132:135], v[216:219], v[180:183], a[132:135]
    ds_read_b64_tr_b16 v[230:231], v239 offset:8192
    v_mfma_f32_16x16x32_bf16 a[136:139], v[216:219], v[184:187], a[136:139]
    v_mfma_f32_16x16x32_bf16 a[140:143], v[216:219], v[188:191], a[140:143]
    s_waitcnt vmcnt(32) lgkmcnt(4)
    s_barrier
    v_mfma_f32_16x16x32_bf16 a[156:159], v[220:223], v[188:191], a[156:159]
    ds_read_b64_tr_b16 v[208:209], v233 offset:24576
    v_mfma_f32_16x16x32_bf16 a[152:155], v[220:223], v[184:187], a[152:155]
    s_add_u32 m0, s60, 0xc000
    ds_read_b64_tr_b16 v[210:211], v233 offset:30720
    v_mfma_f32_16x16x32_bf16 a[148:151], v[220:223], v[180:183], a[148:151]
    s_add_u32 s66, s72, 0x48000
    buffer_load_dwordx4 v8, s[40:43], s66 offen lds
    v_mfma_f32_16x16x32_bf16 a[144:147], v[220:223], v[176:179], a[144:147]
    s_waitcnt lgkmcnt(4)
    v_mfma_f32_16x16x32_bf16 a[160:163], v[224:227], v[176:179], a[160:163]
    ds_read_b64_tr_b16 v[212:213], v235 offset:24576
    v_mfma_f32_16x16x32_bf16 a[164:167], v[224:227], v[180:183], a[164:167]
    ds_read_b64_tr_b16 v[214:215], v235 offset:30720
    v_mfma_f32_16x16x32_bf16 a[168:171], v[224:227], v[184:187], a[168:171]
    s_add_u32 s66, s72, 0x48080
    v_mfma_f32_16x16x32_bf16 a[172:175], v[224:227], v[188:191], a[172:175]
    s_waitcnt lgkmcnt(4)
    buffer_load_dwordx4 v9, s[40:43], s66 offen offset:1024 lds
    v_mfma_f32_16x16x32_bf16 a[188:191], v[228:231], v[188:191], a[188:191]
    ds_read_b64_tr_b16 v[216:217], v237 offset:24576
    v_mfma_f32_16x16x32_bf16 a[184:187], v[228:231], v[184:187], a[184:187]
    ds_read_b64_tr_b16 v[218:219], v237 offset:30720
    v_mfma_f32_16x16x32_bf16 a[180:183], v[228:231], v[180:183], a[180:183]
    v_mfma_f32_16x16x32_bf16 a[176:179], v[228:231], v[176:179], a[176:179]
    s_waitcnt vmcnt(30) lgkmcnt(4)
    v_mfma_f32_16x16x32_bf16 a[0:3], v[208:211], v[16:19], a[0:3]
    ds_read_b64_tr_b16 v[220:221], v239 offset:24576
    v_mfma_f32_16x16x32_bf16 a[4:7], v[208:211], v[20:23], a[4:7]
    ds_read_b64_tr_b16 v[222:223], v239 offset:30720
    v_mfma_f32_16x16x32_bf16 a[8:11], v[208:211], v[24:27], a[8:11]
    s_add_u32 s66, s72, 0x48100
    v_mfma_f32_16x16x32_bf16 a[12:15], v[208:211], v[28:31], a[12:15]
    s_waitcnt lgkmcnt(4)
    buffer_load_dwordx4 v10, s[40:43], s66 offen offset:2048 lds
    v_mfma_f32_16x16x32_bf16 a[28:31], v[212:215], v[28:31], a[28:31]
    ds_read_b64_tr_b16 v[224:225], v233 offset:25600
    v_mfma_f32_16x16x32_bf16 a[24:27], v[212:215], v[24:27], a[24:27]
    ds_read_b64_tr_b16 v[226:227], v233 offset:31744
    v_mfma_f32_16x16x32_bf16 a[20:23], v[212:215], v[20:23], a[20:23]
    v_mfma_f32_16x16x32_bf16 a[16:19], v[212:215], v[16:19], a[16:19]
    s_waitcnt lgkmcnt(4)
    v_mfma_f32_16x16x32_bf16 a[32:35], v[216:219], v[16:19], a[32:35]
    ds_read_b64_tr_b16 v[228:229], v235 offset:25600
    v_mfma_f32_16x16x32_bf16 a[36:39], v[216:219], v[20:23], a[36:39]
    s_add_u32 m0, s60, 0xcc00
    ds_read_b64_tr_b16 v[230:231], v235 offset:31744
    v_mfma_f32_16x16x32_bf16 a[40:43], v[216:219], v[24:27], a[40:43]
    s_add_u32 s66, s72, 0x4a400
    v_mfma_f32_16x16x32_bf16 a[44:47], v[216:219], v[28:31], a[44:47]
    s_waitcnt lgkmcnt(4)
    buffer_load_dwordx4 v8, s[40:43], s66 offen lds
    v_mfma_f32_16x16x32_bf16 a[60:63], v[220:223], v[28:31], a[60:63]
    ds_read_b64_tr_b16 v[208:209], v237 offset:25600
    v_mfma_f32_16x16x32_bf16 a[56:59], v[220:223], v[24:27], a[56:59]
    ds_read_b64_tr_b16 v[210:211], v237 offset:31744
    v_mfma_f32_16x16x32_bf16 a[52:55], v[220:223], v[20:23], a[52:55]
    v_mfma_f32_16x16x32_bf16 a[48:51], v[220:223], v[16:19], a[48:51]
    s_waitcnt lgkmcnt(4)
    v_mfma_f32_16x16x32_bf16 a[64:67], v[224:227], v[16:19], a[64:67]
    ds_read_b64_tr_b16 v[212:213], v239 offset:25600
    v_mfma_f32_16x16x32_bf16 a[68:71], v[224:227], v[20:23], a[68:71]
    ds_read_b64_tr_b16 v[214:215], v239 offset:31744
    v_mfma_f32_16x16x32_bf16 a[72:75], v[224:227], v[24:27], a[72:75]
    s_add_u32 s66, s72, 0x4a480
    v_mfma_f32_16x16x32_bf16 a[76:79], v[224:227], v[28:31], a[76:79]
    s_waitcnt lgkmcnt(4)
    buffer_load_dwordx4 v9, s[40:43], s66 offen offset:1024 lds
    v_mfma_f32_16x16x32_bf16 a[92:95], v[228:231], v[28:31], a[92:95]
    ds_read_b64_tr_b16 v[216:217], v233 offset:26624
    v_mfma_f32_16x16x32_bf16 a[88:91], v[228:231], v[24:27], a[88:91]
    ds_read_b64_tr_b16 v[218:219], v233 offset:32768
    v_mfma_f32_16x16x32_bf16 a[84:87], v[228:231], v[20:23], a[84:87]
    v_mfma_f32_16x16x32_bf16 a[80:83], v[228:231], v[16:19], a[80:83]
    s_waitcnt lgkmcnt(4)
    v_mfma_f32_16x16x32_bf16 a[96:99], v[208:211], v[16:19], a[96:99]
    ds_read_b64_tr_b16 v[220:221], v235 offset:26624
    v_mfma_f32_16x16x32_bf16 a[100:103], v[208:211], v[20:23], a[100:103]
    ds_read_b64_tr_b16 v[222:223], v235 offset:32768
    v_mfma_f32_16x16x32_bf16 a[104:107], v[208:211], v[24:27], a[104:107]
    s_add_u32 s66, s72, 0x4a500
    v_mfma_f32_16x16x32_bf16 a[108:111], v[208:211], v[28:31], a[108:111]
    s_waitcnt lgkmcnt(4)
    buffer_load_dwordx4 v10, s[40:43], s66 offen offset:2048 lds
    v_mfma_f32_16x16x32_bf16 a[124:127], v[212:215], v[28:31], a[124:127]
    ds_read_b64_tr_b16 v[224:225], v237 offset:26624
    v_mfma_f32_16x16x32_bf16 a[120:123], v[212:215], v[24:27], a[120:123]
    ds_read_b64_tr_b16 v[226:227], v237 offset:32768
    v_mfma_f32_16x16x32_bf16 a[116:119], v[212:215], v[20:23], a[116:119]
    v_mfma_f32_16x16x32_bf16 a[112:115], v[212:215], v[16:19], a[112:115]
    s_waitcnt lgkmcnt(4)
    v_mfma_f32_16x16x32_bf16 a[128:131], v[216:219], v[16:19], a[128:131]
    ds_read_b64_tr_b16 v[228:229], v239 offset:26624
    v_mfma_f32_16x16x32_bf16 a[132:135], v[216:219], v[20:23], a[132:135]
    ds_read_b64_tr_b16 v[230:231], v239 offset:32768
    v_mfma_f32_16x16x32_bf16 a[136:139], v[216:219], v[24:27], a[136:139]
    v_mfma_f32_16x16x32_bf16 a[140:143], v[216:219], v[28:31], a[140:143]
    s_waitcnt vmcnt(6) lgkmcnt(4)
    s_barrier
    buffer_store_dword v14, v15, s[48:51], 0 offen offset:384 sc1
    v_cmp_ne_u32 vcc, v13, v250
    s_cbranch_vccz L_ok3
    s_mov_b32 s75, 131072
L_sp3:
    s_sleep 2
    buffer_load_dword v13, v12, s[48:51], 0 offen offset:256 sc1
    s_waitcnt vmcnt(0)
    v_cmp_ne_u32 vcc, v13, v250
    s_cbranch_vccz L_ok3
    s_sub_u32 s75, s75, 1
    s_cmp_lg_u32 s75, 0
    s_cbranch_scc1 L_sp3
L_ok3:
    v_mfma_f32_16x16x32_bf16 a[156:159], v[220:223], v[28:31], a[156:159]
    ds_read_b64_tr_b16 v[208:209], v233 offset:49152
    v_xor_b32 v242, s86, v0
    v_mfma_f32_16x16x32_bf16 a[152:155], v[220:223], v[24:27], a[152:155]
    ds_read_b64_tr_b16 v[210:211], v233 offset:55296
    v_lshlrev_b32 v242, 7, v242
    v_mfma_f32_16x16x32_bf16 a[148:151], v[220:223], v[20:23], a[148:151]
    s_add_u32 s76, s69, 0x4000
    buffer_load_dwordx4 v[192:195], v1, s[48:51], s76 offen sc1
    v_mfma_f32_16x16x32_bf16 a[144:147], v[220:223], v[16:19], a[144:147]
    s_waitcnt lgkmcnt(4)
    buffer_load_dwordx4 v[196:199], v1, s[48:51], s76 offen offset:1024 sc1
    v_mfma_f32_16x16x32_bf16 a[160:163], v[224:227], v[16:19], a[160:163]
    ds_read_b64_tr_b16 v[212:213], v235 offset:49152
    v_add_u32 v70, 0x3014000, v242
    v_mfma_f32_16x16x32_bf16 a[164:167], v[224:227], v[20:23], a[164:167]
    ds_read_b64_tr_b16 v[214:215], v235 offset:55296
    v_cmp_gt_u32 vcc, 1, v0
    v_mfma_f32_16x16x32_bf16 a[168:171], v[224:227], v[24:27], a[168:171]
    buffer_load_dwordx4 v[200:203], v1, s[48:51], s76 offen offset:2048 sc1
    v_mfma_f32_16x16x32_bf16 a[172:175], v[224:227], v[28:31], a[172:175]
    s_waitcnt lgkmcnt(4)
    buffer_load_dwordx4 v[204:207], v1, s[48:51], s76 offen offset:3072 sc1
    v_mfma_f32_16x16x32_bf16 a[188:191], v[228:231], v[28:31], a[188:191]
    ds_read_b64_tr_b16 v[216:217], v237 offset:49152
    v_mfma_f32_16x16x32_bf16 a[184:187], v[228:231], v[24:27], a[184:187]
    s_add_u32 m0, s60, 0x12000
    ds_read_b64_tr_b16 v[218:219], v237 offset:55296
    v_mov_b32 v71, 0x10000000
    v_mfma_f32_16x16x32_bf16 a[180:183], v[228:231], v[20:23], a[180:183]
    s_add_u32 s66, s73, 0x48000
    buffer_load_dwordx4 v8, s[40:43], s66 offen lds
    v_mfma_f32_16x16x32_bf16 a[176:179], v[228:231], v[16:19], a[176:179]
    s_waitcnt lgkmcnt(4)
    v_cndmask_b32 v70, v71, v70, vcc
    v_mfma_f32_16x16x32_bf16 a[0:3], v[208:211], v[32:35], a[0:3]
    ds_read_b64_tr_b16 v[220:221], v239 offset:49152
    v_mfma_f32_16x16x32_bf16 a[4:7], v[208:211], v[36:39], a[4:7]
    ds_read_b64_tr_b16 v[222:223], v239 offset:55296
    v_mfma_f32_16x16x32_bf16 a[8:11], v[208:211], v[40:43], a[8:11]
    s_add_u32 s66, s72, 0x5a000
    v_mov_b32 v71, s61
    v_mfma_f32_16x16x32_bf16 a[12:15], v[208:211], v[44:47], a[12:15]
    s_waitcnt lgkmcnt(4)
    buffer_load_dwordx4 v9, s[40:43], s66 offen offset:1024 lds
    v_mfma_f32_16x16x32_bf16 a[28:31], v[212:215], v[44:47], a[28:31]
    ds_read_b64_tr_b16 v[224:225], v233 offset:50176
    v_mfma_f32_16x16x32_bf16 a[24:27], v[212:215], v[40:43], a[24:27]
    ds_read_b64_tr_b16 v[226:227], v233 offset:56320
    v_cndmask_b32 v71, 0, v71, vcc
    v_mfma_f32_16x16x32_bf16 a[20:23], v[212:215], v[36:39], a[20:23]
    v_and_b32 v240, 15, v0
    v_mfma_f32_16x16x32_bf16 a[16:19], v[212:215], v[32:35], a[16:19]
    s_waitcnt lgkmcnt(4)
    v_mfma_f32_16x16x32_bf16 a[32:35], v[216:219], v[32:35], a[32:35]
    ds_read_b64_tr_b16 v[228:229], v235 offset:50176
    v_lshlrev_b32 v79, 2, v240
    v_mfma_f32_16x16x32_bf16 a[36:39], v[216:219], v[36:39], a[36:39]
    ds_read_b64_tr_b16 v[230:231], v235 offset:56320
    v_mfma_f32_16x16x32_bf16 a[40:43], v[216:219], v[40:43], a[40:43]
    s_add_u32 s66, s73, 0x5a000
    buffer_load_dwordx4 v10, s[40:43], s66 offen offset:2048 lds
    v_mfma_f32_16x16x32_bf16 a[44:47], v[216:219], v[44:47], a[44:47]
    s_waitcnt lgkmcnt(4)
    s_add_u32 s62, s60, 0xc000
    v_mfma_f32_16x16x32_bf16 a[60:63], v[220:223], v[44:47], a[60:63]
    ds_read_b64_tr_b16 v[208:209], v237 offset:50176
    v_mfma_f32_16x16x32_bf16 a[56:59], v[220:223], v[40:43], a[56:59]
    s_add_u32 m0, s60, 0x12c00
    ds_read_b64_tr_b16 v[210:211], v237 offset:56320
    v_add_u32 v74, s62, v1
    v_mfma_f32_16x16x32_bf16 a[52:55], v[220:223], v[36:39], a[52:55]
    s_add_u32 s66, s73, 0x4a400
    v_mfma_f32_16x16x32_bf16 a[48:51], v[220:223], v[32:35], a[48:51]
    s_waitcnt lgkmcnt(4)
    buffer_load_dwordx4 v8, s[40:43], s66 offen lds
    v_mfma_f32_16x16x32_bf16 a[64:67], v[224:227], v[32:35], a[64:67]
    ds_read_b64_tr_b16 v[212:213], v239 offset:50176
    s_xor_b32 s62, s59, 1
    v_mfma_f32_16x16x32_bf16 a[68:71], v[224:227], v[36:39], a[68:71]
    ds_read_b64_tr_b16 v[214:215], v239 offset:56320
    v_mfma_f32_16x16x32_bf16 a[72:75], v[224:227], v[40:43], a[72:75]
    s_mul_i32 s62, s62, 0x1800
    v_mfma_f32_16x16x32_bf16 a[76:79], v[224:227], v[44:47], a[76:79]
    s_waitcnt lgkmcnt(4)
    s_add_u32 s62, s62, 0xc000
    v_mfma_f32_16x16x32_bf16 a[92:95], v[228:231], v[44:47], a[92:95]
    ds_read_b64_tr_b16 v[216:217], v233 offset:51200
    v_mfma_f32_16x16x32_bf16 a[88:91], v[228:231], v[40:43], a[88:91]
    ds_read_b64_tr_b16 v[218:219], v233 offset:57344
    v_mfma_f32_16x16x32_bf16 a[84:87], v[228:231], v[36:39], a[84:87]
    s_add_u32 s66, s72, 0x5c400
    buffer_load_dwordx4 v9, s[40:43], s66 offen offset:1024 lds
    v_mfma_f32_16x16x32_bf16 a[80:83], v[228:231], v[32:35], a[80:83]
    s_waitcnt lgkmcnt(4)
    v_add_u32 v75, s62, v1
    v_mfma_f32_16x16x32_bf16 a[96:99], v[208:211], v[32:35], a[96:99]
    ds_read_b64_tr_b16 v[220:221], v235 offset:51200
    v_mfma_f32_16x16x32_bf16 a[100:103], v[208:211], v[36:39], a[100:103]
    ds_read_b64_tr_b16 v[222:223], v235 offset:57344
    v_lshrrev_b32 v241, 4, v0
    v_mfma_f32_16x16x32_bf16 a[104:107], v[208:211], v[40:43], a[104:107]
    s_add_u32 s66, s73, 0x5c400
    v_lshlrev_b32 v242, 2, v241
    v_mfma_f32_16x16x32_bf16 a[108:111], v[208:211], v[44:47], a[108:111]
    s_waitcnt lgkmcnt(4)
    buffer_load_dwordx4 v10, s[40:43], s66 offen offset:2048 lds
    v_mfma_f32_16x16x32_bf16 a[124:127], v[212:215], v[44:47], a[124:127]
    ds_read_b64_tr_b16 v[224:225], v237 offset:51200
    v_mfma_f32_16x16x32_bf16 a[120:123], v[212:215], v[40:43], a[120:123]
    ds_read_b64_tr_b16 v[226:227], v237 offset:57344
    v_mfma_f32_16x16x32_bf16 a[116:119], v[212:215], v[36:39], a[116:119]
    v_sub_u32 v242, v240, v242
    v_mfma_f32_16x16x32_bf16 a[112:115], v[212:215], v[32:35], a[112:115]
    s_waitcnt lgkmcnt(4)
    v_and_b32 v243, 1, v242
    v_mfma_f32_16x16x32_bf16 a[128:131], v[216:219], v[32:35], a[128:131]
    ds_read_b64_tr_b16 v[228:229], v239 offset:51200
    v_mfma_f32_16x16x32_bf16 a[132:135], v[216:219], v[36:39], a[132:135]
    ds_read_b64_tr_b16 v[230:231], v239 offset:57344
    v_lshlrev_b32 v243, 4, v243
    v_mfma_f32_16x16x32_bf16 a[136:139], v[216:219], v[40:43], a[136:139]
    v_mfma_f32_16x16x32_bf16 a[140:143], v[216:219], v[44:47], a[140:143]
    s_waitcnt lgkmcnt(4)
    s_barrier
    v_mov_b32 v241, 0x3f80
    v_mfma_f32_16x16x32_bf16 a[156:159], v[220:223], v[44:47], a[156:159]
    ds_read_b64_tr_b16 v[208:209], v232
    v_mfma_f32_16x16x32_bf16 a[152:155], v[220:223], v[40:43], a[152:155]
    ds_read_b64_tr_b16 v[210:211], v232 offset:6144
    v_mfma_f32_16x16x32_bf16 a[148:151], v[220:223], v[36:39], a[148:151]
    s_add_u32 s76, s70, 0x4000
    buffer_load_dwordx4 v[80:83], v1, s[48:51], s76 offen sc1
    v_mfma_f32_16x16x32_bf16 a[144:147], v[220:223], v[32:35], a[144:147]
    s_waitcnt lgkmcnt(4)
    buffer_load_dwordx4 v[84:87], v1, s[48:51], s76 offen offset:1024 sc1
    v_mfma_f32_16x16x32_bf16 a[160:163], v[224:227], v[32:35], a[160:163]
    ds_read_b64_tr_b16 v[212:213], v234
    v_lshlrev_b32 v243, v243, v241
    v_mfma_f32_16x16x32_bf16 a[164:167], v[224:227], v[36:39], a[164:167]
    ds_read_b64_tr_b16 v[214:215], v234 offset:6144
    v_mfma_f32_16x16x32_bf16 a[168:171], v[224:227], v[40:43], a[168:171]
    buffer_load_dwordx4 v[88:91], v1, s[48:51], s76 offen offset:2048 sc1
    v_mfma_f32_16x16x32_bf16 a[172:175], v[224:227], v[44:47], a[172:175]
    s_waitcnt lgkmcnt(4)
    buffer_load_dwordx4 v[92:95], v1, s[48:51], s76 offen offset:3072 sc1
    v_mfma_f32_16x16x32_bf16 a[188:191], v[228:231], v[44:47], a[188:191]
    ds_read_b64_tr_b16 v[216:217], v236
    v_lshrrev_b32 v242, 1, v242
    v_mfma_f32_16x16x32_bf16 a[184:187], v[228:231], v[40:43], a[184:187]
    s_add_u32 m0, s60, 0x18000
    ds_read_b64_tr_b16 v[218:219], v236 offset:6144
    v_mfma_f32_16x16x32_bf16 a[180:183], v[228:231], v[36:39], a[180:183]
    s_add_u32 s66, s73, 0x48080
    buffer_load_dwordx4 v8, s[40:43], s66 offen lds
    v_mfma_f32_16x16x32_bf16 a[176:179], v[228:231], v[32:35], a[176:179]
    s_waitcnt lgkmcnt(4)
    v_cmp_eq_u32 vcc, 0, v242
    v_mfma_f32_16x16x32_bf16 a[0:3], v[208:211], v[48:51], a[0:3]
    ds_read_b64_tr_b16 v[220:221], v238
    v_mfma_f32_16x16x32_bf16 a[4:7], v[208:211], v[52:55], a[4:7]
    ds_read_b64_tr_b16 v[222:223], v238 offset:6144
    v_mfma_f32_16x16x32_bf16 a[8:11], v[208:211], v[56:59], a[8:11]
    s_add_u32 s66, s72, 0x5a080
    v_mov_b32 v64, 0
    v_mfma_f32_16x16x32_bf16 a[12:15], v[208:211], v[60:63], a[12:15]
    s_waitcnt lgkmcnt(4)
    buffer_load_dwordx4 v9, s[40:43], s66 offen offset:1024 lds
    v_mfma_f32_16x16x32_bf16 a[28:31], v[212:215], v[60:63], a[28:31]
    ds_read_b64_tr_b16 v[224:225], v232 offset:1024
    v_mov_b32 v65, 0
    v_mfma_f32_16x16x32_bf16 a[24:27], v[212:215], v[56:59], a[24:27]
    ds_read_b64_tr_b16 v[226:227], v232 offset:7168
    v_mfma_f32_16x16x32_bf16 a[20:23], v[212:215], v[52:55], a[20:23]
    v_cndmask_b32 v66, 0, v243, vcc
    v_mfma_f32_16x16x32_bf16 a[16:19], v[212:215], v[48:51], a[16:19]
    s_waitcnt lgkmcnt(4)
    v_mfma_f32_16x16x32_bf16 a[32:35], v[216:219], v[48:51], a[32:35]
    ds_read_b64_tr_b16 v[228:229], v234 offset:1024
    v_cmp_eq_u32 vcc, 1, v242
    v_mfma_f32_16x16x32_bf16 a[36:39], v[216:219], v[52:55], a[36:39]
    ds_read_b64_tr_b16 v[230:231], v234 offset:7168
    v_mfma_f32_16x16x32_bf16 a[40:43], v[216:219], v[56:59], a[40:43]
    s_add_u32 s66, s73, 0x5a080
    buffer_load_dwordx4 v10, s[40:43], s66 offen offset:2048 lds
    v_mfma_f32_16x16x32_bf16 a[44:47], v[216:219], v[60:63], a[44:47]
    s_waitcnt lgkmcnt(4)
    buffer_load_dword v13, v12, s[48:51], 0 offen offset:384 sc1
    v_mfma_f32_16x16x32_bf16 a[60:63], v[220:223], v[60:63], a[60:63]
    ds_read_b64_tr_b16 v[208:209], v236 offset:1024
    v_mov_b32 v68, 0
    v_mfma_f32_16x16x32_bf16 a[56:59], v[220:223], v[56:59], a[56:59]
    s_add_u32 m0, s60, 0x18c00
    ds_read_b64_tr_b16 v[210:211], v236 offset:7168
    v_mfma_f32_16x16x32_bf16 a[52:55], v[220:223], v[52:55], a[52:55]
    s_add_u32 s66, s73, 0x4a480
    v_mov_b32 v69, 0
    v_mfma_f32_16x16x32_bf16 a[48:51], v[220:223], v[48:51], a[48:51]
    s_waitcnt lgkmcnt(4)
    buffer_load_dwordx4 v8, s[40:43], s66 offen lds
    v_mfma_f32_16x16x32_bf16 a[64:67], v[224:227], v[48:51], a[64:67]
    ds_read_b64_tr_b16 v[212:213], v238 offset:1024
    v_mfma_f32_16x16x32_bf16 a[68:71], v[224:227], v[52:55], a[68:71]
    ds_read_b64_tr_b16 v[214:215], v238 offset:7168
    v_cndmask_b32 v67, 0, v243, vcc
    v_mfma_f32_16x16x32_bf16 a[72:75], v[224:227], v[56:59], a[72:75]
    v_mfma_f32_16x16x32_bf16 a[76:79], v[224:227], v[60:63], a[76:79]
    s_waitcnt lgkmcnt(4)
    s_lshl_b32 s62, s56, 7
    v_mfma_f32_16x16x32_bf16 a[92:95], v[228:231], v[60:63], a[92:95]
    ds_read_b64_tr_b16 v[216:217], v232 offset:2048
    v_mfma_f32_16x16x32_bf16 a[88:91], v[228:231], v[56:59], a[88:91]
    ds_read_b64_tr_b16 v[218:219], v232 offset:8192
    s_lshl_b32 s63, s59, 5
    v_mfma_f32_16x16x32_bf16 a[84:87], v[228:231], v[52:55], a[84:87]
    s_add_u32 s66, s72, 0x5c480
    buffer_load_dwordx4 v9, s[40:43], s66 offen offset:1024 lds
    v_mfma_f32_16x16x32_bf16 a[80:83], v[228:231], v[48:51], a[80:83]
    s_waitcnt lgkmcnt(4)
    s_add_u32 s62, s62, s63
    v_mfma_f32_16x16x32_bf16 a[96:99], v[208:211], v[48:51], a[96:99]
    ds_read_b64_tr_b16 v[220:221], v234 offset:2048
    v_mfma_f32_16x16x32_bf16 a[100:103], v[208:211], v[52:55], a[100:103]
    ds_read_b64_tr_b16 v[222:223], v234 offset:8192
    v_mfma_f32_16x16x32_bf16 a[104:107], v[208:211], v[56:59], a[104:107]
    s_add_u32 s66, s73, 0x5c480
    v_and_b32 v242, 31, v0
    v_mfma_f32_16x16x32_bf16 a[108:111], v[208:211], v[60:63], a[108:111]
    s_waitcnt lgkmcnt(4)
    buffer_load_dwordx4 v10, s[40:43], s66 offen offset:2048 lds
    v_mfma_f32_16x16x32_bf16 a[124:127], v[212:215], v[60:63], a[124:127]
    ds_read_b64_tr_b16 v[224:225], v236 offset:2048
    v_mfma_f32_16x16x32_bf16 a[120:123], v[212:215], v[56:59], a[120:123]
    ds_read_b64_tr_b16 v[226:227], v236 offset:8192
    v_add_u32 v242, s62, v242
    v_mfma_f32_16x16x32_bf16 a[116:119], v[212:215], v[52:55], a[116:119]
    v_mul_u32_u24 v242, 0x480, v242
    v_mfma_f32_16x16x32_bf16 a[112:115], v[212:215], v[48:51], a[112:115]
    s_waitcnt lgkmcnt(4)
    v_mfma_f32_16x16x32_bf16 a[128:131], v[216:219], v[48:51], a[128:131]
    ds_read_b64_tr_b16 v[228:229], v238 offset:2048
    v_lshrrev_b32 v243, 5, v0
    v_mfma_f32_16x16x32_bf16 a[132:135], v[216:219], v[52:55], a[132:135]
    ds_read_b64_tr_b16 v[230:231], v238 offset:8192
    v_mfma_f32_16x16x32_bf16 a[136:139], v[216:219], v[56:59], a[136:139]
    v_lshl_add_u32 v242, v243, 4, v242
    v_mfma_f32_16x16x32_bf16 a[140:143], v[216:219], v[60:63], a[140:143]
    s_waitcnt lgkmcnt(4)
    s_barrier
    v_mfma_f32_16x16x32_bf16 a[156:159], v[220:223], v[60:63], a[156:159]
    ds_read_b64_tr_b16 v[208:209], v232 offset:24576
    s_mul_i32 s62, s58, 0x180
    v_mfma_f32_16x16x32_bf16 a[152:155], v[220:223], v[56:59], a[152:155]
    s_add_u32 m0, s60, 0x1e000
    ds_read_b64_tr_b16 v[210:211], v232 offset:30720
    v_mfma_f32_16x16x32_bf16 a[148:151], v[220:223], v[52:55], a[148:151]
    s_add_u32 s66, s73, 0x48100
    buffer_load_dwordx4 v8, s[40:43], s66 offen lds
    v_mfma_f32_16x16x32_bf16 a[144:147], v[220:223], v[48:51], a[144:147]
    s_waitcnt lgkmcnt(4)
    s_add_u32 s66, s72, 0x5a100
    buffer_load_dwordx4 v9, s[40:43], s66 offen offset:1024 lds
    v_mfma_f32_16x16x32_bf16 a[160:163], v[224:227], v[48:51], a[160:163]
    ds_read_b64_tr_b16 v[212:213], v234 offset:24576
    v_mfma_f32_16x16x32_bf16 a[164:167], v[224:227], v[52:55], a[164:167]
    ds_read_b64_tr_b16 v[214:215], v234 offset:30720
    s_lshl_b32 s63, s57, 5
    v_mfma_f32_16x16x32_bf16 a[168:171], v[224:227], v[56:59], a[168:171]
    s_add_u32 s66, s73, 0x5a100
    v_mfma_f32_16x16x32_bf16 a[172:175], v[224:227], v[60:63], a[172:175]
    s_waitcnt lgkmcnt(4)
    buffer_load_dwordx4 v10, s[40:43], s66 offen offset:2048 lds
    v_mfma_f32_16x16x32_bf16 a[188:191], v[228:231], v[60:63], a[188:191]
    ds_read_b64_tr_b16 v[216:217], v236 offset:24576
    s_add_u32 s62, s62, s63
    v_mfma_f32_16x16x32_bf16 a[184:187], v[228:231], v[56:59], a[184:187]
    s_add_u32 m0, s60, 0x1ec00
    ds_read_b64_tr_b16 v[218:219], v236 offset:30720
    v_mfma_f32_16x16x32_bf16 a[180:183], v[228:231], v[52:55], a[180:183]
    s_add_u32 s66, s73, 0x4a500
    v_add_u32 v76, s62, v242
    v_mfma_f32_16x16x32_bf16 a[176:179], v[228:231], v[48:51], a[176:179]
    s_waitcnt lgkmcnt(4)
    buffer_load_dwordx4 v8, s[40:43], s66 offen lds
    v_mfma_f32_16x16x32_bf16 a[0:3], v[208:211], v[144:147], a[0:3]
    ds_read_b64_tr_b16 v[220:221], v238 offset:24576
    v_mfma_f32_16x16x32_bf16 a[4:7], v[208:211], v[148:151], a[4:7]
    ds_read_b64_tr_b16 v[222:223], v238 offset:30720
    v_and_b32 v242, 3, v0
    v_mfma_f32_16x16x32_bf16 a[8:11], v[208:211], v[152:155], a[8:11]
    s_add_u32 s66, s72, 0x5c500
    v_mfma_f32_16x16x32_bf16 a[12:15], v[208:211], v[156:159], a[12:15]
    s_waitcnt lgkmcnt(4)
    buffer_load_dwordx4 v9, s[40:43], s66 offen offset:1024 lds
    v_mfma_f32_16x16x32_bf16 a[28:31], v[212:215], v[156:159], a[28:31]
    ds_read_b64_tr_b16 v[224:225], v232 offset:25600
    s_xor_b32 s63, s57, 3
    v_mfma_f32_16x16x32_bf16 a[24:27], v[212:215], v[152:155], a[24:27]
    ds_read_b64_tr_b16 v[226:227], v232 offset:31744
    v_mfma_f32_16x16x32_bf16 a[20:23], v[212:215], v[148:151], a[20:23]
    s_add_u32 s66, s73, 0x5c500
    v_xor_b32 v242, s63, v242
    v_mfma_f32_16x16x32_bf16 a[16:19], v[212:215], v[144:147], a[16:19]
    s_waitcnt lgkmcnt(4)
    buffer_load_dwordx4 v10, s[40:43], s66 offen offset:2048 lds
    v_mfma_f32_16x16x32_bf16 a[32:35], v[216:219], v[144:147], a[32:35]
    ds_read_b64_tr_b16 v[228:229], v234 offset:25600
    v_mfma_f32_16x16x32_bf16 a[36:39], v[216:219], v[148:151], a[36:39]
    s_add_u32 m0, s60, 0x24000
    ds_read_b64_tr_b16 v[230:231], v234 offset:31744
    v_subrev_u32 v242, s57, v242
    v_mfma_f32_16x16x32_bf16 a[40:43], v[216:219], v[152:155], a[40:43]
    s_add_u32 s66, s89, 0x24000
    v_mfma_f32_16x16x32_bf16 a[44:47], v[216:219], v[156:159], a[44:47]
    s_waitcnt lgkmcnt(4)
    buffer_load_dwordx4 v8, s[36:39], s66 offen lds
    v_mfma_f32_16x16x32_bf16 a[60:63], v[220:223], v[156:159], a[60:63]
    ds_read_b64_tr_b16 v[208:209], v236 offset:25600
    v_mul_i32_i24 v242, 0x3000, v242
    v_mfma_f32_16x16x32_bf16 a[56:59], v[220:223], v[152:155], a[56:59]
    ds_read_b64_tr_b16 v[210:211], v236 offset:31744
    v_mfma_f32_16x16x32_bf16 a[52:55], v[220:223], v[148:151], a[52:55]
    s_add_u32 s66, s89, 0x24080
    v_add_u32 v77, s92, v242
    v_mfma_f32_16x16x32_bf16 a[48:51], v[220:223], v[144:147], a[48:51]
    s_waitcnt lgkmcnt(4)
    buffer_load_dwordx4 v9, s[36:39], s66 offen offset:1024 lds
    v_mfma_f32_16x16x32_bf16 a[64:67], v[224:227], v[144:147], a[64:67]
    ds_read_b64_tr_b16 v[212:213], v238 offset:25600
    v_mfma_f32_16x16x32_bf16 a[68:71], v[224:227], v[148:151], a[68:71]
    ds_read_b64_tr_b16 v[214:215], v238 offset:31744
    v_cmp_gt_u32 vcc, 3, v0
    v_mfma_f32_16x16x32_bf16 a[72:75], v[224:227], v[152:155], a[72:75]
    s_add_u32 s66, s89, 0x24100
    v_mfma_f32_16x16x32_bf16 a[76:79], v[224:227], v[156:159], a[76:79]
    s_waitcnt lgkmcnt(4)
    buffer_load_dwordx4 v10, s[36:39], s66 offen offset:2048 lds
    v_mfma_f32_16x16x32_bf16 a[92:95], v[228:231], v[156:159], a[92:95]
    ds_read_b64_tr_b16 v[216:217], v232 offset:26624
    v_mov_b32 v78, 0x10000000
    v_mfma_f32_16x16x32_bf16 a[88:91], v[228:231], v[152:155], a[88:91]
    s_add_u32 m0, s60, 0x24c00
    ds_read_b64_tr_b16 v[218:219], v232 offset:32768
    v_mfma_f32_16x16x32_bf16 a[84:87], v[228:231], v[148:151], a[84:87]
    s_add_u32 s66, s89, 0x26400
    v_cndmask_b32 v77, v78, v77, vcc
    v_mfma_f32_16x16x32_bf16 a[80:83], v[228:231], v[144:147], a[80:83]
    s_waitcnt lgkmcnt(4)
L_pad_f7:
    s_cbranch_execz L_padret_f
    buffer_load_dwordx4 v8, s[36:39], s66 offen lds
    v_mfma_f32_16x16x32_bf16 a[96:99], v[208:211], v[144:147], a[96:99]
    ds_read_b64_tr_b16 v[220:221], v234 offset:26624
    v_mfma_f32_16x16x32_bf16 a[100:103], v[208:211], v[148:151], a[100:103]
    ds_read_b64_tr_b16 v[222:223], v234 offset:32768
    v_mov_b32 v78, s61
    v_mfma_f32_16x16x32_bf16 a[104:107], v[208:211], v[152:155], a[104:107]
    s_add_u32 s66, s89, 0x26480
    v_mfma_f32_16x16x32_bf16 a[108:111], v[208:211], v[156:159], a[108:111]
    s_waitcnt lgkmcnt(4)
    buffer_load_dwordx4 v9, s[36:39], s66 offen offset:1024 lds
    v_mfma_f32_16x16x32_bf16 a[124:127], v[212:215], v[156:159], a[124:127]
    ds_read_b64_tr_b16 v[224:225], v236 offset:26624
    v_cndmask_b32 v78, 0, v78, vcc
    v_mfma_f32_16x16x32_bf16 a[120:123], v[212:215], v[152:155], a[120:123]
    ds_read_b64_tr_b16 v[226:227], v236 offset:32768
    v_mfma_f32_16x16x32_bf16 a[116:119], v[212:215], v[148:151], a[116:119]
    s_add_u32 s66, s89, 0x26500
    v_mfma_f32_16x16x32_bf16 a[112:115], v[212:215], v[144:147], a[112:115]
    s_waitcnt lgkmcnt(4)
    buffer_load_dwordx4 v10, s[36:39], s66 offen offset:2048 lds
    v_mfma_f32_16x16x32_bf16 a[128:131], v[216:219], v[144:147], a[128:131]
    ds_read_b64_tr_b16 v[228:229], v238 offset:26624
    v_mfma_f32_16x16x32_bf16 a[132:135], v[216:219], v[148:151], a[132:135]
    ds_read_b64_tr_b16 v[230:231], v238 offset:32768
    v_mfma_f32_16x16x32_bf16 a[136:139], v[216:219], v[152:155], a[136:139]
    v_mfma_f32_16x16x32_bf16 a[140:143], v[216:219], v[156:159], a[140:143]
    s_waitcnt vmcnt(15) lgkmcnt(4)
    s_barrier
    v_cmp_ne_u32 vcc, v13, v250
    s_cbranch_vccz L_ok4
    s_mov_b32 s75, 131072
L_sp4:
    s_sleep 2
    buffer_load_dword v13, v12, s[48:51], 0 offen offset:384 sc1
    s_waitcnt vmcnt(0)
    v_cmp_ne_u32 vcc, v13, v250
    s_cbranch_vccz L_ok4
    s_sub_u32 s75, s75, 1
    s_cmp_lg_u32 s75, 0
    s_cbranch_scc1 L_sp4
L_ok4:
    v_mfma_f32_16x16x32_bf16 a[156:159], v[220:223], v[156:159], a[156:159]
    ds_read_b64_tr_b16 v[208:209], v232 offset:49152
    v_mfma_f32_16x16x32_bf16 a[152:155], v[220:223], v[152:155], a[152:155]
    ds_read_b64_tr_b16 v[210:211], v232 offset:55296
    v_mfma_f32_16x16x32_bf16 a[148:151], v[220:223], v[148:151], a[148:151]
    s_add_u32 s76, s69, 0x5000
    buffer_load_dwordx4 v[96:99], v1, s[48:51], s76 offen sc1
    v_mfma_f32_16x16x32_bf16 a[144:147], v[220:223], v[144:147], a[144:147]
    s_waitcnt lgkmcnt(4)
    buffer_load_dwordx4 v[100:103], v1, s[48:51], s76 offen offset:1024 sc1
    v_mfma_f32_16x16x32_bf16 a[160:163], v[224:227], v[144:147], a[160:163]
    ds_read_b64_tr_b16 v[212:213], v234 offset:49152
    v_mfma_f32_16x16x32_bf16 a[164:167], v[224:227], v[148:151], a[164:167]
    ds_read_b64_tr_b16 v[214:215], v234 offset:55296
    v_mfma_f32_16x16x32_bf16 a[168:171], v[224:227], v[152:155], a[168:171]
    buffer_load_dwordx4 v[104:107], v1, s[48:51], s76 offen offset:2048 sc1
    v_mfma_f32_16x16x32_bf16 a[172:175], v[224:227], v[156:159], a[172:175]
    s_waitcnt lgkmcnt(4)
    buffer_load_dwordx4 v[108:111], v1, s[48:51], s76 offen offset:3072 sc1
    v_mfma_f32_16x16x32_bf16 a[188:191], v[228:231], v[156:159], a[188:191]
    ds_read_b64_tr_b16 v[216:217], v236 offset:49152
    v_mfma_f32_16x16x32_bf16 a[184:187], v[228:231], v[152:155], a[184:187]
    ds_read_b64_tr_b16 v[218:219], v236 offset:55296
    v_mfma_f32_16x16x32_bf16 a[180:183], v[228:231], v[148:151], a[180:183]
    s_add_u32 s76, s70, 0x5000
    buffer_load_dwordx4 v[112:115], v1, s[48:51], s76 offen sc1
    v_mfma_f32_16x16x32_bf16 a[176:179], v[228:231], v[144:147], a[176:179]
    s_waitcnt lgkmcnt(4)
    buffer_load_dwordx4 v[116:119], v1, s[48:51], s76 offen offset:1024 sc1
    v_mfma_f32_16x16x32_bf16 a[0:3], v[208:211], v[192:195], a[0:3]
    ds_read_b64_tr_b16 v[220:221], v238 offset:49152
    v_mfma_f32_16x16x32_bf16 a[4:7], v[208:211], v[196:199], a[4:7]
    ds_read_b64_tr_b16 v[222:223], v238 offset:55296
    v_mfma_f32_16x16x32_bf16 a[8:11], v[208:211], v[200:203], a[8:11]
    buffer_load_dwordx4 v[120:123], v1, s[48:51], s76 offen offset:2048 sc1
    v_mfma_f32_16x16x32_bf16 a[12:15], v[208:211], v[204:207], a[12:15]
    s_waitcnt lgkmcnt(4)
    buffer_load_dwordx4 v[124:127], v1, s[48:51], s76 offen offset:3072 sc1
    v_mfma_f32_16x16x32_bf16 a[28:31], v[212:215], v[204:207], a[28:31]
    ds_read_b64_tr_b16 v[224:225], v232 offset:50176
    v_mfma_f32_16x16x32_bf16 a[24:27], v[212:215], v[200:203], a[24:27]
    s_add_u32 m0, s60, 0
    ds_read_b64_tr_b16 v[226:227], v232 offset:56320
    v_mfma_f32_16x16x32_bf16 a[20:23], v[212:215], v[196:199], a[20:23]
    s_add_u32 s66, s88, 0
    buffer_load_dwordx4 v8, s[36:39], s66 offen lds
    v_mfma_f32_16x16x32_bf16 a[16:19], v[212:215], v[192:195], a[16:19]
    s_waitcnt lgkmcnt(4)
    v_mfma_f32_16x16x32_bf16 a[32:35], v[216:219], v[192:195], a[32:35]
    ds_read_b64_tr_b16 v[228:229], v234 offset:50176
    v_mfma_f32_16x16x32_bf16 a[36:39], v[216:219], v[196:199], a[36:39]
    ds_read_b64_tr_b16 v[230:231], v234 offset:56320
    v_mfma_f32_16x16x32_bf16 a[40:43], v[216:219], v[200:203], a[40:43]
    s_add_u32 s66, s88, 0x80
    buffer_load_dwordx4 v9, s[36:39], s66 offen offset:1024 lds
    v_mfma_f32_16x16x32_bf16 a[44:47], v[216:219], v[204:207], a[44:47]
    s_waitcnt lgkmcnt(4)
    v_mfma_f32_16x16x32_bf16 a[60:63], v[220:223], v[204:207], a[60:63]
    ds_read_b64_tr_b16 v[208:209], v236 offset:50176
    v_mfma_f32_16x16x32_bf16 a[56:59], v[220:223], v[200:203], a[56:59]
    ds_read_b64_tr_b16 v[210:211], v236 offset:56320
    v_mfma_f32_16x16x32_bf16 a[52:55], v[220:223], v[196:199], a[52:55]
    s_add_u32 s66, s88, 0x100
    v_mfma_f32_16x16x32_bf16 a[48:51], v[220:223], v[192:195], a[48:51]
    s_waitcnt lgkmcnt(4)
    buffer_load_dwordx4 v10, s[36:39], s66 offen offset:2048 lds
    v_mfma_f32_16x16x32_bf16 a[64:67], v[224:227], v[192:195], a[64:67]
    ds_read_b64_tr_b16 v[212:213], v238 offset:50176
    v_mfma_f32_16x16x32_bf16 a[68:71], v[224:227], v[196:199], a[68:71]
    s_add_u32 m0, s60, 0xc00
    ds_read_b64_tr_b16 v[214:215], v238 offset:56320
    v_mfma_f32_16x16x32_bf16 a[72:75], v[224:227], v[200:203], a[72:75]
    s_add_u32 s66, s88, 0x2400
    v_mfma_f32_16x16x32_bf16 a[76:79], v[224:227], v[204:207], a[76:79]
    s_waitcnt lgkmcnt(4)
    buffer_load_dwordx4 v8, s[36:39], s66 offen lds
    v_mfma_f32_16x16x32_bf16 a[92:95], v[228:231], v[204:207], a[92:95]
    ds_read_b64_tr_b16 v[216:217], v232 offset:51200
    v_mfma_f32_16x16x32_bf16 a[88:91], v[228:231], v[200:203], a[88:91]
    ds_read_b64_tr_b16 v[218:219], v232 offset:57344
    v_mfma_f32_16x16x32_bf16 a[84:87], v[228:231], v[196:199], a[84:87]
    v_mfma_f32_16x16x32_bf16 a[80:83], v[228:231], v[192:195], a[80:83]
    s_waitcnt lgkmcnt(4)
    v_mfma_f32_16x16x32_bf16 a[96:99], v[208:211], v[192:195], a[96:99]
    ds_read_b64_tr_b16 v[220:221], v234 offset:51200
    v_mfma_f32_16x16x32_bf16 a[100:103], v[208:211], v[196:199], a[100:103]
    ds_read_b64_tr_b16 v[222:223], v234 offset:57344
    v_mfma_f32_16x16x32_bf16 a[104:107], v[208:211], v[200:203], a[104:107]
    s_add_u32 s66, s88, 0x2480
    buffer_load_dwordx4 v9, s[36:39], s66 offen offset:1024 lds
    v_mfma_f32_16x16x32_bf16 a[108:111], v[208:211], v[204:207], a[108:111]
    s_waitcnt lgkmcnt(4)
    v_mfma_f32_16x16x32_bf16 a[124:127], v[212:215], v[204:207], a[124:127]
    ds_read_b64_tr_b16 v[224:225], v236 offset:51200
    v_mfma_f32_16x16x32_bf16 a[120:123], v[212:215], v[200:203], a[120:123]
    ds_read_b64_tr_b16 v[226:227], v236 offset:57344
    v_mfma_f32_16x16x32_bf16 a[116:119], v[212:215], v[196:199], a[116:119]
    s_add_u32 s66, s88, 0x2500
    buffer_load_dwordx4 v10, s[36:39], s66 offen offset:2048 lds
    v_mfma_f32_16x16x32_bf16 a[112:115], v[212:215], v[192:195], a[112:115]
    s_waitcnt lgkmcnt(4)
    v_mfma_f32_16x16x32_bf16 a[128:131], v[216:219], v[192:195], a[128:131]
    ds_read_b64_tr_b16 v[228:229], v238 offset:51200
    v_mfma_f32_16x16x32_bf16 a[132:135], v[216:219], v[196:199], a[132:135]
    ds_read_b64_tr_b16 v[230:231], v238 offset:57344
    v_mfma_f32_16x16x32_bf16 a[136:139], v[216:219], v[200:203], a[136:139]
    v_mfma_f32_16x16x32_bf16 a[140:143], v[216:219], v[204:207], a[140:143]
    s_waitcnt lgkmcnt(4)
    s_barrier
    buffer_load_dword v13, v70, s[48:51], 0 offen sc1
    v_mfma_f32_16x16x32_bf16 a[156:159], v[220:223], v[204:207], a[156:159]
    ds_read_b64_tr_b16 v[208:209], v233
    v_mfma_f32_16x16x32_bf16 a[152:155], v[220:223], v[200:203], a[152:155]
    s_add_u32 m0, s60, 0x6000
    ds_read_b64_tr_b16 v[210:211], v233 offset:6144
    v_mfma_f32_16x16x32_bf16 a[148:151], v[220:223], v[196:199], a[148:151]
    s_add_u32 s66, s88, 0x12000
    buffer_load_dwordx4 v8, s[36:39], s66 offen lds
    v_mfma_f32_16x16x32_bf16 a[144:147], v[220:223], v[192:195], a[144:147]
    s_waitcnt lgkmcnt(4)
    s_add_u32 s66, s88, 0x12080
    buffer_load_dwordx4 v9, s[36:39], s66 offen offset:1024 lds
    v_mfma_f32_16x16x32_bf16 a[160:163], v[224:227], v[192:195], a[160:163]
    ds_read_b64_tr_b16 v[212:213], v235
    v_mfma_f32_16x16x32_bf16 a[164:167], v[224:227], v[196:199], a[164:167]
    ds_read_b64_tr_b16 v[214:215], v235 offset:6144
    v_mfma_f32_16x16x32_bf16 a[168:171], v[224:227], v[200:203], a[168:171]
    s_add_u32 s66, s88, 0x12100
    buffer_load_dwordx4 v10, s[36:39], s66 offen offset:2048 lds
    v_mfma_f32_16x16x32_bf16 a[172:175], v[224:227], v[204:207], a[172:175]
    s_waitcnt lgkmcnt(4)
    v_mfma_f32_16x16x32_bf16 a[188:191], v[228:231], v[204:207], a[188:191]
    ds_read_b64_tr_b16 v[216:217], v237
    v_mfma_f32_16x16x32_bf16 a[184:187], v[228:231], v[200:203], a[184:187]
    s_add_u32 m0, s60, 0x6c00
    ds_read_b64_tr_b16 v[218:219], v237 offset:6144
    v_mfma_f32_16x16x32_bf16 a[180:183], v[228:231], v[196:199], a[180:183]
    s_add_u32 s66, s88, 0x14400
    buffer_load_dwordx4 v8, s[36:39], s66 offen lds
    v_mfma_f32_16x16x32_bf16 a[176:179], v[228:231], v[192:195], a[176:179]
    s_waitcnt lgkmcnt(4)
    s_add_u32 s66, s88, 0x14480
    buffer_load_dwordx4 v9, s[36:39], s66 offen offset:1024 lds
    v_mfma_f32_16x16x32_bf16 a[0:3], v[208:211], v[80:83], a[0:3]
    ds_read_b64_tr_b16 v[220:221], v233 offset:1024
    v_subrev_u32 v232, s85, v232
    v_mfma_f32_16x16x32_bf16 a[4:7], v[208:211], v[84:87], a[4:7]
    ds_read_b64_tr_b16 v[222:223], v233 offset:7168
    v_add_u32 v2, 0x24000, v232
    v_mfma_f32_16x16x32_bf16 a[8:11], v[208:211], v[88:91], a[8:11]
    ds_read_b64_tr_b16 a[192:193], v239
    v_subrev_u32 v234, s85, v234
    v_mfma_f32_16x16x32_bf16 a[12:15], v[208:211], v[92:95], a[12:15]
    s_waitcnt lgkmcnt(5)
    ds_read_b64_tr_b16 a[194:195], v239 offset:6144
    v_add_u32 v3, 0x24000, v234
    v_mfma_f32_16x16x32_bf16 a[28:31], v[212:215], v[92:95], a[28:31]
    ds_read_b64_tr_b16 v[224:225], v235 offset:1024
    v_mfma_f32_16x16x32_bf16 a[24:27], v[212:215], v[88:91], a[24:27]
    ds_read_b64_tr_b16 v[226:227], v235 offset:7168
    v_subrev_u32 v236, s85, v236
    v_mfma_f32_16x16x32_bf16 a[20:23], v[212:215], v[84:87], a[20:23]
    s_add_u32 s66, s88, 0x14500
    buffer_load_dwordx4 v10, s[36:39], s66 offen offset:2048 lds
    v_mfma_f32_16x16x32_bf16 a[16:19], v[212:215], v[80:83], a[16:19]
    s_waitcnt lgkmcnt(6)
    v_mfma_f32_16x16x32_bf16 a[32:35], v[216:219], v[80:83], a[32:35]
    ds_read_b64_tr_b16 v[228:229], v237 offset:1024
    v_add_u32 v4, 0x24000, v236
    v_mfma_f32_16x16x32_bf16 a[36:39], v[216:219], v[84:87], a[36:39]
    ds_read_b64_tr_b16 v[230:231], v237 offset:7168
    v_mfma_f32_16x16x32_bf16 a[40:43], v[216:219], v[88:91], a[40:43]
    ds_read_b64_tr_b16 a[196:197], v239 offset:1024
    v_mfma_f32_16x16x32_bf16 a[44:47], v[216:219], v[92:95], a[44:47]
    s_waitcnt vmcnt(17) lgkmcnt(7)
    ds_read_b64_tr_b16 a[198:199], v239 offset:7168
    v_subrev_u32 v238, s85, v238
    v_mfma_f32_16x16x32_bf16 a[12:15], v[220:223], v[108:111], a[12:15]
    ds_read_b64_tr_b16 v[208:209], v233 offset:2048
    v_mfma_f32_16x16x32_bf16 a[8:11], v[220:223], v[104:107], a[8:11]
    ds_read_b64_tr_b16 v[210:211], v233 offset:8192
    v_add_u32 v5, 0x24000, v238
    v_mfma_f32_16x16x32_bf16 a[4:7], v[220:223], v[100:103], a[4:7]
    v_mfma_f32_16x16x32_bf16 a[0:3], v[220:223], v[96:99], a[0:3]
    s_waitcnt lgkmcnt(6)
    v_mfma_f32_16x16x32_bf16 a[16:19], v[224:227], v[96:99], a[16:19]
    ds_read_b64_tr_b16 v[212:213], v235 offset:2048
    v_mfma_f32_16x16x32_bf16 a[20:23], v[224:227], v[100:103], a[20:23]
    ds_read_b64_tr_b16 v[214:215], v235 offset:8192
    v_mfma_f32_16x16x32_bf16 a[24:27], v[224:227], v[104:107], a[24:27]
    ds_read_b64_tr_b16 a[200:201], v239 offset:2048
    v_mfma_f32_16x16x32_bf16 a[28:31], v[224:227], v[108:111], a[28:31]
    s_waitcnt lgkmcnt(7)
    ds_read_b64_tr_b16 a[202:203], v239 offset:8192
    v_mfma_f32_16x16x32_bf16 a[44:47], v[228:231], v[108:111], a[44:47]
    ds_read_b64_tr_b16 v[216:217], v237 offset:2048
    v_mfma_f32_16x16x32_bf16 a[40:43], v[228:231], v[104:107], a[40:43]
    ds_read_b64_tr_b16 v[218:219], v237 offset:8192
    v_mfma_f32_16x16x32_bf16 a[36:39], v[228:231], v[100:103], a[36:39]
    v_mfma_f32_16x16x32_bf16 a[32:35], v[228:231], v[96:99], a[32:35]
    s_waitcnt vmcnt(6) lgkmcnt(6)
    s_barrier
    v_cmp_ne_u32 vcc, v13, v71
    s_cbranch_vccz L_ok5
    s_mov_b32 s75, 131072
L_sp5:
    s_sleep 2
    buffer_load_dword v13, v70, s[48:51], 0 offen sc1
    s_waitcnt vmcnt(0)
    v_cmp_ne_u32 vcc, v13, v71
    s_cbranch_vccz L_ok5
    s_sub_u32 s75, s75, 1
    s_cmp_lg_u32 s75, 0
    s_cbranch_scc1 L_sp5
L_ok5:
    v_mfma_f32_16x16x32_bf16 a[0:3], v[208:211], v[112:115], a[0:3]
    s_add_u32 s76, s90, 0
    buffer_load_dwordx4 v[128:131], v1, s[48:51], s76 offen sc1
    ds_read_b64_tr_b16 v[220:221], v233 offset:24576
    v_mfma_f32_16x16x32_bf16 a[4:7], v[208:211], v[116:119], a[4:7]
    ds_read_b64_tr_b16 v[222:223], v233 offset:30720
    v_mfma_f32_16x16x32_bf16 a[8:11], v[208:211], v[120:123], a[8:11]
    v_mfma_f32_16x16x32_bf16 a[12:15], v[208:211], v[124:127], a[12:15]
    s_waitcnt lgkmcnt(6)
    buffer_load_dwordx4 v[132:135], v1, s[48:51], s76 offen offset:1024 sc1
    v_mfma_f32_16x16x32_bf16 a[28:31], v[212:215], v[124:127], a[28:31]
    ds_read_b64_tr_b16 v[224:225], v235 offset:24576
    v_mfma_f32_16x16x32_bf16 a[24:27], v[212:215], v[120:123], a[24:27]
    ds_read_b64_tr_b16 v[226:227], v235 offset:30720
    v_mfma_f32_16x16x32_bf16 a[20:23], v[212:215], v[116:119], a[20:23]
    ds_write_b128 v74, a[8:11]
    v_mfma_f32_16x16x32_bf16 a[16:19], v[212:215], v[112:115], a[16:19]
    s_waitcnt lgkmcnt(5)
    ds_write_b128 v74, a[12:15] offset:1024
    v_mfma_f32_16x16x32_bf16 a[32:35], v[216:219], v[112:115], a[32:35]
    buffer_load_dwordx4 v[136:139], v1, s[48:51], s76 offen offset:2048 sc1
    ds_read_b64_tr_b16 v[228:229], v237 offset:24576
    v_mfma_f32_16x16x32_bf16 a[36:39], v[216:219], v[116:119], a[36:39]
    ds_read_b64_tr_b16 v[230:231], v237 offset:30720
    v_mfma_f32_16x16x32_bf16 a[40:43], v[216:219], v[120:123], a[40:43]
    ds_write_b128 v74, a[24:27] offset:2048
    v_mfma_f32_16x16x32_bf16 a[44:47], v[216:219], v[124:127], a[44:47]
    s_waitcnt lgkmcnt(7)
    v_mfma_f32_16x16x32_bf16 a[76:79], v[220:223], v[92:95], a[76:79]
    buffer_load_dwordx4 v[140:143], v1, s[48:51], s76 offen offset:3072 sc1
    ds_read_b64_tr_b16 v[208:209], v233 offset:25600
    v_mfma_f32_16x16x32_bf16 a[72:75], v[220:223], v[88:91], a[72:75]
    ds_read_b64_tr_b16 v[210:211], v233 offset:31744
    v_mfma_f32_16x16x32_bf16 a[68:71], v[220:223], v[84:87], a[68:71]
    s_add_u32 s76, s90, 0x1000
    ds_read_b64_tr_b16 a[204:205], v239 offset:24576
    v_mfma_f32_16x16x32_bf16 a[64:67], v[220:223], v[80:83], a[64:67]
    s_waitcnt lgkmcnt(8)
    buffer_load_dwordx4 v[160:163], v1, s[48:51], s76 offen sc1
    ds_read_b64_tr_b16 a[206:207], v239 offset:30720
    v_mfma_f32_16x16x32_bf16 a[80:83], v[224:227], v[80:83], a[80:83]
    ds_read_b64_tr_b16 v[212:213], v235 offset:25600
    v_mfma_f32_16x16x32_bf16 a[84:87], v[224:227], v[84:87], a[84:87]
    ds_read_b64_tr_b16 v[214:215], v235 offset:31744
    v_mfma_f32_16x16x32_bf16 a[88:91], v[224:227], v[88:91], a[88:91]
    ds_write_b128 v74, a[28:31] offset:3072
    v_mfma_f32_16x16x32_bf16 a[92:95], v[224:227], v[92:95], a[92:95]
    s_waitcnt lgkmcnt(8)
    ds_write_b128 v74, a[40:43] offset:4096
    v_mfma_f32_16x16x32_bf16 a[108:111], v[228:231], v[92:95], a[108:111]
    buffer_load_dwordx4 v[164:167], v1, s[48:51], s76 offen offset:1024 sc1
    ds_read_b64_tr_b16 v[216:217], v237 offset:25600
    v_mfma_f32_16x16x32_bf16 a[104:107], v[228:231], v[88:91], a[104:107]
    ds_read_b64_tr_b16 v[218:219], v237 offset:31744
    v_mfma_f32_16x16x32_bf16 a[100:103], v[228:231], v[84:87], a[100:103]
    ds_read_b64_tr_b16 a[208:209], v239 offset:25600
    v_mfma_f32_16x16x32_bf16 a[96:99], v[228:231], v[80:83], a[96:99]
    s_waitcnt lgkmcnt(9)
    buffer_load_dwordx4 v[168:171], v1, s[48:51], s76 offen offset:2048 sc1
    ds_read_b64_tr_b16 a[210:211], v239 offset:31744
    v_mfma_f32_16x16x32_bf16 a[64:67], v[208:211], v[96:99], a[64:67]
    ds_read_b64_tr_b16 v[220:221], v233 offset:26624
    v_mfma_f32_16x16x32_bf16 a[68:71], v[208:211], v[100:103], a[68:71]
    ds_read_b64_tr_b16 v[222:223], v233 offset:32768
    v_mfma_f32_16x16x32_bf16 a[72:75], v[208:211], v[104:107], a[72:75]
    ds_write_b128 v74, a[44:47] offset:5120
    v_mfma_f32_16x16x32_bf16 a[76:79], v[208:211], v[108:111], a[76:79]
    s_waitcnt lgkmcnt(9)
    buffer_load_dwordx4 v[172:175], v1, s[48:51], s76 offen offset:3072 sc1
    v_mfma_f32_16x16x32_bf16 a[92:95], v[212:215], v[108:111], a[92:95]
    ds_read_b64_tr_b16 v[224:225], v235 offset:26624
    v_mfma_f32_16x16x32_bf16 a[88:91], v[212:215], v[104:107], a[88:91]
    ds_read_b64_tr_b16 v[226:227], v235 offset:32768
    v_mfma_f32_16x16x32_bf16 a[84:87], v[212:215], v[100:103], a[84:87]
    s_add_u32 s76, s90, 0x2000
    buffer_load_dwordx4 v[184:187], v1, s[48:51], s76 offen sc1
    ds_read_b64_tr_b16 a[212:213], v239 offset:26624
    v_mfma_f32_16x16x32_bf16 a[80:83], v[212:215], v[96:99], a[80:83]
    s_waitcnt lgkmcnt(8)
    ds_read_b64_tr_b16 a[214:215], v239 offset:32768
    v_mfma_f32_16x16x32_bf16 a[96:99], v[216:219], v[96:99], a[96:99]
    ds_read_b64_tr_b16 v[228:229], v237 offset:26624
    v_mfma_f32_16x16x32_bf16 a[100:103], v[216:219], v[100:103], a[100:103]
    buffer_load_dwordx4 v[188:191], v1, s[48:51], s76 offen offset:1024 sc1
    ds_read_b64_tr_b16 v[230:231], v237 offset:32768
    v_mfma_f32_16x16x32_bf16 a[104:107], v[216:219], v[104:107], a[104:107]
    v_mfma_f32_16x16x32_bf16 a[108:111], v[216:219], v[108:111], a[108:111]
    s_waitcnt lgkmcnt(6)
    s_barrier
    v_mfma_f32_16x16x32_bf16 a[76:79], v[220:223], v[124:127], a[76:79]
    ds_read_b64_tr_b16 v[208:209], v233 offset:49152
    ds_read_b128 v[16:19], v75
    v_mfma_f32_16x16x32_bf16 a[72:75], v[220:223], v[120:123], a[72:75]
    buffer_load_dword v72, v79, s[48:51], s78 offen sc1
    ds_read_b64_tr_b16 v[210:211], v233 offset:55296
    v_mfma_f32_16x16x32_bf16 a[68:71], v[220:223], v[116:119], a[68:71]
    ds_read_b128 v[20:23], v75 offset:1024
    ds_read_b128 v[24:27], v75 offset:2048
    ds_read_b128 v[28:31], v75 offset:3072
    ds_read_b128 v[32:35], v75 offset:4096
    v_mfma_f32_16x16x32_bf16 a[64:67], v[220:223], v[112:115], a[64:67]
    s_waitcnt lgkmcnt(11)
    ds_read_b128 v[36:39], v75 offset:5120
    v_accvgpr_read_b32 v200, a0
    v_accvgpr_read_b32 v201, a1
    v_mfma_f32_16x16x32_bf16 a[80:83], v[224:227], v[112:115], a[80:83]
    buffer_load_dword v73, v79, s[48:51], s78 offen offset:64 sc1
    ds_read_b64_tr_b16 v[212:213], v235 offset:49152
    v_mfma_f32_16x16x32_bf16 a[84:87], v[224:227], v[116:119], a[84:87]
    ds_read_b64_tr_b16 v[214:215], v235 offset:55296
    v_accvgpr_read_b32 v202, a2
    v_accvgpr_read_b32 v203, a3
    v_mfma_f32_16x16x32_bf16 a[88:91], v[224:227], v[120:123], a[88:91]
    ds_write_b128 v74, a[72:75] offset:24576
    v_mfma_f32_16x16x32_bf16 a[92:95], v[224:227], v[124:127], a[92:95]
    s_waitcnt lgkmcnt(11)
    ds_write_b128 v74, a[76:79] offset:25600
    v_mfma_f32_16x16x32_bf16 a[108:111], v[228:231], v[124:127], a[108:111]
    ds_read_b64_tr_b16 v[216:217], v237 offset:49152
    v_accvgpr_read_b32 v204, a4
    v_mfma_f32_16x16x32_bf16 a[104:107], v[228:231], v[120:123], a[104:107]
    ds_read_b64_tr_b16 v[218:219], v237 offset:55296
    v_accvgpr_read_b32 v205, a5
    v_accvgpr_read_b32 v206, a6
    v_mfma_f32_16x16x32_bf16 a[100:103], v[228:231], v[116:119], a[100:103]
    ds_write_b128 v74, a[88:91] offset:26624
    v_mfma_f32_16x16x32_bf16 a[96:99], v[228:231], v[112:115], a[96:99]
    s_waitcnt lgkmcnt(12)
    v_accvgpr_read_b32 v207, a7
    v_add_f32 v16, v200, v16
    v_add_f32 v17, v201, v17
    v_mfma_f32_16x16x32_bf16 a[128:131], v[208:211], v[80:83], a[128:131]
    ds_read_b64_tr_b16 v[220:221], v233 offset:50176
    v_add_f32 v18, v202, v18
    v_add_f32 v19, v203, v19
    v_mfma_f32_16x16x32_bf16 a[132:135], v[208:211], v[84:87], a[132:135]
    ds_read_b64_tr_b16 v[222:223], v233 offset:56320
    s_waitcnt lgkmcnt(13)
    v_add_f32 v20, v204, v20
    v_add_f32 v21, v205, v21
    v_mfma_f32_16x16x32_bf16 a[136:139], v[208:211], v[88:91], a[136:139]
    ds_read_b64_tr_b16 a[216:217], v239 offset:49152
    v_add_f32 v22, v206, v22
    v_mfma_f32_16x16x32_bf16 a[140:143], v[208:211], v[92:95], a[140:143]
    s_waitcnt lgkmcnt(8)
    ds_read_b64_tr_b16 a[218:219], v239 offset:55296
    v_add_f32 v23, v207, v23
    v_accvgpr_read_b32 v240, a16
    v_mfma_f32_16x16x32_bf16 a[156:159], v[212:215], v[92:95], a[156:159]
    ds_read_b64_tr_b16 v[224:225], v235 offset:50176
    v_accvgpr_read_b32 v241, a17
    v_accvgpr_read_b32 v242, a18
    v_mfma_f32_16x16x32_bf16 a[152:155], v[212:215], v[88:91], a[152:155]
    ds_read_b64_tr_b16 v[226:227], v235 offset:56320
    v_accvgpr_read_b32 v243, a19
    v_accvgpr_read_b32 v244, a20
    v_mfma_f32_16x16x32_bf16 a[148:151], v[212:215], v[84:87], a[148:151]
    ds_write_b128 v74, a[92:95] offset:27648
    v_mfma_f32_16x16x32_bf16 a[144:147], v[212:215], v[80:83], a[144:147]
    s_waitcnt lgkmcnt(8)
    ds_write_b128 v74, a[104:107] offset:28672
    v_mfma_f32_16x16x32_bf16 a[160:163], v[216:219], v[80:83], a[160:163]
    ds_read_b64_tr_b16 v[228:229], v237 offset:50176
    v_accvgpr_read_b32 v245, a21
    v_mfma_f32_16x16x32_bf16 a[164:167], v[216:219], v[84:87], a[164:167]
    ds_read_b64_tr_b16 v[230:231], v237 offset:56320
    v_accvgpr_read_b32 v246, a22
    v_accvgpr_read_b32 v247, a23
    v_mfma_f32_16x16x32_bf16 a[168:171], v[216:219], v[88:91], a[168:171]
    ds_read_b64_tr_b16 a[220:221], v239 offset:50176
    v_add_f32 v24, v240, v24
    v_add_f32 v25, v241, v25
    v_mfma_f32_16x16x32_bf16 a[172:175], v[216:219], v[92:95], a[172:175]
    s_waitcnt lgkmcnt(9)
    ds_read_b64_tr_b16 a[222:223], v239 offset:56320
    v_add_f32 v26, v242, v26
    v_mfma_f32_16x16x32_bf16 a[140:143], v[220:223], v[108:111], a[140:143]
    ds_read_b64_tr_b16 v[208:209], v233 offset:51200
    v_add_f32 v27, v243, v27
    v_add_f32 v28, v244, v28
    v_mfma_f32_16x16x32_bf16 a[136:139], v[220:223], v[104:107], a[136:139]
    ds_read_b64_tr_b16 v[210:211], v233 offset:57344
    v_add_f32 v29, v245, v29
    v_add_f32 v30, v246, v30
    v_mfma_f32_16x16x32_bf16 a[132:135], v[220:223], v[100:103], a[132:135]
    ds_write_b128 v74, a[108:111] offset:29696
    v_mfma_f32_16x16x32_bf16 a[128:131], v[220:223], v[96:99], a[128:131]
    s_waitcnt lgkmcnt(9)
    v_add_f32 v31, v247, v31
    v_accvgpr_read_b32 v200, a32
    v_accvgpr_read_b32 v201, a33
    v_mfma_f32_16x16x32_bf16 a[144:147], v[224:227], v[96:99], a[144:147]
    ds_read_b64_tr_b16 v[212:213], v235 offset:51200
    v_accvgpr_read_b32 v202, a34
    v_accvgpr_read_b32 v203, a35
    v_mfma_f32_16x16x32_bf16 a[148:151], v[224:227], v[100:103], a[148:151]
    ds_read_b64_tr_b16 v[214:215], v235 offset:57344
    v_accvgpr_read_b32 v204, a36
    v_mfma_f32_16x16x32_bf16 a[152:155], v[224:227], v[104:107], a[152:155]
    ds_read_b64_tr_b16 a[224:225], v239 offset:51200
    v_accvgpr_read_b32 v205, a37
    v_accvgpr_read_b32 v206, a38
    v_mfma_f32_16x16x32_bf16 a[156:159], v[224:227], v[108:111], a[156:159]
    s_waitcnt lgkmcnt(8)
    ds_read_b64_tr_b16 a[226:227], v239 offset:57344
    v_accvgpr_read_b32 v207, a39
    v_add_f32 v32, v200, v32
    v_mfma_f32_16x16x32_bf16 a[172:175], v[228:231], v[108:111], a[172:175]
    ds_read_b64_tr_b16 v[216:217], v237 offset:51200
    v_add_f32 v33, v201, v33
    v_mfma_f32_16x16x32_bf16 a[168:171], v[228:231], v[104:107], a[168:171]
    ds_read_b64_tr_b16 v[218:219], v237 offset:57344
    v_add_f32 v34, v202, v34
    v_add_f32 v35, v203, v35
    v_mfma_f32_16x16x32_bf16 a[164:167], v[228:231], v[100:103], a[164:167]
    v_add_f32 v36, v204, v36
    v_add_f32 v37, v205, v37
    v_add_f32 v38, v206, v38
    v_add_f32 v39, v207, v39
    v_mfma_f32_16x16x32_bf16 a[160:163], v[228:231], v[96:99], a[160:163]
    s_waitcnt vmcnt(12) lgkmcnt(6)
    s_barrier
    v_mfma_f32_16x16x32_bf16 a[128:131], v[208:211], v[112:115], a[128:131]
    ds_read_b64_tr_b16 a[228:229], v232
    ds_read_b128 v[40:43], v75 offset:24576
    ds_read_b128 v[44:47], v75 offset:25600
    v_mfma_f32_16x16x32_bf16 a[132:135], v[208:211], v[116:119], a[132:135]
    ds_read_b64_tr_b16 a[230:231], v232 offset:6144
    ds_read_b128 v[48:51], v75 offset:26624
    ds_read_b128 v[52:55], v75 offset:27648
    v_mfma_f32_16x16x32_bf16 a[136:139], v[208:211], v[120:123], a[136:139]
    ds_read_b64_tr_b16 a[232:233], v232 offset:12288
    ds_read_b128 v[56:59], v75 offset:28672
    ds_read_b128 v[60:63], v75 offset:29696
    v_accvgpr_read_b32 v200, a64
    v_mfma_f32_16x16x32_bf16 a[140:143], v[208:211], v[124:127], a[140:143]
    s_waitcnt lgkmcnt(13)
    ds_read_b64_tr_b16 a[234:235], v232 offset:18432
    v_accvgpr_read_b32 v201, a65
    v_accvgpr_read_b32 v202, a66
    v_mfma_f32_16x16x32_bf16 a[156:159], v[212:215], v[124:127], a[156:159]
    ds_read_b64_tr_b16 a[236:237], v232 offset:24576
    v_accvgpr_read_b32 v203, a67
    v_accvgpr_read_b32 v204, a68
    v_accvgpr_read_b32 v205, a69
    v_mfma_f32_16x16x32_bf16 a[152:155], v[212:215], v[120:123], a[152:155]
    ds_read_b64_tr_b16 a[238:239], v232 offset:30720
    v_accvgpr_read_b32 v206, a70
    v_accvgpr_read_b32 v207, a71
    v_mfma_f32_16x16x32_bf16 a[148:151], v[212:215], v[116:119], a[148:151]
    ds_read_b64_tr_b16 a[240:241], v232 offset:36864
    s_waitcnt lgkmcnt(11)
    v_add_f32 v40, v200, v40
    v_add_f32 v41, v201, v41
    v_add_f32 v42, v202, v42
    v_mfma_f32_16x16x32_bf16 a[144:147], v[212:215], v[112:115], a[144:147]
    ds_read_b64_tr_b16 a[242:243], v232 offset:43008
    ds_write_b128 v74, a[136:139] offset:49152
    v_mfma_f32_16x16x32_bf16 a[160:163], v[216:219], v[112:115], a[160:163]
    ds_read_b64_tr_b16 a[244:245], v2
    v_add_f32 v43, v203, v43
    s_waitcnt lgkmcnt(13)
    v_add_f32 v44, v204, v44
    v_mfma_f32_16x16x32_bf16 a[164:167], v[216:219], v[116:119], a[164:167]
    ds_read_b64_tr_b16 a[246:247], v2 offset:6144
    v_add_f32 v45, v205, v45
    v_add_f32 v46, v206, v46
    v_add_f32 v47, v207, v47
    v_mfma_f32_16x16x32_bf16 a[168:171], v[216:219], v[120:123], a[168:171]
    ds_read_b64_tr_b16 a[248:249], v234
    v_accvgpr_read_b32 v240, a80
    v_accvgpr_read_b32 v241, a81
    v_mfma_f32_16x16x32_bf16 a[172:175], v[216:219], v[124:127], a[172:175]
    ds_read_b64_tr_b16 a[250:251], v234 offset:6144
    ds_write_b128 v74, a[140:143] offset:50176
    s_waitcnt vmcnt(11) lgkmcnt(15)
    v_mfma_f32_16x16x32_bf16 v[16:19], a[228:231], v[128:131], v[16:19]
    ds_read_b64_tr_b16 a[252:253], v234 offset:12288
    ds_read_b64_tr_b16 a[254:255], v234 offset:18432
    s_waitcnt vmcnt(10)
    v_mfma_f32_16x16x32_bf16 v[20:23], a[228:231], v[132:135], v[20:23]
    s_waitcnt vmcnt(8) lgkmcnt(12)
    v_accvgpr_read_b32 v242, a82
    v_accvgpr_read_b32 v243, a83
    v_accvgpr_read_b32 v244, a84
    v_accvgpr_read_b32 v245, a85
    v_accvgpr_read_b32 v246, a86
    v_mfma_f32_16x16x32_bf16 v[16:19], a[232:235], v[136:139], v[16:19]
    ds_read_b64_tr_b16 a[228:229], v234 offset:24576
    ds_read_b64_tr_b16 a[230:231], v234 offset:30720
    v_mfma_f32_16x16x32_bf16 v[20:23], a[232:235], v[140:143], v[20:23]
    s_waitcnt vmcnt(6) lgkmcnt(12)
    v_accvgpr_read_b32 v247, a87
    v_add_f32 v48, v240, v48
    v_add_f32 v49, v241, v49
    v_add_f32 v50, v242, v50
    v_add_f32 v51, v243, v51
    v_mfma_f32_16x16x32_bf16 v[16:19], a[236:239], v[160:163], v[16:19]
    ds_read_b64_tr_b16 a[232:233], v234 offset:36864
    ds_read_b64_tr_b16 a[234:235], v234 offset:43008
    v_mfma_f32_16x16x32_bf16 v[20:23], a[236:239], v[164:167], v[20:23]
    s_waitcnt vmcnt(4) lgkmcnt(12)
    ds_write_b128 v74, a[152:155] offset:51200
    v_mfma_f32_16x16x32_bf16 v[16:19], a[240:243], v[168:171], v[16:19]
    ds_read_b64_tr_b16 a[236:237], v3
    v_add_f32 v52, v244, v52
    v_add_f32 v53, v245, v53
    v_mfma_f32_16x16x32_bf16 v[20:23], a[240:243], v[172:175], v[20:23]
    s_waitcnt vmcnt(2) lgkmcnt(11)
    v_add_f32 v54, v246, v54
    v_add_f32 v55, v247, v55
    v_accvgpr_read_b32 v200, a96
    v_accvgpr_read_b32 v201, a97
    v_accvgpr_read_b32 v202, a98
    v_mfma_f32_16x16x32_bf16 v[16:19], a[244:247], v[184:187], v[16:19]
    ds_read_b64_tr_b16 a[240:241], v236
    ds_read_b64_tr_b16 a[242:243], v236 offset:6144
    v_mfma_f32_16x16x32_bf16 v[20:23], a[244:247], v[188:191], v[20:23]
    s_waitcnt lgkmcnt(11)
    ds_write_b128 v74, a[156:159] offset:52224
    v_mfma_f32_16x16x32_bf16 v[24:27], a[248:251], v[128:131], v[24:27]
L_pad_f8:
    s_cbranch_execz L_padret_f
    ds_read_b64_tr_b16 a[244:245], v236 offset:12288
    ds_read_b64_tr_b16 a[246:247], v236 offset:18432
    v_mfma_f32_16x16x32_bf16 v[28:31], a[248:251], v[132:135], v[28:31]
    s_waitcnt lgkmcnt(11)
    v_accvgpr_read_b32 v203, a99
    v_accvgpr_read_b32 v204, a100
    v_accvgpr_read_b32 v205, a101
    v_accvgpr_read_b32 v206, a102
    v_accvgpr_read_b32 v207, a103
    v_mfma_f32_16x16x32_bf16 v[24:27], a[252:255], v[136:139], v[24:27]
    ds_read_b64_tr_b16 a[248:249], v236 offset:24576
    ds_read_b64_tr_b16 a[250:251], v236 offset:30720
    v_mfma_f32_16x16x32_bf16 v[28:31], a[252:255], v[140:143], v[28:31]
    s_waitcnt lgkmcnt(11)
    v_cvt_pk_bf16_f32 v16, v16, v17
    v_cvt_pk_bf16_f32 v17, v18, v19
    v_mfma_f32_16x16x32_bf16 v[24:27], a[228:231], v[160:163], v[24:27]
    ds_read_b64_tr_b16 a[252:253], v236 offset:36864
    ds_read_b64_tr_b16 a[254:255], v236 offset:43008
    v_mfma_f32_16x16x32_bf16 v[28:31], a[228:231], v[164:167], v[28:31]
    s_waitcnt lgkmcnt(11)
    ds_write_b128 v74, a[168:171] offset:53248
    v_cvt_pk_bf16_f32 v18, v20, v21
    v_cvt_pk_bf16_f32 v19, v22, v23
    v_mfma_f32_16x16x32_bf16 v[24:27], a[232:235], v[168:171], v[24:27]
    ds_read_b64_tr_b16 a[228:229], v4
    v_add_f32 v56, v200, v56
    v_add_f32 v57, v201, v57
    v_add_f32 v58, v202, v58
    v_mfma_f32_16x16x32_bf16 v[28:31], a[232:235], v[172:175], v[28:31]
    s_waitcnt lgkmcnt(11)
    buffer_store_dwordx4 v[16:19], v1, s[48:51], s82 offen sc1
    v_mfma_f32_16x16x32_bf16 v[24:27], a[236:239], v[184:187], v[24:27]
    ds_read_b64_tr_b16 a[232:233], v232 offset:1024
    ds_read_b64_tr_b16 a[234:235], v232 offset:7168
    v_mfma_f32_16x16x32_bf16 v[28:31], a[236:239], v[188:191], v[28:31]
    s_waitcnt lgkmcnt(11)
    v_add_f32 v59, v203, v59
    v_add_f32 v60, v204, v60
    v_add_f32 v61, v205, v61
    v_add_f32 v62, v206, v62
    v_add_f32 v63, v207, v63
    v_mfma_f32_16x16x32_bf16 v[32:35], a[240:243], v[128:131], v[32:35]
    ds_read_b64_tr_b16 a[236:237], v232 offset:13312
    ds_read_b64_tr_b16 a[238:239], v232 offset:19456
    v_mfma_f32_16x16x32_bf16 v[36:39], a[240:243], v[132:135], v[36:39]
    s_waitcnt lgkmcnt(10)
    ds_write_b128 v74, a[172:175] offset:54272
    v_mfma_f32_16x16x32_bf16 v[32:35], a[244:247], v[136:139], v[32:35]
    ds_read_b64_tr_b16 a[240:241], v232 offset:25600
    ds_read_b64_tr_b16 a[242:243], v232 offset:31744
    v_mfma_f32_16x16x32_bf16 v[36:39], a[244:247], v[140:143], v[36:39]
    s_waitcnt lgkmcnt(11)
    v_cvt_pk_bf16_f32 v24, v24, v25
    v_cvt_pk_bf16_f32 v25, v26, v27
    v_mfma_f32_16x16x32_bf16 v[32:35], a[248:251], v[160:163], v[32:35]
    s_waitcnt lgkmcnt(2)
    s_barrier
    ds_read_b64_tr_b16 a[244:245], v232 offset:37888
    ds_read_b64_tr_b16 a[246:247], v232 offset:44032
    v_mfma_f32_16x16x32_bf16 v[36:39], a[248:251], v[164:167], v[36:39]
    v_cvt_pk_bf16_f32 v26, v28, v29
    v_cvt_pk_bf16_f32 v27, v30, v31
    v_mfma_f32_16x16x32_bf16 v[32:35], a[252:255], v[168:171], v[32:35]
    ds_read_b64_tr_b16 a[248:249], v2 offset:1024
    ds_read_b128 v[144:147], v75 offset:49152
    ds_read_b128 v[148:151], v75 offset:50176
    ds_read_b128 v[152:155], v75 offset:51200
    v_mfma_f32_16x16x32_bf16 v[36:39], a[252:255], v[172:175], v[36:39]
    buffer_store_dwordx4 v[24:27], v1, s[48:51], s83 offen sc1
    v_mfma_f32_16x16x32_bf16 v[32:35], a[228:231], v[184:187], v[32:35]
    ds_read_b64_tr_b16 a[252:253], v234 offset:1024
    ds_read_b64_tr_b16 a[254:255], v234 offset:7168
    v_mfma_f32_16x16x32_bf16 v[36:39], a[228:231], v[188:191], v[36:39]
    ds_read_b128 v[156:159], v75 offset:52224
    ds_read_b128 v[192:195], v75 offset:53248
    ds_read_b128 v[196:199], v75 offset:54272
    v_accvgpr_read_b32 v200, a128
    v_accvgpr_read_b32 v201, a129
    v_accvgpr_read_b32 v202, a130
    v_accvgpr_read_b32 v203, a131
    v_mfma_f32_16x16x32_bf16 v[40:43], a[232:235], v[128:131], v[40:43]
    ds_read_b64_tr_b16 a[228:229], v234 offset:13312
    ds_read_b64_tr_b16 a[230:231], v234 offset:19456
    v_mfma_f32_16x16x32_bf16 v[44:47], a[232:235], v[132:135], v[44:47]
    v_accvgpr_read_b32 v204, a132
    v_accvgpr_read_b32 v205, a133
    v_accvgpr_read_b32 v206, a134
    v_accvgpr_read_b32 v207, a135
    s_waitcnt lgkmcnt(9)
    v_add_f32 v144, v200, v144
    v_add_f32 v145, v201, v145
    v_mfma_f32_16x16x32_bf16 v[40:43], a[236:239], v[136:139], v[40:43]
    ds_read_b64_tr_b16 a[232:233], v234 offset:25600
    ds_read_b64_tr_b16 a[234:235], v234 offset:31744
    v_mfma_f32_16x16x32_bf16 v[44:47], a[236:239], v[140:143], v[44:47]
    v_cvt_pk_bf16_f32 v32, v32, v33
    v_cvt_pk_bf16_f32 v33, v34, v35
    v_mfma_f32_16x16x32_bf16 v[40:43], a[240:243], v[160:163], v[40:43]
    ds_read_b64_tr_b16 a[236:237], v234 offset:37888
    ds_read_b64_tr_b16 a[238:239], v234 offset:44032
    v_mfma_f32_16x16x32_bf16 v[44:47], a[240:243], v[164:167], v[44:47]
    v_cvt_pk_bf16_f32 v34, v36, v37
    v_cvt_pk_bf16_f32 v35, v38, v39
    v_mfma_f32_16x16x32_bf16 v[40:43], a[244:247], v[168:171], v[40:43]
    ds_read_b64_tr_b16 a[240:241], v3 offset:1024
    v_add_f32 v146, v202, v146
    v_add_f32 v147, v203, v147
    s_waitcnt lgkmcnt(13)
    v_add_f32 v148, v204, v148
    v_add_f32 v149, v205, v149
    v_mfma_f32_16x16x32_bf16 v[44:47], a[244:247], v[172:175], v[44:47]
    buffer_store_dwordx4 v[32:35], v1, s[48:51], s84 offen sc1
    v_mfma_f32_16x16x32_bf16 v[40:43], a[248:251], v[184:187], v[40:43]
    ds_read_b64_tr_b16 a[244:245], v236 offset:1024
    ds_read_b64_tr_b16 a[246:247], v236 offset:7168
    v_mfma_f32_16x16x32_bf16 v[44:47], a[248:251], v[188:191], v[44:47]
    s_waitcnt lgkmcnt(12)
    v_add_f32 v150, v206, v150
    v_add_f32 v151, v207, v151
    v_accvgpr_read_b32 v240, a144
    v_accvgpr_read_b32 v241, a145
    v_accvgpr_read_b32 v242, a146
    v_accvgpr_read_b32 v243, a147
    v_accvgpr_read_b32 v244, a148
    v_mfma_f32_16x16x32_bf16 v[48:51], a[252:255], v[128:131], v[48:51]
    ds_read_b64_tr_b16 a[248:249], v236 offset:13312
    ds_read_b64_tr_b16 a[250:251], v236 offset:19456
    v_mfma_f32_16x16x32_bf16 v[52:55], a[252:255], v[132:135], v[52:55]
    s_waitcnt lgkmcnt(9)
    v_accvgpr_read_b32 v245, a149
    v_accvgpr_read_b32 v246, a150
    v_accvgpr_read_b32 v247, a151
    v_add_f32 v152, v240, v152
    v_add_f32 v153, v241, v153
    v_add_f32 v154, v242, v154
    v_mfma_f32_16x16x32_bf16 v[48:51], a[228:231], v[136:139], v[48:51]
    ds_read_b64_tr_b16 a[252:253], v236 offset:25600
    ds_read_b64_tr_b16 a[254:255], v236 offset:31744
    v_mfma_f32_16x16x32_bf16 v[52:55], a[228:231], v[140:143], v[52:55]
    s_waitcnt lgkmcnt(9)
    v_cvt_pk_bf16_f32 v40, v40, v41
    v_cvt_pk_bf16_f32 v41, v42, v43
    v_mfma_f32_16x16x32_bf16 v[48:51], a[232:235], v[160:163], v[48:51]
    ds_read_b64_tr_b16 a[228:229], v236 offset:37888
    ds_read_b64_tr_b16 a[230:231], v236 offset:44032
    v_mfma_f32_16x16x32_bf16 v[52:55], a[232:235], v[164:167], v[52:55]
    s_waitcnt lgkmcnt(9)
    v_cvt_pk_bf16_f32 v42, v44, v45
    v_cvt_pk_bf16_f32 v43, v46, v47
    v_mfma_f32_16x16x32_bf16 v[48:51], a[236:239], v[168:171], v[48:51]
    ds_read_b64_tr_b16 a[232:233], v4 offset:1024
    v_add_f32 v155, v243, v155
    v_add_f32 v156, v244, v156
    v_add_f32 v157, v245, v157
    v_add_f32 v158, v246, v158
    v_mfma_f32_16x16x32_bf16 v[52:55], a[236:239], v[172:175], v[52:55]
    s_waitcnt lgkmcnt(9)
    buffer_store_dwordx4 v[40:43], v1, s[48:51], s82 offen offset:1024 sc1
    v_mfma_f32_16x16x32_bf16 v[48:51], a[240:243], v[184:187], v[48:51]
    ds_read_b64_tr_b16 a[236:237], v232 offset:2048
    ds_read_b64_tr_b16 a[238:239], v232 offset:8192
    v_mfma_f32_16x16x32_bf16 v[52:55], a[240:243], v[188:191], v[52:55]
    s_waitcnt lgkmcnt(9)
    v_add_f32 v159, v247, v159
    v_accvgpr_read_b32 v200, a160
    v_accvgpr_read_b32 v201, a161
    v_accvgpr_read_b32 v202, a162
    v_accvgpr_read_b32 v203, a163
    v_accvgpr_read_b32 v204, a164
    v_mfma_f32_16x16x32_bf16 v[56:59], a[244:247], v[128:131], v[56:59]
    ds_read_b64_tr_b16 a[240:241], v232 offset:14336
    ds_read_b64_tr_b16 a[242:243], v232 offset:20480
    v_mfma_f32_16x16x32_bf16 v[60:63], a[244:247], v[132:135], v[60:63]
    s_waitcnt lgkmcnt(9)
    v_accvgpr_read_b32 v205, a165
    v_accvgpr_read_b32 v206, a166
    v_accvgpr_read_b32 v207, a167
    v_add_f32 v192, v200, v192
    v_add_f32 v193, v201, v193
    v_add_f32 v194, v202, v194
    v_add_f32 v195, v203, v195
    v_mfma_f32_16x16x32_bf16 v[56:59], a[248:251], v[136:139], v[56:59]
    ds_read_b64_tr_b16 a[244:245], v232 offset:26624
    ds_read_b64_tr_b16 a[246:247], v232 offset:32768
    v_mfma_f32_16x16x32_bf16 v[60:63], a[248:251], v[140:143], v[60:63]
    s_waitcnt lgkmcnt(9)
    v_cvt_pk_bf16_f32 v48, v48, v49
    v_cvt_pk_bf16_f32 v49, v50, v51
    v_mfma_f32_16x16x32_bf16 v[56:59], a[252:255], v[160:163], v[56:59]
    ds_read_b64_tr_b16 a[248:249], v232 offset:38912
    ds_read_b64_tr_b16 a[250:251], v232 offset:45056
    v_mfma_f32_16x16x32_bf16 v[60:63], a[252:255], v[164:167], v[60:63]
    s_waitcnt lgkmcnt(9)
    v_cvt_pk_bf16_f32 v50, v52, v53
    v_cvt_pk_bf16_f32 v51, v54, v55
    v_mfma_f32_16x16x32_bf16 v[56:59], a[228:231], v[168:171], v[56:59]
    ds_read_b64_tr_b16 a[252:253], v2 offset:2048
    v_add_f32 v196, v204, v196
    v_add_f32 v197, v205, v197
    v_add_f32 v198, v206, v198
    v_add_f32 v199, v207, v199
    v_mfma_f32_16x16x32_bf16 v[60:63], a[228:231], v[172:175], v[60:63]
    s_waitcnt lgkmcnt(9)
    buffer_store_dwordx4 v[48:51], v1, s[48:51], s83 offen offset:1024 sc1
    v_mfma_f32_16x16x32_bf16 v[56:59], a[232:235], v[184:187], v[56:59]
    ds_read_b64_tr_b16 a[228:229], v234 offset:2048
    ds_read_b64_tr_b16 a[230:231], v234 offset:8192
    v_mfma_f32_16x16x32_bf16 v[60:63], a[232:235], v[188:191], v[60:63]
    s_waitcnt lgkmcnt(9)
    v_mfma_f32_16x16x32_bf16 v[144:147], a[236:239], v[128:131], v[144:147]
    ds_read_b64_tr_b16 a[232:233], v234 offset:14336
    ds_read_b64_tr_b16 a[234:235], v234 offset:20480
    v_mfma_f32_16x16x32_bf16 v[148:151], a[236:239], v[132:135], v[148:151]
    s_waitcnt lgkmcnt(9)
    v_mfma_f32_16x16x32_bf16 v[144:147], a[240:243], v[136:139], v[144:147]
    ds_read_b64_tr_b16 a[236:237], v234 offset:26624
    ds_read_b64_tr_b16 a[238:239], v234 offset:32768
    v_mfma_f32_16x16x32_bf16 v[148:151], a[240:243], v[140:143], v[148:151]
    s_waitcnt lgkmcnt(9)
    v_cvt_pk_bf16_f32 v56, v56, v57
    v_cvt_pk_bf16_f32 v57, v58, v59
    v_mfma_f32_16x16x32_bf16 v[144:147], a[244:247], v[160:163], v[144:147]
    ds_read_b64_tr_b16 a[240:241], v234 offset:38912
    ds_read_b64_tr_b16 a[242:243], v234 offset:45056
    v_mfma_f32_16x16x32_bf16 v[148:151], a[244:247], v[164:167], v[148:151]
    s_waitcnt lgkmcnt(9)
    v_cvt_pk_bf16_f32 v58, v60, v61
    v_cvt_pk_bf16_f32 v59, v62, v63
    v_mfma_f32_16x16x32_bf16 v[144:147], a[248:251], v[168:171], v[144:147]
    ds_read_b64_tr_b16 a[244:245], v3 offset:2048
    v_mfma_f32_16x16x32_bf16 v[148:151], a[248:251], v[172:175], v[148:151]
    s_waitcnt lgkmcnt(9)
    buffer_store_dwordx4 v[56:59], v1, s[48:51], s84 offen offset:1024 sc1
    v_mfma_f32_16x16x32_bf16 v[144:147], a[252:255], v[184:187], v[144:147]
    ds_read_b64_tr_b16 a[248:249], v236 offset:2048
    ds_read_b64_tr_b16 a[250:251], v236 offset:8192
    v_mfma_f32_16x16x32_bf16 v[148:151], a[252:255], v[188:191], v[148:151]
    s_waitcnt lgkmcnt(9)
    v_mfma_f32_16x16x32_bf16 v[152:155], a[228:231], v[128:131], v[152:155]
    ds_read_b64_tr_b16 a[252:253], v236 offset:14336
    ds_read_b64_tr_b16 a[254:255], v236 offset:20480
    v_mfma_f32_16x16x32_bf16 v[156:159], a[228:231], v[132:135], v[156:159]
    s_waitcnt lgkmcnt(9)
    v_mfma_f32_16x16x32_bf16 v[152:155], a[232:235], v[136:139], v[152:155]
    ds_read_b64_tr_b16 a[228:229], v236 offset:26624
    ds_read_b64_tr_b16 a[230:231], v236 offset:32768
    v_mfma_f32_16x16x32_bf16 v[156:159], a[232:235], v[140:143], v[156:159]
    s_waitcnt lgkmcnt(9)
    v_cvt_pk_bf16_f32 v144, v144, v145
    v_cvt_pk_bf16_f32 v145, v146, v147
    v_mfma_f32_16x16x32_bf16 v[152:155], a[236:239], v[160:163], v[152:155]
    ds_read_b64_tr_b16 a[232:233], v236 offset:38912
    ds_read_b64_tr_b16 a[234:235], v236 offset:45056
    v_mfma_f32_16x16x32_bf16 v[156:159], a[236:239], v[164:167], v[156:159]
    s_waitcnt lgkmcnt(9)
    v_cvt_pk_bf16_f32 v146, v148, v149
    v_cvt_pk_bf16_f32 v147, v150, v151
    v_mfma_f32_16x16x32_bf16 v[152:155], a[240:243], v[168:171], v[152:155]
    ds_read_b64_tr_b16 a[236:237], v4 offset:2048
    v_mfma_f32_16x16x32_bf16 v[156:159], a[240:243], v[172:175], v[156:159]
    s_waitcnt lgkmcnt(9)
    buffer_store_dwordx4 v[144:147], v1, s[48:51], s82 offen offset:2048 sc1
    v_mfma_f32_16x16x32_bf16 v[152:155], a[244:247], v[184:187], v[152:155]
    ds_read_b64_tr_b16 a[240:241], v238
    ds_read_b64_tr_b16 a[242:243], v238 offset:6144
    v_mfma_f32_16x16x32_bf16 v[156:159], a[244:247], v[188:191], v[156:159]
    s_waitcnt lgkmcnt(9)
    v_mfma_f32_16x16x32_bf16 v[192:195], a[248:251], v[128:131], v[192:195]
    ds_read_b64_tr_b16 a[244:245], v238 offset:12288
    ds_read_b64_tr_b16 a[246:247], v238 offset:18432
    v_mfma_f32_16x16x32_bf16 v[196:199], a[248:251], v[132:135], v[196:199]
    s_waitcnt lgkmcnt(9)
    v_mfma_f32_16x16x32_bf16 v[192:195], a[252:255], v[136:139], v[192:195]
    ds_read_b64_tr_b16 a[248:249], v238 offset:24576
    ds_read_b64_tr_b16 a[250:251], v238 offset:30720
    v_mfma_f32_16x16x32_bf16 v[196:199], a[252:255], v[140:143], v[196:199]
    s_waitcnt lgkmcnt(9)
    v_cvt_pk_bf16_f32 v152, v152, v153
    v_cvt_pk_bf16_f32 v153, v154, v155
    v_mfma_f32_16x16x32_bf16 v[192:195], a[228:231], v[160:163], v[192:195]
    ds_read_b64_tr_b16 a[252:253], v238 offset:36864
    ds_read_b64_tr_b16 a[254:255], v238 offset:43008
    v_mfma_f32_16x16x32_bf16 v[196:199], a[228:231], v[164:167], v[196:199]
    s_waitcnt lgkmcnt(9)
    v_cvt_pk_bf16_f32 v154, v156, v157
    v_cvt_pk_bf16_f32 v155, v158, v159
    v_mfma_f32_16x16x32_bf16 v[192:195], a[232:235], v[168:171], v[192:195]
    ds_read_b64_tr_b16 a[228:229], v5
    v_mfma_f32_16x16x32_bf16 v[196:199], a[232:235], v[172:175], v[196:199]
    s_waitcnt lgkmcnt(9)
    buffer_store_dwordx4 v[152:155], v1, s[48:51], s83 offen offset:2048 sc1
    v_mfma_f32_16x16x32_bf16 v[192:195], a[236:239], v[184:187], v[192:195]
    ds_read_b64_tr_b16 a[232:233], v238 offset:1024
    ds_read_b64_tr_b16 a[234:235], v238 offset:7168
    v_mfma_f32_16x16x32_bf16 v[196:199], a[236:239], v[188:191], v[196:199]
    s_waitcnt lgkmcnt(9)
    v_mfma_f32_16x16x32_bf16 a[56:59], a[192:195], v[88:91], a[56:59]
    v_mfma_f32_16x16x32_bf16 a[56:59], a[196:199], v[104:107], a[56:59]
    v_mfma_f32_16x16x32_bf16 a[56:59], a[200:203], v[120:123], a[56:59]
    s_nop 0
    v_cvt_pk_bf16_f32 v192, v192, v193
    v_cvt_pk_bf16_f32 v193, v194, v195
    s_nop 0
    v_cvt_pk_bf16_f32 v194, v196, v197
    v_cvt_pk_bf16_f32 v195, v198, v199
    v_mfma_f32_16x16x32_bf16 a[60:63], a[200:203], v[124:127], a[60:63]
    buffer_store_dwordx4 v[192:195], v1, s[48:51], s84 offen offset:2048 sc1
    v_mfma_f32_16x16x32_bf16 a[60:63], a[196:199], v[108:111], a[60:63]
    s_waitcnt vmcnt(3)
    buffer_store_dword v14, v15, s[48:51], 0 offen offset:640 sc1
    v_mfma_f32_16x16x32_bf16 a[60:63], a[192:195], v[92:95], a[60:63]
    v_mfma_f32_16x16x32_bf16 a[120:123], a[204:207], v[88:91], a[120:123]
    v_mfma_f32_16x16x32_bf16 a[120:123], a[208:211], v[104:107], a[120:123]
    v_mfma_f32_16x16x32_bf16 a[120:123], a[212:215], v[120:123], a[120:123]
    ds_write_b128 v74, a[56:59]
    v_mfma_f32_16x16x32_bf16 a[124:127], a[212:215], v[124:127], a[124:127]
    v_mfma_f32_16x16x32_bf16 a[124:127], a[208:211], v[108:111], a[124:127]
    v_mfma_f32_16x16x32_bf16 a[124:127], a[204:207], v[92:95], a[124:127]
    v_mfma_f32_16x16x32_bf16 a[184:187], a[216:219], v[88:91], a[184:187]
    buffer_load_dword v13, v77, s[48:51], 0 offen offset:640 sc1
    ds_write_b128 v74, a[60:63] offset:1024
    v_mfma_f32_16x16x32_bf16 a[184:187], a[220:223], v[104:107], a[184:187]
    v_mfma_f32_16x16x32_bf16 a[184:187], a[224:227], v[120:123], a[184:187]
    v_mfma_f32_16x16x32_bf16 a[188:191], a[224:227], v[124:127], a[188:191]
    v_mfma_f32_16x16x32_bf16 a[188:191], a[220:223], v[108:111], a[188:191]
    ds_write_b128 v74, a[120:123] offset:2048
    v_mfma_f32_16x16x32_bf16 a[188:191], a[216:219], v[92:95], a[188:191]
    v_mfma_f32_16x16x32_bf16 a[48:51], a[240:243], v[128:131], a[48:51]
    ds_read_b64_tr_b16 a[236:237], v238 offset:13312
    ds_read_b64_tr_b16 a[238:239], v238 offset:19456
    v_mfma_f32_16x16x32_bf16 a[52:55], a[240:243], v[132:135], a[52:55]
    s_waitcnt lgkmcnt(12)
    v_mfma_f32_16x16x32_bf16 a[48:51], a[244:247], v[136:139], a[48:51]
    ds_read_b64_tr_b16 a[240:241], v238 offset:25600
    ds_read_b64_tr_b16 a[242:243], v238 offset:31744
    v_mfma_f32_16x16x32_bf16 a[52:55], a[244:247], v[140:143], a[52:55]
    s_waitcnt lgkmcnt(12)
    ds_write_b128 v74, a[124:127] offset:3072
    v_mfma_f32_16x16x32_bf16 a[48:51], a[248:251], v[160:163], a[48:51]
    ds_read_b64_tr_b16 a[244:245], v238 offset:37888
    ds_read_b64_tr_b16 a[246:247], v238 offset:44032
    v_mfma_f32_16x16x32_bf16 a[52:55], a[248:251], v[164:167], a[52:55]
    s_waitcnt lgkmcnt(13)
    v_mfma_f32_16x16x32_bf16 a[48:51], a[252:255], v[168:171], a[48:51]
    ds_read_b64_tr_b16 a[248:249], v5 offset:1024
    v_mfma_f32_16x16x32_bf16 a[52:55], a[252:255], v[172:175], a[52:55]
    s_waitcnt lgkmcnt(13)
    ds_write_b128 v74, a[184:187] offset:4096
    v_mfma_f32_16x16x32_bf16 a[48:51], a[228:231], v[184:187], a[48:51]
    ds_read_b64_tr_b16 a[252:253], v238 offset:2048
    ds_read_b64_tr_b16 a[254:255], v238 offset:8192
    v_mfma_f32_16x16x32_bf16 a[52:55], a[228:231], v[188:191], a[52:55]
    s_waitcnt lgkmcnt(14)
    v_mfma_f32_16x16x32_bf16 a[112:115], a[232:235], v[128:131], a[112:115]
    s_waitcnt vmcnt(2)
    ds_read_b64_tr_b16 a[228:229], v238 offset:14336
    ds_read_b64_tr_b16 a[230:231], v238 offset:20480
    buffer_store_dword v14, v15, s[48:51], 0 offen offset:768 sc1
    v_mfma_f32_16x16x32_bf16 a[116:119], a[232:235], v[132:135], a[116:119]
    s_waitcnt lgkmcnt(11)
    ds_write_b128 v74, a[188:191] offset:5120
    v_mfma_f32_16x16x32_bf16 a[112:115], a[236:239], v[136:139], a[112:115]
    ds_read_b64_tr_b16 a[232:233], v238 offset:26624
    ds_read_b64_tr_b16 a[234:235], v238 offset:32768
    v_mfma_f32_16x16x32_bf16 a[116:119], a[236:239], v[140:143], a[116:119]
    s_waitcnt lgkmcnt(12)
    v_mfma_f32_16x16x32_bf16 a[112:115], a[240:243], v[160:163], a[112:115]
    s_waitcnt lgkmcnt(2)
    s_barrier
    ds_read_b64_tr_b16 a[236:237], v238 offset:38912
    ds_read_b64_tr_b16 a[238:239], v238 offset:45056
    v_mfma_f32_16x16x32_bf16 a[116:119], a[240:243], v[164:167], a[116:119]
    ds_read_b128 v[16:19], v75
    ds_read_b128 v[20:23], v75 offset:1024
    v_mfma_f32_16x16x32_bf16 a[112:115], a[244:247], v[168:171], a[112:115]
    ds_read_b64_tr_b16 a[240:241], v5 offset:2048
    ds_read_b128 v[24:27], v75 offset:2048
    v_mfma_f32_16x16x32_bf16 a[116:119], a[244:247], v[172:175], a[116:119]
    ds_read_b128 v[28:31], v75 offset:3072
    ds_read_b128 v[32:35], v75 offset:4096
    v_mfma_f32_16x16x32_bf16 a[112:115], a[248:251], v[184:187], a[112:115]
    s_waitcnt vmcnt(1)
    v_cmp_ne_u32 vcc, v13, v78
    s_cbranch_vccz L_ok6
    s_mov_b32 s75, 131072
L_sp6:
    s_sleep 2
    buffer_load_dword v13, v77, s[48:51], 0 offen offset:640 sc1
    s_waitcnt vmcnt(0)
    v_cmp_ne_u32 vcc, v13, v78
    s_cbranch_vccz L_ok6
    s_sub_u32 s75, s75, 1
    s_cmp_lg_u32 s75, 0
    s_cbranch_scc1 L_sp6
L_ok6:
    ds_read_b128 v[36:39], v75 offset:5120
    v_mfma_f32_16x16x32_bf16 a[116:119], a[248:251], v[188:191], a[116:119]
    buffer_load_dwordx4 a[0:3], v1, s[48:51], s93 offen sc1
    v_mfma_f32_16x16x32_bf16 a[176:179], a[252:255], v[128:131], a[176:179]
    buffer_load_dwordx4 a[12:15], v1, s[48:51], s94 offen sc1
    v_mfma_f32_16x16x32_bf16 a[180:183], a[252:255], v[132:135], a[180:183]
    buffer_load_dwordx4 a[24:27], v1, s[48:51], s95 offen sc1
    v_mfma_f32_16x16x32_bf16 a[176:179], a[228:231], v[136:139], a[176:179]
    buffer_load_dwordx4 a[4:7], v1, s[48:51], s93 offen offset:1024 sc1
    v_mfma_f32_16x16x32_bf16 a[180:183], a[228:231], v[140:143], a[180:183]
    s_waitcnt lgkmcnt(9)
    buffer_load_dwordx4 a[16:19], v1, s[48:51], s94 offen offset:1024 sc1
    v_mfma_f32_16x16x32_bf16 a[176:179], a[232:235], v[160:163], a[176:179]
    buffer_load_dwordx4 a[28:31], v1, s[48:51], s95 offen offset:1024 sc1
    v_mfma_f32_16x16x32_bf16 a[180:183], a[232:235], v[164:167], a[180:183]
    s_waitcnt lgkmcnt(7)
    s_waitcnt lgkmcnt(6)
    v_mul_f32 v16, v16, v72
    v_mul_f32 v17, v17, v72
    v_mfma_f32_16x16x32_bf16 a[176:179], a[236:239], v[168:171], a[176:179]
    v_mul_f32 v18, v18, v72
    v_mul_f32 v19, v19, v72
    v_mfma_f32_16x16x32_bf16 a[180:183], a[236:239], v[172:175], a[180:183]
    s_waitcnt lgkmcnt(4)
    v_mul_f32 v20, v20, v73
    v_mul_f32 v21, v21, v73
    v_mfma_f32_16x16x32_bf16 a[176:179], a[240:243], v[184:187], a[176:179]
    v_mul_f32 v22, v22, v73
    v_mfma_f32_16x16x32_bf16 a[180:183], a[240:243], v[188:191], a[180:183]
    v_mul_f32 v23, v23, v73
    v_mfma_f32_16x16x32_bf16 a[48:51], a[192:195], v[80:83], a[48:51]
    buffer_load_dword v13, v77, s[48:51], 0 offen offset:768 sc1
    v_mfma_f32_16x16x32_bf16 a[48:51], a[196:199], v[96:99], a[48:51]
    s_waitcnt lgkmcnt(3)
    v_mul_f32 v24, v24, v72
    v_mfma_f32_16x16x32_bf16 a[48:51], a[200:203], v[112:115], a[48:51]
    v_mul_f32 v25, v25, v72
    v_mfma_f32_16x16x32_bf16 a[52:55], a[200:203], v[116:119], a[52:55]
    v_mul_f32 v26, v26, v72
    v_mfma_f32_16x16x32_bf16 a[52:55], a[196:199], v[100:103], a[52:55]
    v_mul_f32 v27, v27, v72
    v_mfma_f32_16x16x32_bf16 a[52:55], a[192:195], v[84:87], a[52:55]
    s_waitcnt lgkmcnt(2)
    v_mul_f32 v28, v28, v73
    v_mfma_f32_16x16x32_bf16 a[112:115], a[204:207], v[80:83], a[112:115]
    v_mul_f32 v29, v29, v73
    v_mfma_f32_16x16x32_bf16 a[112:115], a[208:211], v[96:99], a[112:115]
    v_mul_f32 v30, v30, v73
    v_mul_f32 v31, v31, v73
    v_mfma_f32_16x16x32_bf16 a[112:115], a[212:215], v[112:115], a[112:115]
    s_waitcnt lgkmcnt(1)
    v_mul_f32 v32, v32, v72
    v_mfma_f32_16x16x32_bf16 a[116:119], a[212:215], v[116:119], a[116:119]
    v_mul_f32 v33, v33, v72
    v_mfma_f32_16x16x32_bf16 a[116:119], a[208:211], v[100:103], a[116:119]
    v_mul_f32 v34, v34, v72
    v_mfma_f32_16x16x32_bf16 a[116:119], a[204:207], v[84:87], a[116:119]
    v_mul_f32 v35, v35, v72
    v_mfma_f32_16x16x32_bf16 a[176:179], a[216:219], v[80:83], a[176:179]
    s_waitcnt lgkmcnt(0)
    v_mul_f32 v36, v36, v73
    v_mfma_f32_16x16x32_bf16 a[176:179], a[220:223], v[96:99], a[176:179]
    v_mul_f32 v37, v37, v73
    v_mfma_f32_16x16x32_bf16 a[176:179], a[224:227], v[112:115], a[176:179]
    v_mul_f32 v38, v38, v73
    v_mfma_f32_16x16x32_bf16 a[180:183], a[224:227], v[116:119], a[180:183]
    v_mul_f32 v39, v39, v73
    v_mfma_f32_16x16x32_bf16 a[180:183], a[220:223], v[100:103], a[180:183]
    v_mfma_f32_16x16x32_bf16 a[180:183], a[216:219], v[84:87], a[180:183]
    s_waitcnt vmcnt(0)
    v_cmp_ne_u32 vcc, v13, v78
    s_cbranch_vccz L_ok7
    s_mov_b32 s75, 131072
L_sp7:
    s_sleep 2
    buffer_load_dword v13, v77, s[48:51], 0 offen offset:768 sc1
    s_waitcnt vmcnt(0)
    v_cmp_ne_u32 vcc, v13, v78
    s_cbranch_vccz L_ok7
    s_sub_u32 s75, s75, 1
    s_cmp_lg_u32 s75, 0
    s_cbranch_scc1 L_sp7
L_ok7:
    buffer_load_dwordx4 a[8:11], v1, s[48:51], s93 offen offset:2048 sc1
    buffer_load_dwordx4 a[20:23], v1, s[48:51], s94 offen offset:2048 sc1
    buffer_load_dwordx4 a[32:35], v1, s[48:51], s95 offen offset:2048 sc1
    v_mfma_f32_16x16x32_bf16 a[48:51], v[66:69], a[0:3], a[48:51]
    v_mfma_f32_16x16x32_bf16 a[52:55], v[64:67], a[0:3], a[52:55]
    v_mfma_f32_16x16x32_bf16 a[48:51], v[66:69], a[12:15], a[48:51]
    v_mfma_f32_16x16x32_bf16 a[52:55], v[64:67], a[12:15], a[52:55]
    v_mfma_f32_16x16x32_bf16 a[48:51], v[66:69], a[24:27], a[48:51]
    v_mfma_f32_16x16x32_bf16 a[52:55], v[64:67], a[24:27], a[52:55]
    v_mfma_f32_16x16x32_bf16 a[112:115], v[66:69], a[4:7], a[112:115]
    v_mfma_f32_16x16x32_bf16 a[116:119], v[64:67], a[4:7], a[116:119]
    v_mfma_f32_16x16x32_bf16 a[112:115], v[66:69], a[16:19], a[112:115]
    v_mfma_f32_16x16x32_bf16 a[116:119], v[64:67], a[16:19], a[116:119]
    v_mfma_f32_16x16x32_bf16 a[112:115], v[66:69], a[28:31], a[112:115]
    v_mfma_f32_16x16x32_bf16 a[116:119], v[64:67], a[28:31], a[116:119]
    s_nop 0
    v_accvgpr_read_b32 v200, a48
    v_accvgpr_read_b32 v201, a49
    v_accvgpr_read_b32 v202, a50
    v_accvgpr_read_b32 v203, a51
    v_accvgpr_read_b32 v204, a52
    v_accvgpr_read_b32 v205, a53
    v_accvgpr_read_b32 v206, a54
    v_accvgpr_read_b32 v207, a55
    v_fmac_f32 v16, v200, v72
    v_fmac_f32 v17, v201, v72
    v_fmac_f32 v18, v202, v72
    v_fmac_f32 v19, v203, v72
    v_fmac_f32 v20, v204, v73
    v_fmac_f32 v21, v205, v73
    v_fmac_f32 v22, v206, v73
    v_fmac_f32 v23, v207, v73
    v_cvt_pk_bf16_f32 v40, v16, v17
    v_cvt_pk_bf16_f32 v42, v20, v21
    v_cvt_pk_bf16_f32 v41, v18, v19
    v_cvt_pk_bf16_f32 v43, v22, v23
    v_permlane16_swap_b32 v40, v42
    s_nop 0
    v_permlane16_swap_b32 v41, v43
    buffer_store_dwordx4 v[40:43], v76, s[52:55], 0 offen sc1
    v_accvgpr_read_b32 v240, a112
    v_accvgpr_read_b32 v241, a113
    v_accvgpr_read_b32 v242, a114
    v_accvgpr_read_b32 v243, a115
    v_accvgpr_read_b32 v244, a116
    v_accvgpr_read_b32 v245, a117
    v_accvgpr_read_b32 v246, a118
    v_accvgpr_read_b32 v247, a119
    v_fmac_f32 v24, v240, v72
    v_fmac_f32 v25, v241, v72
    v_fmac_f32 v26, v242, v72
    v_fmac_f32 v27, v243, v72
    v_fmac_f32 v28, v244, v73
    v_fmac_f32 v29, v245, v73
    v_fmac_f32 v30, v246, v73
    v_fmac_f32 v31, v247, v73
    v_cvt_pk_bf16_f32 v44, v24, v25
    v_cvt_pk_bf16_f32 v46, v28, v29
    v_cvt_pk_bf16_f32 v45, v26, v27
    v_cvt_pk_bf16_f32 v47, v30, v31
    v_permlane16_swap_b32 v44, v46
    s_nop 0
    v_permlane16_swap_b32 v45, v47
    buffer_store_dwordx4 v[44:47], v76, s[52:55], 0 offen offset:128 sc1
    s_or_b32 s62, s58, s59
    s_or_b32 s62, s62, s57
    s_cmp_lg_u32 s62, 0
    s_cbranch_scc1 L_nobump
    v_min_u32 v249, 1, v0
    v_lshl_add_u32 v249, v249, 28, s74
    buffer_store_dword v14, v249, s[48:51], 0 offen sc1
L_nobump:
    s_waitcnt vmcnt(4)
    v_mfma_f32_16x16x32_bf16 a[176:179], v[66:69], a[8:11], a[176:179]
    v_mfma_f32_16x16x32_bf16 a[180:183], v[64:67], a[8:11], a[180:183]
    s_waitcnt vmcnt(3)
    v_mfma_f32_16x16x32_bf16 a[176:179], v[66:69], a[20:23], a[176:179]
    v_mfma_f32_16x16x32_bf16 a[180:183], v[64:67], a[20:23], a[180:183]
    s_waitcnt vmcnt(2)
    v_mfma_f32_16x16x32_bf16 a[176:179], v[66:69], a[32:35], a[176:179]
    v_mfma_f32_16x16x32_bf16 a[180:183], v[64:67], a[32:35], a[180:183]
    s_nop 6
    v_accvgpr_read_b32 v200, a176
    v_accvgpr_read_b32 v201, a177
    v_accvgpr_read_b32 v202, a178
    v_accvgpr_read_b32 v203, a179
    v_accvgpr_read_b32 v204, a180
    v_accvgpr_read_b32 v205, a181
    v_accvgpr_read_b32 v206, a182
    v_accvgpr_read_b32 v207, a183
    v_fmac_f32 v32, v200, v72
    v_fmac_f32 v33, v201, v72
    v_fmac_f32 v34, v202, v72
    v_fmac_f32 v35, v203, v72
    v_fmac_f32 v36, v204, v73
    v_fmac_f32 v37, v205, v73
    v_fmac_f32 v38, v206, v73
    v_fmac_f32 v39, v207, v73
    v_cvt_pk_bf16_f32 v48, v32, v33
    v_cvt_pk_bf16_f32 v50, v36, v37
    v_cvt_pk_bf16_f32 v49, v34, v35
    v_cvt_pk_bf16_f32 v51, v38, v39
    v_permlane16_swap_b32 v48, v50
    s_nop 0
    v_permlane16_swap_b32 v49, v51
    buffer_store_dwordx4 v[48:51], v76, s[52:55], 0 offen offset:256 sc1
    s_endpgm
.p2align 12
L_attn:
    v_lshrrev_b32 v250, 3, v0
    s_lshl_b32 s62, s56, 7
    s_lshl_b32 s63, s59, 5
    s_add_u32 s62, s62, s63
    v_add_u32 v250, s62, v250
    v_mul_u32_u24 v250, 0x480, v250
    v_lshrrev_b32 v251, 4, v0
    v_and_b32 v240, 7, v0
    v_xor_b32 v251, v251, v240
    v_lshl_add_u32 v240, v251, 4, v250
    v_xor_b32 v251, 4, v251
    v_lshl_add_u32 v241, v251, 4, v250
    v_add_u32 v241, 0x2400, v241
    s_lshl_b32 s64, s59, 12
    s_lshr_b32 s62, s59, 1
    s_mul_i32 s60, s62, 0x2400
    s_and_b32 s62, s59, 1
    s_lshl_b32 s62, s62, 12
    s_add_u32 s60, s60, s62
    s_lshr_b32 s62, s60, 4
    s_mul_i32 s68, s57, 0x120
    s_mul_i32 s96, s93, 0x6c0
    s_add_u32 s96, s96, s68
    s_mul_i32 s97, s94, 0x6c0
    s_add_u32 s97, s97, s68
    s_mul_i32 s98, s95, 0x6c0
    s_add_u32 s98, s98, s68
    v_add_u32 v250, s62, v0
    v_mul_u32_u24 v251, 0xe39, v250
    v_lshrrev_b32 v251, 16, v251
    v_mul_u32_u24 v252, 18, v251
    v_sub_u32 v250, v250, v252
    v_lshrrev_b32 v252, 1, v251
    v_xor_b32 v252, v252, v251
    v_and_b32 v252, 4, v252
    v_mul_u32_u24 v252, 3, v252
    v_xor_b32 v251, v251, v252
    v_mul_u32_u24 v251, 0xd80, v251
    v_lshl_add_u32 v4, v250, 4, v251
    s_add_u32 s62, s62, 64
    v_add_u32 v250, s62, v0
    v_mul_u32_u24 v251, 0xe39, v250
    v_lshrrev_b32 v251, 16, v251
    v_mul_u32_u24 v252, 18, v251
    v_sub_u32 v250, v250, v252
    v_lshrrev_b32 v252, 1, v251
    v_xor_b32 v252, v252, v251
    v_and_b32 v252, 4, v252
    v_mul_u32_u24 v252, 3, v252
    v_xor_b32 v251, v251, v252
    v_mul_u32_u24 v251, 0xd80, v251
    v_lshl_add_u32 v5, v250, 4, v251
    s_add_u32 s62, s62, 64
    v_subrev_u32 v5, 0x400, v5
    v_add_u32 v250, s62, v0
    v_mul_u32_u24 v251, 0xe39, v250
    v_lshrrev_b32 v251, 16, v251
    v_mul_u32_u24 v252, 18, v251
    v_sub_u32 v250, v250, v252
    v_lshrrev_b32 v252, 1, v251
    v_xor_b32 v252, v252, v251
    v_and_b32 v252, 4, v252
    v_mul_u32_u24 v252, 3, v252
    v_xor_b32 v251, v251, v252
    v_mul_u32_u24 v251, 0xd80, v251
    v_lshl_add_u32 v6, v250, 4, v251
    s_add_u32 s62, s62, 64
    v_subrev_u32 v6, 0x800, v6
    v_add_u32 v250, s62, v0
    v_mul_u32_u24 v251, 0xe39, v250
    v_lshrrev_b32 v251, 16, v251
    v_mul_u32_u24 v252, 18, v251
    v_sub_u32 v250, v250, v252
    v_lshrrev_b32 v252, 1, v251
    v_xor_b32 v252, v252, v251
    v_and_b32 v252, 4, v252
    v_mul_u32_u24 v252, 3, v252
    v_xor_b32 v251, v251, v252
    v_mul_u32_u24 v251, 0xd80, v251
    v_lshl_add_u32 v7, v250, 4, v251
    s_add_u32 s62, s62, 64
    v_subrev_u32 v7, 0xc00, v7
    v_add_u32 v250, s62, v0
    v_mul_u32_u24 v251, 0xe39, v250
    v_lshrrev_b32 v251, 16, v251
    v_mul_u32_u24 v252, 18, v251
    v_sub_u32 v250, v250, v252
    v_lshrrev_b32 v252, 1, v251
    v_xor_b32 v252, v252, v251
    v_and_b32 v252, 4, v252
    v_mul_u32_u24 v252, 3, v252
    v_xor_b32 v251, v251, v252
    v_mul_u32_u24 v251, 0xd80, v251
    v_lshl_add_u32 v8, v250, 4, v251
    s_add_u32 s62, s62, 64
    s_waitcnt lgkmcnt(0)
    s_mov_b32 s32, s8
    s_mov_b32 s33, s9
    s_mov_b32 s34, 0x240000
    s_mov_b32 s35, 0x20000
    s_add_u32 m0, s64, 0x1b000
    s_add_u32 s66, s93, 0
    buffer_load_dwordx4 v240, s[32:35], s66 offen lds
    s_add_u32 m0, s64, 0x1b400
    s_add_u32 s66, s93, 0
    buffer_load_dwordx4 v241, s[32:35], s66 offen lds
    s_add_u32 m0, s64, 0x1b800
    s_add_u32 s66, s93, 0x4800
    buffer_load_dwordx4 v240, s[32:35], s66 offen lds
    s_add_u32 m0, s64, 0x1bc00
    s_add_u32 s66, s93, 0x4800
    buffer_load_dwordx4 v241, s[32:35], s66 offen lds
    s_mov_b32 s36, s10
    s_mov_b32 s37, s11
    s_mov_b32 s38, 0x1e6000
    s_mov_b32 s39, 0x20000
    s_add_u32 m0, s60, 0
    s_add_u32 s66, s96, 0x480
    buffer_load_dwordx4 v4, s[36:39], s66 offen lds
    buffer_load_dwordx4 v5, s[36:39], s66 offen offset:1024 lds
    buffer_load_dwordx4 v6, s[36:39], s66 offen offset:2048 lds
    buffer_load_dwordx4 v7, s[36:39], s66 offen offset:3072 lds
    s_add_u32 m0, s60, 0x1000
    s_nop 0
    buffer_load_dwordx4 v8, s[36:39], s66 offen lds
    s_add_u32 m0, s64, 0x1f000
    s_add_u32 s66, s93, 0x80
    buffer_load_dwordx4 v240, s[32:35], s66 offen lds
    s_add_u32 m0, s64, 0x1f400
    s_add_u32 s66, s93, 0x80
    buffer_load_dwordx4 v241, s[32:35], s66 offen lds
    s_add_u32 m0, s64, 0x1f800
    s_add_u32 s66, s93, 0x4880
    buffer_load_dwordx4 v240, s[32:35], s66 offen lds
    s_add_u32 m0, s64, 0x1fc00
    s_add_u32 s66, s93, 0x4880
    buffer_load_dwordx4 v241, s[32:35], s66 offen lds
    s_lshl_b32 s74, s57, 7
    s_add_u32 s74, s74, 0x301e000
    s_load_dword s61, s[28:29], s74
    s_lshl_b32 s62, s56, 7
    s_add_u32 s62, s62, 0x301c000
    s_load_dword s79, s[28:29], s62
    v_bfe_u32 v250, v0, 2, 3
    v_lshrrev_b32 v251, 5, v0
    v_lshl_add_u32 v250, v251, 4, v250
    v_mul_u32_u24 v250, 0x120, v250
    v_and_b32 v251, 3, v0
    v_lshl_add_u32 v2, v251, 3, v250
    v_add_u32 v3, 0xd800, v2
    v_and_b32 v250, 15, v0
    v_lshlrev_b32 v250, 7, v250
    v_bfe_u32 v251, v0, 1, 3
    v_lshrrev_b32 v252, 4, v0
    v_xor_b32 v251, v251, v252
    v_lshl_add_u32 v250, v251, 4, v250
    s_add_u32 s62, s64, 0x1b000
    v_add_u32 v9, s62, v250
    v_xor_b32 v10, 64, v9
    v_lshlrev_b32 v1, 4, v0
    s_mov_b32 s48, s28
    s_mov_b32 s49, s29
    s_mov_b32 s50, 0x10000000
    s_mov_b32 s51, 0x20000
    s_mov_b32 s40, s12
    s_mov_b32 s41, s13
    s_mov_b32 s42, 0xa2000
    s_mov_b32 s43, 0x20000
    s_mov_b32 s44, s22
    s_mov_b32 s45, s23
    s_mov_b32 s46, 0x480
    s_mov_b32 s47, 0x20000
    s_mov_b32 s52, s24
    s_mov_b32 s53, s25
    s_mov_b32 s54, 0x240000
    s_mov_b32 s55, 0x20000
    s_and_b32 s62, s56, 7
    s_lshl_b32 s62, s62, 2
    s_add_u32 s70, s62, s59
    s_mul_i32 s63, s70, 43
    s_lshr_b32 s63, s63, 7
    s_mul_i32 s71, s63, 3
    s_sub_u32 s71, s70, s71
    s_mul_i32 s63, s63, 0x36000
    s_lshl_b32 s71, s71, 7
    s_add_u32 s78, s63, s71
    s_add_u32 s78, s78, s68
    v_mul_u32_u24 v239, 0xd80, v0
    s_lshl_b32 s70, s70, 13
    v_lshl_add_u32 v12, v0, 7, s70
    v_min_u32 v12, 0x28780, v12
    s_mul_i32 s69, s57, 0x28800
    v_mov_b32 v246, 0x3f803f80
    v_mov_b32 v247, 0x3f803f80
    v_mov_b32 v248, 0x3f803f80
    v_mov_b32 v249, 0x3f803f80
    s_mov_b32 s4, 0xffff
    s_mov_b32 s5, 0
    s_mov_b32 s6, -1
    s_mov_b32 s7, 0
    s_mov_b32 s82, -1
    s_mov_b32 s83, 0xffff
    s_mov_b32 s65, 0x358637bd
    s_add_u32 m0, s60, 0x4800
    s_add_u32 s66, s96, 0x36480
    buffer_load_dwordx4 v4, s[36:39], s66 offen lds
    buffer_load_dwordx4 v5, s[36:39], s66 offen offset:1024 lds
    buffer_load_dwordx4 v6, s[36:39], s66 offen offset:2048 lds
    buffer_load_dwordx4 v7, s[36:39], s66 offen offset:3072 lds
    s_add_u32 m0, s60, 0x5800
    s_nop 0
    buffer_load_dwordx4 v8, s[36:39], s66 offen lds
    s_waitcnt lgkmcnt(0)
    s_waitcnt vmcnt(14)
    ds_read_b128 a[0:3], v9
    ds_read_b128 a[4:7], v9 offset:2048
    ds_read_b128 a[8:11], v10
    ds_read_b128 a[12:15], v10 offset:2048
    s_waitcnt vmcnt(9)
    s_barrier
    ds_read_b64_tr_b16 a[144:145], v2
    ds_read_b64_tr_b16 a[146:147], v2 offset:2304
    ds_read_b64_tr_b16 a[148:149], v2 offset:9216
    ds_read_b64_tr_b16 a[150:151], v2 offset:11520
    ds_read_b64_tr_b16 a[152:153], v2 offset:32
    ds_read_b64_tr_b16 a[154:155], v2 offset:2336
    ds_read_b64_tr_b16 a[156:157], v2 offset:9248
    ds_read_b64_tr_b16 a[158:159], v2 offset:11552
    ds_read_b64_tr_b16 a[160:161], v2 offset:64
    ds_read_b64_tr_b16 a[162:163], v2 offset:2368
    ds_read_b64_tr_b16 a[164:165], v2 offset:9280
    ds_read_b64_tr_b16 a[166:167], v2 offset:11584
    s_waitcnt lgkmcnt(8)
    v_mfma_f32_16x16x32_bf16 v[16:19], a[0:3], a[144:147], 0
    s_add_u32 m0, s64, 0x23000
    ds_read_b64_tr_b16 a[168:169], v2 offset:96
    ds_read_b64_tr_b16 a[170:171], v2 offset:2400
    v_mfma_f32_16x16x32_bf16 v[16:19], a[8:11], a[148:151], v[16:19]
    s_add_u32 s66, s93, 0x100
    buffer_load_dwordx4 v240, s[32:35], s66 offen lds
    v_mfma_f32_16x16x32_bf16 v[20:23], a[12:15], a[148:151], 0
    ds_read_b64_tr_b16 a[172:173], v2 offset:9312
    ds_read_b64_tr_b16 a[174:175], v2 offset:11616
    v_mfma_f32_16x16x32_bf16 v[20:23], a[4:7], a[144:147], v[20:23]
    s_waitcnt lgkmcnt(8)
    v_mfma_f32_16x16x32_bf16 v[28:31], a[4:7], a[152:155], 0
    s_add_u32 m0, s64, 0x23400
    ds_read_b64_tr_b16 a[144:145], v2 offset:128
    ds_read_b64_tr_b16 a[146:147], v2 offset:2432
    v_mfma_f32_16x16x32_bf16 v[28:31], a[12:15], a[156:159], v[28:31]
    s_add_u32 s66, s93, 0x100
    buffer_load_dwordx4 v241, s[32:35], s66 offen lds
    v_mfma_f32_16x16x32_bf16 v[24:27], a[8:11], a[156:159], 0
    ds_read_b64_tr_b16 a[148:149], v2 offset:9344
    ds_read_b64_tr_b16 a[150:151], v2 offset:11648
    v_mfma_f32_16x16x32_bf16 v[24:27], a[0:3], a[152:155], v[24:27]
    s_waitcnt lgkmcnt(8)
    v_mfma_f32_16x16x32_bf16 v[32:35], a[0:3], a[160:163], 0
    s_add_u32 m0, s64, 0x23800
    ds_read_b64_tr_b16 a[152:153], v2 offset:160
    ds_read_b64_tr_b16 a[154:155], v2 offset:2464
    v_mfma_f32_16x16x32_bf16 v[32:35], a[8:11], a[164:167], v[32:35]
    s_add_u32 s66, s93, 0x4900
    buffer_load_dwordx4 v240, s[32:35], s66 offen lds
    v_mfma_f32_16x16x32_bf16 v[36:39], a[12:15], a[164:167], 0
    ds_read_b64_tr_b16 a[156:157], v2 offset:9376
    ds_read_b64_tr_b16 a[158:159], v2 offset:11680
    v_mfma_f32_16x16x32_bf16 v[36:39], a[4:7], a[160:163], v[36:39]
    s_waitcnt lgkmcnt(8)
    v_mfma_f32_16x16x32_bf16 v[44:47], a[4:7], a[168:171], 0
    s_add_u32 m0, s64, 0x23c00
    ds_read_b64_tr_b16 a[160:161], v2 offset:192
    ds_read_b64_tr_b16 a[162:163], v2 offset:2496
    v_mfma_f32_16x16x32_bf16 v[44:47], a[12:15], a[172:175], v[44:47]
    s_add_u32 s66, s93, 0x4900
    buffer_load_dwordx4 v241, s[32:35], s66 offen lds
    v_mfma_f32_16x16x32_bf16 v[40:43], a[8:11], a[172:175], 0
    ds_read_b64_tr_b16 a[164:165], v2 offset:9408
    ds_read_b64_tr_b16 a[166:167], v2 offset:11712
    v_mfma_f32_16x16x32_bf16 v[40:43], a[0:3], a[168:171], v[40:43]
    s_waitcnt lgkmcnt(8)
    v_mfma_f32_16x16x32_bf16 v[48:51], a[0:3], a[144:147], 0
    s_add_u32 m0, s60, 0x9000
    ds_read_b64_tr_b16 a[168:169], v2 offset:224
    ds_read_b64_tr_b16 a[170:171], v2 offset:2528
    v_mfma_f32_16x16x32_bf16 v[48:51], a[8:11], a[148:151], v[48:51]
    s_add_u32 s66, s96, 0x6c480
    buffer_load_dwordx4 v4, s[36:39], s66 offen lds
    v_mfma_f32_16x16x32_bf16 v[52:55], a[12:15], a[148:151], 0
    ds_read_b64_tr_b16 a[172:173], v2 offset:9440
    ds_read_b64_tr_b16 a[174:175], v2 offset:11744
    v_mfma_f32_16x16x32_bf16 v[52:55], a[4:7], a[144:147], v[52:55]
    s_waitcnt lgkmcnt(8)
    v_mfma_f32_16x16x32_bf16 v[60:63], a[4:7], a[152:155], 0
    ds_read_b64_tr_b16 a[144:145], v2 offset:256
    ds_read_b64_tr_b16 a[146:147], v2 offset:2560
    v_mfma_f32_16x16x32_bf16 v[60:63], a[12:15], a[156:159], v[60:63]
    buffer_load_dwordx4 v5, s[36:39], s66 offen offset:1024 lds
    v_mfma_f32_16x16x32_bf16 v[56:59], a[8:11], a[156:159], 0
    ds_read_b64_tr_b16 a[148:149], v2 offset:9472
    ds_read_b64_tr_b16 a[150:151], v2 offset:11776
    v_mfma_f32_16x16x32_bf16 v[56:59], a[0:3], a[152:155], v[56:59]
    s_mov_b64 exec, 0
    s_cmp_eq_u32 s59, 0
    s_cbranch_scc1 L_pad_a0
    s_cmp_eq_u32 s59, 1
    s_cbranch_scc1 L_pad_a1
    s_cmp_eq_u32 s59, 2
    s_cbranch_scc1 L_pad_a2
    s_branch L_pad_a3
L_padret_a:
    s_mov_b64 exec, -1
    s_waitcnt vmcnt(6) lgkmcnt(8)
    s_barrier
    v_mfma_f32_16x16x32_bf16 v[64:67], a[0:3], a[160:163], 0
    ds_read_b64_tr_b16 a[152:153], v2 offset:18432
    ds_read_b64_tr_b16 a[154:155], v2 offset:20736
    v_mfma_f32_16x16x32_bf16 v[64:67], a[8:11], a[164:167], v[64:67]
    buffer_load_dwordx4 v6, s[36:39], s66 offen offset:2048 lds
    v_mfma_f32_16x16x32_bf16 v[68:71], a[12:15], a[164:167], 0
    ds_read_b64_tr_b16 a[156:157], v2 offset:27648
    ds_read_b64_tr_b16 a[158:159], v2 offset:29952
    v_mfma_f32_16x16x32_bf16 v[68:71], a[4:7], a[160:163], v[68:71]
    s_waitcnt lgkmcnt(8)
    ds_read_b128 a[16:19], v9 offset:16384
    ds_read_b128 a[20:23], v9 offset:18432
    v_mfma_f32_16x16x32_bf16 v[76:79], a[4:7], a[168:171], 0
    ds_read_b64_tr_b16 a[160:161], v2 offset:18464
    ds_read_b64_tr_b16 a[162:163], v2 offset:20768
    v_mfma_f32_16x16x32_bf16 v[76:79], a[12:15], a[172:175], v[76:79]
    buffer_load_dwordx4 v7, s[36:39], s66 offen offset:3072 lds
    v_mfma_f32_16x16x32_bf16 v[72:75], a[8:11], a[172:175], 0
    ds_read_b64_tr_b16 a[164:165], v2 offset:27680
    ds_read_b64_tr_b16 a[166:167], v2 offset:29984
    v_mfma_f32_16x16x32_bf16 v[72:75], a[0:3], a[168:171], v[72:75]
    s_waitcnt lgkmcnt(10)
    ds_read_b128 a[24:27], v10 offset:16384
    ds_read_b128 a[28:31], v10 offset:18432
    v_mfma_f32_16x16x32_bf16 v[80:83], a[0:3], a[144:147], 0
    s_add_u32 m0, s60, 0xa000
    ds_read_b64_tr_b16 a[168:169], v2 offset:18496
    ds_read_b64_tr_b16 a[170:171], v2 offset:20800
    v_mfma_f32_16x16x32_bf16 v[80:83], a[8:11], a[148:151], v[80:83]
    buffer_load_dwordx4 v8, s[36:39], s66 offen lds
    v_mfma_f32_16x16x32_bf16 v[84:87], a[12:15], a[148:151], 0
    ds_read_b64_tr_b16 a[172:173], v2 offset:27712
    ds_read_b64_tr_b16 a[174:175], v2 offset:30016
    v_mfma_f32_16x16x32_bf16 v[84:87], a[4:7], a[144:147], v[84:87]
    s_waitcnt lgkmcnt(4)
    v_mfma_f32_16x16x32_bf16 v[20:23], a[20:23], a[152:155], v[20:23]
    s_add_u32 m0, s64, 0x1b000
    ds_read_b64_tr_b16 a[144:145], v2 offset:18528
    ds_read_b64_tr_b16 a[146:147], v2 offset:20832
    v_mfma_f32_16x16x32_bf16 v[20:23], a[28:31], a[156:159], v[20:23]
    s_add_u32 s66, s94, 0
    buffer_load_dwordx4 v240, s[32:35], s66 offen lds
    v_mfma_f32_16x16x32_bf16 v[16:19], a[24:27], a[156:159], v[16:19]
    ds_read_b64_tr_b16 a[148:149], v2 offset:27744
    ds_read_b64_tr_b16 a[150:151], v2 offset:30048
    v_mfma_f32_16x16x32_bf16 v[16:19], a[16:19], a[152:155], v[16:19]
    v_mfma_f32_16x16x32_bf16 v[24:27], a[16:19], a[160:163], v[24:27]
    s_add_u32 m0, s64, 0x1b400
    ds_read_b64_tr_b16 a[152:153], v2 offset:18560
    ds_read_b64_tr_b16 a[154:155], v2 offset:20864
    v_mfma_f32_16x16x32_bf16 v[24:27], a[24:27], a[164:167], v[24:27]
    s_add_u32 s66, s94, 0
    buffer_load_dwordx4 v241, s[32:35], s66 offen lds
    v_mfma_f32_16x16x32_bf16 v[28:31], a[28:31], a[164:167], v[28:31]
    ds_read_b64_tr_b16 a[156:157], v2 offset:27776
    ds_read_b64_tr_b16 a[158:159], v2 offset:30080
    v_mfma_f32_16x16x32_bf16 v[28:31], a[20:23], a[160:163], v[28:31]
    s_waitcnt lgkmcnt(8)
    v_mfma_f32_16x16x32_bf16 v[36:39], a[20:23], a[168:171], v[36:39]
    s_add_u32 m0, s64, 0x1b800
    ds_read_b64_tr_b16 a[160:161], v2 offset:18592
    ds_read_b64_tr_b16 a[162:163], v2 offset:20896
    v_mfma_f32_16x16x32_bf16 v[36:39], a[28:31], a[172:175], v[36:39]
    s_add_u32 s66, s94, 0x4800
    buffer_load_dwordx4 v240, s[32:35], s66 offen lds
    v_mfma_f32_16x16x32_bf16 v[32:35], a[24:27], a[172:175], v[32:35]
    ds_read_b64_tr_b16 a[164:165], v2 offset:27808
    ds_read_b64_tr_b16 a[166:167], v2 offset:30112
    v_mfma_f32_16x16x32_bf16 v[32:35], a[16:19], a[168:171], v[32:35]
    s_waitcnt lgkmcnt(8)
    v_mfma_f32_16x16x32_bf16 v[40:43], a[16:19], a[144:147], v[40:43]
    s_add_u32 m0, s64, 0x1bc00
    ds_read_b64_tr_b16 a[168:169], v2 offset:18624
    ds_read_b64_tr_b16 a[170:171], v2 offset:20928
    v_mfma_f32_16x16x32_bf16 v[40:43], a[24:27], a[148:151], v[40:43]
    s_add_u32 s66, s94, 0x4800
    buffer_load_dwordx4 v241, s[32:35], s66 offen lds
    v_mfma_f32_16x16x32_bf16 v[44:47], a[28:31], a[148:151], v[44:47]
    ds_read_b64_tr_b16 a[172:173], v2 offset:27840
    ds_read_b64_tr_b16 a[174:175], v2 offset:30144
    v_mfma_f32_16x16x32_bf16 v[44:47], a[20:23], a[144:147], v[44:47]
    s_waitcnt lgkmcnt(8)
    v_mfma_f32_16x16x32_bf16 v[52:55], a[20:23], a[152:155], v[52:55]
    s_add_u32 m0, s60, 0xd800
    ds_read_b64_tr_b16 a[144:145], v2 offset:18656
    ds_read_b64_tr_b16 a[146:147], v2 offset:20960
    v_mfma_f32_16x16x32_bf16 v[52:55], a[28:31], a[156:159], v[52:55]
    s_add_u32 s66, s97, 0x480
    buffer_load_dwordx4 v4, s[36:39], s66 offen lds
    v_mfma_f32_16x16x32_bf16 v[48:51], a[24:27], a[156:159], v[48:51]
    ds_read_b64_tr_b16 a[148:149], v2 offset:27872
    ds_read_b64_tr_b16 a[150:151], v2 offset:30176
    v_mfma_f32_16x16x32_bf16 v[48:51], a[16:19], a[152:155], v[48:51]
    s_waitcnt lgkmcnt(8)
    v_mfma_f32_16x16x32_bf16 v[56:59], a[16:19], a[160:163], v[56:59]
    ds_read_b64_tr_b16 a[152:153], v2 offset:18688
    ds_read_b64_tr_b16 a[154:155], v2 offset:20992
    v_mfma_f32_16x16x32_bf16 v[56:59], a[24:27], a[164:167], v[56:59]
    buffer_load_dwordx4 v5, s[36:39], s66 offen offset:1024 lds
    v_mfma_f32_16x16x32_bf16 v[60:63], a[28:31], a[164:167], v[60:63]
    ds_read_b64_tr_b16 a[156:157], v2 offset:27904
    ds_read_b64_tr_b16 a[158:159], v2 offset:30208
    v_mfma_f32_16x16x32_bf16 v[60:63], a[20:23], a[160:163], v[60:63]
    s_waitcnt vmcnt(6) lgkmcnt(8)
    s_barrier
    v_mfma_f32_16x16x32_bf16 v[68:71], a[20:23], a[168:171], v[68:71]
    ds_read_b64_tr_b16 a[160:161], v2 offset:36864
    ds_read_b64_tr_b16 a[162:163], v2 offset:39168
    v_mfma_f32_16x16x32_bf16 v[68:71], a[28:31], a[172:175], v[68:71]
    buffer_load_dwordx4 v6, s[36:39], s66 offen offset:2048 lds
    v_mfma_f32_16x16x32_bf16 v[64:67], a[24:27], a[172:175], v[64:67]
    ds_read_b64_tr_b16 a[164:165], v2 offset:46080
    ds_read_b64_tr_b16 a[166:167], v2 offset:48384
    v_mfma_f32_16x16x32_bf16 v[64:67], a[16:19], a[168:171], v[64:67]
    s_waitcnt lgkmcnt(8)
    ds_read_b128 a[32:35], v9 offset:32768
    ds_read_b128 a[36:39], v9 offset:34816
    v_mfma_f32_16x16x32_bf16 v[72:75], a[16:19], a[144:147], v[72:75]
    ds_read_b64_tr_b16 a[168:169], v2 offset:36896
    ds_read_b64_tr_b16 a[170:171], v2 offset:39200
    v_mfma_f32_16x16x32_bf16 v[72:75], a[24:27], a[148:151], v[72:75]
    buffer_load_dwordx4 v7, s[36:39], s66 offen offset:3072 lds
    v_mfma_f32_16x16x32_bf16 v[76:79], a[28:31], a[148:151], v[76:79]
    ds_read_b64_tr_b16 a[172:173], v2 offset:46112
    ds_read_b64_tr_b16 a[174:175], v2 offset:48416
    v_mfma_f32_16x16x32_bf16 v[76:79], a[20:23], a[144:147], v[76:79]
    s_waitcnt lgkmcnt(10)
    ds_read_b128 a[40:43], v10 offset:32768
    ds_read_b128 a[44:47], v10 offset:34816
    v_mfma_f32_16x16x32_bf16 v[84:87], a[20:23], a[152:155], v[84:87]
    s_add_u32 m0, s60, 0xe800
    ds_read_b64_tr_b16 a[144:145], v2 offset:36928
    ds_read_b64_tr_b16 a[146:147], v2 offset:39232
    v_mfma_f32_16x16x32_bf16 v[84:87], a[28:31], a[156:159], v[84:87]
    buffer_load_dwordx4 v8, s[36:39], s66 offen lds
    v_mfma_f32_16x16x32_bf16 v[80:83], a[24:27], a[156:159], v[80:83]
    ds_read_b64_tr_b16 a[148:149], v2 offset:46144
    ds_read_b64_tr_b16 a[150:151], v2 offset:48448
    v_mfma_f32_16x16x32_bf16 v[80:83], a[16:19], a[152:155], v[80:83]
    s_waitcnt lgkmcnt(4)
    v_mfma_f32_16x16x32_bf16 v[16:19], a[32:35], a[160:163], v[16:19]
    s_add_u32 m0, s64, 0x1f000
    ds_read_b64_tr_b16 a[152:153], v2 offset:36960
    ds_read_b64_tr_b16 a[154:155], v2 offset:39264
    v_mfma_f32_16x16x32_bf16 v[16:19], a[40:43], a[164:167], v[16:19]
    s_add_u32 s66, s94, 0x80
    buffer_load_dwordx4 v240, s[32:35], s66 offen lds
    v_mfma_f32_16x16x32_bf16 v[20:23], a[44:47], a[164:167], v[20:23]
    ds_read_b64_tr_b16 a[156:157], v2 offset:46176
    ds_read_b64_tr_b16 a[158:159], v2 offset:48480
    v_mfma_f32_16x16x32_bf16 v[20:23], a[36:39], a[160:163], v[20:23]
    s_mul_i32 s61, s61, 0x19660d
    s_add_u32 s61, s61, 0x3c6ef35f
    v_mfma_f32_16x16x32_bf16 v[28:31], a[36:39], a[168:171], v[28:31]
    s_add_u32 m0, s64, 0x1f400
    ds_read_b64_tr_b16 a[160:161], v2 offset:36992
    ds_read_b64_tr_b16 a[162:163], v2 offset:39296
    v_mfma_f32_16x16x32_bf16 v[28:31], a[44:47], a[172:175], v[28:31]
    s_add_u32 s66, s94, 0x80
    buffer_load_dwordx4 v241, s[32:35], s66 offen lds
    v_mfma_f32_16x16x32_bf16 v[24:27], a[40:43], a[172:175], v[24:27]
    ds_read_b64_tr_b16 a[164:165], v2 offset:46208
    ds_read_b64_tr_b16 a[166:167], v2 offset:48512
    v_mfma_f32_16x16x32_bf16 v[24:27], a[32:35], a[168:171], v[24:27]
    s_waitcnt lgkmcnt(8)
    v_mov_b32 v15, s61
    s_mul_i32 s79, s79, 0x19660d
    v_mfma_f32_16x16x32_bf16 v[32:35], a[32:35], a[144:147], v[32:35]
    s_add_u32 m0, s64, 0x1f800
    ds_read_b64_tr_b16 a[168:169], v2 offset:37024
    ds_read_b64_tr_b16 a[170:171], v2 offset:39328
    v_mfma_f32_16x16x32_bf16 v[32:35], a[40:43], a[148:151], v[32:35]
    s_add_u32 s66, s94, 0x4880
    buffer_load_dwordx4 v240, s[32:35], s66 offen lds
    v_mfma_f32_16x16x32_bf16 v[36:39], a[44:47], a[148:151], v[36:39]
    ds_read_b64_tr_b16 a[172:173], v2 offset:46240
    ds_read_b64_tr_b16 a[174:175], v2 offset:48544
    v_mfma_f32_16x16x32_bf16 v[36:39], a[36:39], a[144:147], v[36:39]
    s_waitcnt lgkmcnt(8)
    s_add_u32 s79, s79, 0x3c6ef35f
    v_mov_b32 v176, 0
    v_mfma_f32_16x16x32_bf16 v[44:47], a[36:39], a[152:155], v[44:47]
    s_add_u32 m0, s64, 0x1fc00
    ds_read_b64_tr_b16 a[144:145], v2 offset:37056
    ds_read_b64_tr_b16 a[146:147], v2 offset:39360
    v_mfma_f32_16x16x32_bf16 v[44:47], a[44:47], a[156:159], v[44:47]
    s_add_u32 s66, s94, 0x4880
    buffer_load_dwordx4 v241, s[32:35], s66 offen lds
    v_mfma_f32_16x16x32_bf16 v[40:43], a[40:43], a[156:159], v[40:43]
    ds_read_b64_tr_b16 a[148:149], v2 offset:46272
    ds_read_b64_tr_b16 a[150:151], v2 offset:48576
    v_mfma_f32_16x16x32_bf16 v[40:43], a[32:35], a[152:155], v[40:43]
    s_waitcnt lgkmcnt(8)
    v_mov_b32 v177, 0
    v_mfma_f32_16x16x32_bf16 v[48:51], a[32:35], a[160:163], v[48:51]
    s_add_u32 m0, s60, 0x12000
    ds_read_b64_tr_b16 a[152:153], v2 offset:37088
    ds_read_b64_tr_b16 a[154:155], v2 offset:39392
    v_mfma_f32_16x16x32_bf16 v[48:51], a[40:43], a[164:167], v[48:51]
    s_add_u32 s66, s97, 0x36480
    buffer_load_dwordx4 v4, s[36:39], s66 offen lds
    v_mfma_f32_16x16x32_bf16 v[52:55], a[44:47], a[164:167], v[52:55]
    ds_read_b64_tr_b16 a[156:157], v2 offset:46304
    ds_read_b64_tr_b16 a[158:159], v2 offset:48608
    v_mfma_f32_16x16x32_bf16 v[52:55], a[36:39], a[160:163], v[52:55]
    s_waitcnt lgkmcnt(8)
    s_lshl_b32 s62, s57, 4
    v_mfma_f32_16x16x32_bf16 v[60:63], a[36:39], a[168:171], v[60:63]
    ds_read_b64_tr_b16 a[160:161], v2 offset:37120
    ds_read_b64_tr_b16 a[162:163], v2 offset:39424
    v_mfma_f32_16x16x32_bf16 v[60:63], a[44:47], a[172:175], v[60:63]
    buffer_load_dwordx4 v5, s[36:39], s66 offen offset:1024 lds
    v_mfma_f32_16x16x32_bf16 v[56:59], a[40:43], a[172:175], v[56:59]
    ds_read_b64_tr_b16 a[164:165], v2 offset:46336
    ds_read_b64_tr_b16 a[166:167], v2 offset:48640
    v_mfma_f32_16x16x32_bf16 v[56:59], a[32:35], a[168:171], v[56:59]
    s_waitcnt vmcnt(6) lgkmcnt(8)
    s_barrier
    s_add_u32 s62, s62, s56
    v_mfma_f32_16x16x32_bf16 v[64:67], a[32:35], a[144:147], v[64:67]
    ds_read_b64_tr_b16 a[168:169], v3
    ds_read_b64_tr_b16 a[170:171], v3 offset:2304
    v_mfma_f32_16x16x32_bf16 v[64:67], a[40:43], a[148:151], v[64:67]
    buffer_load_dwordx4 v6, s[36:39], s66 offen offset:2048 lds
    v_mfma_f32_16x16x32_bf16 v[68:71], a[44:47], a[148:151], v[68:71]
    ds_read_b64_tr_b16 a[172:173], v3 offset:9216
    ds_read_b64_tr_b16 a[174:175], v3 offset:11520
    v_mfma_f32_16x16x32_bf16 v[68:71], a[36:39], a[144:147], v[68:71]
    s_waitcnt lgkmcnt(8)
    ds_read_b128 a[48:51], v9
    ds_read_b128 a[52:55], v9 offset:2048
    v_mfma_f32_16x16x32_bf16 v[76:79], a[36:39], a[152:155], v[76:79]
    ds_read_b64_tr_b16 a[144:145], v3 offset:32
    ds_read_b64_tr_b16 a[146:147], v3 offset:2336
    v_mfma_f32_16x16x32_bf16 v[76:79], a[44:47], a[156:159], v[76:79]
    buffer_load_dwordx4 v7, s[36:39], s66 offen offset:3072 lds
    v_mfma_f32_16x16x32_bf16 v[72:75], a[40:43], a[156:159], v[72:75]
    ds_read_b64_tr_b16 a[148:149], v3 offset:9248
    ds_read_b64_tr_b16 a[150:151], v3 offset:11552
    v_mfma_f32_16x16x32_bf16 v[72:75], a[32:35], a[152:155], v[72:75]
    s_waitcnt lgkmcnt(10)
    ds_read_b128 a[56:59], v10
    ds_read_b128 a[60:63], v10 offset:2048
    v_mfma_f32_16x16x32_bf16 v[80:83], a[32:35], a[160:163], v[80:83]
    s_add_u32 m0, s60, 0x13000
    ds_read_b64_tr_b16 a[152:153], v3 offset:64
    ds_read_b64_tr_b16 a[154:155], v3 offset:2368
    v_mfma_f32_16x16x32_bf16 v[80:83], a[40:43], a[164:167], v[80:83]
    buffer_load_dwordx4 v8, s[36:39], s66 offen lds
    v_mfma_f32_16x16x32_bf16 v[84:87], a[44:47], a[164:167], v[84:87]
    ds_read_b64_tr_b16 a[156:157], v3 offset:9280
    ds_read_b64_tr_b16 a[158:159], v3 offset:11584
    v_mfma_f32_16x16x32_bf16 v[84:87], a[36:39], a[160:163], v[84:87]
    s_waitcnt lgkmcnt(4)
    s_lshl_b32 s62, s62, 8
    v_mfma_f32_16x16x32_bf16 v[20:23], a[52:55], a[168:171], v[20:23]
    s_add_u32 m0, s64, 0x23000
    ds_read_b64_tr_b16 a[160:161], v3 offset:96
    ds_read_b64_tr_b16 a[162:163], v3 offset:2400
    v_mfma_f32_16x16x32_bf16 v[20:23], a[60:63], a[172:175], v[20:23]
    s_add_u32 s66, s94, 0x100
    buffer_load_dwordx4 v240, s[32:35], s66 offen lds
    v_mfma_f32_16x16x32_bf16 v[16:19], a[56:59], a[172:175], v[16:19]
    ds_read_b64_tr_b16 a[164:165], v3 offset:9312
    ds_read_b64_tr_b16 a[166:167], v3 offset:11616
    v_mfma_f32_16x16x32_bf16 v[16:19], a[48:51], a[168:171], v[16:19]
    s_lshl_b32 s63, s59, 28
    v_mfma_f32_16x16x32_bf16 v[24:27], a[48:51], a[144:147], v[24:27]
    s_add_u32 m0, s64, 0x23400
    ds_read_b64_tr_b16 a[168:169], v3 offset:128
    ds_read_b64_tr_b16 a[170:171], v3 offset:2432
    v_mfma_f32_16x16x32_bf16 v[24:27], a[56:59], a[148:151], v[24:27]
    s_add_u32 s66, s94, 0x100
    buffer_load_dwordx4 v241, s[32:35], s66 offen lds
    v_mfma_f32_16x16x32_bf16 v[28:31], a[60:63], a[148:151], v[28:31]
    ds_read_b64_tr_b16 a[172:173], v3 offset:9344
    ds_read_b64_tr_b16 a[174:175], v3 offset:11648
    v_mfma_f32_16x16x32_bf16 v[28:31], a[52:55], a[144:147], v[28:31]
    s_waitcnt lgkmcnt(8)
    s_add_u32 s62, s62, s63
    v_mfma_f32_16x16x32_bf16 v[36:39], a[52:55], a[152:155], v[36:39]
    s_add_u32 m0, s64, 0x23800
L_pad_a0:
    s_cbranch_execz L_pad_a4
    ds_read_b64_tr_b16 a[144:145], v3 offset:160
    ds_read_b64_tr_b16 a[146:147], v3 offset:2464
    v_mfma_f32_16x16x32_bf16 v[36:39], a[60:63], a[156:159], v[36:39]
    s_add_u32 s66, s94, 0x4900
    buffer_load_dwordx4 v240, s[32:35], s66 offen lds
    v_mfma_f32_16x16x32_bf16 v[32:35], a[56:59], a[156:159], v[32:35]
    ds_read_b64_tr_b16 a[148:149], v3 offset:9376
    ds_read_b64_tr_b16 a[150:151], v3 offset:11680
    v_mfma_f32_16x16x32_bf16 v[32:35], a[48:51], a[152:155], v[32:35]
    s_waitcnt lgkmcnt(8)
    s_add_u32 s62, s62, 0x3010000
    v_mfma_f32_16x16x32_bf16 v[40:43], a[48:51], a[160:163], v[40:43]
    s_add_u32 m0, s64, 0x23c00
    ds_read_b64_tr_b16 a[152:153], v3 offset:192
    ds_read_b64_tr_b16 a[154:155], v3 offset:2496
    v_mfma_f32_16x16x32_bf16 v[40:43], a[56:59], a[164:167], v[40:43]
    s_add_u32 s66, s94, 0x4900
    buffer_load_dwordx4 v241, s[32:35], s66 offen lds
    v_mfma_f32_16x16x32_bf16 v[44:47], a[60:63], a[164:167], v[44:47]
    ds_read_b64_tr_b16 a[156:157], v3 offset:9408
    ds_read_b64_tr_b16 a[158:159], v3 offset:11712
    v_mfma_f32_16x16x32_bf16 v[44:47], a[52:55], a[160:163], v[44:47]
    s_waitcnt lgkmcnt(8)
    v_lshlrev_b32 v251, 2, v0
    v_mfma_f32_16x16x32_bf16 v[52:55], a[52:55], a[168:171], v[52:55]
    s_add_u32 m0, s60, 0x16800
    ds_read_b64_tr_b16 a[160:161], v3 offset:224
    ds_read_b64_tr_b16 a[162:163], v3 offset:2528
    v_mfma_f32_16x16x32_bf16 v[52:55], a[60:63], a[172:175], v[52:55]
    s_add_u32 s66, s97, 0x6c480
    buffer_load_dwordx4 v4, s[36:39], s66 offen lds
    v_mfma_f32_16x16x32_bf16 v[48:51], a[56:59], a[172:175], v[48:51]
    ds_read_b64_tr_b16 a[164:165], v3 offset:9440
    ds_read_b64_tr_b16 a[166:167], v3 offset:11744
    v_mfma_f32_16x16x32_bf16 v[48:51], a[48:51], a[168:171], v[48:51]
    s_waitcnt lgkmcnt(8)
    buffer_store_dword v176, v251, s[48:51], s62 offen sc1
    v_mfma_f32_16x16x32_bf16 v[56:59], a[48:51], a[144:147], v[56:59]
    ds_read_b64_tr_b16 a[168:169], v3 offset:256
    ds_read_b64_tr_b16 a[170:171], v3 offset:2560
    v_mfma_f32_16x16x32_bf16 v[56:59], a[56:59], a[148:151], v[56:59]
    buffer_load_dwordx4 v5, s[36:39], s66 offen offset:1024 lds
    v_mfma_f32_16x16x32_bf16 v[60:63], a[60:63], a[148:151], v[60:63]
    ds_read_b64_tr_b16 a[172:173], v3 offset:9472
    ds_read_b64_tr_b16 a[174:175], v3 offset:11776
    v_mfma_f32_16x16x32_bf16 v[60:63], a[52:55], a[144:147], v[60:63]
    s_waitcnt vmcnt(7) lgkmcnt(8)
    s_barrier
    v_mfma_f32_16x16x32_bf16 v[68:71], a[52:55], a[152:155], v[68:71]
    ds_read_b64_tr_b16 a[144:145], v3 offset:18432
    ds_read_b64_tr_b16 a[146:147], v3 offset:20736
    v_mfma_f32_16x16x32_bf16 v[68:71], a[60:63], a[156:159], v[68:71]
    buffer_load_dwordx4 v6, s[36:39], s66 offen offset:2048 lds
    v_mfma_f32_16x16x32_bf16 v[64:67], a[56:59], a[156:159], v[64:67]
    ds_read_b64_tr_b16 a[148:149], v3 offset:27648
    ds_read_b64_tr_b16 a[150:151], v3 offset:29952
    v_mfma_f32_16x16x32_bf16 v[64:67], a[48:51], a[152:155], v[64:67]
    s_waitcnt lgkmcnt(8)
    ds_read_b128 a[64:67], v9 offset:16384
    ds_read_b128 a[68:71], v9 offset:18432
    v_mfma_f32_16x16x32_bf16 v[72:75], a[48:51], a[160:163], v[72:75]
    ds_read_b64_tr_b16 a[152:153], v3 offset:18464
    ds_read_b64_tr_b16 a[154:155], v3 offset:20768
    v_mfma_f32_16x16x32_bf16 v[72:75], a[56:59], a[164:167], v[72:75]
    buffer_load_dwordx4 v7, s[36:39], s66 offen offset:3072 lds
    v_mfma_f32_16x16x32_bf16 v[76:79], a[60:63], a[164:167], v[76:79]
    ds_read_b64_tr_b16 a[156:157], v3 offset:27680
    ds_read_b64_tr_b16 a[158:159], v3 offset:29984
    v_mfma_f32_16x16x32_bf16 v[76:79], a[52:55], a[160:163], v[76:79]
    s_waitcnt lgkmcnt(10)
    ds_read_b128 a[72:75], v10 offset:16384
    ds_read_b128 a[76:79], v10 offset:18432
    v_mfma_f32_16x16x32_bf16 v[84:87], a[52:55], a[168:171], v[84:87]
    s_add_u32 m0, s60, 0x17800
    ds_read_b64_tr_b16 a[160:161], v3 offset:18496
    ds_read_b64_tr_b16 a[162:163], v3 offset:20800
    v_mfma_f32_16x16x32_bf16 v[84:87], a[60:63], a[172:175], v[84:87]
    buffer_load_dwordx4 v8, s[36:39], s66 offen lds
    v_mfma_f32_16x16x32_bf16 v[80:83], a[56:59], a[172:175], v[80:83]
    ds_read_b64_tr_b16 a[164:165], v3 offset:27712
    ds_read_b64_tr_b16 a[166:167], v3 offset:30016
    v_mfma_f32_16x16x32_bf16 v[80:83], a[48:51], a[168:171], v[80:83]
    s_waitcnt lgkmcnt(4)
    v_mfma_f32_16x16x32_bf16 v[16:19], a[64:67], a[144:147], v[16:19]
    s_add_u32 m0, s64, 0x1b000
    ds_read_b64_tr_b16 a[168:169], v3 offset:18528
    ds_read_b64_tr_b16 a[170:171], v3 offset:20832
    v_mfma_f32_16x16x32_bf16 v[16:19], a[72:75], a[148:151], v[16:19]
    s_add_u32 s66, s95, 0
    buffer_load_dwordx4 v240, s[32:35], s66 offen lds
    v_mfma_f32_16x16x32_bf16 v[20:23], a[76:79], a[148:151], v[20:23]
    ds_read_b64_tr_b16 a[172:173], v3 offset:27744
    ds_read_b64_tr_b16 a[174:175], v3 offset:30048
    v_mfma_f32_16x16x32_bf16 v[20:23], a[68:71], a[144:147], v[20:23]
    s_lshl_b32 s62, s56, 2
    v_mfma_f32_16x16x32_bf16 v[28:31], a[68:71], a[152:155], v[28:31]
    s_add_u32 m0, s64, 0x1b400
    ds_read_b64_tr_b16 a[144:145], v3 offset:18560
    ds_read_b64_tr_b16 a[146:147], v3 offset:20864
    v_mfma_f32_16x16x32_bf16 v[28:31], a[76:79], a[156:159], v[28:31]
    s_add_u32 s66, s95, 0
    buffer_load_dwordx4 v241, s[32:35], s66 offen lds
    v_mfma_f32_16x16x32_bf16 v[24:27], a[72:75], a[156:159], v[24:27]
    ds_read_b64_tr_b16 a[148:149], v3 offset:27776
    ds_read_b64_tr_b16 a[150:151], v3 offset:30080
    v_mfma_f32_16x16x32_bf16 v[24:27], a[64:67], a[152:155], v[24:27]
    s_waitcnt lgkmcnt(8)
    s_add_u32 s62, s62, s57
    v_mfma_f32_16x16x32_bf16 v[32:35], a[64:67], a[160:163], v[32:35]
    s_add_u32 m0, s64, 0x1b800
    ds_read_b64_tr_b16 a[152:153], v3 offset:18592
    ds_read_b64_tr_b16 a[154:155], v3 offset:20896
    v_mfma_f32_16x16x32_bf16 v[32:35], a[72:75], a[164:167], v[32:35]
    s_add_u32 s66, s95, 0x4800
    buffer_load_dwordx4 v240, s[32:35], s66 offen lds
    v_mfma_f32_16x16x32_bf16 v[36:39], a[76:79], a[164:167], v[36:39]
    ds_read_b64_tr_b16 a[156:157], v3 offset:27808
    ds_read_b64_tr_b16 a[158:159], v3 offset:30112
    v_mfma_f32_16x16x32_bf16 v[36:39], a[68:71], a[160:163], v[36:39]
    s_waitcnt lgkmcnt(8)
    s_lshl_b32 s62, s62, 9
    v_mfma_f32_16x16x32_bf16 v[44:47], a[68:71], a[168:171], v[44:47]
    s_add_u32 m0, s64, 0x1bc00
    ds_read_b64_tr_b16 a[160:161], v3 offset:18624
    ds_read_b64_tr_b16 a[162:163], v3 offset:20928
    v_mfma_f32_16x16x32_bf16 v[44:47], a[76:79], a[172:175], v[44:47]
    s_add_u32 s66, s95, 0x4800
    buffer_load_dwordx4 v241, s[32:35], s66 offen lds
    v_mfma_f32_16x16x32_bf16 v[40:43], a[72:75], a[172:175], v[40:43]
    ds_read_b64_tr_b16 a[164:165], v3 offset:27840
    ds_read_b64_tr_b16 a[166:167], v3 offset:30144
    v_mfma_f32_16x16x32_bf16 v[40:43], a[64:67], a[168:171], v[40:43]
    s_waitcnt lgkmcnt(8)
    s_add_u32 s62, s62, s63
    v_mfma_f32_16x16x32_bf16 v[48:51], a[64:67], a[144:147], v[48:51]
    s_add_u32 m0, s60, 0
    ds_read_b64_tr_b16 a[168:169], v3 offset:18656
    ds_read_b64_tr_b16 a[170:171], v3 offset:20960
    v_mfma_f32_16x16x32_bf16 v[48:51], a[72:75], a[148:151], v[48:51]
    s_add_u32 s66, s98, 0x480
    buffer_load_dwordx4 v4, s[36:39], s66 offen lds
    v_mfma_f32_16x16x32_bf16 v[52:55], a[76:79], a[148:151], v[52:55]
    ds_read_b64_tr_b16 a[172:173], v3 offset:27872
    ds_read_b64_tr_b16 a[174:175], v3 offset:30176
    v_mfma_f32_16x16x32_bf16 v[52:55], a[68:71], a[144:147], v[52:55]
    s_waitcnt lgkmcnt(8)
    s_add_u32 s62, s62, 0x3014000
    v_lshlrev_b32 v251, 3, v0
    v_mfma_f32_16x16x32_bf16 v[60:63], a[68:71], a[152:155], v[60:63]
    ds_read_b64_tr_b16 a[144:145], v3 offset:18688
    ds_read_b64_tr_b16 a[146:147], v3 offset:20992
    v_mfma_f32_16x16x32_bf16 v[60:63], a[76:79], a[156:159], v[60:63]
    buffer_load_dwordx4 v5, s[36:39], s66 offen offset:1024 lds
    v_mfma_f32_16x16x32_bf16 v[56:59], a[72:75], a[156:159], v[56:59]
    ds_read_b64_tr_b16 a[148:149], v3 offset:27904
    ds_read_b64_tr_b16 a[150:151], v3 offset:30208
    v_mfma_f32_16x16x32_bf16 v[56:59], a[64:67], a[152:155], v[56:59]
    s_waitcnt vmcnt(6) lgkmcnt(8)
    s_barrier
    v_mfma_f32_16x16x32_bf16 v[64:67], a[64:67], a[160:163], v[64:67]
    ds_read_b64_tr_b16 a[152:153], v3 offset:36864
    ds_read_b64_tr_b16 a[154:155], v3 offset:39168
    v_mfma_f32_16x16x32_bf16 v[64:67], a[72:75], a[164:167], v[64:67]
    buffer_load_dwordx4 v6, s[36:39], s66 offen offset:2048 lds
    v_mfma_f32_16x16x32_bf16 v[68:71], a[76:79], a[164:167], v[68:71]
    ds_read_b64_tr_b16 a[156:157], v3 offset:46080
    ds_read_b64_tr_b16 a[158:159], v3 offset:48384
    v_mfma_f32_16x16x32_bf16 v[68:71], a[68:71], a[160:163], v[68:71]
    s_waitcnt lgkmcnt(8)
    ds_read_b128 a[80:83], v9 offset:32768
    ds_read_b128 a[84:87], v9 offset:34816
    v_mfma_f32_16x16x32_bf16 v[76:79], a[68:71], a[168:171], v[76:79]
    ds_read_b64_tr_b16 a[160:161], v3 offset:36896
    ds_read_b64_tr_b16 a[162:163], v3 offset:39200
    v_mfma_f32_16x16x32_bf16 v[76:79], a[76:79], a[172:175], v[76:79]
    buffer_load_dwordx4 v7, s[36:39], s66 offen offset:3072 lds
    v_mfma_f32_16x16x32_bf16 v[72:75], a[72:75], a[172:175], v[72:75]
    ds_read_b64_tr_b16 a[164:165], v3 offset:46112
    ds_read_b64_tr_b16 a[166:167], v3 offset:48416
    v_mfma_f32_16x16x32_bf16 v[72:75], a[64:67], a[168:171], v[72:75]
    s_waitcnt lgkmcnt(10)
    ds_read_b128 a[88:91], v10 offset:32768
    ds_read_b128 a[92:95], v10 offset:34816
    v_mfma_f32_16x16x32_bf16 v[80:83], a[64:67], a[144:147], v[80:83]
    s_add_u32 m0, s60, 0x1000
    ds_read_b64_tr_b16 a[168:169], v3 offset:36928
    ds_read_b64_tr_b16 a[170:171], v3 offset:39232
    v_mfma_f32_16x16x32_bf16 v[80:83], a[72:75], a[148:151], v[80:83]
    buffer_load_dwordx4 v8, s[36:39], s66 offen lds
    v_mfma_f32_16x16x32_bf16 v[84:87], a[76:79], a[148:151], v[84:87]
    ds_read_b64_tr_b16 a[172:173], v3 offset:46144
    ds_read_b64_tr_b16 a[174:175], v3 offset:48448
    v_mfma_f32_16x16x32_bf16 v[84:87], a[68:71], a[144:147], v[84:87]
    s_waitcnt lgkmcnt(4)
    buffer_store_dwordx2 v[176:177], v251, s[48:51], s62 offen sc1
    v_mfma_f32_16x16x32_bf16 v[20:23], a[84:87], a[152:155], v[20:23]
    s_add_u32 m0, s64, 0x1f000
    ds_read_b64_tr_b16 a[144:145], v3 offset:36960
    ds_read_b64_tr_b16 a[146:147], v3 offset:39264
    v_mfma_f32_16x16x32_bf16 v[20:23], a[92:95], a[156:159], v[20:23]
    s_add_u32 s66, s95, 0x80
    buffer_load_dwordx4 v240, s[32:35], s66 offen lds
    v_mfma_f32_16x16x32_bf16 v[16:19], a[88:91], a[156:159], v[16:19]
    ds_read_b64_tr_b16 a[148:149], v3 offset:46176
    ds_read_b64_tr_b16 a[150:151], v3 offset:48480
    v_mfma_f32_16x16x32_bf16 v[16:19], a[80:83], a[152:155], v[16:19]
    v_mfma_f32_16x16x32_bf16 v[24:27], a[80:83], a[160:163], v[24:27]
    s_add_u32 m0, s64, 0x1f400
    ds_read_b64_tr_b16 a[152:153], v3 offset:36992
    ds_read_b64_tr_b16 a[154:155], v3 offset:39296
    v_mfma_f32_16x16x32_bf16 v[24:27], a[88:91], a[164:167], v[24:27]
    s_add_u32 s66, s95, 0x80
    buffer_load_dwordx4 v241, s[32:35], s66 offen lds
    v_mfma_f32_16x16x32_bf16 v[28:31], a[92:95], a[164:167], v[28:31]
    ds_read_b64_tr_b16 a[156:157], v3 offset:46208
    ds_read_b64_tr_b16 a[158:159], v3 offset:48512
    v_mfma_f32_16x16x32_bf16 v[28:31], a[84:87], a[160:163], v[28:31]
    s_waitcnt lgkmcnt(8)
    v_mfma_f32_16x16x32_bf16 v[36:39], a[84:87], a[168:171], v[36:39]
    s_add_u32 m0, s64, 0x1f800
    ds_read_b64_tr_b16 a[160:161], v3 offset:37024
    ds_read_b64_tr_b16 a[162:163], v3 offset:39328
    v_mfma_f32_16x16x32_bf16 v[36:39], a[92:95], a[172:175], v[36:39]
    s_add_u32 s66, s95, 0x4880
    buffer_load_dwordx4 v240, s[32:35], s66 offen lds
    v_mfma_f32_16x16x32_bf16 v[32:35], a[88:91], a[172:175], v[32:35]
    ds_read_b64_tr_b16 a[164:165], v3 offset:46240
    ds_read_b64_tr_b16 a[166:167], v3 offset:48544
    v_mfma_f32_16x16x32_bf16 v[32:35], a[80:83], a[168:171], v[32:35]
    s_waitcnt lgkmcnt(8)
    s_lshl_b32 s62, s59, 10
    s_add_u32 s62, s62, 0x12000
    v_mfma_f32_16x16x32_bf16 v[40:43], a[80:83], a[144:147], v[40:43]
    s_add_u32 m0, s64, 0x1fc00
    ds_read_b64_tr_b16 a[168:169], v3 offset:37056
    ds_read_b64_tr_b16 a[170:171], v3 offset:39360
    v_mfma_f32_16x16x32_bf16 v[40:43], a[88:91], a[148:151], v[40:43]
    s_add_u32 s66, s95, 0x4880
    buffer_load_dwordx4 v241, s[32:35], s66 offen lds
    v_mfma_f32_16x16x32_bf16 v[44:47], a[92:95], a[148:151], v[44:47]
    ds_read_b64_tr_b16 a[172:173], v3 offset:46272
    ds_read_b64_tr_b16 a[174:175], v3 offset:48576
    v_mfma_f32_16x16x32_bf16 v[44:47], a[84:87], a[144:147], v[44:47]
    s_waitcnt lgkmcnt(8)
    v_add_u32 v11, s62, v1
    v_mfma_f32_16x16x32_bf16 v[52:55], a[84:87], a[152:155], v[52:55]
    s_add_u32 m0, s60, 0x4800
    ds_read_b64_tr_b16 a[144:145], v3 offset:37088
    ds_read_b64_tr_b16 a[146:147], v3 offset:39392
    v_mfma_f32_16x16x32_bf16 v[52:55], a[92:95], a[156:159], v[52:55]
    s_add_u32 s66, s98, 0x36480
    buffer_load_dwordx4 v4, s[36:39], s66 offen lds
    v_mfma_f32_16x16x32_bf16 v[48:51], a[88:91], a[156:159], v[48:51]
    ds_read_b64_tr_b16 a[148:149], v3 offset:46304
    ds_read_b64_tr_b16 a[150:151], v3 offset:48608
    v_mfma_f32_16x16x32_bf16 v[48:51], a[80:83], a[152:155], v[48:51]
    s_waitcnt lgkmcnt(8)
    v_mfma_f32_16x16x32_bf16 v[56:59], a[80:83], a[160:163], v[56:59]
    ds_read_b64_tr_b16 a[152:153], v3 offset:37120
    ds_read_b64_tr_b16 a[154:155], v3 offset:39424
    v_mfma_f32_16x16x32_bf16 v[56:59], a[88:91], a[164:167], v[56:59]
    buffer_load_dwordx4 v5, s[36:39], s66 offen offset:1024 lds
    v_mfma_f32_16x16x32_bf16 v[60:63], a[92:95], a[164:167], v[60:63]
    ds_read_b64_tr_b16 a[156:157], v3 offset:46336
    ds_read_b64_tr_b16 a[158:159], v3 offset:48640
    v_mfma_f32_16x16x32_bf16 v[60:63], a[84:87], a[160:163], v[60:63]
    s_waitcnt vmcnt(7) lgkmcnt(8)
    s_barrier
    v_mfma_f32_16x16x32_bf16 v[68:71], a[84:87], a[168:171], v[68:71]
    ds_read_b64_tr_b16 a[160:161], v2
    ds_read_b64_tr_b16 a[162:163], v2 offset:2304
    v_mfma_f32_16x16x32_bf16 v[68:71], a[92:95], a[172:175], v[68:71]
    buffer_load_dwordx4 v6, s[36:39], s66 offen offset:2048 lds
    v_mfma_f32_16x16x32_bf16 v[64:67], a[88:91], a[172:175], v[64:67]
    ds_read_b64_tr_b16 a[164:165], v2 offset:9216
    ds_read_b64_tr_b16 a[166:167], v2 offset:11520
    v_mfma_f32_16x16x32_bf16 v[64:67], a[80:83], a[168:171], v[64:67]
    s_waitcnt lgkmcnt(8)
    ds_read_b128 a[96:99], v9
    ds_read_b128 a[100:103], v9 offset:2048
    v_mfma_f32_16x16x32_bf16 v[72:75], a[80:83], a[144:147], v[72:75]
    ds_read_b64_tr_b16 a[168:169], v2 offset:32
    ds_read_b64_tr_b16 a[170:171], v2 offset:2336
    v_mfma_f32_16x16x32_bf16 v[72:75], a[88:91], a[148:151], v[72:75]
    buffer_load_dwordx4 v7, s[36:39], s66 offen offset:3072 lds
    v_mfma_f32_16x16x32_bf16 v[76:79], a[92:95], a[148:151], v[76:79]
    ds_read_b64_tr_b16 a[172:173], v2 offset:9248
    ds_read_b64_tr_b16 a[174:175], v2 offset:11552
    v_mfma_f32_16x16x32_bf16 v[76:79], a[84:87], a[144:147], v[76:79]
    s_waitcnt lgkmcnt(10)
    ds_read_b128 a[104:107], v10
    ds_read_b128 a[108:111], v10 offset:2048
    v_mfma_f32_16x16x32_bf16 v[84:87], a[84:87], a[152:155], v[84:87]
    s_add_u32 m0, s60, 0x5800
    ds_read_b64_tr_b16 a[144:145], v2 offset:64
    ds_read_b64_tr_b16 a[146:147], v2 offset:2368
    v_mfma_f32_16x16x32_bf16 v[84:87], a[92:95], a[156:159], v[84:87]
    buffer_load_dwordx4 v8, s[36:39], s66 offen lds
    v_mfma_f32_16x16x32_bf16 v[80:83], a[88:91], a[156:159], v[80:83]
    ds_read_b64_tr_b16 a[148:149], v2 offset:9280
    ds_read_b64_tr_b16 a[150:151], v2 offset:11584
    v_mfma_f32_16x16x32_bf16 v[80:83], a[80:83], a[152:155], v[80:83]
    s_waitcnt lgkmcnt(4)
    v_mfma_f32_16x16x32_bf16 v[16:19], a[96:99], a[160:163], v[16:19]
    s_add_u32 m0, s64, 0x23000
    ds_read_b64_tr_b16 a[152:153], v2 offset:96
    ds_read_b64_tr_b16 a[154:155], v2 offset:2400
    v_mfma_f32_16x16x32_bf16 v[16:19], a[104:107], a[164:167], v[16:19]
    s_add_u32 s66, s95, 0x100
    buffer_load_dwordx4 v240, s[32:35], s66 offen lds
    v_mfma_f32_16x16x32_bf16 v[20:23], a[108:111], a[164:167], v[20:23]
    ds_read_b64_tr_b16 a[156:157], v2 offset:9312
    ds_read_b64_tr_b16 a[158:159], v2 offset:11616
    v_mfma_f32_16x16x32_bf16 v[20:23], a[100:103], a[160:163], v[20:23]
    v_mfma_f32_16x16x32_bf16 v[28:31], a[100:103], a[168:171], v[28:31]
    s_add_u32 m0, s64, 0x23400
    ds_read_b64_tr_b16 a[160:161], v2 offset:128
    ds_read_b64_tr_b16 a[162:163], v2 offset:2432
    v_mfma_f32_16x16x32_bf16 v[28:31], a[108:111], a[172:175], v[28:31]
    s_add_u32 s66, s95, 0x100
    buffer_load_dwordx4 v241, s[32:35], s66 offen lds
    v_mfma_f32_16x16x32_bf16 v[24:27], a[104:107], a[172:175], v[24:27]
    ds_read_b64_tr_b16 a[164:165], v2 offset:9344
    ds_read_b64_tr_b16 a[166:167], v2 offset:11648
    v_mfma_f32_16x16x32_bf16 v[24:27], a[96:99], a[168:171], v[24:27]
    s_waitcnt lgkmcnt(8)
    v_mfma_f32_16x16x32_bf16 v[32:35], a[96:99], a[144:147], v[32:35]
    s_add_u32 m0, s64, 0x23800
    ds_read_b64_tr_b16 a[168:169], v2 offset:160
    ds_read_b64_tr_b16 a[170:171], v2 offset:2464
    v_mfma_f32_16x16x32_bf16 v[32:35], a[104:107], a[148:151], v[32:35]
    s_add_u32 s66, s95, 0x4900
    buffer_load_dwordx4 v240, s[32:35], s66 offen lds
    v_mfma_f32_16x16x32_bf16 v[36:39], a[108:111], a[148:151], v[36:39]
    ds_read_b64_tr_b16 a[172:173], v2 offset:9376
    ds_read_b64_tr_b16 a[174:175], v2 offset:11680
    v_mfma_f32_16x16x32_bf16 v[36:39], a[100:103], a[144:147], v[36:39]
    s_waitcnt lgkmcnt(8)
    v_mfma_f32_16x16x32_bf16 v[44:47], a[100:103], a[152:155], v[44:47]
    s_add_u32 m0, s64, 0x23c00
    ds_read_b64_tr_b16 a[144:145], v2 offset:192
    ds_read_b64_tr_b16 a[146:147], v2 offset:2496
    v_mfma_f32_16x16x32_bf16 v[44:47], a[108:111], a[156:159], v[44:47]
    s_add_u32 s66, s95, 0x4900
    buffer_load_dwordx4 v241, s[32:35], s66 offen lds
    v_mfma_f32_16x16x32_bf16 v[40:43], a[104:107], a[156:159], v[40:43]
    ds_read_b64_tr_b16 a[148:149], v2 offset:9408
    ds_read_b64_tr_b16 a[150:151], v2 offset:11712
    v_mfma_f32_16x16x32_bf16 v[40:43], a[96:99], a[152:155], v[40:43]
    s_waitcnt lgkmcnt(8)
    v_mfma_f32_16x16x32_bf16 v[48:51], a[96:99], a[160:163], v[48:51]
    s_add_u32 m0, s60, 0x9000
    ds_read_b64_tr_b16 a[152:153], v2 offset:224
    ds_read_b64_tr_b16 a[154:155], v2 offset:2528
    v_mfma_f32_16x16x32_bf16 v[48:51], a[104:107], a[164:167], v[48:51]
    s_add_u32 s66, s98, 0x6c480
    buffer_load_dwordx4 v4, s[36:39], s66 offen lds
    v_mfma_f32_16x16x32_bf16 v[52:55], a[108:111], a[164:167], v[52:55]
    ds_read_b64_tr_b16 a[156:157], v2 offset:9440
    ds_read_b64_tr_b16 a[158:159], v2 offset:11744
    v_mfma_f32_16x16x32_bf16 v[52:55], a[100:103], a[160:163], v[52:55]
    s_waitcnt lgkmcnt(8)
    v_mfma_f32_16x16x32_bf16 v[60:63], a[100:103], a[168:171], v[60:63]
    ds_read_b64_tr_b16 a[160:161], v2 offset:256
    ds_read_b64_tr_b16 a[162:163], v2 offset:2560
    v_mfma_f32_16x16x32_bf16 v[60:63], a[108:111], a[172:175], v[60:63]
    buffer_load_dwordx4 v5, s[36:39], s66 offen offset:1024 lds
    v_mfma_f32_16x16x32_bf16 v[56:59], a[104:107], a[172:175], v[56:59]
    ds_read_b64_tr_b16 a[164:165], v2 offset:9472
    ds_read_b64_tr_b16 a[166:167], v2 offset:11776
    v_mfma_f32_16x16x32_bf16 v[56:59], a[96:99], a[168:171], v[56:59]
    s_waitcnt vmcnt(6) lgkmcnt(8)
    s_barrier
    v_mfma_f32_16x16x32_bf16 v[64:67], a[96:99], a[144:147], v[64:67]
    ds_read_b64_tr_b16 a[168:169], v2 offset:18432
    ds_read_b64_tr_b16 a[170:171], v2 offset:20736
    v_mfma_f32_16x16x32_bf16 v[64:67], a[104:107], a[148:151], v[64:67]
    buffer_load_dwordx4 v6, s[36:39], s66 offen offset:2048 lds
    v_mfma_f32_16x16x32_bf16 v[68:71], a[108:111], a[148:151], v[68:71]
    ds_read_b64_tr_b16 a[172:173], v2 offset:27648
    ds_read_b64_tr_b16 a[174:175], v2 offset:29952
    v_mfma_f32_16x16x32_bf16 v[68:71], a[100:103], a[144:147], v[68:71]
    s_waitcnt lgkmcnt(8)
    ds_read_b128 a[112:115], v9 offset:16384
    ds_read_b128 a[116:119], v9 offset:18432
    v_mfma_f32_16x16x32_bf16 v[76:79], a[100:103], a[152:155], v[76:79]
    ds_read_b64_tr_b16 a[144:145], v2 offset:18464
    ds_read_b64_tr_b16 a[146:147], v2 offset:20768
    v_mfma_f32_16x16x32_bf16 v[76:79], a[108:111], a[156:159], v[76:79]
    buffer_load_dwordx4 v7, s[36:39], s66 offen offset:3072 lds
    v_mfma_f32_16x16x32_bf16 v[72:75], a[104:107], a[156:159], v[72:75]
    ds_read_b64_tr_b16 a[148:149], v2 offset:27680
    ds_read_b64_tr_b16 a[150:151], v2 offset:29984
    v_mfma_f32_16x16x32_bf16 v[72:75], a[96:99], a[152:155], v[72:75]
    s_waitcnt lgkmcnt(10)
    ds_read_b128 a[120:123], v10 offset:16384
    ds_read_b128 a[124:127], v10 offset:18432
    v_mfma_f32_16x16x32_bf16 v[80:83], a[96:99], a[160:163], v[80:83]
    s_add_u32 m0, s60, 0xa000
    ds_read_b64_tr_b16 a[152:153], v2 offset:18496
    ds_read_b64_tr_b16 a[154:155], v2 offset:20800
    v_mfma_f32_16x16x32_bf16 v[80:83], a[104:107], a[164:167], v[80:83]
    buffer_load_dwordx4 v8, s[36:39], s66 offen lds
    v_mfma_f32_16x16x32_bf16 v[84:87], a[108:111], a[164:167], v[84:87]
    ds_read_b64_tr_b16 a[156:157], v2 offset:27712
    ds_read_b64_tr_b16 a[158:159], v2 offset:30016
    v_mfma_f32_16x16x32_bf16 v[84:87], a[100:103], a[160:163], v[84:87]
    s_waitcnt lgkmcnt(4)
    buffer_load_dword v253, v239, s[36:39], s78 offen offset:2304
    v_mfma_f32_16x16x32_bf16 v[20:23], a[116:119], a[168:171], v[20:23]
    s_add_u32 m0, s60, 0xd800
    ds_read_b64_tr_b16 a[160:161], v2 offset:18528
    ds_read_b64_tr_b16 a[162:163], v2 offset:20832
    v_mfma_f32_16x16x32_bf16 v[20:23], a[124:127], a[172:175], v[20:23]
    s_add_u32 s66, s96, 0x900
    buffer_load_dwordx4 v4, s[36:39], s66 offen lds
    v_mfma_f32_16x16x32_bf16 v[16:19], a[120:123], a[172:175], v[16:19]
    ds_read_b64_tr_b16 a[164:165], v2 offset:27744
    ds_read_b64_tr_b16 a[166:167], v2 offset:30048
    v_mfma_f32_16x16x32_bf16 v[16:19], a[112:115], a[168:171], v[16:19]
    v_mfma_f32_16x16x32_bf16 v[24:27], a[112:115], a[144:147], v[24:27]
    ds_read_b64_tr_b16 a[168:169], v2 offset:18560
    ds_read_b64_tr_b16 a[170:171], v2 offset:20864
    v_mfma_f32_16x16x32_bf16 v[24:27], a[120:123], a[148:151], v[24:27]
    buffer_load_dwordx4 v5, s[36:39], s66 offen offset:1024 lds
    v_mfma_f32_16x16x32_bf16 v[28:31], a[124:127], a[148:151], v[28:31]
    ds_read_b64_tr_b16 a[172:173], v2 offset:27776
    ds_read_b64_tr_b16 a[174:175], v2 offset:30080
    v_mfma_f32_16x16x32_bf16 v[28:31], a[116:119], a[144:147], v[28:31]
    s_waitcnt lgkmcnt(8)
    v_mfma_f32_16x16x32_bf16 v[36:39], a[116:119], a[152:155], v[36:39]
    ds_read_b64_tr_b16 a[144:145], v2 offset:18592
    ds_read_b64_tr_b16 a[146:147], v2 offset:20896
    v_mfma_f32_16x16x32_bf16 v[36:39], a[124:127], a[156:159], v[36:39]
    buffer_load_dwordx4 v6, s[36:39], s66 offen offset:2048 lds
    v_mfma_f32_16x16x32_bf16 v[32:35], a[120:123], a[156:159], v[32:35]
    ds_read_b64_tr_b16 a[148:149], v2 offset:27808
    ds_read_b64_tr_b16 a[150:151], v2 offset:30112
    v_mfma_f32_16x16x32_bf16 v[32:35], a[112:115], a[152:155], v[32:35]
    s_waitcnt lgkmcnt(8)
    buffer_load_dwordx4 v7, s[36:39], s66 offen offset:3072 lds
    v_mfma_f32_16x16x32_bf16 v[40:43], a[112:115], a[160:163], v[40:43]
    ds_read_b64_tr_b16 a[152:153], v2 offset:18624
    ds_read_b64_tr_b16 a[154:155], v2 offset:20928
    v_mfma_f32_16x16x32_bf16 v[40:43], a[120:123], a[164:167], v[40:43]
    v_mfma_f32_16x16x32_bf16 v[44:47], a[124:127], a[164:167], v[44:47]
    s_add_u32 m0, s60, 0xe800
    ds_read_b64_tr_b16 a[156:157], v2 offset:27840
    ds_read_b64_tr_b16 a[158:159], v2 offset:30144
    v_mfma_f32_16x16x32_bf16 v[44:47], a[116:119], a[160:163], v[44:47]
    s_waitcnt lgkmcnt(8)
    buffer_load_dwordx4 v8, s[36:39], s66 offen lds
    v_mfma_f32_16x16x32_bf16 v[52:55], a[116:119], a[168:171], v[52:55]
    ds_read_b64_tr_b16 a[160:161], v2 offset:18656
    ds_read_b64_tr_b16 a[162:163], v2 offset:20960
    v_mfma_f32_16x16x32_bf16 v[52:55], a[124:127], a[172:175], v[52:55]
    v_mfma_f32_16x16x32_bf16 v[48:51], a[120:123], a[172:175], v[48:51]
    s_add_u32 m0, s60, 0x12000
    ds_read_b64_tr_b16 a[164:165], v2 offset:27872
    ds_read_b64_tr_b16 a[166:167], v2 offset:30176
    v_mfma_f32_16x16x32_bf16 v[48:51], a[112:115], a[168:171], v[48:51]
    s_waitcnt lgkmcnt(8)
    s_add_u32 s66, s96, 0x36900
    buffer_load_dwordx4 v4, s[36:39], s66 offen lds
    v_mfma_f32_16x16x32_bf16 v[56:59], a[112:115], a[144:147], v[56:59]
    ds_read_b64_tr_b16 a[168:169], v2 offset:18688
    ds_read_b64_tr_b16 a[170:171], v2 offset:20992
    v_mfma_f32_16x16x32_bf16 v[56:59], a[120:123], a[148:151], v[56:59]
    buffer_load_dwordx4 v5, s[36:39], s66 offen offset:1024 lds
    v_mfma_f32_16x16x32_bf16 v[60:63], a[124:127], a[148:151], v[60:63]
    ds_read_b64_tr_b16 a[172:173], v2 offset:27904
    ds_read_b64_tr_b16 a[174:175], v2 offset:30208
    v_mfma_f32_16x16x32_bf16 v[60:63], a[116:119], a[144:147], v[60:63]
    s_waitcnt vmcnt(8) lgkmcnt(8)
    s_barrier
    v_mfma_f32_16x16x32_bf16 v[68:71], a[116:119], a[152:155], v[68:71]
    ds_read_b64_tr_b16 a[144:145], v2 offset:36864
    ds_read_b64_tr_b16 a[146:147], v2 offset:39168
    v_mfma_f32_16x16x32_bf16 v[68:71], a[124:127], a[156:159], v[68:71]
    buffer_load_dwordx4 v6, s[36:39], s66 offen offset:2048 lds
    v_mfma_f32_16x16x32_bf16 v[64:67], a[120:123], a[156:159], v[64:67]
    ds_read_b64_tr_b16 a[148:149], v2 offset:46080
    ds_read_b64_tr_b16 a[150:151], v2 offset:48384
    v_mfma_f32_16x16x32_bf16 v[64:67], a[112:115], a[152:155], v[64:67]
    s_waitcnt lgkmcnt(8)
    ds_read_b128 a[128:131], v9 offset:32768
    ds_read_b128 a[132:135], v9 offset:34816
    v_mfma_f32_16x16x32_bf16 v[72:75], a[112:115], a[160:163], v[72:75]
    ds_read_b64_tr_b16 a[152:153], v2 offset:36896
    ds_read_b64_tr_b16 a[154:155], v2 offset:39200
    v_mfma_f32_16x16x32_bf16 v[72:75], a[120:123], a[164:167], v[72:75]
    buffer_load_dwordx4 v7, s[36:39], s66 offen offset:3072 lds
    v_mfma_f32_16x16x32_bf16 v[76:79], a[124:127], a[164:167], v[76:79]
    ds_read_b64_tr_b16 a[156:157], v2 offset:46112
    ds_read_b64_tr_b16 a[158:159], v2 offset:48416
    v_mfma_f32_16x16x32_bf16 v[76:79], a[116:119], a[160:163], v[76:79]
    s_waitcnt lgkmcnt(10)
    ds_read_b128 a[136:139], v10 offset:32768
    ds_read_b128 a[140:143], v10 offset:34816
    v_mfma_f32_16x16x32_bf16 v[84:87], a[116:119], a[168:171], v[84:87]
    s_add_u32 m0, s60, 0x13000
    ds_read_b64_tr_b16 a[160:161], v2 offset:36928
    ds_read_b64_tr_b16 a[162:163], v2 offset:39232
    v_mfma_f32_16x16x32_bf16 v[84:87], a[124:127], a[172:175], v[84:87]
    buffer_load_dwordx4 v8, s[36:39], s66 offen lds
    v_mfma_f32_16x16x32_bf16 v[80:83], a[120:123], a[172:175], v[80:83]
    ds_read_b64_tr_b16 a[164:165], v2 offset:46144
    ds_read_b64_tr_b16 a[166:167], v2 offset:48448
    v_mfma_f32_16x16x32_bf16 v[80:83], a[112:115], a[168:171], v[80:83]
    s_waitcnt lgkmcnt(4)
    v_mfma_f32_16x16x32_bf16 v[16:19], a[128:131], a[144:147], v[16:19]
    s_add_u32 m0, s60, 0x16800
    ds_read_b64_tr_b16 a[168:169], v2 offset:36960
    ds_read_b64_tr_b16 a[170:171], v2 offset:39264
    v_mfma_f32_16x16x32_bf16 v[16:19], a[136:139], a[148:151], v[16:19]
    s_add_u32 s66, s96, 0x6c900
    buffer_load_dwordx4 v4, s[36:39], s66 offen lds
    v_mfma_f32_16x16x32_bf16 v[20:23], a[140:143], a[148:151], v[20:23]
    ds_read_b64_tr_b16 a[172:173], v2 offset:46176
    ds_read_b64_tr_b16 a[174:175], v2 offset:48480
    v_mfma_f32_16x16x32_bf16 v[20:23], a[132:135], a[144:147], v[20:23]
    v_mfma_f32_16x16x32_bf16 v[28:31], a[132:135], a[152:155], v[28:31]
    ds_read_b64_tr_b16 a[144:145], v2 offset:36992
    ds_read_b64_tr_b16 a[146:147], v2 offset:39296
    v_mfma_f32_16x16x32_bf16 v[28:31], a[140:143], a[156:159], v[28:31]
    buffer_load_dwordx4 v5, s[36:39], s66 offen offset:1024 lds
    v_mfma_f32_16x16x32_bf16 v[24:27], a[136:139], a[156:159], v[24:27]
    ds_read_b64_tr_b16 a[148:149], v2 offset:46208
    ds_read_b64_tr_b16 a[150:151], v2 offset:48512
    v_mfma_f32_16x16x32_bf16 v[24:27], a[128:131], a[152:155], v[24:27]
    s_waitcnt lgkmcnt(8)
    v_mfma_f32_16x16x32_bf16 v[32:35], a[128:131], a[160:163], v[32:35]
    ds_read_b64_tr_b16 a[152:153], v2 offset:37024
    ds_read_b64_tr_b16 a[154:155], v2 offset:39328
    v_mfma_f32_16x16x32_bf16 v[32:35], a[136:139], a[164:167], v[32:35]
    buffer_load_dwordx4 v6, s[36:39], s66 offen offset:2048 lds
    v_mfma_f32_16x16x32_bf16 v[36:39], a[140:143], a[164:167], v[36:39]
    ds_read_b64_tr_b16 a[156:157], v2 offset:46240
    ds_read_b64_tr_b16 a[158:159], v2 offset:48544
L_pad_a1:
    s_cbranch_execz L_pad_a5
    v_mfma_f32_16x16x32_bf16 v[36:39], a[132:135], a[160:163], v[36:39]
    s_waitcnt lgkmcnt(8)
    buffer_load_dwordx4 v7, s[36:39], s66 offen offset:3072 lds
    v_mfma_f32_16x16x32_bf16 v[44:47], a[132:135], a[168:171], v[44:47]
    ds_read_b64_tr_b16 a[160:161], v2 offset:37056
    ds_read_b64_tr_b16 a[162:163], v2 offset:39360
    v_mfma_f32_16x16x32_bf16 v[44:47], a[140:143], a[172:175], v[44:47]
    v_mfma_f32_16x16x32_bf16 v[40:43], a[136:139], a[172:175], v[40:43]
    s_add_u32 m0, s60, 0x17800
    ds_read_b64_tr_b16 a[164:165], v2 offset:46272
    ds_read_b64_tr_b16 a[166:167], v2 offset:48576
    v_mfma_f32_16x16x32_bf16 v[40:43], a[128:131], a[168:171], v[40:43]
    s_waitcnt lgkmcnt(8)
    buffer_load_dwordx4 v8, s[36:39], s66 offen lds
    v_mfma_f32_16x16x32_bf16 v[48:51], a[128:131], a[144:147], v[48:51]
    ds_read_b64_tr_b16 a[168:169], v2 offset:37088
    ds_read_b64_tr_b16 a[170:171], v2 offset:39392
    v_mfma_f32_16x16x32_bf16 v[48:51], a[136:139], a[148:151], v[48:51]
    v_mfma_f32_16x16x32_bf16 v[52:55], a[140:143], a[148:151], v[52:55]
    s_add_u32 m0, s60, 0
    ds_read_b64_tr_b16 a[172:173], v2 offset:46304
    ds_read_b64_tr_b16 a[174:175], v2 offset:48608
    v_mfma_f32_16x16x32_bf16 v[52:55], a[132:135], a[144:147], v[52:55]
    s_waitcnt lgkmcnt(8)
    s_add_u32 s66, s97, 0x900
    buffer_load_dwordx4 v4, s[36:39], s66 offen lds
    v_mfma_f32_16x16x32_bf16 v[60:63], a[132:135], a[152:155], v[60:63]
    ds_read_b64_tr_b16 a[144:145], v2 offset:37120
    ds_read_b64_tr_b16 a[146:147], v2 offset:39424
    v_mfma_f32_16x16x32_bf16 v[60:63], a[140:143], a[156:159], v[60:63]
    buffer_load_dwordx4 v5, s[36:39], s66 offen offset:1024 lds
    v_mfma_f32_16x16x32_bf16 v[56:59], a[136:139], a[156:159], v[56:59]
    ds_read_b64_tr_b16 a[148:149], v2 offset:46336
    ds_read_b64_tr_b16 a[150:151], v2 offset:48640
    v_mfma_f32_16x16x32_bf16 v[56:59], a[128:131], a[152:155], v[56:59]
    s_waitcnt vmcnt(12) lgkmcnt(8)
    s_barrier
    v_mfma_f32_16x16x32_bf16 v[64:67], a[128:131], a[160:163], v[64:67]
    ds_read_b64_tr_b16 a[152:153], v3
    ds_read_b64_tr_b16 a[154:155], v3 offset:2304
    v_mfma_f32_16x16x32_bf16 v[64:67], a[136:139], a[164:167], v[64:67]
    buffer_load_dwordx4 v6, s[36:39], s66 offen offset:2048 lds
    v_mfma_f32_16x16x32_bf16 v[68:71], a[140:143], a[164:167], v[68:71]
    ds_read_b64_tr_b16 a[156:157], v3 offset:9216
    ds_read_b64_tr_b16 a[158:159], v3 offset:11520
    v_mfma_f32_16x16x32_bf16 v[68:71], a[132:135], a[160:163], v[68:71]
    s_waitcnt lgkmcnt(8)
    v_mfma_f32_16x16x32_bf16 v[76:79], a[132:135], a[168:171], v[76:79]
    ds_read_b64_tr_b16 a[160:161], v3 offset:32
    ds_read_b64_tr_b16 a[162:163], v3 offset:2336
    v_mfma_f32_16x16x32_bf16 v[76:79], a[140:143], a[172:175], v[76:79]
    buffer_load_dwordx4 v7, s[36:39], s66 offen offset:3072 lds
    v_mfma_f32_16x16x32_bf16 v[72:75], a[136:139], a[172:175], v[72:75]
    ds_read_b64_tr_b16 a[164:165], v3 offset:9248
    ds_read_b64_tr_b16 a[166:167], v3 offset:11552
    v_mfma_f32_16x16x32_bf16 v[72:75], a[128:131], a[168:171], v[72:75]
    s_waitcnt lgkmcnt(8)
    v_mfma_f32_16x16x32_bf16 v[80:83], a[128:131], a[144:147], v[80:83]
    s_add_u32 m0, s60, 0x1000
    ds_read_b64_tr_b16 a[168:169], v3 offset:64
    ds_read_b64_tr_b16 a[170:171], v3 offset:2368
    v_mfma_f32_16x16x32_bf16 v[80:83], a[136:139], a[148:151], v[80:83]
    buffer_load_dwordx4 v8, s[36:39], s66 offen lds
    v_mfma_f32_16x16x32_bf16 v[84:87], a[140:143], a[148:151], v[84:87]
    ds_read_b64_tr_b16 a[172:173], v3 offset:9280
    ds_read_b64_tr_b16 a[174:175], v3 offset:11584
    v_mfma_f32_16x16x32_bf16 v[84:87], a[132:135], a[144:147], v[84:87]
    s_waitcnt lgkmcnt(8)
    v_mfma_f32_16x16x32_bf16 v[92:95], a[4:7], a[152:155], 0
    s_add_u32 m0, s60, 0x4800
    ds_read_b64_tr_b16 a[144:145], v3 offset:96
    ds_read_b64_tr_b16 a[146:147], v3 offset:2400
    v_mfma_f32_16x16x32_bf16 v[92:95], a[12:15], a[156:159], v[92:95]
    s_add_u32 s66, s97, 0x36900
    buffer_load_dwordx4 v4, s[36:39], s66 offen lds
    v_mfma_f32_16x16x32_bf16 v[88:91], a[8:11], a[156:159], 0
    ds_read_b64_tr_b16 a[148:149], v3 offset:9312
    ds_read_b64_tr_b16 a[150:151], v3 offset:11616
    v_mfma_f32_16x16x32_bf16 v[88:91], a[0:3], a[152:155], v[88:91]
    s_waitcnt lgkmcnt(8)
    v_mfma_f32_16x16x32_bf16 v[96:99], a[0:3], a[160:163], 0
    ds_read_b64_tr_b16 a[152:153], v3 offset:128
    ds_read_b64_tr_b16 a[154:155], v3 offset:2432
    v_mfma_f32_16x16x32_bf16 v[96:99], a[8:11], a[164:167], v[96:99]
    buffer_load_dwordx4 v5, s[36:39], s66 offen offset:1024 lds
    v_mfma_f32_16x16x32_bf16 v[100:103], a[12:15], a[164:167], 0
    ds_read_b64_tr_b16 a[156:157], v3 offset:9344
    ds_read_b64_tr_b16 a[158:159], v3 offset:11648
    v_mfma_f32_16x16x32_bf16 v[100:103], a[4:7], a[160:163], v[100:103]
    s_waitcnt lgkmcnt(8)
    v_add_u32 v9, 0x9000, v11
    v_mul_f32 v242, s67, v16
    v_mul_f32 v243, s67, v17
    v_mfma_f32_16x16x32_bf16 v[108:111], a[4:7], a[168:171], 0
    ds_read_b64_tr_b16 a[160:161], v3 offset:160
    ds_read_b64_tr_b16 a[162:163], v3 offset:2464
    v_mfma_f32_16x16x32_bf16 v[108:111], a[12:15], a[172:175], v[108:111]
    buffer_load_dwordx4 v6, s[36:39], s66 offen offset:2048 lds
    v_mfma_f32_16x16x32_bf16 v[104:107], a[8:11], a[172:175], 0
    ds_read_b64_tr_b16 a[164:165], v3 offset:9376
    ds_read_b64_tr_b16 a[166:167], v3 offset:11680
    v_mfma_f32_16x16x32_bf16 v[104:107], a[0:3], a[168:171], v[104:107]
    s_waitcnt lgkmcnt(8)
    v_exp_f32_e64 v242, v242 clamp
    v_max_f32 v16, s65, v16
    v_mul_f32 v244, s67, v18
    v_mfma_f32_16x16x32_bf16 v[112:115], a[0:3], a[144:147], 0
    ds_read_b64_tr_b16 a[168:169], v3 offset:192
    ds_read_b64_tr_b16 a[170:171], v3 offset:2496
    v_mfma_f32_16x16x32_bf16 v[112:115], a[8:11], a[148:151], v[112:115]
    buffer_load_dwordx4 v7, s[36:39], s66 offen offset:3072 lds
    v_mfma_f32_16x16x32_bf16 v[116:119], a[12:15], a[148:151], 0
    ds_read_b64_tr_b16 a[172:173], v3 offset:9408
    ds_read_b64_tr_b16 a[174:175], v3 offset:11712
    v_mfma_f32_16x16x32_bf16 v[116:119], a[4:7], a[144:147], v[116:119]
    s_waitcnt lgkmcnt(8)
    v_exp_f32_e64 v243, v243 clamp
    v_max_f32 v17, s65, v17
    v_mul_f32 v245, s67, v19
    v_mfma_f32_16x16x32_bf16 v[124:127], a[4:7], a[152:155], 0
    s_add_u32 m0, s60, 0x5800
    ds_read_b64_tr_b16 a[144:145], v3 offset:224
    ds_read_b64_tr_b16 a[146:147], v3 offset:2528
    v_mfma_f32_16x16x32_bf16 v[124:127], a[12:15], a[156:159], v[124:127]
    buffer_load_dwordx4 v8, s[36:39], s66 offen lds
    v_mfma_f32_16x16x32_bf16 v[120:123], a[8:11], a[156:159], 0
    ds_read_b64_tr_b16 a[148:149], v3 offset:9440
    ds_read_b64_tr_b16 a[150:151], v3 offset:11744
    v_mfma_f32_16x16x32_bf16 v[120:123], a[0:3], a[152:155], v[120:123]
    s_waitcnt lgkmcnt(8)
    v_exp_f32_e64 v244, v244 clamp
    v_max_f32 v18, s65, v18
    v_add_f32 v16, v16, v242
    v_mul_f32 v242, s67, v20
    v_mfma_f32_16x16x32_bf16 v[128:131], a[0:3], a[160:163], 0
    ds_read_b64_tr_b16 a[152:153], v3 offset:256
    ds_read_b64_tr_b16 a[154:155], v3 offset:2560
    v_mfma_f32_16x16x32_bf16 v[128:131], a[8:11], a[164:167], v[128:131]
    v_exp_f32_e64 v245, v245 clamp
    v_max_f32 v19, s65, v19
    v_add_f32 v17, v17, v243
    v_mul_f32 v243, s67, v21
    v_mfma_f32_16x16x32_bf16 v[132:135], a[12:15], a[164:167], 0
    ds_read_b64_tr_b16 a[156:157], v3 offset:9472
    ds_read_b64_tr_b16 a[158:159], v3 offset:11776
    v_mfma_f32_16x16x32_bf16 v[132:135], a[4:7], a[160:163], v[132:135]
    s_waitcnt vmcnt(15) lgkmcnt(8)
    s_barrier
    v_max_f32 v20, s65, v20
    v_mfma_f32_16x16x32_bf16 v[140:143], a[4:7], a[168:171], 0
    s_add_u32 m0, s60, 0x9000
    ds_read_b64_tr_b16 a[160:161], v3 offset:18432
    ds_read_b64_tr_b16 a[162:163], v3 offset:20736
    v_mfma_f32_16x16x32_bf16 v[140:143], a[12:15], a[172:175], v[140:143]
    s_add_u32 s66, s97, 0x6c900
    buffer_load_dwordx4 v4, s[36:39], s66 offen lds
    v_mfma_f32_16x16x32_bf16 v[136:139], a[8:11], a[172:175], 0
    ds_read_b64_tr_b16 a[164:165], v3 offset:27648
    ds_read_b64_tr_b16 a[166:167], v3 offset:29952
    v_mfma_f32_16x16x32_bf16 v[136:139], a[0:3], a[168:171], v[136:139]
    s_waitcnt lgkmcnt(8)
    v_exp_f32_e64 v242, v242 clamp
    v_add_f32 v18, v18, v244
    v_mul_f32 v244, s67, v22
    v_exp_f32_e64 v243, v243 clamp
    v_mfma_f32_16x16x32_bf16 v[144:147], a[0:3], a[144:147], 0
    ds_read_b64_tr_b16 a[168:169], v3 offset:18464
    ds_read_b64_tr_b16 a[170:171], v3 offset:20768
    v_mfma_f32_16x16x32_bf16 v[144:147], a[8:11], a[148:151], v[144:147]
    buffer_load_dwordx4 v5, s[36:39], s66 offen offset:1024 lds
    v_mfma_f32_16x16x32_bf16 v[148:151], a[12:15], a[148:151], 0
    ds_read_b64_tr_b16 a[172:173], v3 offset:27680
    ds_read_b64_tr_b16 a[174:175], v3 offset:29984
    v_mfma_f32_16x16x32_bf16 v[148:151], a[4:7], a[144:147], v[148:151]
    s_waitcnt lgkmcnt(8)
    v_max_f32 v21, s65, v21
    v_add_f32 v19, v19, v245
    v_mul_f32 v245, s67, v23
    v_mfma_f32_16x16x32_bf16 v[156:159], a[4:7], a[152:155], 0
    ds_read_b64_tr_b16 a[144:145], v3 offset:18496
    ds_read_b64_tr_b16 a[146:147], v3 offset:20800
    v_mfma_f32_16x16x32_bf16 v[156:159], a[12:15], a[156:159], v[156:159]
    buffer_load_dwordx4 v6, s[36:39], s66 offen offset:2048 lds
    v_mfma_f32_16x16x32_bf16 v[152:155], a[8:11], a[156:159], 0
    ds_read_b64_tr_b16 a[148:149], v3 offset:27712
    ds_read_b64_tr_b16 a[150:151], v3 offset:30016
    v_mfma_f32_16x16x32_bf16 v[152:155], a[0:3], a[152:155], v[152:155]
    s_waitcnt lgkmcnt(8)
    v_exp_f32_e64 v244, v244 clamp
    v_max_f32 v22, s65, v22
    v_add_f32 v20, v20, v242
    v_mul_f32 v242, s67, v24
    v_mfma_f32_16x16x32_bf16 v[88:91], a[16:19], a[160:163], v[88:91]
    ds_read_b64_tr_b16 a[152:153], v3 offset:18528
    ds_read_b64_tr_b16 a[154:155], v3 offset:20832
    v_mfma_f32_16x16x32_bf16 v[88:91], a[24:27], a[164:167], v[88:91]
    buffer_load_dwordx4 v7, s[36:39], s66 offen offset:3072 lds
    v_mfma_f32_16x16x32_bf16 v[92:95], a[28:31], a[164:167], v[92:95]
    ds_read_b64_tr_b16 a[156:157], v3 offset:27744
    ds_read_b64_tr_b16 a[158:159], v3 offset:30048
    v_mfma_f32_16x16x32_bf16 v[92:95], a[20:23], a[160:163], v[92:95]
    s_waitcnt lgkmcnt(8)
    v_exp_f32_e64 v245, v245 clamp
    v_max_f32 v23, s65, v23
    v_add_f32 v21, v21, v243
    v_mul_f32 v243, s67, v25
    v_mfma_f32_16x16x32_bf16 v[100:103], a[20:23], a[168:171], v[100:103]
    s_add_u32 m0, s60, 0xa000
    ds_read_b64_tr_b16 a[160:161], v3 offset:18560
    ds_read_b64_tr_b16 a[162:163], v3 offset:20864
    v_mfma_f32_16x16x32_bf16 v[100:103], a[28:31], a[172:175], v[100:103]
    buffer_load_dwordx4 v8, s[36:39], s66 offen lds
    v_mfma_f32_16x16x32_bf16 v[96:99], a[24:27], a[172:175], v[96:99]
    ds_read_b64_tr_b16 a[164:165], v3 offset:27776
    ds_read_b64_tr_b16 a[166:167], v3 offset:30080
    v_mfma_f32_16x16x32_bf16 v[96:99], a[16:19], a[168:171], v[96:99]
    s_waitcnt lgkmcnt(8)
    v_exp_f32_e64 v242, v242 clamp
    v_max_f32 v24, s65, v24
    v_add_f32 v22, v22, v244
    v_mfma_f32_16x16x32_bf16 v[104:107], a[16:19], a[144:147], v[104:107]
    ds_read_b64_tr_b16 a[168:169], v3 offset:18592
    ds_read_b64_tr_b16 a[170:171], v3 offset:20896
    v_mfma_f32_16x16x32_bf16 v[104:107], a[24:27], a[148:151], v[104:107]
    v_mul_f32 v244, s67, v26
    v_max_f32 v25, s65, v25
    v_exp_f32_e64 v243, v243 clamp
    v_mfma_f32_16x16x32_bf16 v[108:111], a[28:31], a[148:151], v[108:111]
    ds_read_b64_tr_b16 a[172:173], v3 offset:27808
    ds_read_b64_tr_b16 a[174:175], v3 offset:30112
    v_mfma_f32_16x16x32_bf16 v[108:111], a[20:23], a[144:147], v[108:111]
    s_waitcnt lgkmcnt(8)
    s_and_b32 s62, s59, 1
    s_lshl_b32 s62, s62, 10
    s_add_u32 m0, s62, 0x27000
    s_add_u32 s62, s62, s93
    v_add_u32 v251, s62, v1
    v_subrev_u32 v252, 0x480, v251
    v_min_u32 v251, v251, v252
    buffer_load_dwordx4 v251, s[44:47], 0 offen lds
    v_mfma_f32_16x16x32_bf16 v[116:119], a[20:23], a[152:155], v[116:119]
    ds_read_b64_tr_b16 a[144:145], v3 offset:18624
    ds_read_b64_tr_b16 a[146:147], v3 offset:20928
    v_mfma_f32_16x16x32_bf16 v[116:119], a[28:31], a[156:159], v[116:119]
    v_add_f32 v23, v23, v245
    v_mul_f32 v245, s67, v27
    v_exp_f32_e64 v244, v244 clamp
    v_mfma_f32_16x16x32_bf16 v[112:115], a[24:27], a[156:159], v[112:115]
    ds_read_b64_tr_b16 a[148:149], v3 offset:27840
    ds_read_b64_tr_b16 a[150:151], v3 offset:30144
    v_mfma_f32_16x16x32_bf16 v[112:115], a[16:19], a[152:155], v[112:115]
    s_waitcnt lgkmcnt(8)
    v_max_f32 v26, s65, v26
    v_add_f32 v24, v24, v242
    v_mul_f32 v242, s67, v28
    v_exp_f32_e64 v245, v245 clamp
    v_mfma_f32_16x16x32_bf16 v[120:123], a[16:19], a[160:163], v[120:123]
    ds_read_b64_tr_b16 a[152:153], v3 offset:18656
    ds_read_b64_tr_b16 a[154:155], v3 offset:20960
    v_mfma_f32_16x16x32_bf16 v[120:123], a[24:27], a[164:167], v[120:123]
    v_max_f32 v27, s65, v27
    v_add_f32 v25, v25, v243
    v_mul_f32 v243, s67, v29
    v_mfma_f32_16x16x32_bf16 v[124:127], a[28:31], a[164:167], v[124:127]
    ds_read_b64_tr_b16 a[156:157], v3 offset:27872
    ds_read_b64_tr_b16 a[158:159], v3 offset:30176
    v_mfma_f32_16x16x32_bf16 v[124:127], a[20:23], a[160:163], v[124:127]
    s_waitcnt lgkmcnt(8)
    v_exp_f32_e64 v242, v242 clamp
    v_max_f32 v28, s65, v28
    v_add_f32 v26, v26, v244
    v_mul_f32 v244, s67, v30
    v_mfma_f32_16x16x32_bf16 v[132:135], a[20:23], a[168:171], v[132:135]
    ds_read_b64_tr_b16 a[160:161], v3 offset:18688
    ds_read_b64_tr_b16 a[162:163], v3 offset:20992
    v_mfma_f32_16x16x32_bf16 v[132:135], a[28:31], a[172:175], v[132:135]
    v_exp_f32_e64 v243, v243 clamp
    v_max_f32 v29, s65, v29
    v_add_f32 v27, v27, v245
    v_mul_f32 v245, s67, v31
    v_mfma_f32_16x16x32_bf16 v[128:131], a[24:27], a[172:175], v[128:131]
    ds_read_b64_tr_b16 a[164:165], v3 offset:27904
    ds_read_b64_tr_b16 a[166:167], v3 offset:30208
    v_mfma_f32_16x16x32_bf16 v[128:131], a[16:19], a[168:171], v[128:131]
    s_waitcnt vmcnt(16) lgkmcnt(8)
    s_barrier
    v_max_f32 v30, s65, v30
    v_mfma_f32_16x16x32_bf16 v[136:139], a[16:19], a[144:147], v[136:139]
    ds_read_b64_tr_b16 a[168:169], v3 offset:36864
    ds_read_b64_tr_b16 a[170:171], v3 offset:39168
    v_mfma_f32_16x16x32_bf16 v[136:139], a[24:27], a[148:151], v[136:139]
    buffer_load_dword v253, v239, s[36:39], s78 offen
    v_mfma_f32_16x16x32_bf16 v[140:143], a[28:31], a[148:151], v[140:143]
    ds_read_b64_tr_b16 a[172:173], v3 offset:46080
    ds_read_b64_tr_b16 a[174:175], v3 offset:48384
    v_mfma_f32_16x16x32_bf16 v[140:143], a[20:23], a[144:147], v[140:143]
    s_waitcnt lgkmcnt(8)
    v_exp_f32_e64 v244, v244 clamp
    v_add_f32 v28, v28, v242
    v_mul_f32 v242, s67, v32
    v_mfma_f32_16x16x32_bf16 v[148:151], a[20:23], a[152:155], v[148:151]
    ds_read_b64_tr_b16 a[144:145], v3 offset:36896
    ds_read_b64_tr_b16 a[146:147], v3 offset:39200
    v_mfma_f32_16x16x32_bf16 v[148:151], a[28:31], a[156:159], v[148:151]
    v_exp_f32_e64 v245, v245 clamp
    v_max_f32 v31, s65, v31
    v_add_f32 v29, v29, v243
    v_mul_f32 v243, s67, v33
    v_cvt_pk_bf16_f32 v16, v16, v17
    v_mfma_f32_16x16x32_bf16 v[144:147], a[24:27], a[156:159], v[144:147]
    ds_read_b64_tr_b16 a[148:149], v3 offset:46112
    ds_read_b64_tr_b16 a[150:151], v3 offset:48416
    v_mfma_f32_16x16x32_bf16 v[144:147], a[16:19], a[152:155], v[144:147]
    s_waitcnt lgkmcnt(8)
    v_cvt_pk_bf16_f32 v17, v18, v19
    v_cvt_pk_bf16_f32 v18, v20, v21
    v_cvt_pk_bf16_f32 v19, v22, v23
    v_mfma_f32_16x16x32_bf16 v[152:155], a[16:19], a[160:163], v[152:155]
    ds_read_b64_tr_b16 a[152:153], v3 offset:36928
    ds_read_b64_tr_b16 a[154:155], v3 offset:39232
    v_mfma_f32_16x16x32_bf16 v[152:155], a[24:27], a[164:167], v[152:155]
    ds_write_b128 v9, v[16:19]
    v_mfma_f32_16x16x32_bf16 v[156:159], a[28:31], a[164:167], v[156:159]
    ds_read_b64_tr_b16 a[156:157], v3 offset:46144
    ds_read_b64_tr_b16 a[158:159], v3 offset:48448
    v_mfma_f32_16x16x32_bf16 v[156:159], a[20:23], a[160:163], v[156:159]
    s_waitcnt lgkmcnt(9)
    v_exp_f32_e64 v242, v242 clamp
    v_max_f32 v32, s65, v32
    v_mfma_f32_16x16x32_bf16 v[92:95], a[36:39], a[168:171], v[92:95]
    s_lshl_b32 s88, s59, 13
    ds_read_b64_tr_b16 a[160:161], v3 offset:36960
    ds_read_b64_tr_b16 a[162:163], v3 offset:39264
    v_mfma_f32_16x16x32_bf16 v[92:95], a[44:47], a[172:175], v[92:95]
    s_add_u32 s88, s88, 0x11000
    v_add_f32 v30, v30, v244
    v_mul_f32 v244, s67, v34
    v_exp_f32_e64 v243, v243 clamp
    v_max_f32 v33, s65, v33
    v_mfma_f32_16x16x32_bf16 v[88:91], a[40:43], a[172:175], v[88:91]
    s_and_b32 s89, s59, 1
    ds_read_b64_tr_b16 a[164:165], v3 offset:46176
    ds_read_b64_tr_b16 a[166:167], v3 offset:48480
    v_mfma_f32_16x16x32_bf16 v[88:91], a[32:35], a[168:171], v[88:91]
    s_waitcnt lgkmcnt(9)
    v_add_f32 v31, v31, v245
    v_mul_f32 v245, s67, v35
    v_exp_f32_e64 v244, v244 clamp
    v_mfma_f32_16x16x32_bf16 v[96:99], a[32:35], a[144:147], v[96:99]
    s_lshl_b32 s89, s89, 12
    ds_read_b64_tr_b16 a[168:169], v3 offset:36992
    ds_read_b64_tr_b16 a[170:171], v3 offset:39296
    v_mfma_f32_16x16x32_bf16 v[96:99], a[40:43], a[148:151], v[96:99]
    s_add_u32 s89, s89, 0x19000
    v_max_f32 v34, s65, v34
    v_add_f32 v32, v32, v242
    v_mul_f32 v242, s67, v36
    v_mfma_f32_16x16x32_bf16 v[100:103], a[44:47], a[148:151], v[100:103]
    s_lshl_b32 s72, s57, 4
    ds_read_b64_tr_b16 a[172:173], v3 offset:46208
    ds_read_b64_tr_b16 a[174:175], v3 offset:48512
    v_mfma_f32_16x16x32_bf16 v[100:103], a[36:39], a[144:147], v[100:103]
    s_waitcnt lgkmcnt(8)
    v_exp_f32_e64 v245, v245 clamp
    v_max_f32 v35, s65, v35
    v_add_f32 v33, v33, v243
    v_mul_f32 v243, s67, v37
    v_mfma_f32_16x16x32_bf16 v[108:111], a[36:39], a[152:155], v[108:111]
    s_add_u32 s76, s72, s56
    ds_read_b64_tr_b16 a[144:145], v3 offset:37024
    ds_read_b64_tr_b16 a[146:147], v3 offset:39328
    v_mfma_f32_16x16x32_bf16 v[108:111], a[44:47], a[156:159], v[108:111]
    s_mul_i32 s72, s72, 0x4800
    v_exp_f32_e64 v242, v242 clamp
    v_max_f32 v36, s65, v36
    v_add_f32 v34, v34, v244
    v_mul_f32 v244, s67, v38
    v_mfma_f32_16x16x32_bf16 v[104:107], a[40:43], a[156:159], v[104:107]
    s_add_u32 s72, s72, 0x2c00000
    ds_read_b64_tr_b16 a[148:149], v3 offset:46240
    ds_read_b64_tr_b16 a[150:151], v3 offset:48544
    v_mfma_f32_16x16x32_bf16 v[104:107], a[32:35], a[152:155], v[104:107]
    s_waitcnt lgkmcnt(8)
    v_exp_f32_e64 v243, v243 clamp
    v_max_f32 v37, s65, v37
    v_add_f32 v35, v35, v245
    v_mfma_f32_16x16x32_bf16 v[112:115], a[32:35], a[160:163], v[112:115]
    s_lshl_b32 s92, s76, 8
    ds_read_b64_tr_b16 a[152:153], v3 offset:37056
    ds_read_b64_tr_b16 a[154:155], v3 offset:39360
    v_mfma_f32_16x16x32_bf16 v[112:115], a[40:43], a[164:167], v[112:115]
    s_mul_i32 s76, s76, 0x4800
    v_mul_f32 v245, s67, v39
    v_max_f32 v38, s65, v38
    v_exp_f32_e64 v244, v244 clamp
    v_add_f32 v36, v36, v242
    v_mfma_f32_16x16x32_bf16 v[116:119], a[44:47], a[164:167], v[116:119]
    s_add_u32 s76, s76, 0x2c00000
    ds_read_b64_tr_b16 a[156:157], v3 offset:46272
    ds_read_b64_tr_b16 a[158:159], v3 offset:48576
    v_mfma_f32_16x16x32_bf16 v[116:119], a[36:39], a[160:163], v[116:119]
    s_waitcnt lgkmcnt(8)
    v_mul_f32 v242, s67, v40
    v_max_f32 v39, s65, v39
    v_exp_f32_e64 v245, v245 clamp
    v_mfma_f32_16x16x32_bf16 v[124:127], a[36:39], a[168:171], v[124:127]
    s_lshl_b32 s71, s59, 28
    ds_read_b64_tr_b16 a[160:161], v3 offset:37088
    ds_read_b64_tr_b16 a[162:163], v3 offset:39392
    v_mfma_f32_16x16x32_bf16 v[124:127], a[44:47], a[172:175], v[124:127]
    s_add_u32 s92, s92, s71
    v_add_f32 v37, v37, v243
    v_mul_f32 v243, s67, v41
    v_cvt_pk_bf16_f32 v24, v24, v25
    v_cvt_pk_bf16_f32 v25, v26, v27
    v_mfma_f32_16x16x32_bf16 v[120:123], a[40:43], a[172:175], v[120:123]
    s_add_u32 s92, s92, 0x3010000
    ds_read_b64_tr_b16 a[164:165], v3 offset:46304
    ds_read_b64_tr_b16 a[166:167], v3 offset:48608
    v_mfma_f32_16x16x32_bf16 v[120:123], a[32:35], a[168:171], v[120:123]
    s_waitcnt lgkmcnt(8)
    v_cvt_pk_bf16_f32 v26, v28, v29
    v_cvt_pk_bf16_f32 v27, v30, v31
    v_mfma_f32_16x16x32_bf16 v[128:131], a[32:35], a[144:147], v[128:131]
    s_lshl_b32 s63, s59, 12
    ds_read_b64_tr_b16 a[168:169], v3 offset:37120
    ds_read_b64_tr_b16 a[170:171], v3 offset:39424
    v_mfma_f32_16x16x32_bf16 v[128:131], a[40:43], a[148:151], v[128:131]
    s_add_u32 s63, s63, s76
    ds_write_b128 v9, v[24:27] offset:4096
    v_mfma_f32_16x16x32_bf16 v[132:135], a[44:47], a[148:151], v[132:135]
    s_lshl_b32 s70, s59, 10
    ds_read_b64_tr_b16 a[172:173], v3 offset:46336
    ds_read_b64_tr_b16 a[174:175], v3 offset:48640
    v_mfma_f32_16x16x32_bf16 v[132:135], a[36:39], a[144:147], v[132:135]
    s_waitcnt vmcnt(12) lgkmcnt(9)
    s_barrier
    v_max_f32 v40, s65, v40
    v_exp_f32_e64 v242, v242 clamp
    v_mfma_f32_16x16x32_bf16 v[140:143], a[36:39], a[152:155], v[140:143]
    s_add_u32 s70, s70, s76
    ds_read_b64_tr_b16 a[144:145], v2
    ds_read_b64_tr_b16 a[146:147], v2 offset:2304
    v_mfma_f32_16x16x32_bf16 v[140:143], a[44:47], a[156:159], v[140:143]
    s_add_u32 s70, s70, 0x4000
    v_add_f32 v38, v38, v244
    v_mul_f32 v244, s67, v42
    v_exp_f32_e64 v243, v243 clamp
    v_mfma_f32_16x16x32_bf16 v[136:139], a[40:43], a[156:159], v[136:139]
    s_cmp_lt_u32 s59, 2
    s_cselect_b32 s70, s70, 0x10000000
    ds_read_b64_tr_b16 a[148:149], v2 offset:9216
    ds_read_b64_tr_b16 a[150:151], v2 offset:11520
    v_mfma_f32_16x16x32_bf16 v[136:139], a[32:35], a[152:155], v[136:139]
    s_waitcnt lgkmcnt(9)
    v_max_f32 v41, s65, v41
    v_add_f32 v39, v39, v245
    v_mul_f32 v245, s67, v43
    v_exp_f32_e64 v244, v244 clamp
    v_mfma_f32_16x16x32_bf16 v[144:147], a[32:35], a[160:163], v[144:147]
    ds_read_b64_tr_b16 a[152:153], v2 offset:32
    ds_read_b64_tr_b16 a[154:155], v2 offset:2336
    v_mfma_f32_16x16x32_bf16 v[144:147], a[40:43], a[164:167], v[144:147]
    v_max_f32 v42, s65, v42
    v_add_f32 v40, v40, v242
    v_mul_f32 v242, s67, v44
    v_mfma_f32_16x16x32_bf16 v[148:151], a[44:47], a[164:167], v[148:151]
    ds_read_b64_tr_b16 a[156:157], v2 offset:9248
    ds_read_b64_tr_b16 a[158:159], v2 offset:11552
    v_mfma_f32_16x16x32_bf16 v[148:151], a[36:39], a[160:163], v[148:151]
    s_waitcnt lgkmcnt(8)
    v_exp_f32_e64 v245, v245 clamp
    v_max_f32 v43, s65, v43
    v_add_f32 v41, v41, v243
    v_mul_f32 v243, s67, v45
    v_mfma_f32_16x16x32_bf16 v[156:159], a[36:39], a[168:171], v[156:159]
    ds_read_b64_tr_b16 a[160:161], v2 offset:64
    ds_read_b64_tr_b16 a[162:163], v2 offset:2368
    v_mfma_f32_16x16x32_bf16 v[156:159], a[44:47], a[172:175], v[156:159]
    v_exp_f32_e64 v242, v242 clamp
    v_max_f32 v44, s65, v44
    v_add_f32 v42, v42, v244
    v_mul_f32 v244, s67, v46
    v_mfma_f32_16x16x32_bf16 v[152:155], a[40:43], a[172:175], v[152:155]
    ds_read_b64_tr_b16 a[164:165], v2 offset:9280
    ds_read_b64_tr_b16 a[166:167], v2 offset:11584
    v_mfma_f32_16x16x32_bf16 v[152:155], a[32:35], a[168:171], v[152:155]
    s_waitcnt lgkmcnt(8)
    v_exp_f32_e64 v243, v243 clamp
    v_max_f32 v45, s65, v45
    v_add_f32 v43, v43, v245
    v_mfma_f32_16x16x32_bf16 v[88:91], a[48:51], a[144:147], v[88:91]
    ds_read_b64_tr_b16 a[168:169], v2 offset:96
    ds_read_b64_tr_b16 a[170:171], v2 offset:2400
    v_mfma_f32_16x16x32_bf16 v[88:91], a[56:59], a[148:151], v[88:91]
    v_mul_f32 v245, s67, v47
    v_max_f32 v46, s65, v46
    v_exp_f32_e64 v244, v244 clamp
    v_mfma_f32_16x16x32_bf16 v[92:95], a[60:63], a[148:151], v[92:95]
    ds_read_b64_tr_b16 a[172:173], v2 offset:9312
    ds_read_b64_tr_b16 a[174:175], v2 offset:11616
    v_mfma_f32_16x16x32_bf16 v[92:95], a[52:55], a[144:147], v[92:95]
    s_waitcnt lgkmcnt(8)
    v_add_f32 v44, v44, v242
    v_mul_f32 v242, s67, v48
    v_exp_f32_e64 v245, v245 clamp
    v_max_f32 v47, s65, v47
    v_mfma_f32_16x16x32_bf16 v[100:103], a[52:55], a[152:155], v[100:103]
    ds_read_b64_tr_b16 a[144:145], v2 offset:128
    ds_read_b64_tr_b16 a[146:147], v2 offset:2432
    v_mfma_f32_16x16x32_bf16 v[100:103], a[60:63], a[156:159], v[100:103]
    v_add_f32 v45, v45, v243
    v_mul_f32 v243, s67, v49
    v_cvt_pk_bf16_f32 v32, v32, v33
    v_cvt_pk_bf16_f32 v33, v34, v35
    v_mfma_f32_16x16x32_bf16 v[96:99], a[56:59], a[156:159], v[96:99]
    ds_read_b64_tr_b16 a[148:149], v2 offset:9344
    ds_read_b64_tr_b16 a[150:151], v2 offset:11648
    v_mfma_f32_16x16x32_bf16 v[96:99], a[48:51], a[152:155], v[96:99]
    s_waitcnt lgkmcnt(8)
    v_cvt_pk_bf16_f32 v34, v36, v37
    v_cvt_pk_bf16_f32 v35, v38, v39
    v_mfma_f32_16x16x32_bf16 v[104:107], a[48:51], a[160:163], v[104:107]
    ds_read_b64_tr_b16 a[152:153], v2 offset:160
    ds_read_b64_tr_b16 a[154:155], v2 offset:2464
    v_mfma_f32_16x16x32_bf16 v[104:107], a[56:59], a[164:167], v[104:107]
    ds_write_b128 v9, v[32:35] offset:8192
    v_mfma_f32_16x16x32_bf16 v[108:111], a[60:63], a[164:167], v[108:111]
    ds_read_b64_tr_b16 a[156:157], v2 offset:9376
    ds_read_b64_tr_b16 a[158:159], v2 offset:11680
    v_mfma_f32_16x16x32_bf16 v[108:111], a[52:55], a[160:163], v[108:111]
    s_waitcnt lgkmcnt(9)
    v_exp_f32_e64 v242, v242 clamp
    v_max_f32 v48, s65, v48
    v_add_f32 v46, v46, v244
    v_mul_f32 v244, s67, v50
    v_mfma_f32_16x16x32_bf16 v[116:119], a[52:55], a[168:171], v[116:119]
    ds_read_b64_tr_b16 a[160:161], v2 offset:192
    ds_read_b64_tr_b16 a[162:163], v2 offset:2496
    v_mfma_f32_16x16x32_bf16 v[116:119], a[60:63], a[172:175], v[116:119]
    v_exp_f32_e64 v243, v243 clamp
    v_max_f32 v49, s65, v49
    v_add_f32 v47, v47, v245
    v_mfma_f32_16x16x32_bf16 v[112:115], a[56:59], a[172:175], v[112:115]
    ds_read_b64_tr_b16 a[164:165], v2 offset:9408
    ds_read_b64_tr_b16 a[166:167], v2 offset:11712
    v_mfma_f32_16x16x32_bf16 v[112:115], a[48:51], a[168:171], v[112:115]
    s_waitcnt lgkmcnt(9)
    v_mul_f32 v245, s67, v51
    v_max_f32 v50, s65, v50
    v_exp_f32_e64 v244, v244 clamp
    v_add_f32 v48, v48, v242
    v_mfma_f32_16x16x32_bf16 v[120:123], a[48:51], a[144:147], v[120:123]
    ds_read_b64_tr_b16 a[168:169], v2 offset:224
    ds_read_b64_tr_b16 a[170:171], v2 offset:2528
    v_mfma_f32_16x16x32_bf16 v[120:123], a[56:59], a[148:151], v[120:123]
    v_mul_f32 v242, s67, v52
    v_max_f32 v51, s65, v51
    v_exp_f32_e64 v245, v245 clamp
    v_mfma_f32_16x16x32_bf16 v[124:127], a[60:63], a[148:151], v[124:127]
    ds_read_b64_tr_b16 a[172:173], v2 offset:9440
    ds_read_b64_tr_b16 a[174:175], v2 offset:11744
    v_mfma_f32_16x16x32_bf16 v[124:127], a[52:55], a[144:147], v[124:127]
    s_waitcnt lgkmcnt(8)
    v_add_f32 v49, v49, v243
    v_mul_f32 v243, s67, v53
    v_exp_f32_e64 v242, v242 clamp
    v_mfma_f32_16x16x32_bf16 v[132:135], a[52:55], a[152:155], v[132:135]
    ds_read_b64_tr_b16 a[144:145], v2 offset:256
    ds_read_b64_tr_b16 a[146:147], v2 offset:2560
    v_mfma_f32_16x16x32_bf16 v[132:135], a[60:63], a[156:159], v[132:135]
    v_max_f32 v52, s65, v52
    v_add_f32 v50, v50, v244
    v_mul_f32 v244, s67, v54
    v_mfma_f32_16x16x32_bf16 v[128:131], a[56:59], a[156:159], v[128:131]
    ds_read_b64_tr_b16 a[148:149], v2 offset:9472
    ds_read_b64_tr_b16 a[150:151], v2 offset:11776
    v_mfma_f32_16x16x32_bf16 v[128:131], a[48:51], a[152:155], v[128:131]
    s_waitcnt vmcnt(7) lgkmcnt(8)
    s_barrier
    v_max_f32 v53, s65, v53
    v_exp_f32_e64 v243, v243 clamp
    v_add_f32 v51, v51, v245
    v_mfma_f32_16x16x32_bf16 v[136:139], a[48:51], a[160:163], v[136:139]
    s_add_u32 m0, s60, 0xd800
    ds_read_b64_tr_b16 a[152:153], v2 offset:18432
    ds_read_b64_tr_b16 a[154:155], v2 offset:20736
    v_mfma_f32_16x16x32_bf16 v[136:139], a[56:59], a[164:167], v[136:139]
    s_add_u32 s66, s98, 0x900
    buffer_load_dwordx4 v4, s[36:39], s66 offen lds
    v_mfma_f32_16x16x32_bf16 v[140:143], a[60:63], a[164:167], v[140:143]
    ds_read_b64_tr_b16 a[156:157], v2 offset:27648
    ds_read_b64_tr_b16 a[158:159], v2 offset:29952
    v_mfma_f32_16x16x32_bf16 v[140:143], a[52:55], a[160:163], v[140:143]
    s_waitcnt lgkmcnt(8)
    v_mul_f32 v245, s67, v55
    v_max_f32 v54, s65, v54
    v_exp_f32_e64 v244, v244 clamp
    v_mfma_f32_16x16x32_bf16 v[148:151], a[52:55], a[168:171], v[148:151]
    ds_read_b64_tr_b16 a[160:161], v2 offset:18464
    ds_read_b64_tr_b16 a[162:163], v2 offset:20768
    v_mfma_f32_16x16x32_bf16 v[148:151], a[60:63], a[172:175], v[148:151]
L_pad_a2:
    s_cbranch_execz L_pad_a6
    buffer_load_dwordx4 v5, s[36:39], s66 offen offset:1024 lds
    v_mfma_f32_16x16x32_bf16 v[144:147], a[56:59], a[172:175], v[144:147]
    ds_read_b64_tr_b16 a[164:165], v2 offset:27680
    ds_read_b64_tr_b16 a[166:167], v2 offset:29984
    v_mfma_f32_16x16x32_bf16 v[144:147], a[48:51], a[168:171], v[144:147]
    s_waitcnt lgkmcnt(8)
    v_add_f32 v52, v52, v242
    v_mul_f32 v242, s67, v56
    v_exp_f32_e64 v245, v245 clamp
    v_mfma_f32_16x16x32_bf16 v[152:155], a[48:51], a[144:147], v[152:155]
    ds_read_b64_tr_b16 a[168:169], v2 offset:18496
    ds_read_b64_tr_b16 a[170:171], v2 offset:20800
    v_mfma_f32_16x16x32_bf16 v[152:155], a[56:59], a[148:151], v[152:155]
    buffer_load_dwordx4 v6, s[36:39], s66 offen offset:2048 lds
    v_mfma_f32_16x16x32_bf16 v[156:159], a[60:63], a[148:151], v[156:159]
    ds_read_b64_tr_b16 a[172:173], v2 offset:27712
    ds_read_b64_tr_b16 a[174:175], v2 offset:30016
    v_mfma_f32_16x16x32_bf16 v[156:159], a[52:55], a[144:147], v[156:159]
    s_waitcnt lgkmcnt(8)
    buffer_load_dwordx4 v7, s[36:39], s66 offen offset:3072 lds
    v_mfma_f32_16x16x32_bf16 v[92:95], a[68:71], a[152:155], v[92:95]
    ds_read_b64_tr_b16 a[144:145], v2 offset:18528
    ds_read_b64_tr_b16 a[146:147], v2 offset:20832
    v_mfma_f32_16x16x32_bf16 v[92:95], a[76:79], a[156:159], v[92:95]
    v_max_f32 v55, s65, v55
    v_add_f32 v53, v53, v243
    v_mul_f32 v243, s67, v57
    v_cvt_pk_bf16_f32 v40, v40, v41
    v_cvt_pk_bf16_f32 v41, v42, v43
    v_mfma_f32_16x16x32_bf16 v[88:91], a[72:75], a[156:159], v[88:91]
    s_add_u32 m0, s60, 0xe800
    ds_read_b64_tr_b16 a[148:149], v2 offset:27744
    ds_read_b64_tr_b16 a[150:151], v2 offset:30048
    v_mfma_f32_16x16x32_bf16 v[88:91], a[64:67], a[152:155], v[88:91]
    s_waitcnt lgkmcnt(8)
    buffer_load_dwordx4 v8, s[36:39], s66 offen lds
    v_mfma_f32_16x16x32_bf16 v[96:99], a[64:67], a[160:163], v[96:99]
    ds_read_b64_tr_b16 a[152:153], v2 offset:18560
    ds_read_b64_tr_b16 a[154:155], v2 offset:20864
    v_mfma_f32_16x16x32_bf16 v[96:99], a[72:75], a[164:167], v[96:99]
    v_cvt_pk_bf16_f32 v42, v44, v45
    v_cvt_pk_bf16_f32 v43, v46, v47
    v_mfma_f32_16x16x32_bf16 v[100:103], a[76:79], a[164:167], v[100:103]
    s_add_u32 m0, s60, 0x12000
    ds_read_b64_tr_b16 a[156:157], v2 offset:27776
    ds_read_b64_tr_b16 a[158:159], v2 offset:30080
    v_mfma_f32_16x16x32_bf16 v[100:103], a[68:71], a[160:163], v[100:103]
    s_waitcnt lgkmcnt(8)
    s_add_u32 s66, s98, 0x36900
    buffer_load_dwordx4 v4, s[36:39], s66 offen lds
    v_mfma_f32_16x16x32_bf16 v[108:111], a[68:71], a[168:171], v[108:111]
    ds_read_b64_tr_b16 a[160:161], v2 offset:18592
    ds_read_b64_tr_b16 a[162:163], v2 offset:20896
    v_mfma_f32_16x16x32_bf16 v[108:111], a[76:79], a[172:175], v[108:111]
    buffer_load_dwordx4 v5, s[36:39], s66 offen offset:1024 lds
    v_mfma_f32_16x16x32_bf16 v[104:107], a[72:75], a[172:175], v[104:107]
    ds_read_b64_tr_b16 a[164:165], v2 offset:27808
    ds_read_b64_tr_b16 a[166:167], v2 offset:30112
    v_mfma_f32_16x16x32_bf16 v[104:107], a[64:67], a[168:171], v[104:107]
    s_waitcnt lgkmcnt(8)
    ds_write_b128 v9, v[40:43] offset:12288
    v_mfma_f32_16x16x32_bf16 v[112:115], a[64:67], a[144:147], v[112:115]
    ds_read_b64_tr_b16 a[168:169], v2 offset:18624
    ds_read_b64_tr_b16 a[170:171], v2 offset:20928
    v_mfma_f32_16x16x32_bf16 v[112:115], a[72:75], a[148:151], v[112:115]
    buffer_load_dwordx4 v6, s[36:39], s66 offen offset:2048 lds
    v_mfma_f32_16x16x32_bf16 v[116:119], a[76:79], a[148:151], v[116:119]
    ds_read_b64_tr_b16 a[172:173], v2 offset:27840
    ds_read_b64_tr_b16 a[174:175], v2 offset:30144
    v_mfma_f32_16x16x32_bf16 v[116:119], a[68:71], a[144:147], v[116:119]
    s_waitcnt lgkmcnt(9)
    v_exp_f32_e64 v242, v242 clamp
    v_max_f32 v56, s65, v56
    v_add_f32 v54, v54, v244
    v_mul_f32 v244, s67, v58
    v_mfma_f32_16x16x32_bf16 v[124:127], a[68:71], a[152:155], v[124:127]
    ds_read_b64_tr_b16 a[144:145], v2 offset:18656
    ds_read_b64_tr_b16 a[146:147], v2 offset:20960
    v_mfma_f32_16x16x32_bf16 v[124:127], a[76:79], a[156:159], v[124:127]
    buffer_load_dwordx4 v7, s[36:39], s66 offen offset:3072 lds
    v_mfma_f32_16x16x32_bf16 v[120:123], a[72:75], a[156:159], v[120:123]
    ds_read_b64_tr_b16 a[148:149], v2 offset:27872
    ds_read_b64_tr_b16 a[150:151], v2 offset:30176
    v_mfma_f32_16x16x32_bf16 v[120:123], a[64:67], a[152:155], v[120:123]
    s_waitcnt lgkmcnt(9)
    v_exp_f32_e64 v243, v243 clamp
    v_max_f32 v57, s65, v57
    v_add_f32 v55, v55, v245
    v_mfma_f32_16x16x32_bf16 v[128:131], a[64:67], a[160:163], v[128:131]
    s_add_u32 m0, s60, 0x13000
    ds_read_b64_tr_b16 a[152:153], v2 offset:18688
    ds_read_b64_tr_b16 a[154:155], v2 offset:20992
    v_mfma_f32_16x16x32_bf16 v[128:131], a[72:75], a[164:167], v[128:131]
    buffer_load_dwordx4 v8, s[36:39], s66 offen lds
    v_mfma_f32_16x16x32_bf16 v[132:135], a[76:79], a[164:167], v[132:135]
    ds_read_b64_tr_b16 a[156:157], v2 offset:27904
    ds_read_b64_tr_b16 a[158:159], v2 offset:30208
    v_mfma_f32_16x16x32_bf16 v[132:135], a[68:71], a[160:163], v[132:135]
    s_waitcnt vmcnt(12) lgkmcnt(8)
    s_barrier
    v_mul_f32 v245, s67, v59
    v_mfma_f32_16x16x32_bf16 v[140:143], a[68:71], a[168:171], v[140:143]
    s_add_u32 m0, s60, 0x16800
    ds_read_b64_tr_b16 a[160:161], v2 offset:36864
    ds_read_b64_tr_b16 a[162:163], v2 offset:39168
    v_mfma_f32_16x16x32_bf16 v[140:143], a[76:79], a[172:175], v[140:143]
    s_add_u32 s66, s98, 0x6c900
    buffer_load_dwordx4 v4, s[36:39], s66 offen lds
    v_mfma_f32_16x16x32_bf16 v[136:139], a[72:75], a[172:175], v[136:139]
    ds_read_b64_tr_b16 a[164:165], v2 offset:46080
    ds_read_b64_tr_b16 a[166:167], v2 offset:48384
    v_mfma_f32_16x16x32_bf16 v[136:139], a[64:67], a[168:171], v[136:139]
    s_waitcnt lgkmcnt(8)
    v_exp_f32_e64 v244, v244 clamp
    v_max_f32 v58, s65, v58
    v_add_f32 v56, v56, v242
    v_mul_f32 v242, s67, v60
    v_mfma_f32_16x16x32_bf16 v[144:147], a[64:67], a[144:147], v[144:147]
    ds_read_b64_tr_b16 a[168:169], v2 offset:36896
    ds_read_b64_tr_b16 a[170:171], v2 offset:39200
    v_mfma_f32_16x16x32_bf16 v[144:147], a[72:75], a[148:151], v[144:147]
    buffer_load_dwordx4 v5, s[36:39], s66 offen offset:1024 lds
    v_mfma_f32_16x16x32_bf16 v[148:151], a[76:79], a[148:151], v[148:151]
    ds_read_b64_tr_b16 a[172:173], v2 offset:46112
    ds_read_b64_tr_b16 a[174:175], v2 offset:48416
    v_mfma_f32_16x16x32_bf16 v[148:151], a[68:71], a[144:147], v[148:151]
    s_waitcnt lgkmcnt(8)
    v_exp_f32_e64 v245, v245 clamp
    v_max_f32 v59, s65, v59
    v_add_f32 v57, v57, v243
    v_mul_f32 v243, s67, v61
    v_mfma_f32_16x16x32_bf16 v[156:159], a[68:71], a[152:155], v[156:159]
    ds_read_b64_tr_b16 a[144:145], v2 offset:36928
    ds_read_b64_tr_b16 a[146:147], v2 offset:39232
    v_mfma_f32_16x16x32_bf16 v[156:159], a[76:79], a[156:159], v[156:159]
    buffer_load_dwordx4 v6, s[36:39], s66 offen offset:2048 lds
    v_mfma_f32_16x16x32_bf16 v[152:155], a[72:75], a[156:159], v[152:155]
    ds_read_b64_tr_b16 a[148:149], v2 offset:46144
    ds_read_b64_tr_b16 a[150:151], v2 offset:48448
    v_mfma_f32_16x16x32_bf16 v[152:155], a[64:67], a[152:155], v[152:155]
    s_waitcnt lgkmcnt(8)
    buffer_load_dwordx4 v7, s[36:39], s66 offen offset:3072 lds
    v_mfma_f32_16x16x32_bf16 v[88:91], a[80:83], a[160:163], v[88:91]
    ds_read_b64_tr_b16 a[152:153], v2 offset:36960
    ds_read_b64_tr_b16 a[154:155], v2 offset:39264
    v_mfma_f32_16x16x32_bf16 v[88:91], a[88:91], a[164:167], v[88:91]
    v_exp_f32_e64 v242, v242 clamp
    v_max_f32 v60, s65, v60
    v_add_f32 v58, v58, v244
    v_mfma_f32_16x16x32_bf16 v[92:95], a[92:95], a[164:167], v[92:95]
    s_add_u32 m0, s60, 0x17800
    ds_read_b64_tr_b16 a[156:157], v2 offset:46176
    ds_read_b64_tr_b16 a[158:159], v2 offset:48480
    v_mfma_f32_16x16x32_bf16 v[92:95], a[84:87], a[160:163], v[92:95]
    s_waitcnt lgkmcnt(8)
    buffer_load_dwordx4 v8, s[36:39], s66 offen lds
    v_mfma_f32_16x16x32_bf16 v[100:103], a[84:87], a[168:171], v[100:103]
    ds_read_b64_tr_b16 a[160:161], v2 offset:36992
    ds_read_b64_tr_b16 a[162:163], v2 offset:39296
    v_mfma_f32_16x16x32_bf16 v[100:103], a[92:95], a[172:175], v[100:103]
    v_mul_f32 v244, s67, v62
    v_max_f32 v61, s65, v61
    v_exp_f32_e64 v243, v243 clamp
    v_mfma_f32_16x16x32_bf16 v[96:99], a[88:91], a[172:175], v[96:99]
    s_add_u32 m0, s60, 0
    ds_read_b64_tr_b16 a[164:165], v2 offset:46208
    ds_read_b64_tr_b16 a[166:167], v2 offset:48512
    v_mfma_f32_16x16x32_bf16 v[96:99], a[80:83], a[168:171], v[96:99]
    s_waitcnt lgkmcnt(8)
    s_add_u32 s66, s96, 0
    buffer_load_dwordx4 v4, s[36:39], s66 offen lds
    v_mfma_f32_16x16x32_bf16 v[104:107], a[80:83], a[144:147], v[104:107]
    ds_read_b64_tr_b16 a[168:169], v2 offset:37024
    ds_read_b64_tr_b16 a[170:171], v2 offset:39328
    v_mfma_f32_16x16x32_bf16 v[104:107], a[88:91], a[148:151], v[104:107]
    buffer_load_dwordx4 v5, s[36:39], s66 offen offset:1024 lds
    v_mfma_f32_16x16x32_bf16 v[108:111], a[92:95], a[148:151], v[108:111]
    ds_read_b64_tr_b16 a[172:173], v2 offset:46240
    ds_read_b64_tr_b16 a[174:175], v2 offset:48544
    v_mfma_f32_16x16x32_bf16 v[108:111], a[84:87], a[144:147], v[108:111]
    s_waitcnt lgkmcnt(8)
    v_add_f32 v59, v59, v245
    v_mul_f32 v245, s67, v63
    v_exp_f32_e64 v244, v244 clamp
    v_max_f32 v62, s65, v62
    v_mfma_f32_16x16x32_bf16 v[116:119], a[84:87], a[152:155], v[116:119]
    ds_read_b64_tr_b16 a[144:145], v2 offset:37056
    ds_read_b64_tr_b16 a[146:147], v2 offset:39360
    v_mfma_f32_16x16x32_bf16 v[116:119], a[92:95], a[156:159], v[116:119]
    buffer_load_dwordx4 v6, s[36:39], s66 offen offset:2048 lds
    v_mfma_f32_16x16x32_bf16 v[112:115], a[88:91], a[156:159], v[112:115]
    ds_read_b64_tr_b16 a[148:149], v2 offset:46272
    ds_read_b64_tr_b16 a[150:151], v2 offset:48576
    v_mfma_f32_16x16x32_bf16 v[112:115], a[80:83], a[152:155], v[112:115]
    s_waitcnt lgkmcnt(8)
    v_add_f32 v60, v60, v242
    v_mul_f32 v242, s67, v64
    v_exp_f32_e64 v245, v245 clamp
    v_mfma_f32_16x16x32_bf16 v[120:123], a[80:83], a[160:163], v[120:123]
    ds_read_b64_tr_b16 a[152:153], v2 offset:37088
    ds_read_b64_tr_b16 a[154:155], v2 offset:39392
    v_mfma_f32_16x16x32_bf16 v[120:123], a[88:91], a[164:167], v[120:123]
    buffer_load_dwordx4 v7, s[36:39], s66 offen offset:3072 lds
    v_mfma_f32_16x16x32_bf16 v[124:127], a[92:95], a[164:167], v[124:127]
    ds_read_b64_tr_b16 a[156:157], v2 offset:46304
    ds_read_b64_tr_b16 a[158:159], v2 offset:48608
    v_mfma_f32_16x16x32_bf16 v[124:127], a[84:87], a[160:163], v[124:127]
    s_waitcnt lgkmcnt(8)
    v_max_f32 v63, s65, v63
    v_add_f32 v61, v61, v243
    v_mul_f32 v243, s67, v65
    v_cvt_pk_bf16_f32 v48, v48, v49
    v_mfma_f32_16x16x32_bf16 v[132:135], a[84:87], a[168:171], v[132:135]
    s_add_u32 m0, s60, 0x1000
    ds_read_b64_tr_b16 a[160:161], v2 offset:37120
    ds_read_b64_tr_b16 a[162:163], v2 offset:39424
    v_mfma_f32_16x16x32_bf16 v[132:135], a[92:95], a[172:175], v[132:135]
    buffer_load_dwordx4 v8, s[36:39], s66 offen lds
    v_mfma_f32_16x16x32_bf16 v[128:131], a[88:91], a[172:175], v[128:131]
    ds_read_b64_tr_b16 a[164:165], v2 offset:46336
    ds_read_b64_tr_b16 a[166:167], v2 offset:48640
    v_mfma_f32_16x16x32_bf16 v[128:131], a[80:83], a[168:171], v[128:131]
    s_waitcnt vmcnt(15) lgkmcnt(8)
    s_barrier
    v_cvt_pk_bf16_f32 v49, v50, v51
    v_cvt_pk_bf16_f32 v50, v52, v53
    v_mfma_f32_16x16x32_bf16 v[136:139], a[80:83], a[144:147], v[136:139]
    s_add_u32 m0, s60, 0x4800
    ds_read_b64_tr_b16 a[168:169], v3
    ds_read_b64_tr_b16 a[170:171], v3 offset:2304
    v_mfma_f32_16x16x32_bf16 v[136:139], a[88:91], a[148:151], v[136:139]
    s_add_u32 s66, s96, 0x36000
    buffer_load_dwordx4 v4, s[36:39], s66 offen lds
    v_mfma_f32_16x16x32_bf16 v[140:143], a[92:95], a[148:151], v[140:143]
    ds_read_b64_tr_b16 a[172:173], v3 offset:9216
    ds_read_b64_tr_b16 a[174:175], v3 offset:11520
    v_mfma_f32_16x16x32_bf16 v[140:143], a[84:87], a[144:147], v[140:143]
    s_waitcnt lgkmcnt(8)
    v_cvt_pk_bf16_f32 v51, v54, v55
    v_max_f32 v64, s65, v64
    v_mfma_f32_16x16x32_bf16 v[148:151], a[84:87], a[152:155], v[148:151]
    ds_read_b64_tr_b16 a[144:145], v3 offset:32
    ds_read_b64_tr_b16 a[146:147], v3 offset:2336
    v_mfma_f32_16x16x32_bf16 v[148:151], a[92:95], a[156:159], v[148:151]
    buffer_load_dwordx4 v5, s[36:39], s66 offen offset:1024 lds
    v_mfma_f32_16x16x32_bf16 v[144:147], a[88:91], a[156:159], v[144:147]
    ds_read_b64_tr_b16 a[148:149], v3 offset:9248
    ds_read_b64_tr_b16 a[150:151], v3 offset:11552
    v_mfma_f32_16x16x32_bf16 v[144:147], a[80:83], a[152:155], v[144:147]
    s_waitcnt lgkmcnt(8)
    ds_write_b128 v9, v[48:51] offset:16384
    v_mfma_f32_16x16x32_bf16 v[152:155], a[80:83], a[160:163], v[152:155]
    ds_read_b64_tr_b16 a[152:153], v3 offset:64
    ds_read_b64_tr_b16 a[154:155], v3 offset:2368
    v_mfma_f32_16x16x32_bf16 v[152:155], a[88:91], a[164:167], v[152:155]
    buffer_load_dwordx4 v6, s[36:39], s66 offen offset:2048 lds
    v_mfma_f32_16x16x32_bf16 v[156:159], a[92:95], a[164:167], v[156:159]
    ds_read_b64_tr_b16 a[156:157], v3 offset:9280
    ds_read_b64_tr_b16 a[158:159], v3 offset:11584
    v_mfma_f32_16x16x32_bf16 v[156:159], a[84:87], a[160:163], v[156:159]
    s_waitcnt lgkmcnt(9)
    v_exp_f32_e64 v242, v242 clamp
    v_add_f32 v62, v62, v244
    v_mul_f32 v244, s67, v66
    v_mfma_f32_16x16x32_bf16 v[92:95], a[100:103], a[168:171], v[92:95]
    ds_read_b64_tr_b16 a[160:161], v3 offset:96
    ds_read_b64_tr_b16 a[162:163], v3 offset:2400
    v_mfma_f32_16x16x32_bf16 v[92:95], a[108:111], a[172:175], v[92:95]
    buffer_load_dwordx4 v7, s[36:39], s66 offen offset:3072 lds
    v_mfma_f32_16x16x32_bf16 v[88:91], a[104:107], a[172:175], v[88:91]
    ds_read_b64_tr_b16 a[164:165], v3 offset:9312
    ds_read_b64_tr_b16 a[166:167], v3 offset:11616
    v_mfma_f32_16x16x32_bf16 v[88:91], a[96:99], a[168:171], v[88:91]
    s_waitcnt lgkmcnt(9)
    v_add_u32 v250, s88, v1
    v_add_u32 v252, s89, v1
    v_mfma_f32_16x16x32_bf16 v[96:99], a[96:99], a[144:147], v[96:99]
    s_add_u32 m0, s60, 0x5800
    ds_read_b64_tr_b16 a[168:169], v3 offset:128
    ds_read_b64_tr_b16 a[170:171], v3 offset:2432
    v_mfma_f32_16x16x32_bf16 v[96:99], a[104:107], a[148:151], v[96:99]
    buffer_load_dwordx4 v8, s[36:39], s66 offen lds
    v_mfma_f32_16x16x32_bf16 v[100:103], a[108:111], a[148:151], v[100:103]
    ds_read_b64_tr_b16 a[172:173], v3 offset:9344
    ds_read_b64_tr_b16 a[174:175], v3 offset:11648
    v_mfma_f32_16x16x32_bf16 v[100:103], a[100:103], a[144:147], v[100:103]
    s_waitcnt lgkmcnt(8)
    v_add_u32 v251, 0x23000, v1
    v_max_f32 v65, s65, v65
    v_exp_f32_e64 v243, v243 clamp
    v_mfma_f32_16x16x32_bf16 v[108:111], a[100:103], a[152:155], v[108:111]
    ds_read_b64_tr_b16 a[144:145], v3 offset:160
    ds_read_b64_tr_b16 a[146:147], v3 offset:2464
    v_mfma_f32_16x16x32_bf16 v[108:111], a[108:111], a[156:159], v[108:111]
    buffer_load_dword v253, v12, s[40:43], s69 offen
    v_mfma_f32_16x16x32_bf16 v[104:107], a[104:107], a[156:159], v[104:107]
    ds_read_b64_tr_b16 a[148:149], v3 offset:9376
    ds_read_b64_tr_b16 a[150:151], v3 offset:11680
    v_mfma_f32_16x16x32_bf16 v[104:107], a[96:99], a[152:155], v[104:107]
    s_waitcnt lgkmcnt(8)
    v_add_f32 v63, v63, v245
    v_mul_f32 v245, s67, v67
    v_exp_f32_e64 v244, v244 clamp
    v_max_f32 v66, s65, v66
    v_mfma_f32_16x16x32_bf16 v[112:115], a[96:99], a[160:163], v[112:115]
    ds_read_b64_tr_b16 a[152:153], v3 offset:192
    ds_read_b64_tr_b16 a[154:155], v3 offset:2496
    v_mfma_f32_16x16x32_bf16 v[112:115], a[104:107], a[164:167], v[112:115]
    v_add_f32 v64, v64, v242
    v_mul_f32 v242, s67, v68
    v_exp_f32_e64 v245, v245 clamp
    v_mfma_f32_16x16x32_bf16 v[116:119], a[108:111], a[164:167], v[116:119]
    ds_read_b64_tr_b16 a[156:157], v3 offset:9408
    ds_read_b64_tr_b16 a[158:159], v3 offset:11712
    v_mfma_f32_16x16x32_bf16 v[116:119], a[100:103], a[160:163], v[116:119]
    s_waitcnt lgkmcnt(8)
    v_lshrrev_b32 v240, 5, v0
    v_max_f32 v67, s65, v67
    v_add_f32 v65, v65, v243
    v_mfma_f32_16x16x32_bf16 v[124:127], a[100:103], a[168:171], v[124:127]
    ds_read_b64_tr_b16 a[160:161], v3 offset:224
    ds_read_b64_tr_b16 a[162:163], v3 offset:2528
    v_mfma_f32_16x16x32_bf16 v[124:127], a[108:111], a[172:175], v[124:127]
    v_mul_f32 v243, s67, v69
    v_max_f32 v68, s65, v68
    v_exp_f32_e64 v242, v242 clamp
    v_add_f32 v66, v66, v244
    v_mfma_f32_16x16x32_bf16 v[120:123], a[104:107], a[172:175], v[120:123]
    ds_read_b64_tr_b16 a[164:165], v3 offset:9440
    ds_read_b64_tr_b16 a[166:167], v3 offset:11744
    v_mfma_f32_16x16x32_bf16 v[120:123], a[96:99], a[168:171], v[120:123]
    s_waitcnt lgkmcnt(8)
    v_mul_f32 v244, s67, v70
    v_max_f32 v69, s65, v69
    v_exp_f32_e64 v243, v243 clamp
    v_mfma_f32_16x16x32_bf16 v[128:131], a[96:99], a[144:147], v[128:131]
    ds_read_b64_tr_b16 a[168:169], v3 offset:256
    ds_read_b64_tr_b16 a[170:171], v3 offset:2560
    v_mfma_f32_16x16x32_bf16 v[128:131], a[104:107], a[148:151], v[128:131]
    v_add_f32 v67, v67, v245
    v_mul_f32 v245, s67, v71
    v_exp_f32_e64 v244, v244 clamp
    v_mfma_f32_16x16x32_bf16 v[132:135], a[108:111], a[148:151], v[132:135]
    ds_read_b64_tr_b16 a[172:173], v3 offset:9472
    ds_read_b64_tr_b16 a[174:175], v3 offset:11776
    v_mfma_f32_16x16x32_bf16 v[132:135], a[100:103], a[144:147], v[132:135]
    s_waitcnt vmcnt(16) lgkmcnt(8)
    s_barrier
    v_max_f32 v70, s65, v70
    v_add_f32 v68, v68, v242
    v_mfma_f32_16x16x32_bf16 v[140:143], a[100:103], a[152:155], v[140:143]
    ds_read_b64_tr_b16 a[144:145], v3 offset:18432
    ds_read_b64_tr_b16 a[146:147], v3 offset:20736
    v_mfma_f32_16x16x32_bf16 v[140:143], a[108:111], a[156:159], v[140:143]
    v_lshl_add_u32 v240, v240, 28, s92
    v_mul_f32 v242, s67, v72
    v_exp_f32_e64 v245, v245 clamp
    v_mfma_f32_16x16x32_bf16 v[136:139], a[104:107], a[156:159], v[136:139]
    ds_read_b64_tr_b16 a[148:149], v3 offset:27648
    ds_read_b64_tr_b16 a[150:151], v3 offset:29952
    v_mfma_f32_16x16x32_bf16 v[136:139], a[96:99], a[152:155], v[136:139]
    s_waitcnt lgkmcnt(8)
    v_max_f32 v71, s65, v71
    v_add_f32 v69, v69, v243
    v_mul_f32 v243, s67, v73
    v_cvt_pk_bf16_f32 v56, v56, v57
    v_mfma_f32_16x16x32_bf16 v[144:147], a[96:99], a[160:163], v[144:147]
    ds_read_b64_tr_b16 a[152:153], v3 offset:18464
    ds_read_b64_tr_b16 a[154:155], v3 offset:20768
    v_mfma_f32_16x16x32_bf16 v[144:147], a[104:107], a[164:167], v[144:147]
    v_cvt_pk_bf16_f32 v57, v58, v59
    v_cvt_pk_bf16_f32 v58, v60, v61
    v_cvt_pk_bf16_f32 v59, v62, v63
    v_mfma_f32_16x16x32_bf16 v[148:151], a[108:111], a[164:167], v[148:151]
    ds_read_b64_tr_b16 a[156:157], v3 offset:27680
    ds_read_b64_tr_b16 a[158:159], v3 offset:29984
    v_mfma_f32_16x16x32_bf16 v[148:151], a[100:103], a[160:163], v[148:151]
    s_waitcnt lgkmcnt(8)
    ds_write_b128 v9, v[56:59] offset:20480
    v_mfma_f32_16x16x32_bf16 v[156:159], a[100:103], a[168:171], v[156:159]
    ds_read_b64_tr_b16 a[160:161], v3 offset:18496
    ds_read_b64_tr_b16 a[162:163], v3 offset:20800
    v_mfma_f32_16x16x32_bf16 v[156:159], a[108:111], a[172:175], v[156:159]
    v_exp_f32_e64 v242, v242 clamp
    v_max_f32 v72, s65, v72
    v_add_f32 v70, v70, v244
    v_mfma_f32_16x16x32_bf16 v[152:155], a[104:107], a[172:175], v[152:155]
    ds_read_b64_tr_b16 a[164:165], v3 offset:27712
    ds_read_b64_tr_b16 a[166:167], v3 offset:30016
    v_mfma_f32_16x16x32_bf16 v[152:155], a[96:99], a[168:171], v[152:155]
    s_waitcnt lgkmcnt(9)
    v_lshl_add_u32 v240, v0, 2, v240
    v_mul_f32 v244, s67, v74
    v_mfma_f32_16x16x32_bf16 v[88:91], a[112:115], a[144:147], v[88:91]
    ds_read_b64_tr_b16 a[168:169], v3 offset:18528
    ds_read_b64_tr_b16 a[170:171], v3 offset:20832
    v_mfma_f32_16x16x32_bf16 v[88:91], a[120:123], a[148:151], v[88:91]
    v_exp_f32_e64 v243, v243 clamp
    v_max_f32 v73, s65, v73
    v_add_f32 v71, v71, v245
    v_mul_f32 v245, s67, v75
    v_mfma_f32_16x16x32_bf16 v[92:95], a[124:127], a[148:151], v[92:95]
    ds_read_b64_tr_b16 a[172:173], v3 offset:27744
    ds_read_b64_tr_b16 a[174:175], v3 offset:30048
    v_mfma_f32_16x16x32_bf16 v[92:95], a[116:119], a[144:147], v[92:95]
    s_waitcnt lgkmcnt(9)
    v_exp_f32_e64 v244, v244 clamp
    v_max_f32 v74, s65, v74
    v_add_f32 v72, v72, v242
    v_mul_f32 v242, s67, v76
    v_mfma_f32_16x16x32_bf16 v[100:103], a[116:119], a[152:155], v[100:103]
    ds_read_b64_tr_b16 a[144:145], v3 offset:18560
    ds_read_b64_tr_b16 a[146:147], v3 offset:20864
    v_mfma_f32_16x16x32_bf16 v[100:103], a[124:127], a[156:159], v[100:103]
    v_exp_f32_e64 v245, v245 clamp
    v_max_f32 v75, s65, v75
    v_add_f32 v73, v73, v243
    v_mfma_f32_16x16x32_bf16 v[96:99], a[120:123], a[156:159], v[96:99]
    ds_read_b64_tr_b16 a[148:149], v3 offset:27776
    ds_read_b64_tr_b16 a[150:151], v3 offset:30080
    v_mfma_f32_16x16x32_bf16 v[96:99], a[112:115], a[152:155], v[96:99]
    s_waitcnt lgkmcnt(8)
    v_mul_f32 v243, s67, v77
    v_max_f32 v76, s65, v76
    v_exp_f32_e64 v242, v242 clamp
    v_mfma_f32_16x16x32_bf16 v[104:107], a[112:115], a[160:163], v[104:107]
    ds_read_b64_tr_b16 a[152:153], v3 offset:18592
    ds_read_b64_tr_b16 a[154:155], v3 offset:20896
    v_mfma_f32_16x16x32_bf16 v[104:107], a[120:123], a[164:167], v[104:107]
    v_add_f32 v74, v74, v244
    v_mul_f32 v244, s67, v78
    v_exp_f32_e64 v243, v243 clamp
    v_max_f32 v77, s65, v77
    v_mfma_f32_16x16x32_bf16 v[108:111], a[124:127], a[164:167], v[108:111]
    ds_read_b64_tr_b16 a[156:157], v3 offset:27808
    ds_read_b64_tr_b16 a[158:159], v3 offset:30112
    v_mfma_f32_16x16x32_bf16 v[108:111], a[116:119], a[160:163], v[108:111]
    s_waitcnt lgkmcnt(8)
    v_add_f32 v75, v75, v245
    v_mul_f32 v245, s67, v79
    v_exp_f32_e64 v244, v244 clamp
    v_mfma_f32_16x16x32_bf16 v[116:119], a[116:119], a[168:171], v[116:119]
    ds_read_b64_tr_b16 a[160:161], v3 offset:18624
    ds_read_b64_tr_b16 a[162:163], v3 offset:20928
    v_mfma_f32_16x16x32_bf16 v[116:119], a[124:127], a[172:175], v[116:119]
    v_max_f32 v78, s65, v78
    v_add_f32 v76, v76, v242
    v_mul_f32 v242, s67, v80
    v_mfma_f32_16x16x32_bf16 v[112:115], a[120:123], a[172:175], v[112:115]
    ds_read_b64_tr_b16 a[164:165], v3 offset:27840
    ds_read_b64_tr_b16 a[166:167], v3 offset:30144
    v_mfma_f32_16x16x32_bf16 v[112:115], a[112:115], a[168:171], v[112:115]
    s_waitcnt lgkmcnt(8)
    v_exp_f32_e64 v245, v245 clamp
    v_max_f32 v79, s65, v79
    v_add_f32 v77, v77, v243
    v_mul_f32 v243, s67, v81
    v_mfma_f32_16x16x32_bf16 v[120:123], a[112:115], a[144:147], v[120:123]
    ds_read_b64_tr_b16 a[168:169], v3 offset:18656
    ds_read_b64_tr_b16 a[170:171], v3 offset:20960
    v_mfma_f32_16x16x32_bf16 v[120:123], a[120:123], a[148:151], v[120:123]
    v_cvt_pk_bf16_f32 v64, v64, v65
    v_cvt_pk_bf16_f32 v65, v66, v67
    v_cvt_pk_bf16_f32 v66, v68, v69
    v_cvt_pk_bf16_f32 v67, v70, v71
    v_mfma_f32_16x16x32_bf16 v[124:127], a[124:127], a[148:151], v[124:127]
    ds_read_b64_tr_b16 a[172:173], v3 offset:27872
    ds_read_b64_tr_b16 a[174:175], v3 offset:30176
    v_mfma_f32_16x16x32_bf16 v[124:127], a[116:119], a[144:147], v[124:127]
    s_waitcnt lgkmcnt(8)
    ds_write_b128 v9, v[64:67] offset:24576
    v_mfma_f32_16x16x32_bf16 v[132:135], a[116:119], a[152:155], v[132:135]
    ds_read_b64_tr_b16 a[144:145], v3 offset:18688
    ds_read_b64_tr_b16 a[146:147], v3 offset:20992
    v_mfma_f32_16x16x32_bf16 v[132:135], a[124:127], a[156:159], v[132:135]
    v_exp_f32_e64 v242, v242 clamp
    v_max_f32 v80, s65, v80
    v_mfma_f32_16x16x32_bf16 v[128:131], a[120:123], a[156:159], v[128:131]
    ds_read_b64_tr_b16 a[148:149], v3 offset:27904
    ds_read_b64_tr_b16 a[150:151], v3 offset:30208
    v_mfma_f32_16x16x32_bf16 v[128:131], a[112:115], a[152:155], v[128:131]
    s_waitcnt vmcnt(11) lgkmcnt(9)
    s_barrier
    v_add_f32 v78, v78, v244
    v_mul_f32 v244, s67, v82
    v_mfma_f32_16x16x32_bf16 v[136:139], a[112:115], a[160:163], v[136:139]
    s_add_u32 m0, s60, 0x9000
    ds_read_b64_tr_b16 a[152:153], v3 offset:36864
    ds_read_b64_tr_b16 a[154:155], v3 offset:39168
    v_mfma_f32_16x16x32_bf16 v[136:139], a[120:123], a[164:167], v[136:139]
    s_add_u32 s66, s96, 0x6c000
    buffer_load_dwordx4 v4, s[36:39], s66 offen lds
    v_mfma_f32_16x16x32_bf16 v[140:143], a[124:127], a[164:167], v[140:143]
    ds_read_b64_tr_b16 a[156:157], v3 offset:46080
    ds_read_b64_tr_b16 a[158:159], v3 offset:48384
    v_mfma_f32_16x16x32_bf16 v[140:143], a[116:119], a[160:163], v[140:143]
    s_waitcnt lgkmcnt(9)
    v_exp_f32_e64 v243, v243 clamp
    v_max_f32 v81, s65, v81
    v_add_f32 v79, v79, v245
    v_mul_f32 v245, s67, v83
    v_mfma_f32_16x16x32_bf16 v[148:151], a[116:119], a[168:171], v[148:151]
    ds_read_b64_tr_b16 a[160:161], v3 offset:36896
    ds_read_b64_tr_b16 a[162:163], v3 offset:39200
    v_mfma_f32_16x16x32_bf16 v[148:151], a[124:127], a[172:175], v[148:151]
    buffer_load_dwordx4 v5, s[36:39], s66 offen offset:1024 lds
    v_mfma_f32_16x16x32_bf16 v[144:147], a[120:123], a[172:175], v[144:147]
    ds_read_b64_tr_b16 a[164:165], v3 offset:46112
    ds_read_b64_tr_b16 a[166:167], v3 offset:48416
    v_mfma_f32_16x16x32_bf16 v[144:147], a[112:115], a[168:171], v[144:147]
    s_waitcnt lgkmcnt(8)
    v_exp_f32_e64 v244, v244 clamp
    v_max_f32 v82, s65, v82
    v_add_f32 v80, v80, v242
    v_mfma_f32_16x16x32_bf16 v[152:155], a[112:115], a[144:147], v[152:155]
    ds_read_b64_tr_b16 a[168:169], v3 offset:36928
    ds_read_b64_tr_b16 a[170:171], v3 offset:39232
    v_mfma_f32_16x16x32_bf16 v[152:155], a[120:123], a[148:151], v[152:155]
    buffer_load_dwordx4 v6, s[36:39], s66 offen offset:2048 lds
    v_mfma_f32_16x16x32_bf16 v[156:159], a[124:127], a[148:151], v[156:159]
    ds_read_b64_tr_b16 a[172:173], v3 offset:46144
    ds_read_b64_tr_b16 a[174:175], v3 offset:48448
    v_mfma_f32_16x16x32_bf16 v[156:159], a[116:119], a[144:147], v[156:159]
    s_waitcnt lgkmcnt(8)
    buffer_load_dwordx4 v7, s[36:39], s66 offen offset:3072 lds
    v_mfma_f32_16x16x32_bf16 v[92:95], a[132:135], a[152:155], v[92:95]
    ds_read_b64_tr_b16 a[144:145], v3 offset:36960
    ds_read_b64_tr_b16 a[146:147], v3 offset:39264
    v_mfma_f32_16x16x32_bf16 v[92:95], a[140:143], a[156:159], v[92:95]
    v_mul_f32 v242, s67, v84
    v_max_f32 v83, s65, v83
    v_exp_f32_e64 v245, v245 clamp
    v_add_f32 v81, v81, v243
    v_mfma_f32_16x16x32_bf16 v[88:91], a[136:139], a[156:159], v[88:91]
    s_add_u32 m0, s60, 0xa000
    ds_read_b64_tr_b16 a[148:149], v3 offset:46176
    ds_read_b64_tr_b16 a[150:151], v3 offset:48480
    v_mfma_f32_16x16x32_bf16 v[88:91], a[128:131], a[152:155], v[88:91]
    s_waitcnt lgkmcnt(8)
    buffer_load_dwordx4 v8, s[36:39], s66 offen lds
    v_mfma_f32_16x16x32_bf16 v[96:99], a[128:131], a[160:163], v[96:99]
    ds_read_b64_tr_b16 a[152:153], v3 offset:36992
    ds_read_b64_tr_b16 a[154:155], v3 offset:39296
    v_mfma_f32_16x16x32_bf16 v[96:99], a[136:139], a[164:167], v[96:99]
    v_mul_f32 v243, s67, v85
    v_max_f32 v84, s65, v84
    v_exp_f32_e64 v242, v242 clamp
    v_mfma_f32_16x16x32_bf16 v[100:103], a[140:143], a[164:167], v[100:103]
    s_add_u32 m0, s60, 0xd800
    ds_read_b64_tr_b16 a[156:157], v3 offset:46208
    ds_read_b64_tr_b16 a[158:159], v3 offset:48512
    v_mfma_f32_16x16x32_bf16 v[100:103], a[132:135], a[160:163], v[100:103]
    s_waitcnt lgkmcnt(8)
    s_add_u32 s66, s97, 0
    buffer_load_dwordx4 v4, s[36:39], s66 offen lds
    v_mfma_f32_16x16x32_bf16 v[108:111], a[132:135], a[168:171], v[108:111]
    ds_read_b64_tr_b16 a[160:161], v3 offset:37024
    ds_read_b64_tr_b16 a[162:163], v3 offset:39328
    v_mfma_f32_16x16x32_bf16 v[108:111], a[140:143], a[172:175], v[108:111]
    buffer_load_dwordx4 v5, s[36:39], s66 offen offset:1024 lds
    v_mfma_f32_16x16x32_bf16 v[104:107], a[136:139], a[172:175], v[104:107]
    ds_read_b64_tr_b16 a[164:165], v3 offset:46240
    ds_read_b64_tr_b16 a[166:167], v3 offset:48544
    v_mfma_f32_16x16x32_bf16 v[104:107], a[128:131], a[168:171], v[104:107]
    s_waitcnt lgkmcnt(8)
    v_add_f32 v82, v82, v244
    v_mul_f32 v244, s67, v86
    v_exp_f32_e64 v243, v243 clamp
    v_mfma_f32_16x16x32_bf16 v[112:115], a[128:131], a[144:147], v[112:115]
    ds_read_b64_tr_b16 a[168:169], v3 offset:37056
    ds_read_b64_tr_b16 a[170:171], v3 offset:39360
    v_mfma_f32_16x16x32_bf16 v[112:115], a[136:139], a[148:151], v[112:115]
    buffer_load_dwordx4 v6, s[36:39], s66 offen offset:2048 lds
    v_mfma_f32_16x16x32_bf16 v[116:119], a[140:143], a[148:151], v[116:119]
    ds_read_b64_tr_b16 a[172:173], v3 offset:46272
    ds_read_b64_tr_b16 a[174:175], v3 offset:48576
    v_mfma_f32_16x16x32_bf16 v[116:119], a[132:135], a[144:147], v[116:119]
    s_waitcnt lgkmcnt(8)
    v_max_f32 v85, s65, v85
    v_add_f32 v83, v83, v245
    v_mul_f32 v245, s67, v87
    v_mfma_f32_16x16x32_bf16 v[124:127], a[132:135], a[152:155], v[124:127]
    ds_read_b64_tr_b16 a[144:145], v3 offset:37088
    ds_read_b64_tr_b16 a[146:147], v3 offset:39392
    v_mfma_f32_16x16x32_bf16 v[124:127], a[140:143], a[156:159], v[124:127]
L_pad_a3:
    s_cbranch_execz L_padret_a
    buffer_load_dwordx4 v7, s[36:39], s66 offen offset:3072 lds
    v_mfma_f32_16x16x32_bf16 v[120:123], a[136:139], a[156:159], v[120:123]
    ds_read_b64_tr_b16 a[148:149], v3 offset:46304
    ds_read_b64_tr_b16 a[150:151], v3 offset:48608
    v_mfma_f32_16x16x32_bf16 v[120:123], a[128:131], a[152:155], v[120:123]
    s_waitcnt lgkmcnt(8)
    v_exp_f32_e64 v244, v244 clamp
    v_max_f32 v86, s65, v86
    v_add_f32 v84, v84, v242
    v_exp_f32_e64 v245, v245 clamp
    v_mfma_f32_16x16x32_bf16 v[128:131], a[128:131], a[160:163], v[128:131]
    s_add_u32 m0, s60, 0xe800
    ds_read_b64_tr_b16 a[152:153], v3 offset:37120
    ds_read_b64_tr_b16 a[154:155], v3 offset:39424
    v_mfma_f32_16x16x32_bf16 v[128:131], a[136:139], a[164:167], v[128:131]
    buffer_load_dwordx4 v8, s[36:39], s66 offen lds
    v_mfma_f32_16x16x32_bf16 v[132:135], a[140:143], a[164:167], v[132:135]
    ds_read_b64_tr_b16 a[156:157], v3 offset:46336
    ds_read_b64_tr_b16 a[158:159], v3 offset:48640
    v_mfma_f32_16x16x32_bf16 v[132:135], a[132:135], a[160:163], v[132:135]
    s_waitcnt vmcnt(16) lgkmcnt(8)
    s_barrier
    v_max_f32 v87, s65, v87
    v_add_f32 v85, v85, v243
    v_mfma_f32_16x16x32_bf16 v[140:143], a[132:135], a[168:171], v[140:143]
    ds_read_b64_tr_b16 a[160:161], v2
    ds_read_b64_tr_b16 a[162:163], v2 offset:2304
    v_mfma_f32_16x16x32_bf16 v[140:143], a[140:143], a[172:175], v[140:143]
    v_add_f32 v86, v86, v244
    v_add_f32 v87, v87, v245
    v_cvt_pk_bf16_f32 v72, v72, v73
    v_cvt_pk_bf16_f32 v73, v74, v75
    v_mfma_f32_16x16x32_bf16 v[136:139], a[136:139], a[172:175], v[136:139]
    ds_read_b64_tr_b16 a[164:165], v2 offset:9216
    ds_read_b64_tr_b16 a[166:167], v2 offset:11520
    v_mfma_f32_16x16x32_bf16 v[136:139], a[128:131], a[168:171], v[136:139]
    s_waitcnt lgkmcnt(8)
    v_cvt_pk_bf16_f32 v74, v76, v77
    v_cvt_pk_bf16_f32 v75, v78, v79
    v_mfma_f32_16x16x32_bf16 v[144:147], a[128:131], a[144:147], v[144:147]
    ds_read_b64_tr_b16 a[168:169], v2 offset:32
    ds_read_b64_tr_b16 a[170:171], v2 offset:2336
    v_mfma_f32_16x16x32_bf16 v[144:147], a[136:139], a[148:151], v[144:147]
    ds_write_b128 v9, v[72:75] offset:28672
    v_cvt_pk_bf16_f32 v80, v80, v81
    v_mfma_f32_16x16x32_bf16 v[148:151], a[140:143], a[148:151], v[148:151]
    ds_read_b64_tr_b16 a[172:173], v2 offset:9248
    ds_read_b64_tr_b16 a[174:175], v2 offset:11552
    v_mfma_f32_16x16x32_bf16 v[148:151], a[132:135], a[144:147], v[148:151]
    s_waitcnt lgkmcnt(9)
    v_cvt_pk_bf16_f32 v81, v82, v83
    v_cvt_pk_bf16_f32 v82, v84, v85
    v_cvt_pk_bf16_f32 v83, v86, v87
    v_mfma_f32_16x16x32_bf16 v[156:159], a[132:135], a[152:155], v[156:159]
    ds_read_b64_tr_b16 a[144:145], v2 offset:64
    ds_read_b64_tr_b16 a[146:147], v2 offset:2368
    v_mfma_f32_16x16x32_bf16 v[156:159], a[140:143], a[156:159], v[156:159]
    ds_write_b128 v9, v[80:83] offset:32768
    v_mfma_f32_16x16x32_bf16 v[152:155], a[136:139], a[156:159], v[152:155]
    ds_read_b64_tr_b16 a[148:149], v2 offset:9280
    ds_read_b64_tr_b16 a[150:151], v2 offset:11584
    v_mfma_f32_16x16x32_bf16 v[152:155], a[128:131], a[152:155], v[152:155]
    s_waitcnt lgkmcnt(10)
    s_waitcnt lgkmcnt(2)
    s_barrier
    ds_read_b128 a[176:179], v250 offset:40960
    ds_read_b128 a[180:183], v250 offset:45056
    ds_read_b128 a[184:187], v251
    ds_read_b128 a[188:191], v250 offset:41984
    ds_read_b128 a[192:195], v250 offset:46080
    ds_read_b128 a[196:199], v251 offset:1024
    ds_read_b128 a[200:203], v250 offset:43008
    ds_read_b128 a[204:207], v250 offset:47104
    ds_read_b128 a[208:211], v251 offset:2048
    ds_read_b128 a[212:215], v250 offset:44032
    ds_read_b128 a[216:219], v250 offset:48128
    ds_read_b128 a[220:223], v251 offset:3072
    v_cvt_pk_bf16_f32 v88, v88, v89
    v_cvt_pk_bf16_f32 v89, v90, v91
    v_cvt_pk_bf16_f32 v90, v92, v93
    v_cvt_pk_bf16_f32 v91, v94, v95
    ds_write_b128 v11, v[88:91]
    v_cvt_pk_bf16_f32 v96, v96, v97
    v_cvt_pk_bf16_f32 v97, v98, v99
    v_cvt_pk_bf16_f32 v98, v100, v101
    v_cvt_pk_bf16_f32 v99, v102, v103
    ds_write_b128 v11, v[96:99] offset:4096
    v_cvt_pk_bf16_f32 v104, v104, v105
    v_cvt_pk_bf16_f32 v105, v106, v107
    v_cvt_pk_bf16_f32 v106, v108, v109
    v_cvt_pk_bf16_f32 v107, v110, v111
    ds_write_b128 v11, v[104:107] offset:8192
    v_cvt_pk_bf16_f32 v112, v112, v113
    v_cvt_pk_bf16_f32 v113, v114, v115
    v_cvt_pk_bf16_f32 v114, v116, v117
    v_cvt_pk_bf16_f32 v115, v118, v119
    ds_write_b128 v11, v[112:115] offset:12288
    v_cvt_pk_bf16_f32 v120, v120, v121
    v_cvt_pk_bf16_f32 v121, v122, v123
    v_cvt_pk_bf16_f32 v122, v124, v125
    v_cvt_pk_bf16_f32 v123, v126, v127
    ds_write_b128 v11, v[120:123] offset:16384
    v_cvt_pk_bf16_f32 v128, v128, v129
    v_cvt_pk_bf16_f32 v129, v130, v131
    v_cvt_pk_bf16_f32 v130, v132, v133
    v_cvt_pk_bf16_f32 v131, v134, v135
    ds_write_b128 v11, v[128:131] offset:20480
    v_cvt_pk_bf16_f32 v136, v136, v137
    v_cvt_pk_bf16_f32 v137, v138, v139
    v_cvt_pk_bf16_f32 v138, v140, v141
    v_cvt_pk_bf16_f32 v139, v142, v143
    ds_write_b128 v11, v[136:139] offset:24576
    v_cvt_pk_bf16_f32 v144, v144, v145
    v_cvt_pk_bf16_f32 v145, v146, v147
    v_cvt_pk_bf16_f32 v146, v148, v149
    v_cvt_pk_bf16_f32 v147, v150, v151
    ds_write_b128 v11, v[144:147] offset:28672
    v_cvt_pk_bf16_f32 v152, v152, v153
    v_cvt_pk_bf16_f32 v153, v154, v155
    v_cvt_pk_bf16_f32 v154, v156, v157
    v_cvt_pk_bf16_f32 v155, v158, v159
    ds_write_b128 v11, v[152:155] offset:32768
    s_waitcnt lgkmcnt(0)
    s_barrier
    ds_read_b128 v[176:179], v250
    ds_read_b128 v[180:183], v250 offset:4096
    ds_read_b128 v[184:187], v250 offset:8192
    ds_read_b128 v[188:191], v250 offset:12288
    ds_read_b128 v[192:195], v252
    v_mfma_f32_16x16x32_bf16 v[108:111], a[176:179], v[246:249], 0
    v_mfma_f32_16x16x32_bf16 v[124:127], a[180:183], v[246:249], 0
    v_mfma_f32_16x16x32_bf16 v[132:135], a[184:187], v[246:249], 0
    ds_read_b128 v[196:199], v250 offset:1024
    ds_read_b128 v[200:203], v250 offset:5120
    ds_read_b128 v[204:207], v250 offset:9216
    ds_read_b128 v[208:211], v250 offset:13312
    ds_read_b128 v[212:215], v252 offset:1024
    v_mfma_f32_16x16x32_bf16 v[108:111], a[188:191], v[246:249], v[108:111]
    v_mfma_f32_16x16x32_bf16 v[124:127], a[192:195], v[246:249], v[124:127]
    v_mfma_f32_16x16x32_bf16 v[132:135], a[196:199], v[246:249], v[132:135]
    ds_read_b128 v[216:219], v250 offset:2048
    ds_read_b128 v[220:223], v250 offset:6144
    ds_read_b128 v[224:227], v250 offset:10240
    ds_read_b128 v[228:231], v250 offset:14336
    ds_read_b128 v[232:235], v252 offset:2048
    v_mfma_f32_16x16x32_bf16 v[108:111], a[200:203], v[246:249], v[108:111]
    v_mfma_f32_16x16x32_bf16 v[124:127], a[204:207], v[246:249], v[124:127]
    v_mfma_f32_16x16x32_bf16 v[132:135], a[208:211], v[246:249], v[132:135]
    ds_read_b128 a[224:227], v250 offset:3072
    ds_read_b128 a[228:231], v250 offset:7168
    ds_read_b128 a[232:235], v250 offset:11264
    ds_read_b128 a[236:239], v250 offset:15360
    ds_read_b128 a[240:243], v252 offset:3072
    v_mfma_f32_16x16x32_bf16 v[108:111], a[212:215], v[246:249], v[108:111]
    v_mfma_f32_16x16x32_bf16 v[124:127], a[216:219], v[246:249], v[124:127]
    v_mfma_f32_16x16x32_bf16 v[132:135], a[220:223], v[246:249], v[132:135]
    s_waitcnt lgkmcnt(15)
    v_mfma_f32_16x16x32_bf16 v[96:99], a[176:179], v[176:179], 0
    v_mfma_f32_16x16x32_bf16 v[100:103], a[176:179], v[180:183], 0
    v_mfma_f32_16x16x32_bf16 v[104:107], a[176:179], v[184:187], 0
    v_mfma_f32_16x16x32_bf16 v[112:115], a[180:183], v[180:183], 0
    v_mfma_f32_16x16x32_bf16 v[116:119], a[180:183], v[184:187], 0
    v_mfma_f32_16x16x32_bf16 v[120:123], a[180:183], v[188:191], 0
    v_mfma_f32_16x16x32_bf16 v[128:131], a[184:187], v[192:195], 0
    s_waitcnt lgkmcnt(14)
    v_mfma_f32_16x16x32_bf16 v[96:99], a[188:191], v[196:199], v[96:99]
    s_waitcnt lgkmcnt(13)
    v_mfma_f32_16x16x32_bf16 v[100:103], a[188:191], v[200:203], v[100:103]
    s_waitcnt lgkmcnt(12)
    v_mfma_f32_16x16x32_bf16 v[104:107], a[188:191], v[204:207], v[104:107]
    v_mfma_f32_16x16x32_bf16 v[112:115], a[192:195], v[200:203], v[112:115]
    v_mfma_f32_16x16x32_bf16 v[116:119], a[192:195], v[204:207], v[116:119]
    s_waitcnt lgkmcnt(11)
    v_mfma_f32_16x16x32_bf16 v[120:123], a[192:195], v[208:211], v[120:123]
    s_waitcnt lgkmcnt(10)
    v_mfma_f32_16x16x32_bf16 v[128:131], a[196:199], v[212:215], v[128:131]
    s_waitcnt lgkmcnt(9)
    v_mfma_f32_16x16x32_bf16 v[96:99], a[200:203], v[216:219], v[96:99]
    s_waitcnt lgkmcnt(8)
    v_mfma_f32_16x16x32_bf16 v[100:103], a[200:203], v[220:223], v[100:103]
    s_waitcnt lgkmcnt(7)
    v_mfma_f32_16x16x32_bf16 v[104:107], a[200:203], v[224:227], v[104:107]
    v_mfma_f32_16x16x32_bf16 v[112:115], a[204:207], v[220:223], v[112:115]
    v_mfma_f32_16x16x32_bf16 v[116:119], a[204:207], v[224:227], v[116:119]
    s_waitcnt lgkmcnt(6)
    v_mfma_f32_16x16x32_bf16 v[120:123], a[204:207], v[228:231], v[120:123]
    s_waitcnt lgkmcnt(5)
    v_mfma_f32_16x16x32_bf16 v[128:131], a[208:211], v[232:235], v[128:131]
    s_waitcnt lgkmcnt(4)
    v_mfma_f32_16x16x32_bf16 v[96:99], a[212:215], a[224:227], v[96:99]
    s_waitcnt lgkmcnt(3)
    v_mfma_f32_16x16x32_bf16 v[100:103], a[212:215], a[228:231], v[100:103]
    s_waitcnt lgkmcnt(2)
    v_mfma_f32_16x16x32_bf16 v[104:107], a[212:215], a[232:235], v[104:107]
    v_mfma_f32_16x16x32_bf16 v[112:115], a[216:219], a[228:231], v[112:115]
    v_mfma_f32_16x16x32_bf16 v[116:119], a[216:219], a[232:235], v[116:119]
    s_waitcnt lgkmcnt(1)
    v_mfma_f32_16x16x32_bf16 v[120:123], a[216:219], a[236:239], v[120:123]
    s_waitcnt lgkmcnt(0)
    v_mfma_f32_16x16x32_bf16 v[128:131], a[220:223], a[240:243], v[128:131]
    v_mfma_f32_16x16x32_bf16 v[16:19], a[160:163], a[0:3], 0
    ds_read_b64_tr_b16 a[152:153], v2 offset:96
    ds_read_b64_tr_b16 a[154:155], v2 offset:2400
    v_cvt_pk_bf16_f32 v96, v96, v97
    v_cvt_pk_bf16_f32 v97, v98, v99
    v_cvt_pk_bf16_f32 v98, v100, v101
    v_cvt_pk_bf16_f32 v99, v102, v103
    v_mfma_f32_16x16x32_bf16 v[16:19], a[164:167], a[8:11], v[16:19]
    buffer_store_dwordx4 v[96:99], v1, s[48:51], s63 offen sc1
    v_mfma_f32_16x16x32_bf16 v[24:27], a[164:167], a[12:15], 0
    ds_read_b64_tr_b16 a[156:157], v2 offset:9312
    ds_read_b64_tr_b16 a[158:159], v2 offset:11616
    v_cvt_pk_bf16_f32 v104, v104, v105
    v_cvt_pk_bf16_f32 v105, v106, v107
    v_cvt_pk_bf16_f32 v106, v108, v109
    v_cvt_pk_bf16_f32 v107, v110, v111
    v_mfma_f32_16x16x32_bf16 v[24:27], a[160:163], a[4:7], v[24:27]
    buffer_store_dwordx4 v[104:107], v1, s[48:51], s63 offen offset:1024 sc1
    v_mfma_f32_16x16x32_bf16 v[28:31], a[168:171], a[4:7], 0
    ds_read_b64_tr_b16 a[160:161], v2 offset:128
    ds_read_b64_tr_b16 a[162:163], v2 offset:2432
    v_cvt_pk_bf16_f32 v112, v112, v113
    v_cvt_pk_bf16_f32 v113, v114, v115
    v_cvt_pk_bf16_f32 v114, v116, v117
    v_cvt_pk_bf16_f32 v115, v118, v119
    v_mfma_f32_16x16x32_bf16 v[28:31], a[172:175], a[12:15], v[28:31]
    buffer_store_dwordx4 v[112:115], v1, s[48:51], s63 offen offset:2048 sc1
    v_mfma_f32_16x16x32_bf16 v[20:23], a[172:175], a[8:11], 0
    ds_read_b64_tr_b16 a[164:165], v2 offset:9344
    ds_read_b64_tr_b16 a[166:167], v2 offset:11648
    v_cvt_pk_bf16_f32 v120, v120, v121
    v_cvt_pk_bf16_f32 v121, v122, v123
    v_cvt_pk_bf16_f32 v122, v124, v125
    v_cvt_pk_bf16_f32 v123, v126, v127
    v_mfma_f32_16x16x32_bf16 v[20:23], a[168:171], a[0:3], v[20:23]
    buffer_store_dwordx4 v[120:123], v1, s[48:51], s63 offen offset:3072 sc1
    v_mfma_f32_16x16x32_bf16 v[32:35], a[144:147], a[0:3], 0
    ds_read_b64_tr_b16 a[168:169], v2 offset:160
    ds_read_b64_tr_b16 a[170:171], v2 offset:2464
    v_cvt_pk_bf16_f32 v128, v128, v129
    v_cvt_pk_bf16_f32 v129, v130, v131
    v_cvt_pk_bf16_f32 v130, v132, v133
    v_cvt_pk_bf16_f32 v131, v134, v135
    v_mfma_f32_16x16x32_bf16 v[32:35], a[148:151], a[8:11], v[32:35]
    buffer_store_dwordx4 v[128:131], v1, s[48:51], s70 offen sc1
    v_mfma_f32_16x16x32_bf16 v[40:43], a[148:151], a[12:15], 0
    ds_read_b64_tr_b16 a[172:173], v2 offset:9376
    ds_read_b64_tr_b16 a[174:175], v2 offset:11680
    v_mfma_f32_16x16x32_bf16 v[40:43], a[144:147], a[4:7], v[40:43]
    s_waitcnt lgkmcnt(8)
    v_mfma_f32_16x16x32_bf16 v[44:47], a[152:155], a[4:7], 0
    ds_read_b64_tr_b16 a[144:145], v2 offset:192
    ds_read_b64_tr_b16 a[146:147], v2 offset:2496
    v_mfma_f32_16x16x32_bf16 v[44:47], a[156:159], a[12:15], v[44:47]
    s_lshl_b32 s62, s57, 12
    s_add_u32 s62, s62, 0x3010000
    v_mfma_f32_16x16x32_bf16 v[36:39], a[156:159], a[8:11], 0
    ds_read_b64_tr_b16 a[148:149], v2 offset:9408
    ds_read_b64_tr_b16 a[150:151], v2 offset:11712
    v_mfma_f32_16x16x32_bf16 v[36:39], a[152:155], a[0:3], v[36:39]
    s_waitcnt lgkmcnt(8)
    v_lshl_add_u32 v13, v0, 8, s62
    s_cmp_eq_u32 s59, 0
    s_cselect_b32 s62, 16, 0
    v_mfma_f32_16x16x32_bf16 v[48:51], a[160:163], a[0:3], 0
    ds_read_b64_tr_b16 a[152:153], v2 offset:224
    ds_read_b64_tr_b16 a[154:155], v2 offset:2528
    v_mfma_f32_16x16x32_bf16 v[48:51], a[164:167], a[8:11], v[48:51]
    v_cmp_gt_u32 vcc, s62, v0
    v_mov_b32 v241, 0x10000000
    v_mfma_f32_16x16x32_bf16 v[56:59], a[164:167], a[12:15], 0
    ds_read_b64_tr_b16 a[156:157], v2 offset:9440
    ds_read_b64_tr_b16 a[158:159], v2 offset:11744
    v_mfma_f32_16x16x32_bf16 v[56:59], a[160:163], a[4:7], v[56:59]
    s_waitcnt lgkmcnt(8)
    v_cndmask_b32 v13, v241, v13, vcc
    v_mov_b32 v241, s61
    v_mfma_f32_16x16x32_bf16 v[60:63], a[168:171], a[4:7], 0
    ds_read_b64_tr_b16 a[160:161], v2 offset:256
    ds_read_b64_tr_b16 a[162:163], v2 offset:2560
    v_mfma_f32_16x16x32_bf16 v[60:63], a[172:175], a[12:15], v[60:63]
    v_cndmask_b32 v241, 0, v241, vcc
    v_mfma_f32_16x16x32_bf16 v[52:55], a[172:175], a[8:11], 0
    ds_read_b64_tr_b16 a[164:165], v2 offset:9472
    ds_read_b64_tr_b16 a[166:167], v2 offset:11776
    v_mfma_f32_16x16x32_bf16 v[52:55], a[168:171], a[0:3], v[52:55]
    s_waitcnt vmcnt(16) lgkmcnt(8)
    s_barrier
    s_lshl_b32 s69, s59, 4
    v_mfma_f32_16x16x32_bf16 v[64:67], a[144:147], a[0:3], 0
    s_add_u32 m0, s60, 0x12000
    ds_read_b64_tr_b16 a[168:169], v2 offset:18432
    ds_read_b64_tr_b16 a[170:171], v2 offset:20736
    v_mfma_f32_16x16x32_bf16 v[64:67], a[148:151], a[8:11], v[64:67]
    s_add_u32 s66, s97, 0x36000
    buffer_load_dwordx4 v4, s[36:39], s66 offen lds
    v_mfma_f32_16x16x32_bf16 v[72:75], a[148:151], a[12:15], 0
    ds_read_b64_tr_b16 a[172:173], v2 offset:27648
    ds_read_b64_tr_b16 a[174:175], v2 offset:29952
    v_mfma_f32_16x16x32_bf16 v[72:75], a[144:147], a[4:7], v[72:75]
    s_waitcnt lgkmcnt(8)
    s_add_u32 s69, s69, s56
    v_mfma_f32_16x16x32_bf16 v[76:79], a[152:155], a[4:7], 0
    ds_read_b64_tr_b16 a[144:145], v2 offset:18464
    ds_read_b64_tr_b16 a[146:147], v2 offset:20768
    v_mfma_f32_16x16x32_bf16 v[76:79], a[156:159], a[12:15], v[76:79]
    buffer_load_dwordx4 v5, s[36:39], s66 offen offset:1024 lds
    v_mfma_f32_16x16x32_bf16 v[68:71], a[156:159], a[8:11], 0
    ds_read_b64_tr_b16 a[148:149], v2 offset:27680
    ds_read_b64_tr_b16 a[150:151], v2 offset:29984
    v_mfma_f32_16x16x32_bf16 v[68:71], a[152:155], a[0:3], v[68:71]
    s_waitcnt lgkmcnt(8)
    s_cmp_eq_u32 s69, 34
    s_cselect_b32 s62, 19, s69
    v_mfma_f32_16x16x32_bf16 v[80:83], a[160:163], a[0:3], 0
    ds_read_b64_tr_b16 a[152:153], v2 offset:18496
    ds_read_b64_tr_b16 a[154:155], v2 offset:20800
    v_mfma_f32_16x16x32_bf16 v[80:83], a[164:167], a[8:11], v[80:83]
    buffer_load_dwordx4 v6, s[36:39], s66 offen offset:2048 lds
    v_mfma_f32_16x16x32_bf16 v[88:91], a[164:167], a[12:15], 0
    ds_read_b64_tr_b16 a[156:157], v2 offset:27712
    ds_read_b64_tr_b16 a[158:159], v2 offset:30016
    v_mfma_f32_16x16x32_bf16 v[88:91], a[160:163], a[4:7], v[88:91]
    s_waitcnt lgkmcnt(8)
    buffer_load_dwordx4 v7, s[36:39], s66 offen offset:3072 lds
    v_mfma_f32_16x16x32_bf16 v[24:27], a[168:171], a[20:23], v[24:27]
    ds_read_b64_tr_b16 a[160:161], v2 offset:18528
    ds_read_b64_tr_b16 a[162:163], v2 offset:20832
    v_mfma_f32_16x16x32_bf16 v[24:27], a[172:175], a[28:31], v[24:27]
    s_lshr_b32 s70, s62, 2
    s_and_b32 s71, s62, 3
    v_mfma_f32_16x16x32_bf16 v[16:19], a[172:175], a[24:27], v[16:19]
    s_add_u32 m0, s60, 0x13000
    ds_read_b64_tr_b16 a[164:165], v2 offset:27744
    ds_read_b64_tr_b16 a[166:167], v2 offset:30048
    v_mfma_f32_16x16x32_bf16 v[16:19], a[168:171], a[16:19], v[16:19]
    s_waitcnt lgkmcnt(8)
    buffer_load_dwordx4 v8, s[36:39], s66 offen lds
    v_mfma_f32_16x16x32_bf16 v[20:23], a[144:147], a[16:19], v[20:23]
    ds_read_b64_tr_b16 a[168:169], v2 offset:18560
    ds_read_b64_tr_b16 a[170:171], v2 offset:20864
    v_mfma_f32_16x16x32_bf16 v[20:23], a[148:151], a[24:27], v[20:23]
    s_cmp_eq_u32 s62, 33
    s_cselect_b32 s62, 34, s62
    v_mfma_f32_16x16x32_bf16 v[28:31], a[148:151], a[28:31], v[28:31]
    s_add_u32 m0, s60, 0x16800
    ds_read_b64_tr_b16 a[172:173], v2 offset:27776
    ds_read_b64_tr_b16 a[174:175], v2 offset:30080
    v_mfma_f32_16x16x32_bf16 v[28:31], a[144:147], a[20:23], v[28:31]
    s_waitcnt lgkmcnt(8)
    s_add_u32 s66, s97, 0x6c000
    buffer_load_dwordx4 v4, s[36:39], s66 offen lds
    v_mfma_f32_16x16x32_bf16 v[40:43], a[152:155], a[20:23], v[40:43]
    ds_read_b64_tr_b16 a[144:145], v2 offset:18592
    ds_read_b64_tr_b16 a[146:147], v2 offset:20896
    v_mfma_f32_16x16x32_bf16 v[40:43], a[156:159], a[28:31], v[40:43]
    buffer_load_dwordx4 v5, s[36:39], s66 offen offset:1024 lds
    v_mfma_f32_16x16x32_bf16 v[32:35], a[156:159], a[24:27], v[32:35]
    ds_read_b64_tr_b16 a[148:149], v2 offset:27808
    ds_read_b64_tr_b16 a[150:151], v2 offset:30112
    v_mfma_f32_16x16x32_bf16 v[32:35], a[152:155], a[16:19], v[32:35]
    s_waitcnt lgkmcnt(8)
    s_and_b32 s63, s62, 1
    v_mfma_f32_16x16x32_bf16 v[36:39], a[160:163], a[16:19], v[36:39]
    ds_read_b64_tr_b16 a[152:153], v2 offset:18624
    ds_read_b64_tr_b16 a[154:155], v2 offset:20928
    v_mfma_f32_16x16x32_bf16 v[36:39], a[164:167], a[24:27], v[36:39]
    buffer_load_dwordx4 v6, s[36:39], s66 offen offset:2048 lds
    v_mfma_f32_16x16x32_bf16 v[44:47], a[164:167], a[28:31], v[44:47]
    ds_read_b64_tr_b16 a[156:157], v2 offset:27840
    ds_read_b64_tr_b16 a[158:159], v2 offset:30144
    v_mfma_f32_16x16x32_bf16 v[44:47], a[160:163], a[20:23], v[44:47]
    s_waitcnt lgkmcnt(8)
    s_lshl_b32 s63, s63, 3
    s_lshr_b32 s62, s62, 1
    v_mfma_f32_16x16x32_bf16 v[56:59], a[168:171], a[20:23], v[56:59]
    ds_read_b64_tr_b16 a[160:161], v2 offset:18656
    ds_read_b64_tr_b16 a[162:163], v2 offset:20960
    v_mfma_f32_16x16x32_bf16 v[56:59], a[172:175], a[28:31], v[56:59]
    buffer_load_dwordx4 v7, s[36:39], s66 offen offset:3072 lds
    v_mfma_f32_16x16x32_bf16 v[48:51], a[172:175], a[24:27], v[48:51]
    ds_read_b64_tr_b16 a[164:165], v2 offset:27872
    ds_read_b64_tr_b16 a[166:167], v2 offset:30176
    v_mfma_f32_16x16x32_bf16 v[48:51], a[168:171], a[16:19], v[48:51]
    s_waitcnt lgkmcnt(8)
    s_lshl_b32 s62, s62, 10
    v_mfma_f32_16x16x32_bf16 v[52:55], a[144:147], a[16:19], v[52:55]
    s_add_u32 m0, s60, 0x17800
    ds_read_b64_tr_b16 a[168:169], v2 offset:18688
    ds_read_b64_tr_b16 a[170:171], v2 offset:20992
    v_mfma_f32_16x16x32_bf16 v[52:55], a[148:151], a[24:27], v[52:55]
    buffer_load_dwordx4 v8, s[36:39], s66 offen lds
    v_mfma_f32_16x16x32_bf16 v[60:63], a[148:151], a[28:31], v[60:63]
    ds_read_b64_tr_b16 a[172:173], v2 offset:27904
    ds_read_b64_tr_b16 a[174:175], v2 offset:30208
    v_mfma_f32_16x16x32_bf16 v[60:63], a[144:147], a[20:23], v[60:63]
    s_waitcnt vmcnt(20) lgkmcnt(8)
    s_barrier
    s_add_u32 s62, s62, s63
    v_mfma_f32_16x16x32_bf16 v[72:75], a[152:155], a[20:23], v[72:75]
    s_add_u32 m0, s60, 0
    ds_read_b64_tr_b16 a[144:145], v2 offset:36864
    ds_read_b64_tr_b16 a[146:147], v2 offset:39168
    v_mfma_f32_16x16x32_bf16 v[72:75], a[156:159], a[28:31], v[72:75]
    s_add_u32 s66, s98, 0
    buffer_load_dwordx4 v4, s[36:39], s66 offen lds
    v_mfma_f32_16x16x32_bf16 v[64:67], a[156:159], a[24:27], v[64:67]
    ds_read_b64_tr_b16 a[148:149], v2 offset:46080
    ds_read_b64_tr_b16 a[150:151], v2 offset:48384
    v_mfma_f32_16x16x32_bf16 v[64:67], a[152:155], a[16:19], v[64:67]
    s_waitcnt lgkmcnt(8)
    s_add_u32 s72, s72, s62
    v_mfma_f32_16x16x32_bf16 v[68:71], a[160:163], a[16:19], v[68:71]
    ds_read_b64_tr_b16 a[152:153], v2 offset:36896
    ds_read_b64_tr_b16 a[154:155], v2 offset:39200
    v_mfma_f32_16x16x32_bf16 v[68:71], a[164:167], a[24:27], v[68:71]
    buffer_load_dwordx4 v5, s[36:39], s66 offen offset:1024 lds
    v_mfma_f32_16x16x32_bf16 v[76:79], a[164:167], a[28:31], v[76:79]
    ds_read_b64_tr_b16 a[156:157], v2 offset:46112
    ds_read_b64_tr_b16 a[158:159], v2 offset:48416
    v_mfma_f32_16x16x32_bf16 v[76:79], a[160:163], a[20:23], v[76:79]
    s_waitcnt lgkmcnt(8)
    s_waitcnt vmcnt(12)
    s_barrier
    buffer_store_dword v15, v240, s[48:51], 0 offen sc1
    v_mfma_f32_16x16x32_bf16 v[88:91], a[168:171], a[20:23], v[88:91]
    ds_read_b64_tr_b16 a[160:161], v2 offset:36928
    ds_read_b64_tr_b16 a[162:163], v2 offset:39232
    v_mfma_f32_16x16x32_bf16 v[88:91], a[172:175], a[28:31], v[88:91]
    buffer_load_dwordx4 v6, s[36:39], s66 offen offset:2048 lds
    v_mfma_f32_16x16x32_bf16 v[80:83], a[172:175], a[24:27], v[80:83]
    ds_read_b64_tr_b16 a[164:165], v2 offset:46144
    ds_read_b64_tr_b16 a[166:167], v2 offset:48448
    v_mfma_f32_16x16x32_bf16 v[80:83], a[168:171], a[16:19], v[80:83]
    s_waitcnt lgkmcnt(8)
    s_sub_u32 s62, s69, 1
    v_mfma_f32_16x16x32_bf16 v[16:19], a[144:147], a[32:35], v[16:19]
    ds_read_b64_tr_b16 a[168:169], v2 offset:36960
    ds_read_b64_tr_b16 a[170:171], v2 offset:39264
    v_mfma_f32_16x16x32_bf16 v[16:19], a[148:151], a[40:43], v[16:19]
    buffer_load_dwordx4 v7, s[36:39], s66 offen offset:3072 lds
    v_mfma_f32_16x16x32_bf16 v[24:27], a[148:151], a[44:47], v[24:27]
    ds_read_b64_tr_b16 a[172:173], v2 offset:46176
    ds_read_b64_tr_b16 a[174:175], v2 offset:48480
    v_mfma_f32_16x16x32_bf16 v[24:27], a[144:147], a[36:39], v[24:27]
    s_waitcnt lgkmcnt(8)
    s_cmp_gt_u32 s62, 34
    s_cselect_b32 s72, 0x10000000, s72
    v_and_b32 v242, 15, v0
    v_mfma_f32_16x16x32_bf16 v[28:31], a[152:155], a[36:39], v[28:31]
    s_add_u32 m0, s60, 0x1000
    ds_read_b64_tr_b16 a[144:145], v2 offset:36992
    ds_read_b64_tr_b16 a[146:147], v2 offset:39296
    v_mfma_f32_16x16x32_bf16 v[28:31], a[156:159], a[44:47], v[28:31]
    buffer_load_dwordx4 v8, s[36:39], s66 offen lds
    v_mfma_f32_16x16x32_bf16 v[20:23], a[156:159], a[40:43], v[20:23]
    ds_read_b64_tr_b16 a[148:149], v2 offset:46208
    ds_read_b64_tr_b16 a[150:151], v2 offset:48512
    v_mfma_f32_16x16x32_bf16 v[20:23], a[152:155], a[32:35], v[20:23]
    s_waitcnt lgkmcnt(8)
    v_lshrrev_b32 v243, 4, v0
    v_mfma_f32_16x16x32_bf16 v[32:35], a[160:163], a[32:35], v[32:35]
    ds_read_b64_tr_b16 a[152:153], v2 offset:37024
    ds_read_b64_tr_b16 a[154:155], v2 offset:39328
    v_mfma_f32_16x16x32_bf16 v[32:35], a[164:167], a[40:43], v[32:35]
    v_lshlrev_b32 v243, 2, v243
    v_mfma_f32_16x16x32_bf16 v[40:43], a[164:167], a[44:47], v[40:43]
    ds_read_b64_tr_b16 a[156:157], v2 offset:46240
    ds_read_b64_tr_b16 a[158:159], v2 offset:48544
    v_mfma_f32_16x16x32_bf16 v[40:43], a[160:163], a[36:39], v[40:43]
    s_waitcnt lgkmcnt(8)
    v_sub_u32 v242, v242, v243
    v_and_b32 v243, 1, v242
    v_mfma_f32_16x16x32_bf16 v[44:47], a[168:171], a[36:39], v[44:47]
    ds_read_b64_tr_b16 a[160:161], v2 offset:37056
    ds_read_b64_tr_b16 a[162:163], v2 offset:39360
    v_mfma_f32_16x16x32_bf16 v[44:47], a[172:175], a[44:47], v[44:47]
    v_lshlrev_b32 v243, 4, v243
    v_mfma_f32_16x16x32_bf16 v[36:39], a[172:175], a[40:43], v[36:39]
    ds_read_b64_tr_b16 a[164:165], v2 offset:46272
    ds_read_b64_tr_b16 a[166:167], v2 offset:48576
    v_mfma_f32_16x16x32_bf16 v[36:39], a[168:171], a[32:35], v[36:39]
    s_waitcnt lgkmcnt(8)
    v_mov_b32 v244, 0x3f80
    v_mfma_f32_16x16x32_bf16 v[48:51], a[144:147], a[32:35], v[48:51]
    ds_read_b64_tr_b16 a[168:169], v2 offset:37088
    ds_read_b64_tr_b16 a[170:171], v2 offset:39392
    v_mfma_f32_16x16x32_bf16 v[48:51], a[148:151], a[40:43], v[48:51]
    v_lshlrev_b32 v243, v243, v244
    v_lshrrev_b32 v242, 1, v242
    v_mfma_f32_16x16x32_bf16 v[56:59], a[148:151], a[44:47], v[56:59]
    ds_read_b64_tr_b16 a[172:173], v2 offset:46304
    ds_read_b64_tr_b16 a[174:175], v2 offset:48608
    v_mfma_f32_16x16x32_bf16 v[56:59], a[144:147], a[36:39], v[56:59]
    s_waitcnt lgkmcnt(8)
    v_cmp_eq_u32 vcc, 0, v242
    v_mfma_f32_16x16x32_bf16 v[60:63], a[152:155], a[36:39], v[60:63]
    ds_read_b64_tr_b16 a[144:145], v2 offset:37120
    ds_read_b64_tr_b16 a[146:147], v2 offset:39424
    v_mfma_f32_16x16x32_bf16 v[60:63], a[156:159], a[44:47], v[60:63]
    v_cndmask_b32 v140, 0, v243, vcc
    v_mfma_f32_16x16x32_bf16 v[52:55], a[156:159], a[40:43], v[52:55]
    ds_read_b64_tr_b16 a[148:149], v2 offset:46336
    ds_read_b64_tr_b16 a[150:151], v2 offset:48640
    v_mfma_f32_16x16x32_bf16 v[52:55], a[152:155], a[32:35], v[52:55]
    s_waitcnt lgkmcnt(8)
    s_barrier
    v_cndmask_b32 v142, 0, v243, vcc
    v_mfma_f32_16x16x32_bf16 v[64:67], a[160:163], a[32:35], v[64:67]
    s_add_u32 m0, s60, 0x4800
    ds_read_b64_tr_b16 a[152:153], v3
    ds_read_b64_tr_b16 a[154:155], v3 offset:2304
    v_mfma_f32_16x16x32_bf16 v[64:67], a[164:167], a[40:43], v[64:67]
    s_add_u32 s66, s98, 0x36000
    buffer_load_dwordx4 v4, s[36:39], s66 offen lds
    v_mfma_f32_16x16x32_bf16 v[72:75], a[164:167], a[44:47], v[72:75]
    ds_read_b64_tr_b16 a[156:157], v3 offset:9216
    ds_read_b64_tr_b16 a[158:159], v3 offset:11520
    v_mfma_f32_16x16x32_bf16 v[72:75], a[160:163], a[36:39], v[72:75]
    s_waitcnt lgkmcnt(8)
    v_cmp_eq_u32 vcc, 1, v242
    v_mfma_f32_16x16x32_bf16 v[76:79], a[168:171], a[36:39], v[76:79]
    ds_read_b64_tr_b16 a[160:161], v3 offset:32
    ds_read_b64_tr_b16 a[162:163], v3 offset:2336
    v_mfma_f32_16x16x32_bf16 v[76:79], a[172:175], a[44:47], v[76:79]
    buffer_load_dwordx4 v5, s[36:39], s66 offen offset:1024 lds
    v_mfma_f32_16x16x32_bf16 v[68:71], a[172:175], a[40:43], v[68:71]
    ds_read_b64_tr_b16 a[164:165], v3 offset:9248
    ds_read_b64_tr_b16 a[166:167], v3 offset:11552
    v_mfma_f32_16x16x32_bf16 v[68:71], a[168:171], a[32:35], v[68:71]
    s_waitcnt lgkmcnt(8)
    v_cndmask_b32 v141, 0, v243, vcc
    v_cndmask_b32 v143, 0, v243, vcc
    v_mfma_f32_16x16x32_bf16 v[80:83], a[144:147], a[32:35], v[80:83]
    ds_read_b64_tr_b16 a[168:169], v3 offset:64
    ds_read_b64_tr_b16 a[170:171], v3 offset:2368
    v_mfma_f32_16x16x32_bf16 v[80:83], a[148:151], a[40:43], v[80:83]
    buffer_load_dwordx4 v6, s[36:39], s66 offen offset:2048 lds
    v_mfma_f32_16x16x32_bf16 v[88:91], a[148:151], a[44:47], v[88:91]
    ds_read_b64_tr_b16 a[172:173], v3 offset:9280
    ds_read_b64_tr_b16 a[174:175], v3 offset:11584
    v_mfma_f32_16x16x32_bf16 v[88:91], a[144:147], a[36:39], v[88:91]
    s_waitcnt lgkmcnt(8)
    v_mfma_f32_16x16x32_bf16 v[24:27], a[152:155], a[52:55], v[24:27]
    ds_read_b64_tr_b16 a[144:145], v3 offset:96
    ds_read_b64_tr_b16 a[146:147], v3 offset:2400
    v_mfma_f32_16x16x32_bf16 v[24:27], a[156:159], a[60:63], v[24:27]
    buffer_load_dwordx4 v7, s[36:39], s66 offen offset:3072 lds
    v_mfma_f32_16x16x32_bf16 v[16:19], a[156:159], a[56:59], v[16:19]
    ds_read_b64_tr_b16 a[148:149], v3 offset:9312
    ds_read_b64_tr_b16 a[150:151], v3 offset:11616
    v_mfma_f32_16x16x32_bf16 v[16:19], a[152:155], a[48:51], v[16:19]
    s_waitcnt lgkmcnt(8)
    v_mfma_f32_16x16x32_bf16 v[20:23], a[160:163], a[48:51], v[20:23]
    s_add_u32 m0, s60, 0x5800
    ds_read_b64_tr_b16 a[152:153], v3 offset:128
    ds_read_b64_tr_b16 a[154:155], v3 offset:2432
    v_mfma_f32_16x16x32_bf16 v[20:23], a[164:167], a[56:59], v[20:23]
    buffer_load_dwordx4 v8, s[36:39], s66 offen lds
    v_mfma_f32_16x16x32_bf16 v[28:31], a[164:167], a[60:63], v[28:31]
    ds_read_b64_tr_b16 a[156:157], v3 offset:9344
    ds_read_b64_tr_b16 a[158:159], v3 offset:11648
L_pad_a4:
    s_cbranch_execz L_padret_a
    v_mfma_f32_16x16x32_bf16 v[28:31], a[160:163], a[52:55], v[28:31]
    s_waitcnt lgkmcnt(8)
    buffer_load_dword v14, v13, s[48:51], 0 offen sc1
    v_mfma_f32_16x16x32_bf16 v[40:43], a[168:171], a[52:55], v[40:43]
    ds_read_b64_tr_b16 a[160:161], v3 offset:160
    ds_read_b64_tr_b16 a[162:163], v3 offset:2464
    v_mfma_f32_16x16x32_bf16 v[40:43], a[172:175], a[60:63], v[40:43]
    v_mfma_f32_16x16x32_bf16 v[32:35], a[172:175], a[56:59], v[32:35]
    ds_read_b64_tr_b16 a[164:165], v3 offset:9376
    ds_read_b64_tr_b16 a[166:167], v3 offset:11680
    v_mfma_f32_16x16x32_bf16 v[32:35], a[168:171], a[48:51], v[32:35]
    s_waitcnt lgkmcnt(8)
    v_mfma_f32_16x16x32_bf16 v[36:39], a[144:147], a[48:51], v[36:39]
    ds_read_b64_tr_b16 a[168:169], v3 offset:192
    ds_read_b64_tr_b16 a[170:171], v3 offset:2496
    v_mfma_f32_16x16x32_bf16 v[36:39], a[148:151], a[56:59], v[36:39]
    v_mfma_f32_16x16x32_bf16 v[44:47], a[148:151], a[60:63], v[44:47]
    ds_read_b64_tr_b16 a[172:173], v3 offset:9408
    ds_read_b64_tr_b16 a[174:175], v3 offset:11712
    v_mfma_f32_16x16x32_bf16 v[44:47], a[144:147], a[52:55], v[44:47]
    s_waitcnt lgkmcnt(8)
    v_mfma_f32_16x16x32_bf16 v[56:59], a[152:155], a[52:55], v[56:59]
    ds_read_b64_tr_b16 a[144:145], v3 offset:224
    ds_read_b64_tr_b16 a[146:147], v3 offset:2528
    v_mfma_f32_16x16x32_bf16 v[56:59], a[156:159], a[60:63], v[56:59]
    v_mfma_f32_16x16x32_bf16 v[48:51], a[156:159], a[56:59], v[48:51]
    ds_read_b64_tr_b16 a[148:149], v3 offset:9440
    ds_read_b64_tr_b16 a[150:151], v3 offset:11744
    v_mfma_f32_16x16x32_bf16 v[48:51], a[152:155], a[48:51], v[48:51]
    s_waitcnt lgkmcnt(8)
    v_mfma_f32_16x16x32_bf16 v[52:55], a[160:163], a[48:51], v[52:55]
    ds_read_b64_tr_b16 a[152:153], v3 offset:256
    ds_read_b64_tr_b16 a[154:155], v3 offset:2560
    v_mfma_f32_16x16x32_bf16 v[52:55], a[164:167], a[56:59], v[52:55]
    v_mfma_f32_16x16x32_bf16 v[60:63], a[164:167], a[60:63], v[60:63]
    ds_read_b64_tr_b16 a[156:157], v3 offset:9472
    ds_read_b64_tr_b16 a[158:159], v3 offset:11776
    v_mfma_f32_16x16x32_bf16 v[60:63], a[160:163], a[52:55], v[60:63]
    s_waitcnt vmcnt(17) lgkmcnt(8)
    s_barrier
    v_mfma_f32_16x16x32_bf16 v[72:75], a[168:171], a[52:55], v[72:75]
    s_add_u32 m0, s60, 0x9000
    ds_read_b64_tr_b16 a[160:161], v3 offset:18432
    ds_read_b64_tr_b16 a[162:163], v3 offset:20736
    v_mfma_f32_16x16x32_bf16 v[72:75], a[172:175], a[60:63], v[72:75]
    s_add_u32 s66, s98, 0x6c000
    buffer_load_dwordx4 v4, s[36:39], s66 offen lds
    v_mfma_f32_16x16x32_bf16 v[64:67], a[172:175], a[56:59], v[64:67]
    ds_read_b64_tr_b16 a[164:165], v3 offset:27648
    ds_read_b64_tr_b16 a[166:167], v3 offset:29952
    v_mfma_f32_16x16x32_bf16 v[64:67], a[168:171], a[48:51], v[64:67]
    s_waitcnt lgkmcnt(8)
    v_mfma_f32_16x16x32_bf16 v[68:71], a[144:147], a[48:51], v[68:71]
    ds_read_b64_tr_b16 a[168:169], v3 offset:18464
    ds_read_b64_tr_b16 a[170:171], v3 offset:20768
    v_mfma_f32_16x16x32_bf16 v[68:71], a[148:151], a[56:59], v[68:71]
    buffer_load_dwordx4 v5, s[36:39], s66 offen offset:1024 lds
    v_mfma_f32_16x16x32_bf16 v[76:79], a[148:151], a[60:63], v[76:79]
    ds_read_b64_tr_b16 a[172:173], v3 offset:27680
    ds_read_b64_tr_b16 a[174:175], v3 offset:29984
    v_mfma_f32_16x16x32_bf16 v[76:79], a[144:147], a[52:55], v[76:79]
    s_waitcnt lgkmcnt(8)
    v_mfma_f32_16x16x32_bf16 v[88:91], a[152:155], a[52:55], v[88:91]
    ds_read_b64_tr_b16 a[144:145], v3 offset:18496
    ds_read_b64_tr_b16 a[146:147], v3 offset:20800
    v_mfma_f32_16x16x32_bf16 v[88:91], a[156:159], a[60:63], v[88:91]
    buffer_load_dwordx4 v6, s[36:39], s66 offen offset:2048 lds
    v_mfma_f32_16x16x32_bf16 v[80:83], a[156:159], a[56:59], v[80:83]
    ds_read_b64_tr_b16 a[148:149], v3 offset:27712
    ds_read_b64_tr_b16 a[150:151], v3 offset:30016
    v_mfma_f32_16x16x32_bf16 v[80:83], a[152:155], a[48:51], v[80:83]
    s_waitcnt lgkmcnt(8)
    v_mfma_f32_16x16x32_bf16 v[16:19], a[160:163], a[64:67], v[16:19]
    ds_read_b64_tr_b16 a[152:153], v3 offset:18528
    ds_read_b64_tr_b16 a[154:155], v3 offset:20832
    v_mfma_f32_16x16x32_bf16 v[16:19], a[164:167], a[72:75], v[16:19]
    buffer_load_dwordx4 v7, s[36:39], s66 offen offset:3072 lds
    v_mfma_f32_16x16x32_bf16 v[24:27], a[164:167], a[76:79], v[24:27]
    ds_read_b64_tr_b16 a[156:157], v3 offset:27744
    ds_read_b64_tr_b16 a[158:159], v3 offset:30048
    v_mfma_f32_16x16x32_bf16 v[24:27], a[160:163], a[68:71], v[24:27]
    s_waitcnt lgkmcnt(8)
    v_mfma_f32_16x16x32_bf16 v[28:31], a[168:171], a[68:71], v[28:31]
    s_add_u32 m0, s60, 0xa000
    ds_read_b64_tr_b16 a[160:161], v3 offset:18560
    ds_read_b64_tr_b16 a[162:163], v3 offset:20864
    v_mfma_f32_16x16x32_bf16 v[28:31], a[172:175], a[76:79], v[28:31]
    buffer_load_dwordx4 v8, s[36:39], s66 offen lds
    v_mfma_f32_16x16x32_bf16 v[20:23], a[172:175], a[72:75], v[20:23]
    ds_read_b64_tr_b16 a[164:165], v3 offset:27776
    ds_read_b64_tr_b16 a[166:167], v3 offset:30080
    v_mfma_f32_16x16x32_bf16 v[20:23], a[168:171], a[64:67], v[20:23]
    s_waitcnt lgkmcnt(8)
    v_mfma_f32_16x16x32_bf16 v[32:35], a[144:147], a[64:67], v[32:35]
    ds_read_b64_tr_b16 a[168:169], v3 offset:18592
    ds_read_b64_tr_b16 a[170:171], v3 offset:20896
    v_mfma_f32_16x16x32_bf16 v[32:35], a[148:151], a[72:75], v[32:35]
    v_mfma_f32_16x16x32_bf16 v[40:43], a[148:151], a[76:79], v[40:43]
    ds_read_b64_tr_b16 a[172:173], v3 offset:27808
    ds_read_b64_tr_b16 a[174:175], v3 offset:30112
    v_mfma_f32_16x16x32_bf16 v[40:43], a[144:147], a[68:71], v[40:43]
    s_waitcnt lgkmcnt(8)
    v_mfma_f32_16x16x32_bf16 v[44:47], a[152:155], a[68:71], v[44:47]
    ds_read_b64_tr_b16 a[144:145], v3 offset:18624
    ds_read_b64_tr_b16 a[146:147], v3 offset:20928
    v_mfma_f32_16x16x32_bf16 v[44:47], a[156:159], a[76:79], v[44:47]
    v_mfma_f32_16x16x32_bf16 v[36:39], a[156:159], a[72:75], v[36:39]
    ds_read_b64_tr_b16 a[148:149], v3 offset:27840
    ds_read_b64_tr_b16 a[150:151], v3 offset:30144
    v_mfma_f32_16x16x32_bf16 v[36:39], a[152:155], a[64:67], v[36:39]
    s_waitcnt lgkmcnt(8)
    v_mfma_f32_16x16x32_bf16 v[48:51], a[160:163], a[64:67], v[48:51]
    ds_read_b64_tr_b16 a[152:153], v3 offset:18656
    ds_read_b64_tr_b16 a[154:155], v3 offset:20960
    v_mfma_f32_16x16x32_bf16 v[48:51], a[164:167], a[72:75], v[48:51]
    s_waitcnt vmcnt(5)
    v_cmp_ne_u32 vcc, v14, v241
    s_cbranch_vccz L_ok8
    s_mov_b32 s75, 131072
L_sp8:
    s_sleep 2
    buffer_load_dword v14, v13, s[48:51], 0 offen sc1
    s_waitcnt vmcnt(0)
    v_cmp_ne_u32 vcc, v14, v241
    s_cbranch_vccz L_ok8
    s_sub_u32 s75, s75, 1
    s_cmp_lg_u32 s75, 0
    s_cbranch_scc1 L_sp8
L_ok8:
    s_barrier
    v_mfma_f32_16x16x32_bf16 v[56:59], a[164:167], a[76:79], v[56:59]
    s_add_u32 s62, s72, 0
    ds_read_b64_tr_b16 a[156:157], v3 offset:27872
    ds_read_b64_tr_b16 a[158:159], v3 offset:30176
    v_mfma_f32_16x16x32_bf16 v[56:59], a[160:163], a[68:71], v[56:59]
    s_waitcnt lgkmcnt(8)
    buffer_load_dwordx2 v[176:177], v1, s[48:51], s62 offen sc1
    v_mfma_f32_16x16x32_bf16 v[60:63], a[168:171], a[68:71], v[60:63]
    s_add_u32 s62, s72, 0x4800
    ds_read_b64_tr_b16 a[160:161], v3 offset:18688
    ds_read_b64_tr_b16 a[162:163], v3 offset:20992
    v_mfma_f32_16x16x32_bf16 v[60:63], a[172:175], a[76:79], v[60:63]
    buffer_load_dwordx2 v[178:179], v1, s[48:51], s62 offen sc1
    v_mfma_f32_16x16x32_bf16 v[52:55], a[172:175], a[72:75], v[52:55]
    s_add_u32 s62, s72, 0x9000
    ds_read_b64_tr_b16 a[164:165], v3 offset:27904
    ds_read_b64_tr_b16 a[166:167], v3 offset:30208
    v_mfma_f32_16x16x32_bf16 v[52:55], a[168:171], a[64:67], v[52:55]
    s_waitcnt lgkmcnt(8)
    s_barrier
    buffer_load_dwordx2 v[180:181], v1, s[48:51], s62 offen sc1
    v_mfma_f32_16x16x32_bf16 v[64:67], a[144:147], a[64:67], v[64:67]
    s_add_u32 s62, s72, 0xd800
    ds_read_b64_tr_b16 a[168:169], v3 offset:36864
    ds_read_b64_tr_b16 a[170:171], v3 offset:39168
    v_mfma_f32_16x16x32_bf16 v[64:67], a[148:151], a[72:75], v[64:67]
    buffer_load_dwordx2 v[182:183], v1, s[48:51], s62 offen sc1
    v_mfma_f32_16x16x32_bf16 v[72:75], a[148:151], a[76:79], v[72:75]
    s_add_u32 s62, s72, 0x12000
    ds_read_b64_tr_b16 a[172:173], v3 offset:46080
    ds_read_b64_tr_b16 a[174:175], v3 offset:48384
    v_mfma_f32_16x16x32_bf16 v[72:75], a[144:147], a[68:71], v[72:75]
    s_waitcnt lgkmcnt(8)
    buffer_load_dwordx2 v[184:185], v1, s[48:51], s62 offen sc1
    v_mfma_f32_16x16x32_bf16 v[76:79], a[152:155], a[68:71], v[76:79]
    s_add_u32 s62, s72, 0x16800
    ds_read_b64_tr_b16 a[144:145], v3 offset:36896
    ds_read_b64_tr_b16 a[146:147], v3 offset:39200
    v_mfma_f32_16x16x32_bf16 v[76:79], a[156:159], a[76:79], v[76:79]
    buffer_load_dwordx2 v[186:187], v1, s[48:51], s62 offen sc1
    v_mfma_f32_16x16x32_bf16 v[68:71], a[156:159], a[72:75], v[68:71]
    s_add_u32 s62, s72, 0x1b000
    ds_read_b64_tr_b16 a[148:149], v3 offset:46112
    ds_read_b64_tr_b16 a[150:151], v3 offset:48416
    v_mfma_f32_16x16x32_bf16 v[68:71], a[152:155], a[64:67], v[68:71]
    s_waitcnt lgkmcnt(8)
    buffer_load_dwordx2 v[188:189], v1, s[48:51], s62 offen sc1
    v_mfma_f32_16x16x32_bf16 v[80:83], a[160:163], a[64:67], v[80:83]
    s_add_u32 s62, s72, 0x1f800
    ds_read_b64_tr_b16 a[152:153], v3 offset:36928
    ds_read_b64_tr_b16 a[154:155], v3 offset:39232
    v_mfma_f32_16x16x32_bf16 v[80:83], a[164:167], a[72:75], v[80:83]
    buffer_load_dwordx2 v[190:191], v1, s[48:51], s62 offen sc1
    v_mfma_f32_16x16x32_bf16 v[88:91], a[164:167], a[76:79], v[88:91]
    s_add_u32 s62, s72, 0x24000
    ds_read_b64_tr_b16 a[156:157], v3 offset:46144
    ds_read_b64_tr_b16 a[158:159], v3 offset:48448
    v_mfma_f32_16x16x32_bf16 v[88:91], a[160:163], a[68:71], v[88:91]
    s_waitcnt lgkmcnt(8)
    buffer_load_dwordx2 v[192:193], v1, s[48:51], s62 offen sc1
    v_mfma_f32_16x16x32_bf16 v[24:27], a[168:171], a[84:87], v[24:27]
    s_add_u32 s62, s72, 0x28800
    ds_read_b64_tr_b16 a[160:161], v3 offset:36960
    ds_read_b64_tr_b16 a[162:163], v3 offset:39264
    v_mfma_f32_16x16x32_bf16 v[24:27], a[172:175], a[92:95], v[24:27]
    buffer_load_dwordx2 v[194:195], v1, s[48:51], s62 offen sc1
    v_mfma_f32_16x16x32_bf16 v[16:19], a[172:175], a[88:91], v[16:19]
    s_add_u32 s62, s72, 0x2d000
    ds_read_b64_tr_b16 a[164:165], v3 offset:46176
    ds_read_b64_tr_b16 a[166:167], v3 offset:48480
    v_mfma_f32_16x16x32_bf16 v[16:19], a[168:171], a[80:83], v[16:19]
    s_waitcnt lgkmcnt(8)
    buffer_load_dwordx2 v[196:197], v1, s[48:51], s62 offen sc1
    v_mfma_f32_16x16x32_bf16 v[20:23], a[144:147], a[80:83], v[20:23]
    s_add_u32 s62, s72, 0x31800
    ds_read_b64_tr_b16 a[168:169], v3 offset:36992
    ds_read_b64_tr_b16 a[170:171], v3 offset:39296
    v_mfma_f32_16x16x32_bf16 v[20:23], a[148:151], a[88:91], v[20:23]
    buffer_load_dwordx2 v[198:199], v1, s[48:51], s62 offen sc1
    v_mfma_f32_16x16x32_bf16 v[28:31], a[148:151], a[92:95], v[28:31]
    s_add_u32 s62, s72, 0x36000
    ds_read_b64_tr_b16 a[172:173], v3 offset:46208
    ds_read_b64_tr_b16 a[174:175], v3 offset:48512
    v_mfma_f32_16x16x32_bf16 v[28:31], a[144:147], a[84:87], v[28:31]
    s_waitcnt lgkmcnt(8)
    buffer_load_dwordx2 v[200:201], v1, s[48:51], s62 offen sc1
    v_mfma_f32_16x16x32_bf16 v[40:43], a[152:155], a[84:87], v[40:43]
    s_add_u32 s62, s72, 0x3a800
    ds_read_b64_tr_b16 a[144:145], v3 offset:37024
    ds_read_b64_tr_b16 a[146:147], v3 offset:39328
    v_mfma_f32_16x16x32_bf16 v[40:43], a[156:159], a[92:95], v[40:43]
    buffer_load_dwordx2 v[202:203], v1, s[48:51], s62 offen sc1
    v_mfma_f32_16x16x32_bf16 v[32:35], a[156:159], a[88:91], v[32:35]
    s_add_u32 s62, s72, 0x3f000
    ds_read_b64_tr_b16 a[148:149], v3 offset:46240
    ds_read_b64_tr_b16 a[150:151], v3 offset:48544
    v_mfma_f32_16x16x32_bf16 v[32:35], a[152:155], a[80:83], v[32:35]
    s_waitcnt lgkmcnt(8)
    buffer_load_dwordx2 v[204:205], v1, s[48:51], s62 offen sc1
    v_mfma_f32_16x16x32_bf16 v[36:39], a[160:163], a[80:83], v[36:39]
    s_add_u32 s62, s72, 0x43800
    ds_read_b64_tr_b16 a[152:153], v3 offset:37056
    ds_read_b64_tr_b16 a[154:155], v3 offset:39360
    v_mfma_f32_16x16x32_bf16 v[36:39], a[164:167], a[88:91], v[36:39]
    buffer_load_dwordx2 v[206:207], v1, s[48:51], s62 offen sc1
    v_mfma_f32_16x16x32_bf16 v[44:47], a[164:167], a[92:95], v[44:47]
    ds_read_b64_tr_b16 a[156:157], v3 offset:46272
    ds_read_b64_tr_b16 a[158:159], v3 offset:48576
    v_mfma_f32_16x16x32_bf16 v[44:47], a[160:163], a[84:87], v[44:47]
    s_waitcnt lgkmcnt(8)
    s_add_u32 s63, s70, s71
    s_lshl_b32 s63, s63, 4
    v_mfma_f32_16x16x32_bf16 v[56:59], a[168:171], a[84:87], v[56:59]
    ds_read_b64_tr_b16 a[160:161], v3 offset:37088
    ds_read_b64_tr_b16 a[162:163], v3 offset:39392
    v_mfma_f32_16x16x32_bf16 v[56:59], a[172:175], a[92:95], v[56:59]
    s_sub_u32 s63, s63, 16
    v_and_b32 v250, 15, v0
    v_add_u32 v250, s63, v250
    v_mfma_f32_16x16x32_bf16 v[48:51], a[172:175], a[88:91], v[48:51]
    ds_read_b64_tr_b16 a[164:165], v3 offset:46304
    ds_read_b64_tr_b16 a[166:167], v3 offset:48608
    v_mfma_f32_16x16x32_bf16 v[48:51], a[168:171], a[80:83], v[48:51]
    s_waitcnt lgkmcnt(8)
    v_mul_u32_u24 v250, 57, v250
    v_lshrrev_b32 v250, 10, v250
    s_cmp_gt_u32 s69, 19
    s_cselect_b32 s63, 4, 0
    v_mfma_f32_16x16x32_bf16 v[52:55], a[144:147], a[80:83], v[52:55]
    ds_read_b64_tr_b16 a[168:169], v3 offset:37120
    ds_read_b64_tr_b16 a[170:171], v3 offset:39424
    v_mfma_f32_16x16x32_bf16 v[52:55], a[148:151], a[88:91], v[52:55]
    v_and_b32 v251, 3, v0
    v_add_u32 v251, s63, v251
    v_mfma_f32_16x16x32_bf16 v[60:63], a[148:151], a[92:95], v[60:63]
    ds_read_b64_tr_b16 a[172:173], v3 offset:46336
    ds_read_b64_tr_b16 a[174:175], v3 offset:48640
    v_mfma_f32_16x16x32_bf16 v[60:63], a[144:147], a[84:87], v[60:63]
    s_waitcnt lgkmcnt(8)
    s_barrier
    s_cmp_eq_u32 s71, 3
    s_cselect_b64 vcc, -1, 0
    v_cndmask_b32 v250, v250, v251, vcc
    s_lshl_b32 s63, s70, 4
    v_mfma_f32_16x16x32_bf16 v[72:75], a[152:155], a[84:87], v[72:75]
    ds_read_b64_tr_b16 a[144:145], v2
    ds_read_b64_tr_b16 a[146:147], v2 offset:2304
    v_mfma_f32_16x16x32_bf16 v[72:75], a[156:159], a[92:95], v[72:75]
    v_lshrrev_b32 v251, 4, v0
    v_lshl_add_u32 v251, v251, 2, s63
    v_mfma_f32_16x16x32_bf16 v[64:67], a[156:159], a[88:91], v[64:67]
    ds_read_b64_tr_b16 a[148:149], v2 offset:9216
    ds_read_b64_tr_b16 a[150:151], v2 offset:11520
    v_mfma_f32_16x16x32_bf16 v[64:67], a[152:155], a[80:83], v[64:67]
    s_waitcnt lgkmcnt(8)
    s_lshl_b32 s73, s57, 15
    s_add_u32 s73, s73, 0x2f00000
    s_lshl_b32 s77, s69, 9
    v_mfma_f32_16x16x32_bf16 v[68:71], a[160:163], a[80:83], v[68:71]
    ds_read_b64_tr_b16 a[152:153], v2 offset:32
    ds_read_b64_tr_b16 a[154:155], v2 offset:2336
    v_mfma_f32_16x16x32_bf16 v[68:71], a[164:167], a[88:91], v[68:71]
    s_add_u32 s77, s77, s73
    v_lshlrev_b32 v252, 3, v0
    v_add_u32 v242, 0, v251
    v_mfma_f32_16x16x32_bf16 v[76:79], a[164:167], a[92:95], v[76:79]
    ds_read_b64_tr_b16 a[156:157], v2 offset:9248
    ds_read_b64_tr_b16 a[158:159], v2 offset:11552
    v_mfma_f32_16x16x32_bf16 v[76:79], a[160:163], a[84:87], v[76:79]
    s_waitcnt lgkmcnt(8)
    v_mul_u32_u24 v242, 57, v242
    v_lshrrev_b32 v242, 10, v242
    v_mfma_f32_16x16x32_bf16 v[88:91], a[168:171], a[84:87], v[88:91]
    ds_read_b64_tr_b16 a[160:161], v2 offset:64
    ds_read_b64_tr_b16 a[162:163], v2 offset:2368
    v_mfma_f32_16x16x32_bf16 v[88:91], a[172:175], a[92:95], v[88:91]
    v_cmp_eq_u32 vcc, v242, v250
    s_nop 1
    v_cndmask_b32_e64 v144, 0, -1, vcc
    v_add_u32 v242, 1, v251
    v_mfma_f32_16x16x32_bf16 v[80:83], a[172:175], a[88:91], v[80:83]
    ds_read_b64_tr_b16 a[164:165], v2 offset:9280
    ds_read_b64_tr_b16 a[166:167], v2 offset:11584
    v_mfma_f32_16x16x32_bf16 v[80:83], a[168:171], a[80:83], v[80:83]
    s_waitcnt lgkmcnt(8)
    v_mul_u32_u24 v242, 57, v242
    v_lshrrev_b32 v242, 10, v242
    v_cmp_eq_u32 vcc, v242, v250
    v_mfma_f32_16x16x32_bf16 v[16:19], a[144:147], a[96:99], v[16:19]
    ds_read_b64_tr_b16 a[168:169], v2 offset:96
    ds_read_b64_tr_b16 a[170:171], v2 offset:2400
    v_mfma_f32_16x16x32_bf16 v[16:19], a[148:151], a[104:107], v[16:19]
    v_cndmask_b32_e64 v145, 0, -1, vcc
    v_add_u32 v242, 2, v251
    v_mfma_f32_16x16x32_bf16 v[24:27], a[148:151], a[108:111], v[24:27]
    ds_read_b64_tr_b16 a[172:173], v2 offset:9312
    ds_read_b64_tr_b16 a[174:175], v2 offset:11616
    v_mfma_f32_16x16x32_bf16 v[24:27], a[144:147], a[100:103], v[24:27]
    s_waitcnt lgkmcnt(8)
    v_mul_u32_u24 v242, 57, v242
    v_lshrrev_b32 v242, 10, v242
    v_cmp_eq_u32 vcc, v242, v250
    v_mfma_f32_16x16x32_bf16 v[28:31], a[152:155], a[100:103], v[28:31]
    ds_read_b64_tr_b16 a[144:145], v2 offset:128
    ds_read_b64_tr_b16 a[146:147], v2 offset:2432
    v_mfma_f32_16x16x32_bf16 v[28:31], a[156:159], a[108:111], v[28:31]
    v_cndmask_b32_e64 v146, 0, -1, vcc
    v_add_u32 v242, 3, v251
    v_mul_u32_u24 v242, 57, v242
    v_mfma_f32_16x16x32_bf16 v[20:23], a[156:159], a[104:107], v[20:23]
    ds_read_b64_tr_b16 a[148:149], v2 offset:9344
    ds_read_b64_tr_b16 a[150:151], v2 offset:11648
    v_mfma_f32_16x16x32_bf16 v[20:23], a[152:155], a[96:99], v[20:23]
    s_waitcnt lgkmcnt(8)
    v_lshrrev_b32 v242, 10, v242
    v_cmp_eq_u32 vcc, v242, v250
    v_mfma_f32_16x16x32_bf16 v[32:35], a[160:163], a[96:99], v[32:35]
    ds_read_b64_tr_b16 a[152:153], v2 offset:160
    ds_read_b64_tr_b16 a[154:155], v2 offset:2464
    v_mfma_f32_16x16x32_bf16 v[32:35], a[164:167], a[104:107], v[32:35]
    v_cndmask_b32_e64 v147, 0, -1, vcc
    v_and_b32 v12, 48, v0
    v_add_u32 v12, 0x27000, v12
    v_mfma_f32_16x16x32_bf16 v[40:43], a[164:167], a[108:111], v[40:43]
    ds_read_b64_tr_b16 a[156:157], v2 offset:9376
    ds_read_b64_tr_b16 a[158:159], v2 offset:11680
    v_mfma_f32_16x16x32_bf16 v[40:43], a[160:163], a[100:103], v[40:43]
    s_waitcnt lgkmcnt(8)
    v_and_b32 v242, 3, v0
    v_min_u32 v242, 1, v242
    v_lshl_add_u32 v12, v242, 18, v12
    v_mfma_f32_16x16x32_bf16 v[44:47], a[168:171], a[100:103], v[44:47]
    ds_read_b64_tr_b16 a[160:161], v2 offset:192
    ds_read_b64_tr_b16 a[162:163], v2 offset:2496
    v_mfma_f32_16x16x32_bf16 v[44:47], a[172:175], a[108:111], v[44:47]
    s_waitcnt vmcnt(14)
    v_mfma_f32_16x16x32_bf16 v[208:211], v[140:143], v[176:179], 0
    s_waitcnt vmcnt(12)
    v_mfma_f32_16x16x32_bf16 v[208:211], v[140:143], v[180:183], v[208:211]
    s_waitcnt vmcnt(10)
    v_mfma_f32_16x16x32_bf16 v[208:211], v[140:143], v[184:187], v[208:211]
    s_waitcnt vmcnt(8)
    v_mfma_f32_16x16x32_bf16 v[208:211], v[140:143], v[188:191], v[208:211]
    s_waitcnt vmcnt(6)
    v_mfma_f32_16x16x32_bf16 v[208:211], v[140:143], v[192:195], v[208:211]
    s_waitcnt vmcnt(4)
    v_mfma_f32_16x16x32_bf16 v[208:211], v[140:143], v[196:199], v[208:211]
    s_waitcnt vmcnt(2)
    v_mfma_f32_16x16x32_bf16 v[208:211], v[140:143], v[200:203], v[208:211]
    s_waitcnt vmcnt(0)
    v_mfma_f32_16x16x32_bf16 v[208:211], v[140:143], v[204:207], v[208:211]
    v_mfma_f32_16x16x32_bf16 v[36:39], a[172:175], a[104:107], v[36:39]
    ds_read_b64_tr_b16 a[164:165], v2 offset:9408
    ds_read_b64_tr_b16 a[166:167], v2 offset:11712
    v_mfma_f32_16x16x32_bf16 v[36:39], a[168:171], a[96:99], v[36:39]
    s_waitcnt lgkmcnt(8)
    v_mfma_f32_16x16x32_bf16 v[48:51], a[144:147], a[96:99], v[48:51]
    ds_read_b64_tr_b16 a[168:169], v2 offset:224
    ds_read_b64_tr_b16 a[170:171], v2 offset:2528
    v_mfma_f32_16x16x32_bf16 v[48:51], a[148:151], a[104:107], v[48:51]
    v_and_b32 v208, v144, v208
    v_and_b32 v209, v145, v209
    v_and_b32 v210, v146, v210
    v_and_b32 v211, v147, v211
    v_cvt_pk_bf16_f32 v208, v208, v209
    v_cvt_pk_bf16_f32 v209, v210, v211
    v_mfma_f32_16x16x32_bf16 v[56:59], a[148:151], a[108:111], v[56:59]
    buffer_store_dwordx2 v[208:209], v252, s[48:51], s77 offen sc1
    ds_read_b64_tr_b16 a[172:173], v2 offset:9440
    ds_read_b64_tr_b16 a[174:175], v2 offset:11744
    v_mfma_f32_16x16x32_bf16 v[56:59], a[144:147], a[100:103], v[56:59]
    s_waitcnt lgkmcnt(8)
    v_mfma_f32_16x16x32_bf16 v[60:63], a[152:155], a[100:103], v[60:63]
    ds_read_b64_tr_b16 a[144:145], v2 offset:256
    ds_read_b64_tr_b16 a[146:147], v2 offset:2560
    v_mfma_f32_16x16x32_bf16 v[60:63], a[156:159], a[108:111], v[60:63]
    v_add_u32 v252, 0x1b000, v252
    s_lshl_b32 s62, s59, 10
    s_add_u32 s63, s62, s73
    v_mfma_f32_16x16x32_bf16 v[52:55], a[156:159], a[104:107], v[52:55]
    ds_read_b64_tr_b16 a[148:149], v2 offset:9472
    ds_read_b64_tr_b16 a[150:151], v2 offset:11776
    v_mfma_f32_16x16x32_bf16 v[52:55], a[152:155], a[96:99], v[52:55]
    s_waitcnt lgkmcnt(8)
    s_barrier
    v_mfma_f32_16x16x32_bf16 v[64:67], a[160:163], a[96:99], v[64:67]
    ds_read_b64_tr_b16 a[152:153], v2 offset:18432
    ds_read_b64_tr_b16 a[154:155], v2 offset:20736
    v_mfma_f32_16x16x32_bf16 v[64:67], a[164:167], a[104:107], v[64:67]
    s_lshl_b32 s90, s56, 2
    s_add_u32 s90, s90, s57
    v_mfma_f32_16x16x32_bf16 v[72:75], a[164:167], a[108:111], v[72:75]
    ds_read_b64_tr_b16 a[156:157], v2 offset:27648
    ds_read_b64_tr_b16 a[158:159], v2 offset:29952
    v_mfma_f32_16x16x32_bf16 v[72:75], a[160:163], a[100:103], v[72:75]
    s_waitcnt lgkmcnt(8)
    s_lshl_b32 s90, s90, 2
    v_mfma_f32_16x16x32_bf16 v[76:79], a[168:171], a[100:103], v[76:79]
    ds_read_b64_tr_b16 a[160:161], v2 offset:18464
    ds_read_b64_tr_b16 a[162:163], v2 offset:20768
    v_mfma_f32_16x16x32_bf16 v[76:79], a[172:175], a[108:111], v[76:79]
    v_mfma_f32_16x16x32_bf16 v[68:71], a[172:175], a[104:107], v[68:71]
    ds_read_b64_tr_b16 a[164:165], v2 offset:27680
    ds_read_b64_tr_b16 a[166:167], v2 offset:29984
    v_mfma_f32_16x16x32_bf16 v[68:71], a[168:171], a[96:99], v[68:71]
    s_waitcnt lgkmcnt(8)
    s_add_u32 s90, s90, s59
    v_mfma_f32_16x16x32_bf16 v[80:83], a[144:147], a[96:99], v[80:83]
    ds_read_b64_tr_b16 a[168:169], v2 offset:18496
    ds_read_b64_tr_b16 a[170:171], v2 offset:20800
    v_mfma_f32_16x16x32_bf16 v[80:83], a[148:151], a[104:107], v[80:83]
    v_mfma_f32_16x16x32_bf16 v[88:91], a[148:151], a[108:111], v[88:91]
    ds_read_b64_tr_b16 a[172:173], v2 offset:27712
    ds_read_b64_tr_b16 a[174:175], v2 offset:30016
    v_mfma_f32_16x16x32_bf16 v[88:91], a[144:147], a[100:103], v[88:91]
    s_waitcnt lgkmcnt(8)
    v_mfma_f32_16x16x32_bf16 v[24:27], a[152:155], a[116:119], v[24:27]
    ds_read_b64_tr_b16 a[144:145], v2 offset:18528
    ds_read_b64_tr_b16 a[146:147], v2 offset:20832
    v_mfma_f32_16x16x32_bf16 v[24:27], a[156:159], a[124:127], v[24:27]
    s_mul_i32 s90, s90, 0x2400
    v_mfma_f32_16x16x32_bf16 v[16:19], a[156:159], a[120:123], v[16:19]
    ds_read_b64_tr_b16 a[148:149], v2 offset:27744
    ds_read_b64_tr_b16 a[150:151], v2 offset:30048
    v_mfma_f32_16x16x32_bf16 v[16:19], a[152:155], a[112:115], v[16:19]
    s_waitcnt lgkmcnt(8)
    v_mfma_f32_16x16x32_bf16 v[20:23], a[160:163], a[112:115], v[20:23]
    ds_read_b64_tr_b16 a[152:153], v2 offset:18560
    ds_read_b64_tr_b16 a[154:155], v2 offset:20864
    v_mfma_f32_16x16x32_bf16 v[20:23], a[164:167], a[120:123], v[20:23]
    v_mfma_f32_16x16x32_bf16 v[28:31], a[164:167], a[124:127], v[28:31]
    ds_read_b64_tr_b16 a[156:157], v2 offset:27776
    ds_read_b64_tr_b16 a[158:159], v2 offset:30080
    v_mfma_f32_16x16x32_bf16 v[28:31], a[160:163], a[116:119], v[28:31]
    s_waitcnt lgkmcnt(8)
    v_mov_b32 v148, 0
    v_mfma_f32_16x16x32_bf16 v[40:43], a[168:171], a[116:119], v[40:43]
    ds_read_b64_tr_b16 a[160:161], v2 offset:18592
    ds_read_b64_tr_b16 a[162:163], v2 offset:20896
    v_mfma_f32_16x16x32_bf16 v[40:43], a[172:175], a[124:127], v[40:43]
    v_mfma_f32_16x16x32_bf16 v[32:35], a[172:175], a[120:123], v[32:35]
    ds_read_b64_tr_b16 a[164:165], v2 offset:27808
    ds_read_b64_tr_b16 a[166:167], v2 offset:30112
    v_mfma_f32_16x16x32_bf16 v[32:35], a[168:171], a[112:115], v[32:35]
    s_waitcnt lgkmcnt(8)
    v_mfma_f32_16x16x32_bf16 v[36:39], a[144:147], a[112:115], v[36:39]
    ds_read_b64_tr_b16 a[168:169], v2 offset:18624
    ds_read_b64_tr_b16 a[170:171], v2 offset:20928
    v_mfma_f32_16x16x32_bf16 v[36:39], a[148:151], a[120:123], v[36:39]
    v_mov_b32 v149, 0
    v_mfma_f32_16x16x32_bf16 v[44:47], a[148:151], a[124:127], v[44:47]
    ds_read_b64_tr_b16 a[172:173], v2 offset:27840
    ds_read_b64_tr_b16 a[174:175], v2 offset:30144
    v_mfma_f32_16x16x32_bf16 v[44:47], a[144:147], a[116:119], v[44:47]
    s_waitcnt lgkmcnt(8)
    v_mfma_f32_16x16x32_bf16 v[56:59], a[152:155], a[116:119], v[56:59]
    ds_read_b64_tr_b16 a[144:145], v2 offset:18656
    ds_read_b64_tr_b16 a[146:147], v2 offset:20960
    v_mfma_f32_16x16x32_bf16 v[56:59], a[156:159], a[124:127], v[56:59]
    v_mfma_f32_16x16x32_bf16 v[48:51], a[156:159], a[120:123], v[48:51]
    ds_read_b64_tr_b16 a[148:149], v2 offset:27872
    ds_read_b64_tr_b16 a[150:151], v2 offset:30176
    v_mfma_f32_16x16x32_bf16 v[48:51], a[152:155], a[112:115], v[48:51]
    s_waitcnt lgkmcnt(8)
    v_mov_b32 v150, 0
    v_mfma_f32_16x16x32_bf16 v[52:55], a[160:163], a[112:115], v[52:55]
    ds_read_b64_tr_b16 a[152:153], v2 offset:18688
    ds_read_b64_tr_b16 a[154:155], v2 offset:20992
    v_mfma_f32_16x16x32_bf16 v[52:55], a[164:167], a[120:123], v[52:55]
    v_mfma_f32_16x16x32_bf16 v[60:63], a[164:167], a[124:127], v[60:63]
    ds_read_b64_tr_b16 a[156:157], v2 offset:27904
    ds_read_b64_tr_b16 a[158:159], v2 offset:30208
    v_mfma_f32_16x16x32_bf16 v[60:63], a[160:163], a[116:119], v[60:63]
    s_waitcnt lgkmcnt(8)
    s_barrier
    v_mfma_f32_16x16x32_bf16 v[72:75], a[168:171], a[116:119], v[72:75]
    ds_read_b64_tr_b16 a[160:161], v2 offset:36864
    ds_read_b64_tr_b16 a[162:163], v2 offset:39168
    v_mfma_f32_16x16x32_bf16 v[72:75], a[172:175], a[124:127], v[72:75]
    v_mov_b32 v151, 0
    v_mfma_f32_16x16x32_bf16 v[64:67], a[172:175], a[120:123], v[64:67]
    ds_read_b64_tr_b16 a[164:165], v2 offset:46080
    ds_read_b64_tr_b16 a[166:167], v2 offset:48384
    v_mfma_f32_16x16x32_bf16 v[64:67], a[168:171], a[112:115], v[64:67]
    s_waitcnt lgkmcnt(8)
    v_mfma_f32_16x16x32_bf16 v[68:71], a[144:147], a[112:115], v[68:71]
    ds_read_b64_tr_b16 a[168:169], v2 offset:36896
    ds_read_b64_tr_b16 a[170:171], v2 offset:39200
    v_mfma_f32_16x16x32_bf16 v[68:71], a[148:151], a[120:123], v[68:71]
    v_mfma_f32_16x16x32_bf16 v[76:79], a[148:151], a[124:127], v[76:79]
    ds_read_b64_tr_b16 a[172:173], v2 offset:46112
    ds_read_b64_tr_b16 a[174:175], v2 offset:48416
    v_mfma_f32_16x16x32_bf16 v[76:79], a[144:147], a[116:119], v[76:79]
    s_waitcnt lgkmcnt(8)
    v_mfma_f32_16x16x32_bf16 v[88:91], a[152:155], a[116:119], v[88:91]
    ds_read_b64_tr_b16 a[144:145], v2 offset:36928
    ds_read_b64_tr_b16 a[146:147], v2 offset:39232
    v_mfma_f32_16x16x32_bf16 v[88:91], a[156:159], a[124:127], v[88:91]
    v_mfma_f32_16x16x32_bf16 v[80:83], a[156:159], a[120:123], v[80:83]
    ds_read_b64_tr_b16 a[148:149], v2 offset:46144
    ds_read_b64_tr_b16 a[150:151], v2 offset:48448
    v_mfma_f32_16x16x32_bf16 v[80:83], a[152:155], a[112:115], v[80:83]
    s_waitcnt lgkmcnt(8)
    v_mfma_f32_16x16x32_bf16 v[16:19], a[160:163], a[128:131], v[16:19]
    ds_read_b64_tr_b16 a[152:153], v2 offset:36960
    ds_read_b64_tr_b16 a[154:155], v2 offset:39264
    v_mfma_f32_16x16x32_bf16 v[16:19], a[164:167], a[136:139], v[16:19]
    v_mfma_f32_16x16x32_bf16 v[24:27], a[164:167], a[140:143], v[24:27]
    ds_read_b64_tr_b16 a[156:157], v2 offset:46176
    ds_read_b64_tr_b16 a[158:159], v2 offset:48480
    v_mfma_f32_16x16x32_bf16 v[24:27], a[160:163], a[132:135], v[24:27]
    s_waitcnt lgkmcnt(8)
    v_mfma_f32_16x16x32_bf16 v[28:31], a[168:171], a[132:135], v[28:31]
    ds_read_b64_tr_b16 a[160:161], v2 offset:36992
    ds_read_b64_tr_b16 a[162:163], v2 offset:39296
    v_mfma_f32_16x16x32_bf16 v[28:31], a[172:175], a[140:143], v[28:31]
    v_mfma_f32_16x16x32_bf16 v[20:23], a[172:175], a[136:139], v[20:23]
    ds_read_b64_tr_b16 a[164:165], v2 offset:46208
    ds_read_b64_tr_b16 a[166:167], v2 offset:48512
    v_mfma_f32_16x16x32_bf16 v[20:23], a[168:171], a[128:131], v[20:23]
    s_waitcnt lgkmcnt(8)
    v_mfma_f32_16x16x32_bf16 v[32:35], a[144:147], a[128:131], v[32:35]
    ds_read_b64_tr_b16 a[168:169], v2 offset:37024
    ds_read_b64_tr_b16 a[170:171], v2 offset:39328
    v_mfma_f32_16x16x32_bf16 v[32:35], a[148:151], a[136:139], v[32:35]
    s_waitcnt vmcnt(0)
    s_barrier
    buffer_store_dword v15, v240, s[48:51], 0 offen offset:128 sc1
    v_mfma_f32_16x16x32_bf16 v[40:43], a[148:151], a[140:143], v[40:43]
    ds_read_b64_tr_b16 a[172:173], v2 offset:46240
    ds_read_b64_tr_b16 a[174:175], v2 offset:48544
    v_mfma_f32_16x16x32_bf16 v[40:43], a[144:147], a[132:135], v[40:43]
    s_waitcnt lgkmcnt(8)
    buffer_store_dwordx4 v[148:151], v1, s[52:55], s90 offen sc1
    v_mfma_f32_16x16x32_bf16 v[44:47], a[152:155], a[132:135], v[44:47]
    ds_read_b64_tr_b16 a[144:145], v2 offset:37056
    ds_read_b64_tr_b16 a[146:147], v2 offset:39360
    v_mfma_f32_16x16x32_bf16 v[44:47], a[156:159], a[140:143], v[44:47]
    buffer_store_dwordx4 v[148:151], v1, s[52:55], s90 offen offset:1024 sc1
    v_mfma_f32_16x16x32_bf16 v[36:39], a[156:159], a[136:139], v[36:39]
    ds_read_b64_tr_b16 a[148:149], v2 offset:46272
    ds_read_b64_tr_b16 a[150:151], v2 offset:48576
    v_mfma_f32_16x16x32_bf16 v[36:39], a[152:155], a[128:131], v[36:39]
    s_waitcnt lgkmcnt(8)
    v_mfma_f32_16x16x32_bf16 v[48:51], a[160:163], a[128:131], v[48:51]
    ds_read_b64_tr_b16 a[152:153], v2 offset:37088
    ds_read_b64_tr_b16 a[154:155], v2 offset:39392
    v_mfma_f32_16x16x32_bf16 v[48:51], a[164:167], a[136:139], v[48:51]
L_pad_a5:
    s_cbranch_execz L_padret_a
    buffer_store_dwordx4 v[148:151], v1, s[52:55], s90 offen offset:2048 sc1
    v_mfma_f32_16x16x32_bf16 v[56:59], a[164:167], a[140:143], v[56:59]
    ds_read_b64_tr_b16 a[156:157], v2 offset:46304
    ds_read_b64_tr_b16 a[158:159], v2 offset:48608
    v_mfma_f32_16x16x32_bf16 v[56:59], a[160:163], a[132:135], v[56:59]
    s_waitcnt lgkmcnt(8)
    buffer_store_dwordx4 v[148:151], v1, s[52:55], s90 offen offset:3072 sc1
    v_mfma_f32_16x16x32_bf16 v[60:63], a[168:171], a[132:135], v[60:63]
    ds_read_b64_tr_b16 a[160:161], v2 offset:37120
    ds_read_b64_tr_b16 a[162:163], v2 offset:39424
    v_mfma_f32_16x16x32_bf16 v[60:63], a[172:175], a[140:143], v[60:63]
    v_mfma_f32_16x16x32_bf16 v[52:55], a[172:175], a[136:139], v[52:55]
    ds_read_b64_tr_b16 a[164:165], v2 offset:46336
    ds_read_b64_tr_b16 a[166:167], v2 offset:48640
    v_mfma_f32_16x16x32_bf16 v[52:55], a[168:171], a[128:131], v[52:55]
    s_waitcnt lgkmcnt(8)
    s_add_u32 s90, s90, 0x1000
    buffer_store_dwordx4 v[148:151], v1, s[52:55], s90 offen sc1
    v_mfma_f32_16x16x32_bf16 v[64:67], a[144:147], a[128:131], v[64:67]
    v_mfma_f32_16x16x32_bf16 v[64:67], a[148:151], a[136:139], v[64:67]
    buffer_store_dwordx4 v[148:151], v1, s[52:55], s90 offen offset:1024 sc1
    v_mfma_f32_16x16x32_bf16 v[72:75], a[148:151], a[140:143], v[72:75]
    v_mfma_f32_16x16x32_bf16 v[72:75], a[144:147], a[132:135], v[72:75]
    s_waitcnt lgkmcnt(4)
    v_mfma_f32_16x16x32_bf16 v[76:79], a[152:155], a[132:135], v[76:79]
    v_mfma_f32_16x16x32_bf16 v[76:79], a[156:159], a[140:143], v[76:79]
    buffer_store_dwordx4 v[148:151], v1, s[52:55], s90 offen offset:2048 sc1
    v_mfma_f32_16x16x32_bf16 v[68:71], a[156:159], a[136:139], v[68:71]
    ds_read_b128 v[188:191], v12
    v_mfma_f32_16x16x32_bf16 v[68:71], a[152:155], a[128:131], v[68:71]
    s_waitcnt lgkmcnt(1)
    buffer_store_dwordx4 v[148:151], v1, s[52:55], s90 offen offset:3072 sc1
    v_mfma_f32_16x16x32_bf16 v[80:83], a[160:163], a[128:131], v[80:83]
    ds_read_b128 v[192:195], v12 offset:64
    v_mfma_f32_16x16x32_bf16 v[80:83], a[164:167], a[136:139], v[80:83]
    v_mfma_f32_16x16x32_bf16 v[88:91], a[164:167], a[140:143], v[88:91]
    v_mfma_f32_16x16x32_bf16 v[88:91], a[160:163], a[132:135], v[88:91]
    s_add_u32 s90, s90, 0x1000
    buffer_store_dwordx4 v[148:151], v1, s[52:55], s90 offen sc1
    s_waitcnt lgkmcnt(1)
    v_mfma_f32_16x16x32_bf16 v[200:203], v[188:191], a[0:3], 0
    ds_read_b128 v[196:199], v12 offset:128
    v_mfma_f32_16x16x32_bf16 v[204:207], v[188:191], a[4:7], 0
    s_waitcnt lgkmcnt(1)
    v_mfma_f32_16x16x32_bf16 v[200:203], v[192:195], a[8:11], v[200:203]
    ds_read_b128 v[188:191], v12 offset:192
    v_mfma_f32_16x16x32_bf16 v[204:207], v[192:195], a[12:15], v[204:207]
    s_waitcnt lgkmcnt(1)
    buffer_load_dword v14, v13, s[48:51], 0 offen offset:128 sc1
    v_mfma_f32_16x16x32_bf16 v[200:203], v[196:199], a[16:19], v[200:203]
    ds_read_b128 v[192:195], v12 offset:256
    v_mul_f32 v242, s67, v16
    v_mul_f32 v243, s67, v17
    v_exp_f32_e64 v242, v242 clamp
    v_max_f32 v16, s65, v16
    v_mul_f32 v244, s67, v18
    v_exp_f32_e64 v243, v243 clamp
    v_max_f32 v17, s65, v17
    v_mul_f32 v245, s67, v19
    v_mfma_f32_16x16x32_bf16 v[204:207], v[196:199], a[20:23], v[204:207]
    s_waitcnt lgkmcnt(1)
    v_exp_f32_e64 v244, v244 clamp
    v_max_f32 v18, s65, v18
    v_add_f32 v16, v16, v242
    v_mul_f32 v242, s67, v20
    v_exp_f32_e64 v245, v245 clamp
    v_max_f32 v19, s65, v19
    v_add_f32 v17, v17, v243
    v_mul_f32 v243, s67, v21
    v_exp_f32_e64 v242, v242 clamp
    v_max_f32 v20, s65, v20
    v_add_f32 v18, v18, v244
    v_mul_f32 v244, s67, v22
    v_exp_f32_e64 v243, v243 clamp
    v_max_f32 v21, s65, v21
    v_add_f32 v19, v19, v245
    v_mul_f32 v245, s67, v23
    v_mfma_f32_16x16x32_bf16 v[200:203], v[188:191], a[24:27], v[200:203]
    ds_read_b128 v[196:199], v12 offset:320
    v_max_f32 v22, s65, v22
    v_exp_f32_e64 v244, v244 clamp
    v_add_f32 v20, v20, v242
    v_mul_f32 v242, s67, v24
    v_exp_f32_e64 v245, v245 clamp
    v_max_f32 v23, s65, v23
    v_add_f32 v21, v21, v243
    v_mul_f32 v243, s67, v25
    v_mfma_f32_16x16x32_bf16 v[204:207], v[188:191], a[28:31], v[204:207]
    s_waitcnt lgkmcnt(1)
    v_exp_f32_e64 v242, v242 clamp
    v_max_f32 v24, s65, v24
    v_add_f32 v22, v22, v244
    v_mul_f32 v244, s67, v26
    v_exp_f32_e64 v243, v243 clamp
    v_max_f32 v25, s65, v25
    v_add_f32 v23, v23, v245
    v_mul_f32 v245, s67, v27
    v_exp_f32_e64 v244, v244 clamp
    v_max_f32 v26, s65, v26
    v_add_f32 v24, v24, v242
    v_mul_f32 v242, s67, v28
    v_exp_f32_e64 v245, v245 clamp
    v_max_f32 v27, s65, v27
    v_add_f32 v25, v25, v243
    v_mul_f32 v243, s67, v29
    v_mfma_f32_16x16x32_bf16 v[200:203], v[192:195], a[32:35], v[200:203]
    ds_read_b128 v[188:191], v12 offset:384
    v_max_f32 v28, s65, v28
    v_exp_f32_e64 v242, v242 clamp
    v_add_f32 v26, v26, v244
    v_mul_f32 v244, s67, v30
    v_exp_f32_e64 v243, v243 clamp
    v_max_f32 v29, s65, v29
    v_add_f32 v27, v27, v245
    v_mul_f32 v245, s67, v31
    v_mfma_f32_16x16x32_bf16 v[204:207], v[192:195], a[36:39], v[204:207]
    s_waitcnt lgkmcnt(1)
    v_exp_f32_e64 v244, v244 clamp
    v_max_f32 v30, s65, v30
    v_add_f32 v28, v28, v242
    v_mul_f32 v242, s67, v32
    v_exp_f32_e64 v245, v245 clamp
    v_max_f32 v31, s65, v31
    v_add_f32 v29, v29, v243
    v_mul_f32 v243, s67, v33
    v_cvt_pk_bf16_f32 v16, v16, v17
    v_cvt_pk_bf16_f32 v17, v18, v19
    v_cvt_pk_bf16_f32 v18, v20, v21
    v_cvt_pk_bf16_f32 v19, v22, v23
    v_exp_f32_e64 v242, v242 clamp
    v_max_f32 v32, s65, v32
    v_add_f32 v30, v30, v244
    v_mul_f32 v244, s67, v34
    v_mfma_f32_16x16x32_bf16 v[200:203], v[196:199], a[40:43], v[200:203]
    ds_read_b128 v[192:195], v12 offset:448
    v_max_f32 v33, s65, v33
    v_exp_f32_e64 v243, v243 clamp
    v_add_f32 v31, v31, v245
    v_mul_f32 v245, s67, v35
    v_exp_f32_e64 v244, v244 clamp
    v_max_f32 v34, s65, v34
    v_add_f32 v32, v32, v242
    v_mul_f32 v242, s67, v36
    v_mfma_f32_16x16x32_bf16 v[204:207], v[196:199], a[44:47], v[204:207]
    s_waitcnt lgkmcnt(1)
    v_exp_f32_e64 v245, v245 clamp
    v_max_f32 v35, s65, v35
    v_add_f32 v33, v33, v243
    v_mul_f32 v243, s67, v37
    v_exp_f32_e64 v242, v242 clamp
    v_max_f32 v36, s65, v36
    v_add_f32 v34, v34, v244
    v_mul_f32 v244, s67, v38
    v_exp_f32_e64 v243, v243 clamp
    v_max_f32 v37, s65, v37
    v_add_f32 v35, v35, v245
    v_mul_f32 v245, s67, v39
    v_exp_f32_e64 v244, v244 clamp
    v_max_f32 v38, s65, v38
    v_add_f32 v36, v36, v242
    v_mul_f32 v242, s67, v40
    v_mfma_f32_16x16x32_bf16 v[200:203], v[188:191], a[48:51], v[200:203]
    ds_read_b128 v[196:199], v12 offset:512
    v_max_f32 v39, s65, v39
    v_exp_f32_e64 v245, v245 clamp
    v_add_f32 v37, v37, v243
    v_mul_f32 v243, s67, v41
    v_cvt_pk_bf16_f32 v24, v24, v25
    v_cvt_pk_bf16_f32 v25, v26, v27
    v_cvt_pk_bf16_f32 v26, v28, v29
    v_cvt_pk_bf16_f32 v27, v30, v31
    v_exp_f32_e64 v242, v242 clamp
    v_mfma_f32_16x16x32_bf16 v[204:207], v[188:191], a[52:55], v[204:207]
    s_waitcnt lgkmcnt(1)
    v_max_f32 v40, s65, v40
    v_add_f32 v38, v38, v244
    v_mul_f32 v244, s67, v42
    v_exp_f32_e64 v243, v243 clamp
    v_max_f32 v41, s65, v41
    v_add_f32 v39, v39, v245
    v_mul_f32 v245, s67, v43
    v_exp_f32_e64 v244, v244 clamp
    v_max_f32 v42, s65, v42
    v_add_f32 v40, v40, v242
    v_mul_f32 v242, s67, v44
    v_exp_f32_e64 v245, v245 clamp
    v_max_f32 v43, s65, v43
    v_add_f32 v41, v41, v243
    v_mul_f32 v243, s67, v45
    v_exp_f32_e64 v242, v242 clamp
    v_mfma_f32_16x16x32_bf16 v[200:203], v[192:195], a[56:59], v[200:203]
    ds_read_b128 v[188:191], v12 offset:576
    v_max_f32 v44, s65, v44
    v_add_f32 v42, v42, v244
    v_mul_f32 v244, s67, v46
    v_exp_f32_e64 v243, v243 clamp
    v_max_f32 v45, s65, v45
    v_add_f32 v43, v43, v245
    v_mul_f32 v245, s67, v47
    v_exp_f32_e64 v244, v244 clamp
    v_mfma_f32_16x16x32_bf16 v[204:207], v[192:195], a[60:63], v[204:207]
    s_waitcnt lgkmcnt(1)
    s_waitcnt vmcnt(0)
    v_cmp_ne_u32 vcc, v14, v241
    s_cbranch_vccz L_ok9
    s_mov_b32 s75, 131072
L_sp9:
    s_sleep 2
    buffer_load_dword v14, v13, s[48:51], 0 offen offset:128 sc1
    s_waitcnt vmcnt(0)
    v_cmp_ne_u32 vcc, v14, v241
    s_cbranch_vccz L_ok9
    s_sub_u32 s75, s75, 1
    s_cmp_lg_u32 s75, 0
    s_cbranch_scc1 L_sp9
L_ok9:
    s_barrier
    s_add_u32 m0, s62, 0x1b000
    s_add_u32 s66, s63, 0
    buffer_load_dwordx4 v1, s[48:51], s66 offen sc1 lds
    s_add_u32 m0, s62, 0x1c000
    s_add_u32 s66, s63, 0x1000
    buffer_load_dwordx4 v1, s[48:51], s66 offen sc1 lds
    s_add_u32 m0, s62, 0x1d000
    s_add_u32 s66, s63, 0x2000
    buffer_load_dwordx4 v1, s[48:51], s66 offen sc1 lds
    v_mfma_f32_16x16x32_bf16 v[200:203], v[196:199], a[64:67], v[200:203]
    ds_read_b128 v[192:195], v12 offset:640
    v_max_f32 v46, s65, v46
    v_add_f32 v44, v44, v242
    v_mul_f32 v242, s67, v48
    v_exp_f32_e64 v245, v245 clamp
    v_max_f32 v47, s65, v47
    v_add_f32 v45, v45, v243
    v_mul_f32 v243, s67, v49
    v_cvt_pk_bf16_f32 v32, v32, v33
    v_cvt_pk_bf16_f32 v33, v34, v35
    v_mfma_f32_16x16x32_bf16 v[204:207], v[196:199], a[68:71], v[204:207]
    s_waitcnt lgkmcnt(1)
    s_add_u32 m0, s62, 0x1e000
    s_add_u32 s66, s63, 0x3000
    buffer_load_dwordx4 v1, s[48:51], s66 offen sc1 lds
    s_add_u32 m0, s62, 0x1f000
    s_add_u32 s66, s63, 0x4000
    buffer_load_dwordx4 v1, s[48:51], s66 offen sc1 lds
    v_mfma_f32_16x16x32_bf16 v[200:203], v[188:191], a[72:75], v[200:203]
    ds_read_b128 v[196:199], v12 offset:704
    v_cvt_pk_bf16_f32 v34, v36, v37
    v_cvt_pk_bf16_f32 v35, v38, v39
    v_exp_f32_e64 v242, v242 clamp
    v_max_f32 v48, s65, v48
    v_add_f32 v46, v46, v244
    v_mul_f32 v244, s67, v50
    v_exp_f32_e64 v243, v243 clamp
    v_max_f32 v49, s65, v49
    v_mfma_f32_16x16x32_bf16 v[204:207], v[188:191], a[76:79], v[204:207]
    s_waitcnt lgkmcnt(1)
    v_add_f32 v47, v47, v245
    v_mul_f32 v245, s67, v51
    v_exp_f32_e64 v244, v244 clamp
    v_max_f32 v50, s65, v50
    v_add_f32 v48, v48, v242
    v_mul_f32 v242, s67, v52
    v_exp_f32_e64 v245, v245 clamp
    v_max_f32 v51, s65, v51
    v_add_f32 v49, v49, v243
    v_mul_f32 v243, s67, v53
    v_exp_f32_e64 v242, v242 clamp
    v_max_f32 v52, s65, v52
    v_add_f32 v50, v50, v244
    v_mul_f32 v244, s67, v54
    v_exp_f32_e64 v243, v243 clamp
    v_max_f32 v53, s65, v53
    v_mfma_f32_16x16x32_bf16 v[200:203], v[192:195], a[80:83], v[200:203]
    ds_read_b128 v[188:191], v12 offset:768
    v_add_f32 v51, v51, v245
    v_mul_f32 v245, s67, v55
    v_exp_f32_e64 v244, v244 clamp
    v_max_f32 v54, s65, v54
    v_add_f32 v52, v52, v242
    v_mul_f32 v242, s67, v56
    v_exp_f32_e64 v245, v245 clamp
    v_max_f32 v55, s65, v55
    v_mfma_f32_16x16x32_bf16 v[204:207], v[192:195], a[84:87], v[204:207]
    s_waitcnt lgkmcnt(1)
    v_add_f32 v53, v53, v243
    v_mul_f32 v243, s67, v57
    v_cvt_pk_bf16_f32 v40, v40, v41
    v_cvt_pk_bf16_f32 v41, v42, v43
    v_cvt_pk_bf16_f32 v42, v44, v45
    v_cvt_pk_bf16_f32 v43, v46, v47
    v_exp_f32_e64 v242, v242 clamp
    v_max_f32 v56, s65, v56
    v_add_f32 v54, v54, v244
    v_mul_f32 v244, s67, v58
    v_exp_f32_e64 v243, v243 clamp
    v_max_f32 v57, s65, v57
    v_add_f32 v55, v55, v245
    v_mul_f32 v245, s67, v59
    v_exp_f32_e64 v244, v244 clamp
    v_max_f32 v58, s65, v58
    v_add_f32 v56, v56, v242
    v_mfma_f32_16x16x32_bf16 v[200:203], v[196:199], a[88:91], v[200:203]
    ds_read_b128 v[192:195], v12 offset:832
    v_mul_f32 v242, s67, v60
    v_exp_f32_e64 v245, v245 clamp
    v_max_f32 v59, s65, v59
    v_add_f32 v57, v57, v243
    v_mul_f32 v243, s67, v61
    v_exp_f32_e64 v242, v242 clamp
    v_max_f32 v60, s65, v60
    v_add_f32 v58, v58, v244
    v_mfma_f32_16x16x32_bf16 v[204:207], v[196:199], a[92:95], v[204:207]
    s_waitcnt lgkmcnt(1)
    v_mul_f32 v244, s67, v62
    v_max_f32 v61, s65, v61
    v_exp_f32_e64 v243, v243 clamp
    v_add_f32 v59, v59, v245
    v_mul_f32 v245, s67, v63
    v_exp_f32_e64 v244, v244 clamp
    v_max_f32 v62, s65, v62
    v_add_f32 v60, v60, v242
    v_mul_f32 v242, s67, v64
    v_exp_f32_e64 v245, v245 clamp
    v_max_f32 v63, s65, v63
    v_add_f32 v61, v61, v243
    v_mul_f32 v243, s67, v65
    v_cvt_pk_bf16_f32 v48, v48, v49
    v_cvt_pk_bf16_f32 v49, v50, v51
    v_cvt_pk_bf16_f32 v50, v52, v53
    v_cvt_pk_bf16_f32 v51, v54, v55
    v_mfma_f32_16x16x32_bf16 v[200:203], v[188:191], a[96:99], v[200:203]
    ds_read_b128 v[196:199], v12 offset:896
    v_max_f32 v64, s65, v64
    v_exp_f32_e64 v242, v242 clamp
    v_add_f32 v62, v62, v244
    v_mul_f32 v244, s67, v66
    v_exp_f32_e64 v243, v243 clamp
    v_max_f32 v65, s65, v65
    v_add_f32 v63, v63, v245
    v_mul_f32 v245, s67, v67
    v_mfma_f32_16x16x32_bf16 v[204:207], v[188:191], a[100:103], v[204:207]
    s_waitcnt lgkmcnt(1)
    v_exp_f32_e64 v244, v244 clamp
    v_max_f32 v66, s65, v66
    v_add_f32 v64, v64, v242
    v_mul_f32 v242, s67, v68
    v_exp_f32_e64 v245, v245 clamp
    v_max_f32 v67, s65, v67
    v_add_f32 v65, v65, v243
    v_mul_f32 v243, s67, v69
    v_exp_f32_e64 v242, v242 clamp
    v_max_f32 v68, s65, v68
    v_add_f32 v66, v66, v244
    v_mul_f32 v244, s67, v70
    v_exp_f32_e64 v243, v243 clamp
    v_max_f32 v69, s65, v69
    v_add_f32 v67, v67, v245
    v_mul_f32 v245, s67, v71
    v_mfma_f32_16x16x32_bf16 v[200:203], v[192:195], a[104:107], v[200:203]
    ds_read_b128 v[188:191], v12 offset:960
    v_max_f32 v70, s65, v70
    v_exp_f32_e64 v244, v244 clamp
    v_add_f32 v68, v68, v242
    v_mul_f32 v242, s67, v72
    v_exp_f32_e64 v245, v245 clamp
    v_max_f32 v71, s65, v71
    v_add_f32 v69, v69, v243
    v_mul_f32 v243, s67, v73
    v_mfma_f32_16x16x32_bf16 v[204:207], v[192:195], a[108:111], v[204:207]
    s_waitcnt lgkmcnt(1)
    v_cvt_pk_bf16_f32 v56, v56, v57
    v_cvt_pk_bf16_f32 v57, v58, v59
    v_cvt_pk_bf16_f32 v58, v60, v61
    v_cvt_pk_bf16_f32 v59, v62, v63
    v_exp_f32_e64 v242, v242 clamp
    v_max_f32 v72, s65, v72
    v_add_f32 v70, v70, v244
    v_mul_f32 v244, s67, v74
    v_exp_f32_e64 v243, v243 clamp
    v_max_f32 v73, s65, v73
    v_add_f32 v71, v71, v245
    v_mul_f32 v245, s67, v75
    v_exp_f32_e64 v244, v244 clamp
    v_max_f32 v74, s65, v74
    v_add_f32 v72, v72, v242
    v_mul_f32 v242, s67, v76
    v_mfma_f32_16x16x32_bf16 v[200:203], v[196:199], a[112:115], v[200:203]
    ds_read_b128 v[192:195], v12 offset:1024
    v_max_f32 v75, s65, v75
    v_exp_f32_e64 v245, v245 clamp
    v_add_f32 v73, v73, v243
    v_mul_f32 v243, s67, v77
    v_exp_f32_e64 v242, v242 clamp
    v_max_f32 v76, s65, v76
    v_add_f32 v74, v74, v244
    v_mul_f32 v244, s67, v78
    v_mfma_f32_16x16x32_bf16 v[204:207], v[196:199], a[116:119], v[204:207]
    s_waitcnt lgkmcnt(1)
    v_exp_f32_e64 v243, v243 clamp
    v_max_f32 v77, s65, v77
    v_add_f32 v75, v75, v245
    v_mul_f32 v245, s67, v79
    v_exp_f32_e64 v244, v244 clamp
    v_max_f32 v78, s65, v78
    v_add_f32 v76, v76, v242
    v_mul_f32 v242, s67, v80
    v_exp_f32_e64 v245, v245 clamp
    v_max_f32 v79, s65, v79
    v_add_f32 v77, v77, v243
    v_mul_f32 v243, s67, v81
    v_cvt_pk_bf16_f32 v64, v64, v65
    v_cvt_pk_bf16_f32 v65, v66, v67
    v_cvt_pk_bf16_f32 v66, v68, v69
    v_cvt_pk_bf16_f32 v67, v70, v71
    v_exp_f32_e64 v242, v242 clamp
    v_mfma_f32_16x16x32_bf16 v[200:203], v[188:191], a[120:123], v[200:203]
    ds_read_b128 v[196:199], v12 offset:1088
    v_max_f32 v80, s65, v80
    v_add_f32 v78, v78, v244
    v_mul_f32 v244, s67, v82
    v_exp_f32_e64 v243, v243 clamp
    v_max_f32 v81, s65, v81
    v_add_f32 v79, v79, v245
    v_mul_f32 v245, s67, v83
    v_exp_f32_e64 v244, v244 clamp
    v_mfma_f32_16x16x32_bf16 v[204:207], v[188:191], a[124:127], v[204:207]
    s_waitcnt lgkmcnt(1)
    s_waitcnt vmcnt(0)
    s_barrier
    ds_read2st64_b64 a[176:179], v252 offset0:3 offset1:7
    ds_read2st64_b64 a[180:183], v252 offset0:11 offset1:15
    ds_read2st64_b64 a[184:187], v252 offset0:19 offset1:0
    ds_read2st64_b64 a[188:191], v252 offset0:34 offset1:23
    ds_read2st64_b64 a[192:195], v252 offset0:27 offset1:31
    ds_read2st64_b64 a[196:199], v252 offset0:35 offset1:0
    ds_read2st64_b64 a[200:203], v252 offset0:1 offset1:4
    ds_read2st64_b64 a[204:207], v252 offset0:2 offset1:5
    v_mfma_f32_16x16x32_bf16 v[200:203], v[192:195], a[128:131], v[200:203]
    v_max_f32 v82, s65, v82
    v_add_f32 v80, v80, v242
    v_mul_f32 v242, s67, v88
    v_exp_f32_e64 v245, v245 clamp
    v_max_f32 v83, s65, v83
    v_add_f32 v81, v81, v243
    v_mul_f32 v243, s67, v89
    v_exp_f32_e64 v242, v242 clamp
    v_max_f32 v88, s65, v88
    v_add_f32 v82, v82, v244
    v_mul_f32 v244, s67, v90
    v_exp_f32_e64 v243, v243 clamp
    v_max_f32 v89, s65, v89
    v_add_f32 v83, v83, v245
    v_mul_f32 v245, s67, v91
    v_exp_f32_e64 v244, v244 clamp
    v_mfma_f32_16x16x32_bf16 v[204:207], v[192:195], a[132:135], v[204:207]
    s_waitcnt lgkmcnt(8)
    ds_read2st64_b64 a[208:211], v252 offset0:8 offset1:0
    ds_read2st64_b64 a[212:215], v252 offset0:0 offset1:6
    ds_read2st64_b64 a[216:219], v252 offset0:9 offset1:12
    ds_read2st64_b64 a[220:223], v252 offset0:10 offset1:13
    ds_read2st64_b64 a[224:227], v252 offset0:16 offset1:0
    ds_read2st64_b64 a[228:231], v252 offset0:0 offset1:14
    ds_read2st64_b64 a[232:235], v252 offset0:17 offset1:20
    ds_read2st64_b64 a[236:239], v252 offset0:18 offset1:21
    v_mfma_f32_16x16x32_bf16 v[200:203], v[196:199], a[136:139], v[200:203]
    v_max_f32 v90, s65, v90
    v_add_f32 v88, v88, v242
    v_exp_f32_e64 v245, v245 clamp
    v_max_f32 v91, s65, v91
    v_add_f32 v89, v89, v243
    v_add_f32 v90, v90, v244
    v_add_f32 v91, v91, v245
    v_cvt_pk_bf16_f32 v72, v72, v73
    v_cvt_pk_bf16_f32 v73, v74, v75
    v_cvt_pk_bf16_f32 v74, v76, v77
    v_cvt_pk_bf16_f32 v75, v78, v79
    v_cvt_pk_bf16_f32 v80, v80, v81
    v_cvt_pk_bf16_f32 v81, v82, v83
    v_mov_b32 v82, 0
    v_mov_b32 v83, 0
    v_cvt_pk_bf16_f32 v88, v88, v89
    v_cvt_pk_bf16_f32 v89, v90, v91
    v_mov_b32 v90, 0
    v_mov_b32 v91, 0
    v_mfma_f32_16x16x32_bf16 v[204:207], v[196:199], a[140:143], v[204:207]
    ds_read2st64_b64 a[240:243], v252 offset0:24 offset1:0
    ds_read2st64_b64 a[244:247], v252 offset0:0 offset1:22
    ds_read2st64_b64 a[248:251], v252 offset0:25 offset1:28
    ds_read2st64_b64 a[252:255], v252 offset0:26 offset1:29
    ds_read2st64_b64 v[176:179], v252 offset0:32 offset1:0
    ds_read2st64_b64 v[180:183], v252 offset0:0 offset1:30
    ds_read2st64_b64 v[184:187], v252 offset0:33 offset1:0
    s_waitcnt lgkmcnt(15)
    v_mfma_f32_16x16x32_bf16 v[208:211], a[176:179], v[16:19], 0
    v_mfma_f32_16x16x32_bf16 v[216:219], a[176:179], v[24:27], 0
    v_mfma_f32_16x16x32_bf16 v[208:211], a[180:183], v[32:35], v[208:211]
    v_min_f32 v201, 0x42700000, v200
    v_mul_f32 v201, s67, v201
    v_mfma_f32_16x16x32_bf16 v[216:219], a[180:183], v[40:43], v[216:219]
    v_exp_f32 v202, v201
    v_mfma_f32_16x16x32_bf16 v[208:211], a[184:187], v[48:51], v[208:211]
    v_min_f32 v205, 0x42700000, v204
    v_mul_f32 v205, s67, v205
    v_mfma_f32_16x16x32_bf16 v[216:219], a[184:187], v[56:59], v[216:219]
    v_exp_f32 v206, v205
    s_lshl_b32 s62, s56, 2
    v_mfma_f32_16x16x32_bf16 v[212:215], a[188:191], v[48:51], 0
    s_add_u32 s62, s62, s57
    s_lshl_b32 s62, s62, 2
    v_mfma_f32_16x16x32_bf16 v[220:223], a[188:191], v[56:59], 0
    s_add_u32 s62, s62, s59
    v_cndmask_b32 v203, v206, v202, s[4:5]
    v_add_f32 v203, 1.0, v203
    v_mfma_f32_16x16x32_bf16 v[212:215], a[192:195], v[64:67], v[212:215]
    v_rcp_f32 v203, v203
    v_mfma_f32_16x16x32_bf16 v[220:223], a[192:195], v[72:75], v[220:223]
    s_mul_i32 s73, s62, 0x2800
    s_add_u32 s73, s73, 0x2000000
    v_mfma_f32_16x16x32_bf16 v[212:215], a[196:199], v[80:83], v[212:215]
    s_lshl_b32 s62, s62, 7
    s_add_u32 s63, s62, 0x3014000
    v_lshrrev_b32 v240, 5, v0
    v_mfma_f32_16x16x32_bf16 v[220:223], a[196:199], v[88:91], v[220:223]
    v_lshl_add_u32 v240, v240, 28, s63
    v_lshl_add_u32 v240, v0, 2, v240
    v_mfma_f32_16x16x32_bf16 v[96:99], a[200:203], v[16:19], 0
    v_mov_b32 v14, s79
    v_add_u32 v250, 0xfff2c000, v240
    v_mfma_f32_16x16x32_bf16 v[104:107], a[200:203], v[24:27], 0
    buffer_store_dword v203, v250, s[48:51], 0 offen sc1
    v_mfma_f32_16x16x32_bf16 v[100:103], a[204:207], v[16:19], 0
    v_add_f32 v208, s65, v208
    v_add_f32 v209, s65, v209
    v_mfma_f32_16x16x32_bf16 v[108:111], a[204:207], v[24:27], 0
    v_add_f32 v210, s65, v210
    v_add_f32 v211, s65, v211
    v_add_f32 v212, s65, v212
    s_waitcnt lgkmcnt(14)
    v_mfma_f32_16x16x32_bf16 v[100:103], a[208:211], v[32:35], v[100:103]
    v_add_f32 v213, s65, v213
    v_add_f32 v214, s65, v214
    v_add_f32 v215, s65, v215
    v_mfma_f32_16x16x32_bf16 v[108:111], a[208:211], v[40:43], v[108:111]
    v_add_f32 v216, s65, v216
    v_add_f32 v217, s65, v217
    v_add_f32 v218, s65, v218
    s_waitcnt lgkmcnt(13)
    v_mfma_f32_16x16x32_bf16 v[112:115], a[212:215], v[16:19], 0
    v_add_f32 v219, s65, v219
    v_add_f32 v220, s65, v220
    v_add_f32 v221, s65, v221
    v_mfma_f32_16x16x32_bf16 v[120:123], a[212:215], v[24:27], 0
    v_add_f32 v222, s65, v222
    v_add_f32 v223, s65, v223
    s_waitcnt lgkmcnt(12)
    v_mfma_f32_16x16x32_bf16 v[112:115], a[216:219], v[32:35], v[112:115]
    v_rcp_f32 v208, v208
    v_rcp_f32 v209, v209
    v_mfma_f32_16x16x32_bf16 v[120:123], a[216:219], v[40:43], v[120:123]
    v_rcp_f32 v210, v210
    s_waitcnt lgkmcnt(11)
    v_mfma_f32_16x16x32_bf16 v[116:119], a[220:223], v[32:35], 0
    v_rcp_f32 v211, v211
    v_rcp_f32 v212, v212
    v_mfma_f32_16x16x32_bf16 v[124:127], a[220:223], v[40:43], 0
    v_rcp_f32 v213, v213
    s_waitcnt lgkmcnt(10)
    v_mfma_f32_16x16x32_bf16 v[116:119], a[224:227], v[48:51], v[116:119]
    v_rcp_f32 v214, v214
    v_rcp_f32 v215, v215
    v_mfma_f32_16x16x32_bf16 v[124:127], a[224:227], v[56:59], v[124:127]
    v_rcp_f32 v216, v216
    s_waitcnt lgkmcnt(9)
    v_mfma_f32_16x16x32_bf16 v[128:131], a[228:231], v[32:35], 0
    v_rcp_f32 v217, v217
    v_mfma_f32_16x16x32_bf16 v[136:139], a[228:231], v[40:43], 0
    v_rcp_f32 v218, v218
    v_rcp_f32 v219, v219
    s_waitcnt lgkmcnt(8)
    v_mfma_f32_16x16x32_bf16 v[128:131], a[232:235], v[48:51], v[128:131]
    v_rcp_f32 v220, v220
    v_mfma_f32_16x16x32_bf16 v[136:139], a[232:235], v[56:59], v[136:139]
    v_rcp_f32 v221, v221
    v_rcp_f32 v222, v222
    s_waitcnt lgkmcnt(7)
    v_mfma_f32_16x16x32_bf16 v[132:135], a[236:239], v[48:51], 0
    v_rcp_f32 v223, v223
    v_mul_f32 v208, v202, v208
    v_mfma_f32_16x16x32_bf16 v[140:143], a[236:239], v[56:59], 0
    v_mul_f32 v209, v202, v209
    v_mul_f32 v210, v202, v210
    v_mul_f32 v211, v202, v211
    s_waitcnt lgkmcnt(6)
    v_mfma_f32_16x16x32_bf16 v[132:135], a[240:243], v[64:67], v[132:135]
    v_mul_f32 v212, v202, v212
    v_mul_f32 v213, v202, v213
    v_mul_f32 v214, v202, v214
    v_mfma_f32_16x16x32_bf16 v[140:143], a[240:243], v[72:75], v[140:143]
    v_mul_f32 v215, v202, v215
    v_mul_f32 v216, v206, v216
    v_mul_f32 v217, v206, v217
    s_waitcnt lgkmcnt(5)
    v_mfma_f32_16x16x32_bf16 v[144:147], a[244:247], v[48:51], 0
    v_mul_f32 v218, v206, v218
    v_mul_f32 v219, v206, v219
    v_mul_f32 v220, v206, v220
    v_mfma_f32_16x16x32_bf16 v[152:155], a[244:247], v[56:59], 0
    v_mul_f32 v221, v206, v221
    v_mul_f32 v222, v206, v222
    v_mul_f32 v223, v206, v223
    s_waitcnt lgkmcnt(4)
    v_mfma_f32_16x16x32_bf16 v[144:147], a[248:251], v[64:67], v[144:147]
    s_add_u32 s63, s73, 0
    v_mul_f32 v96, v208, v96
    v_mul_f32 v97, v208, v97
    v_mul_f32 v98, v208, v98
    v_mfma_f32_16x16x32_bf16 v[152:155], a[248:251], v[72:75], v[152:155]
    v_mul_f32 v99, v208, v99
    v_cndmask_b32 v242, v209, v208, s[4:5]
    v_mul_f32 v100, v242, v100
    v_cndmask_b32 v243, v209, v208, s[4:5]
    s_waitcnt lgkmcnt(3)
    v_mfma_f32_16x16x32_bf16 v[148:151], a[252:255], v[64:67], 0
    v_mul_f32 v101, v243, v101
    v_mul_f32 v102, v209, v102
    v_mul_f32 v103, v209, v103
    v_cvt_pk_bf16_f32 v96, v96, v97
    v_mfma_f32_16x16x32_bf16 v[156:159], a[252:255], v[72:75], 0
    v_cvt_pk_bf16_f32 v97, v98, v99
    v_cvt_pk_bf16_f32 v98, v100, v101
    v_cvt_pk_bf16_f32 v99, v102, v103
    s_waitcnt lgkmcnt(2)
    v_mfma_f32_16x16x32_bf16 v[148:151], v[176:179], v[80:83], v[148:151]
    buffer_store_dwordx4 v[96:99], v1, s[48:51], s63 offen sc1
    v_mfma_f32_16x16x32_bf16 v[156:159], v[176:179], v[88:91], v[156:159]
    v_mul_f32 v104, v216, v104
    v_mul_f32 v105, v216, v105
    v_mul_f32 v106, v216, v106
    s_waitcnt lgkmcnt(1)
    v_mfma_f32_16x16x32_bf16 v[160:163], v[180:183], v[64:67], 0
    v_mul_f32 v107, v216, v107
    v_cndmask_b32 v244, v217, v216, s[4:5]
    v_mul_f32 v108, v244, v108
    v_cndmask_b32 v245, v217, v216, s[4:5]
    v_mfma_f32_16x16x32_bf16 v[168:171], v[180:183], v[72:75], 0
    v_mul_f32 v109, v245, v109
    v_mul_f32 v110, v217, v110
    v_mul_f32 v111, v217, v111
    v_cvt_pk_bf16_f32 v104, v104, v105
    s_waitcnt lgkmcnt(0)
    v_mfma_f32_16x16x32_bf16 v[160:163], v[184:187], v[80:83], v[160:163]
    v_cvt_pk_bf16_f32 v105, v106, v107
    v_cvt_pk_bf16_f32 v106, v108, v109
    v_cvt_pk_bf16_f32 v107, v110, v111
    v_mfma_f32_16x16x32_bf16 v[168:171], v[184:187], v[88:91], v[168:171]
    buffer_store_dwordx4 v[104:107], v1, s[48:51], s63 offen offset:1024 sc1
    s_add_u32 s63, s73, 0x800
    v_cndmask_b32 v242, v210, v209, s[4:5]
    v_mul_f32 v112, v242, v112
    v_cndmask_b32 v243, v210, v209, s[4:5]
    v_mul_f32 v113, v243, v113
    v_cndmask_b32 v244, v210, v209, s[4:5]
    v_mul_f32 v114, v244, v114
    v_cndmask_b32 v245, v210, v209, s[4:5]
    v_mul_f32 v115, v245, v115
    v_cndmask_b32 v242, v211, v210, s[6:7]
    v_mul_f32 v116, v242, v116
    v_cndmask_b32 v243, v211, v210, s[6:7]
    v_mul_f32 v117, v243, v117
    v_cndmask_b32 v244, v211, v210, s[4:5]
    v_mul_f32 v118, v244, v118
    v_cndmask_b32 v245, v211, v210, s[4:5]
    v_mul_f32 v119, v245, v119
    v_cvt_pk_bf16_f32 v112, v112, v113
    v_cvt_pk_bf16_f32 v113, v114, v115
    v_cvt_pk_bf16_f32 v114, v116, v117
    v_cvt_pk_bf16_f32 v115, v118, v119
    buffer_store_dwordx4 v[112:115], v1, s[48:51], s63 offen sc1
    v_cndmask_b32 v242, v218, v217, s[4:5]
    v_mul_f32 v120, v242, v120
    v_cndmask_b32 v243, v218, v217, s[4:5]
    v_mul_f32 v121, v243, v121
    v_cndmask_b32 v244, v218, v217, s[4:5]
    v_mul_f32 v122, v244, v122
    v_cndmask_b32 v245, v218, v217, s[4:5]
    v_mul_f32 v123, v245, v123
    v_cndmask_b32 v242, v219, v218, s[6:7]
    v_mul_f32 v124, v242, v124
    v_cndmask_b32 v243, v219, v218, s[6:7]
    v_mul_f32 v125, v243, v125
    v_cndmask_b32 v244, v219, v218, s[4:5]
    v_mul_f32 v126, v244, v126
    v_cndmask_b32 v245, v219, v218, s[4:5]
    v_mul_f32 v127, v245, v127
    v_cvt_pk_bf16_f32 v120, v120, v121
    v_cvt_pk_bf16_f32 v121, v122, v123
L_pad_a6:
    s_cbranch_execz L_padret_a
    v_cvt_pk_bf16_f32 v122, v124, v125
    v_cvt_pk_bf16_f32 v123, v126, v127
    buffer_store_dwordx4 v[120:123], v1, s[48:51], s63 offen offset:1024 sc1
    s_add_u32 s63, s73, 0x1000
    v_cndmask_b32 v242, v212, v211, s[6:7]
    v_mul_f32 v128, v242, v128
    v_cndmask_b32 v243, v212, v211, s[6:7]
    v_mul_f32 v129, v243, v129
    v_cndmask_b32 v244, v212, v211, s[6:7]
    v_mul_f32 v130, v244, v130
    v_cndmask_b32 v245, v212, v211, s[6:7]
    v_mul_f32 v131, v245, v131
    v_cndmask_b32 v242, v213, v212, s[82:83]
    v_mul_f32 v132, v242, v132
    v_cndmask_b32 v243, v213, v212, s[82:83]
    v_mul_f32 v133, v243, v133
    v_cndmask_b32 v244, v213, v212, s[6:7]
    v_mul_f32 v134, v244, v134
    v_cndmask_b32 v245, v213, v212, s[6:7]
    v_mul_f32 v135, v245, v135
    v_cvt_pk_bf16_f32 v128, v128, v129
    v_cvt_pk_bf16_f32 v129, v130, v131
    v_cvt_pk_bf16_f32 v130, v132, v133
    v_cvt_pk_bf16_f32 v131, v134, v135
    buffer_store_dwordx4 v[128:131], v1, s[48:51], s63 offen sc1
    v_cndmask_b32 v242, v220, v219, s[6:7]
    v_mul_f32 v136, v242, v136
    v_cndmask_b32 v243, v220, v219, s[6:7]
    v_mul_f32 v137, v243, v137
    v_cndmask_b32 v244, v220, v219, s[6:7]
    v_mul_f32 v138, v244, v138
    v_cndmask_b32 v245, v220, v219, s[6:7]
    v_mul_f32 v139, v245, v139
    v_cndmask_b32 v242, v221, v220, s[82:83]
    v_mul_f32 v140, v242, v140
    v_cndmask_b32 v243, v221, v220, s[82:83]
    v_mul_f32 v141, v243, v141
    v_cndmask_b32 v244, v221, v220, s[6:7]
    v_mul_f32 v142, v244, v142
    v_cndmask_b32 v245, v221, v220, s[6:7]
    v_mul_f32 v143, v245, v143
    v_cvt_pk_bf16_f32 v136, v136, v137
    v_cvt_pk_bf16_f32 v137, v138, v139
    v_cvt_pk_bf16_f32 v138, v140, v141
    v_cvt_pk_bf16_f32 v139, v142, v143
    buffer_store_dwordx4 v[136:139], v1, s[48:51], s63 offen offset:1024 sc1
    s_add_u32 s63, s73, 0x1800
    v_cndmask_b32 v242, v214, v213, s[82:83]
    v_mul_f32 v144, v242, v144
    v_cndmask_b32 v243, v214, v213, s[82:83]
    v_mul_f32 v145, v243, v145
    v_cndmask_b32 v244, v214, v213, s[82:83]
    v_mul_f32 v146, v244, v146
    v_cndmask_b32 v245, v214, v213, s[82:83]
    v_mul_f32 v147, v245, v147
    v_mul_f32 v148, v214, v148
    v_mul_f32 v149, v214, v149
    v_cndmask_b32 v242, v215, v214, s[82:83]
    v_mul_f32 v150, v242, v150
    v_cndmask_b32 v243, v215, v214, s[82:83]
    v_mul_f32 v151, v243, v151
    v_cvt_pk_bf16_f32 v144, v144, v145
    v_cvt_pk_bf16_f32 v145, v146, v147
    v_cvt_pk_bf16_f32 v146, v148, v149
    v_cvt_pk_bf16_f32 v147, v150, v151
    buffer_store_dwordx4 v[144:147], v1, s[48:51], s63 offen sc1
    v_cndmask_b32 v244, v222, v221, s[82:83]
    v_mul_f32 v152, v244, v152
    v_cndmask_b32 v245, v222, v221, s[82:83]
    v_mul_f32 v153, v245, v153
    v_cndmask_b32 v242, v222, v221, s[82:83]
    v_mul_f32 v154, v242, v154
    v_cndmask_b32 v243, v222, v221, s[82:83]
    v_mul_f32 v155, v243, v155
    v_mul_f32 v156, v222, v156
    v_mul_f32 v157, v222, v157
    v_cndmask_b32 v244, v223, v222, s[82:83]
    v_mul_f32 v158, v244, v158
    v_cndmask_b32 v245, v223, v222, s[82:83]
    v_mul_f32 v159, v245, v159
    v_cvt_pk_bf16_f32 v152, v152, v153
    v_cvt_pk_bf16_f32 v153, v154, v155
    v_cvt_pk_bf16_f32 v154, v156, v157
    v_cvt_pk_bf16_f32 v155, v158, v159
    buffer_store_dwordx4 v[152:155], v1, s[48:51], s63 offen offset:1024 sc1
    s_add_u32 s63, s73, 0x2000
    v_mul_f32 v160, v215, v160
    v_mul_f32 v161, v215, v161
    v_mul_f32 v162, v215, v162
    v_mul_f32 v163, v215, v163
    v_cvt_pk_bf16_f32 v160, v160, v161
    v_cvt_pk_bf16_f32 v161, v162, v163
    v_mov_b32 v162, 0
    v_mov_b32 v163, 0
    buffer_store_dwordx4 v[160:163], v1, s[48:51], s63 offen sc1
    v_mul_f32 v168, v223, v168
    v_mul_f32 v169, v223, v169
    v_mul_f32 v170, v223, v170
    v_mul_f32 v171, v223, v171
    v_cvt_pk_bf16_f32 v168, v168, v169
    v_cvt_pk_bf16_f32 v169, v170, v171
    v_mov_b32 v170, 0
    v_mov_b32 v171, 0
    buffer_store_dwordx4 v[168:171], v1, s[48:51], s63 offen offset:1024 sc1
    s_waitcnt vmcnt(0)
    buffer_store_dword v14, v240, s[48:51], 0 offen sc1
    s_or_b32 s62, s56, s59
    s_cmp_lg_u32 s62, 0
    s_cbranch_scc1 L_nobump2
    v_min_u32 v250, 1, v0
    v_lshl_add_u32 v250, v250, 28, s74
    buffer_store_dword v15, v250, s[48:51], 0 offen sc1
L_nobump2:
    s_endpgm
L_last:
.section .rodata,"a"
.p2align 6
.amdhsa_kernel gated_mix__linear_attn_block__dense_activation_mish__prompt_kernel
  .amdhsa_next_free_vgpr 512
  .amdhsa_next_free_sgpr 102
  .amdhsa_accum_offset 256
  .amdhsa_group_segment_fixed_size 0
  .amdhsa_kernarg_size 88
  .amdhsa_user_sgpr_count 2
  .amdhsa_user_sgpr_kernarg_segment_ptr 1
  .amdhsa_system_sgpr_workgroup_id_x 1
.end_amdhsa_kernel
```
